```python
import torch

def _softmax(x, axis=-1):
    return torch.softmax(x, dim=axis)
def _gelu(x):
    return torch.nn.functional.gelu(x, approximate="tanh")
def _silu(x):
    return torch.nn.functional.silu(x)
def _sigmoid(x):
    return torch.sigmoid(x)
def _layernorm(x, axis=-1, eps=1e-5):
    m = x.mean(dim=axis, keepdim=True)
    v = x.var(dim=axis, keepdim=True, unbiased=False)
    return (x - m) / torch.sqrt(v + eps)
def _scatter_add(tgt, idx, src, axis=0):
    return tgt.clone().index_add_(axis, idx, src)
def _segment_sum(src, seg, n):
    out = torch.zeros((n,) + src.shape[1:], dtype=src.dtype)
    return out.index_add_(0, seg, src)
def _pad(x, pw):
    flat = tuple(v for pair in reversed(pw) for v in pair)
    return torch.nn.functional.pad(x, flat)

kernel_name = 'recurrent_scan__ssm_conv_h3__glu_gated_bilinear__prompt'

def setup_inputs():

    _w = (lambda a: (lambda t: t.to(torch.bfloat16) if t.is_floating_point() else t)(torch.as_tensor(a)))
    def _A_setup():
        B, S, D = 1, 2048, 576
        ks = 4
        return {
            "q": _w((lambda *s: torch.randn(*s, dtype=torch.bfloat16) * 0.05)(B, S, D)),
            "k": _w((lambda *s: torch.randn(*s, dtype=torch.bfloat16) * 0.8)(B, S, D)),
            "v": _w((lambda *s: torch.randn(*s, dtype=torch.bfloat16) * 0.8)(B, S, D)),
            "shift_k": _w((lambda *s: torch.randn(*s, dtype=torch.bfloat16) * 0.8)(D, ks) * 0.5),
            "ssm_k": _w((lambda *s: torch.randn(*s, dtype=torch.bfloat16) * 0.8)(D, S) * (1.0 / S ** 0.5)),
            "ssm_D": _w((lambda *s: torch.randn(*s, dtype=torch.bfloat16) * 0.8)(D)),
        }
    _A_in = _A_setup()

    def _B_setup():
        B, S, D, F = 1, 2048, 576, 4608
        return {
            "x": _w((lambda *s: torch.randn(*s, dtype=torch.bfloat16) * 0.05)(B, S, D)),
            "w_gate": _w((lambda *s: torch.randn(*s, dtype=torch.bfloat16) * 0.2)(D, F) * (D ** -0.5)),
            "w_up": _w((lambda *s: torch.randn(*s, dtype=torch.bfloat16) * 0.2)(D, F) * (D ** -0.5)),
            "w_down": _w((lambda *s: torch.randn(*s, dtype=torch.bfloat16) * 0.2)(F, D) * (F ** -0.5)),
        }
    _B_in = _B_setup()

    return {
        "A_q": _A_in["q"],
        "A_k": _A_in["k"],
        "A_v": _A_in["v"],
        "A_shift_k": _A_in["shift_k"],
        "A_ssm_k": _A_in["ssm_k"],
        "A_ssm_D": _A_in["ssm_D"],
        "B_x": _B_in["x"],
        "B_w_gate": _B_in["w_gate"],
        "B_w_up": _B_in["w_up"],
        "B_w_down": _B_in["w_down"],
    }

def reference(A_q, A_k, A_v, A_shift_k, A_ssm_k, A_ssm_D, B_x, B_w_gate, B_w_up, B_w_down):
    def _A_ref(q, k, v, shift_k, ssm_k, ssm_D):
        B, S, D = q.shape
        ks = shift_k.shape[-1]
        k_pad = _pad(k, ((0, 0), (ks - 1, 0), (0, 0)))
        k_shift = torch.zeros_like(k)
        for t in range(ks):
            k_shift = k_shift + k_pad[:, t:t + S, :] * shift_k[:, ks - 1 - t][None, None, :]
        kv = k_shift * v
        L = 2 * S
        kv_pad = _pad(kv, ((0, 0), (0, S), (0, 0)))
        kf_pad = _pad(ssm_k, ((0, 0), (0, S)))
        kv_f = (lambda x, axes=(-2,-1): torch.fft.rfft2(x.float(), dim=axes))(kv_pad[:, None, :, :], axes=(1, 2))
        kf_f = (lambda x, axes=(-2,-1): torch.fft.rfft2(x.float(), dim=axes))(kf_pad[:, None, :], axes=(1, 2))
        kf_f = (lambda x, *d: x.permute(*d))(kf_f, 1, 2, 0)
        y_f = kv_f * kf_f[None, :, :, :]
        y = (lambda x, s, axes=(-2,-1): torch.fft.irfft2(x, s=s, dim=axes).to(torch.bfloat16))(y_f, (1, L), axes=(1, 2))[:, 0, :S, :]
        y = y + kv * ssm_D[None, None, :]
        return q * y

    def _B_ref(x, w_gate, w_up, w_down):
        g = torch.einsum("bsd,df->bsf", x, w_gate)
        u = torch.einsum("bsd,df->bsf", x, w_up)
        h = g * u
        return torch.einsum("bsf,fd->bsd", h, w_down)

    x = A_q
    xn = _layernorm(x, axis=-1)
    s = _A_ref(xn, A_k, A_v, A_shift_k, A_ssm_k, A_ssm_D)
    g = _silu(_B_ref(xn, B_w_gate, B_w_up, B_w_down))
    return x + s * g
```

```asm
; @launch grid=(256,1,1) block=(256,1,1) lds=163840
.amdgcn_target "amdgcn-amd-amdhsa--gfx950"
.text
.globl recurrent_scan__ssm_conv_h3__glu_gated_bilinear__prompt_kernel
.p2align 8
.type recurrent_scan__ssm_conv_h3__glu_gated_bilinear__prompt_kernel,@function
recurrent_scan__ssm_conv_h3__glu_gated_bilinear__prompt_kernel:
  s_cmp_ge_u32 s2, 256
  s_cbranch_scc1 K1_done
  s_load_dwordx2 s[4:5], s[0:1], 0
  s_load_dwordx4 s[8:11], s[0:1], 56
  s_load_dwordx2 s[12:13], s[0:1], 72
  s_load_dwordx2 s[6:7], s[0:1], 96
  s_load_dwordx2 s[78:79], s[0:1], 88
  s_load_dwordx2 s[80:81], s[0:1], 32
  s_load_dwordx4 s[68:71], s[0:1], 8
  s_load_dwordx2 s[72:73], s[0:1], 24
  s_load_dwordx2 s[82:83], s[0:1], 40
  s_load_dwordx2 s[98:99], s[0:1], 80
  s_memrealtime s[94:95]
  s_getpc_b64 s[64:65]
  s_lshr_b32 s16, s2, 3
  s_and_b32 s20, s16, 3
  s_mul_i32 s20, s20, 192
  v_add_u32 v5, s20, v0
  v_cmp_gt_u32 vcc, 64, v0
  v_lshrrev_b32 v1, 6, v0
  v_and_b32 v2, 63, v0
  v_cndmask_b32 v5, v5, v0, vcc
  v_min_u32 v5, 582, v5
  v_lshlrev_b32 v5, 7, v5
  global_load_dword a120, v5, s[64:65]
  v_readfirstlane_b32 s14, v1
  s_and_b32 s15, s2, 7
  s_lshr_b32 s17, s16, 1
  s_and_b32 s18, s16, 1
  s_lshl_b32 s19, s15, 1
  s_add_u32 s18, s18, s19
  s_lshl_b32 s19, s17, 7
  s_lshl_b32 s20, s14, 5
  s_add_u32 s19, s19, s20
  v_and_b32 v3, 15, v2
  v_lshrrev_b32 v1, 4, v2
  v_lshrrev_b32 v4, 3, v2
  v_mul_u32_u24 v4, 1152, v4
  v_and_b32 v5, 7, v2
  v_xor_b32 v5, v5, v1
  v_lshl_add_u32 v188, v5, 4, v4
  v_xor_b32 v5, 64, v188
  v_add_u32 v189, 8192, v5
  v_add_u32 v190, 16384, v188
  v_add_u32 v191, 24576, v5
  s_mul_i32 s21, s19, 1152
  s_lshl_b32 s22, s14, 15
  s_add_u32 s22, s22, 32768
  s_waitcnt lgkmcnt(0)
  s_mov_b32 s24, s4
  s_mov_b32 s25, s5
  s_mov_b32 s26, 2359296
  s_mov_b32 s27, 0x20000
  s_add_u32 m0, s22, 0
  s_add_u32 s101, s21, 0
  buffer_load_dwordx4 v188, s[24:27], s101 offen offset:0  lds
  buffer_load_dwordx4 v189, s[24:27], s101 offen offset:1024  lds
  s_add_u32 m0, s22, 2048
  s_add_u32 s101, s21, 128
  buffer_load_dwordx4 v188, s[24:27], s101 offen offset:0  lds
  buffer_load_dwordx4 v189, s[24:27], s101 offen offset:1024  lds
  s_add_u32 m0, s22, 4096
  s_add_u32 s101, s21, 256
  buffer_load_dwordx4 v188, s[24:27], s101 offen offset:0  lds
  buffer_load_dwordx4 v189, s[24:27], s101 offen offset:1024  lds
  s_add_u32 m0, s22, 6144
  s_add_u32 s101, s21, 384
  buffer_load_dwordx4 v188, s[24:27], s101 offen offset:0  lds
  buffer_load_dwordx4 v189, s[24:27], s101 offen offset:1024  lds
  s_add_u32 m0, s22, 8192
  s_add_u32 s101, s21, 512
  buffer_load_dwordx4 v188, s[24:27], s101 offen offset:0  lds
  buffer_load_dwordx4 v189, s[24:27], s101 offen offset:1024  lds
  s_add_u32 m0, s22, 10240
  s_add_u32 s101, s21, 640
  buffer_load_dwordx4 v188, s[24:27], s101 offen offset:0  lds
  buffer_load_dwordx4 v189, s[24:27], s101 offen offset:1024  lds
  s_lshl_b32 s94, s94, 3
  s_or_b32 s94, s94, 4
  v_mov_b32 v6, s94
  s_lshl_b32 s20, s17, 4
  s_add_u32 s91, s20, s18
  s_or_b32 s20, s91, s14
  s_cmp_eq_u32 s20, 0
  s_cselect_b32 s20, 0, 0x1000
  s_mov_b32 s92, s78
  s_mov_b32 s93, s79
  s_mov_b32 s94, 256
  s_mov_b32 s95, 0x20000
  buffer_store_dword v6, off, s[92:95], s20 sc1
  s_mov_b32 s28, s8
  s_mov_b32 s29, s9
  s_mov_b32 s30, 5308416
  s_mov_b32 s31, 0x20000
  s_sub_u32 s32, s10, 1024
  s_subb_u32 s33, s11, 0
  s_mov_b32 s34, 5309440
  s_mov_b32 s35, 0x20000
  s_sub_u32 s36, s12, 3072
  s_subb_u32 s37, s13, 0
  s_mov_b32 s38, 5311488
  s_mov_b32 s39, 0x20000
  s_cmp_ge_u32 s14, 2
  s_cselect_b32 s20, s10, s8
  s_cselect_b32 s23, s11, s9
  s_sub_u32 s40, s20, 3072
  s_subb_u32 s41, s23, 0
  s_mov_b32 s42, 5311488
  s_mov_b32 s43, 0x20000
  s_mov_b32 s44, s6
  s_mov_b32 s45, s7
  s_mov_b32 s46, 268435456
  s_mov_b32 s47, 0x20000
  s_mov_b32 s48, s68
  s_mov_b32 s49, s69
  s_mov_b32 s50, 2359296
  s_mov_b32 s51, 0x20000
  s_sub_u32 s84, s70, 1024
  s_subb_u32 s85, s71, 0
  s_mov_b32 s86, 2360320
  s_mov_b32 s87, 0x20000
  s_mov_b32 s8, s82
  s_mov_b32 s9, s83
  s_mov_b32 s82, 2359296
  s_mov_b32 s83, 0x20000
  s_mov_b32 s63, 0
  s_lshl_b32 s52, s14, 12
  s_and_b32 s20, s18, 1
  s_mul_i32 s53, s18, 576
  s_lshl_b32 s23, s20, 6
  s_add_u32 s54, s53, s23
  s_cmp_eq_u32 s20, 1
  s_cselect_b32 s23, 0, 512
  s_add_u32 s55, s53, s23
  s_mul_i32 s23, s20, 640
  s_lshl_b32 s66, s20, 6
  s_add_u32 s66, s66, 512
  s_mul_i32 s56, s54, 576
  s_mul_i32 s57, s55, 576
  s_xor_b32 s76, s18, 1
  s_mul_i32 s76, s76, 331776
  s_cmp_eq_u32 s20, 0
  s_cselect_b32 s77, 0, 294912
  s_add_u32 s77, s77, s76
  s_cmp_eq_u32 s20, 0
  s_cselect_b32 s59, 36864, 0
  s_add_u32 s76, s76, s59
  s_add_u32 s61, s56, s66
  s_add_u32 s60, s76, s66
  s_sub_u32 s59, s77, 36864
  s_cmp_ge_u32 s14, 2
  s_cselect_b32 s59, s59, s57
  s_add_u32 s59, s59, s66
  s_add_u32 s56, s56, s23
  s_add_u32 s57, s57, s23
  s_add_u32 s76, s76, s23
  s_add_u32 s77, s77, s23
  s_lshr_b32 s58, s18, 1
  s_lshl_b32 s58, s58, 4
  s_add_u32 s58, s58, s17
  s_mul_i32 s58, s58, 313600
  s_add_u32 s58, s58, 6291456
  s_mul_i32 s88, s14, 18432
  s_add_u32 s88, s88, s58
  s_mul_i32 s89, s20, 73728
  s_sub_u32 s91, 73728, s89
  s_add_u32 s62, s88, s91
  s_add_u32 s88, s88, s89
  s_mov_b32 s89, s62
  s_lshl_b32 s90, s20, 7
  s_xor_b32 s91, s90, 128
  s_add_u32 s62, s58, 294912
  s_add_u32 s90, s90, s62
  s_add_u32 s91, s91, s62
  s_cmp_eq_u32 s14, 0
  s_cselect_b32 s90, s90, 0x40000000
  s_lshl_b32 s62, s14, 9
  s_add_u32 s58, s58, s62
  s_add_u32 s58, s58, 147456
  s_lshl_b32 s66, s66, 7
  s_add_u32 s53, s58, s66
  s_lshl_b32 s23, s23, 7
  s_add_u32 s58, s58, s23
  s_lshl_b32 s96, s14, 11
  s_add_u32 s96, s96, 147456
  s_lshl_b32 s71, s14, 3
  s_sub_u32 s71, 28, s71
  s_mul_i32 s71, s71, 1152
  s_and_b32 s20, s2, 3
  s_cmp_eq_u32 s20, 0
  s_cselect_b32 s75, 2097152, 0x40000000
  s_cselect_b32 s10, 1024, 0x40000000
  s_mov_b32 s74, 262144
  s_lshl_b32 s70, s20, 8
  v_lshrrev_b32 v5, 3, v2
  s_lshl_b32 s20, s14, 3
  v_add_u32 v5, s20, v5
  v_and_b32 v6, 7, v2
  v_lshlrev_b32 v7, 1, v1
  v_xor_b32 v7, v7, v6
  v_lshlrev_b32 v7, 4, v7
  v_mul_u32_u24 v252, 9216, v5
  v_add_u32 v252, v252, v7
  v_add_u32 v253, 292864, v252
  v_mul_u32_u24 v5, 1152, v5
  v_add_u32 v5, v5, v7
  v_accvgpr_write_b32 a205, v5
  s_and_b32 s20, s17, 15
  s_lshl_b32 s20, s20, 1
  s_and_b32 s23, s14, 1
  s_add_u32 s20, s20, s23
  s_mul_i32 s20, s20, 18
  v_min_u32 v254, 17, v2
  v_add_u32 v254, s20, v254
  v_mul_u32_u24 v254, 9216, v254
  v_min_u32 v4, 17, v2
  v_add_u32 v4, s20, v4
  v_mul_u32_u24 v4, 9216, v4
  s_and_b32 s20, s17, 15
  s_lshl_b32 s20, s20, 2
  s_add_u32 s20, s20, s14
  s_mul_i32 s20, s20, 42
  v_min_u32 v5, 41, v2
  v_add_u32 v5, s20, v5
  v_lshlrev_b32 v5, 7, v5
  v_accvgpr_write_b32 a210, v5
  s_mul_i32 s20, s16, 43
  s_lshr_b32 s20, s20, 7
  s_mul_i32 s12, s20, 3
  s_sub_u32 s12, s16, s12
  s_mul_i32 s11, s15, 9
  s_add_u32 s11, s11, s20
  s_lshl_b32 s97, s11, 3
  s_lshl_b32 s20, s14, 1
  s_add_u32 s97, s97, s20
  s_lshl_b32 s97, s97, 12
  s_cmp_lt_u32 s16, 27
  s_cselect_b32 s97, s97, 0x40000000
  s_lshr_b32 s20, s11, 4
  s_and_b32 s20, s20, 3
  s_lshl_b32 s20, s20, 8
  s_add_u32 s20, s20, 2428928
  v_lshl_add_u32 v5, v2, 2, s20
  v_accvgpr_write_b32 a214, v5
  v_and_b32 v8, 1, v1
  v_and_b32 v6, 3, v2
  v_lshlrev_b32 v7, 1, v8
  v_xor_b32 v7, v7, v6
  v_lshlrev_b32 v7, 4, v7
  v_lshrrev_b32 v5, 2, v2
  s_and_b32 s20, s14, 1
  s_lshl_b32 s20, s20, 4
  v_add_u32 v6, s20, v5
  v_mul_u32_u24 v6, 9216, v6
  v_add_u32 v6, v6, v7
  v_accvgpr_write_b32 a204, v6
  s_lshl_b32 s20, s14, 4
  v_add_u32 v6, s20, v5
  v_mul_u32_u24 v6, 1152, v6
  v_add_u32 v6, v6, v7
  v_accvgpr_write_b32 a206, v6
  v_lshrrev_b32 v5, 2, v3
  v_and_b32 v6, 3, v3
  v_lshrrev_b32 v7, 1, v5
  v_lshl_add_u32 v7, v1, 1, v7
  v_and_b32 v7, 3, v7
  v_lshl_add_u32 v9, v8, 2, v5
  v_lshlrev_b32 v9, 7, v9
  v_lshrrev_b32 v10, 1, v1
  v_lshl_add_u32 v9, v10, 12, v9
  v_lshl_add_u32 v9, v6, 3, v9
  v_xor_b32 v11, 0, v7
  v_lshl_add_u32 v240, v11, 5, v9
  v_add_u32 v244, 49152, v240
  v_add_u32 v248, 98304, v240
  v_xor_b32 v11, 1, v7
  s_add_u32 m0, s22, 12288
  s_add_u32 s101, s21, 768
  buffer_load_dwordx4 v188, s[24:27], s101 offen offset:0  lds
  buffer_load_dwordx4 v189, s[24:27], s101 offen offset:1024  lds
  s_add_u32 m0, s22, 14336
  s_add_u32 s101, s21, 896
  buffer_load_dwordx4 v188, s[24:27], s101 offen offset:0  lds
  buffer_load_dwordx4 v189, s[24:27], s101 offen offset:1024  lds
  v_lshl_add_u32 v241, v11, 5, v9
  v_add_u32 v245, 49152, v241
  v_add_u32 v249, 98304, v241
  v_xor_b32 v11, 2, v7
  v_lshl_add_u32 v242, v11, 5, v9
  v_add_u32 v246, 49152, v242
  v_add_u32 v250, 98304, v242
  v_xor_b32 v11, 3, v7
  v_lshl_add_u32 v243, v11, 5, v9
  v_add_u32 v247, 49152, v243
  v_add_u32 v251, 98304, v243
  v_lshl_add_u32 v9, v1, 2, v5
  v_lshlrev_b32 v9, 6, v9
  v_lshl_add_u32 v9, v6, 3, v9
  v_lshl_add_u32 v11, v8, 5, v9
  v_accvgpr_write_b32 a208, v11
  v_xor_b32 v11, 32, v11
  v_accvgpr_write_b32 a209, v11
  v_lshlrev_b32 v11, 11, v10
  v_lshl_add_u32 v9, v8, 4, v3
  v_lshl_add_u32 v11, v9, 4, v11
  v_accvgpr_write_b32 a207, v11
  v_lshlrev_b32 v11, 3, v3
  v_cmp_eq_u32 vcc, v5, v1
  s_lshl_b32 s20, s19, 3
  s_add_u32 s20, s20, 2359296
  v_add_u32 v11, s20, v11
  v_cndmask_b32 v11, 0x40000000, v11, vcc
  v_accvgpr_write_b32 a215, v11
  s_lshr_b32 s20, s2, 2
  s_and_b32 s23, s2, 3
  s_lshl_b32 s62, s20, 2
  s_add_u32 s62, s62, s14
  s_mul_i32 s62, s62, 9216
  s_sub_u32 s62, s62, 4608
  v_lshrrev_b32 v9, 3, v2
  v_mul_u32_u24 v9, 1152, v9
  v_and_b32 v11, 7, v2
  v_lshl_add_u32 v9, v11, 4, v9
  v_add_u32 v9, s62, v9
  v_accvgpr_write_b32 a211, v9
  v_lshlrev_b32 v9, 11, v1
  v_lshl_add_u32 v9, v5, 7, v9
  v_lshl_add_u32 v9, v6, 3, v9
  s_lshl_b32 s62, s14, 5
  s_add_u32 s62, s62, 147456
  v_add_u32 v9, s62, v9
  v_accvgpr_write_b32 a212, v9
  s_lshl_b32 s66, s14, 4
  v_add_u32 v13, s66, v3
  s_lshl_b32 s23, s23, 7
  v_add_u32 v9, s23, v13
  v_lshlrev_b32 v184, 3, v9
  v_lshlrev_b32 v185, 3, v13
  s_lshl_b32 s20, s20, 6
  s_sub_u32 s20, 4080, s20
  v_lshlrev_b32 v9, 12, v9
  v_lshlrev_b32 v11, 4, v1
  v_sub_u32 v9, v9, v11
  v_add_u32 v9, s20, v9
  v_accvgpr_write_b32 a213, v9
  s_lshl_b32 s20, s17, 4
  s_add_u32 s20, s20, s18
  s_lshl_b32 s20, s20, 3
  v_and_b32 v9, 7, v2
  v_add_u32 v9, s20, v9
  v_lshrrev_b32 v10, 3, v2
  s_lshl_b32 s23, s14, 3
  v_add_u32 v10, s23, v10
  v_mul_u32_u24 v11, 1152, v9
  v_lshl_add_u32 v11, v10, 4, v11
  v_accvgpr_write_b32 a234, v11
  v_and_b32 v9, 15, v9
  v_lshlrev_b32 v9, 4, v9
  v_lshl_add_u32 v9, v10, 8, v9
  s_and_b32 s20, s91, 0xffffff00
  s_add_u32 s20, s20, 256
  v_add_u32 v9, s20, v9
  v_accvgpr_write_b32 a235, v9
  s_cmp_eq_u32 s12, 0
  s_cselect_b32 s62, 2, 3
  s_cselect_b32 s23, 0, 1
  s_mul_i32 s62, s62, s14
  s_mul_i32 s15, s12, 12
  s_sub_u32 s15, 24, s15
  s_add_u32 s15, s15, s62
  s_lshr_b32 s66, s15, 1
  v_and_b32 v10, s23, v1
  s_add_u32 m0, s22, 16384
  s_add_u32 s101, s21, 1024
  buffer_load_dwordx4 v188, s[24:27], s101 offen offset:0  lds
  buffer_load_dwordx4 v189, s[24:27], s101 offen offset:1024  lds
  s_add_u32 m0, s22, 16384
  s_add_u32 s101, s21, 0
  buffer_load_dwordx4 v190, s[24:27], s101 offen offset:2048  lds
  buffer_load_dwordx4 v191, s[24:27], s101 offen offset:3072  lds
  v_add_u32 v10, s66, v10
  v_lshrrev_b32 v11, 1, v3
  v_lshl_add_u32 v10, v11, 4, v10
  s_mov_b32 s20, 313600
  v_mul_lo_u32 v10, v10, s20
  v_and_b32 v11, 1, v3
  v_lshl_add_u32 v10, v11, 7, v10
  v_add_u32 v10, 6586368, v10
  v_accvgpr_write_b32 a241, v10
  v_lshrrev_b32 v9, 2, v3
  v_and_b32 v10, 3, v3
  v_mul_u32_u24 v9, 2112, v9
  v_lshl_add_u32 v9, v10, 3, v9
  v_lshl_add_u32 v9, v1, 5, v9
  s_lshl_b32 s23, s62, 7
  s_add_u32 s23, s23, 81920
  v_add_u32 v9, s23, v9
  v_accvgpr_write_b32 a240, v9
  s_mul_i32 s20, s14, 13440
  s_add_u32 s62, s20, 13440
  s_add_u32 s20, s20, 114688
  s_cmp_eq_u32 s14, 3
  s_cselect_b32 s20, 0, s20
  s_sub_u32 s19, s62, s20
  v_cmp_eq_u32 vcc, 1, v11
  v_mov_b32 v9, 4160
  s_nop 0
  v_cndmask_b32 v9, v9, 2, vcc
  v_lshl_add_u32 v9, v3, 1, v9
  v_lshl_add_u32 v9, v1, 4, v9
  v_add_u32 v9, s20, v9
  v_accvgpr_write_b32 a236, v9
  v_lshl_add_u32 v9, v2, 4, s20
  v_accvgpr_write_b32 a243, v9
  s_add_u32 s23, s20, 8800
  v_lshlrev_b32 v9, 5, v3
  v_sub_u32 v10, s23, v9
  v_lshl_add_u32 v10, v1, 4, v10
  v_accvgpr_write_b32 a237, v10
  s_add_u32 s23, s20, 8824
  v_sub_u32 v10, s23, v9
  v_lshlrev_b32 v11, 3, v1
  v_sub_u32 v10, v10, v11
  v_accvgpr_write_b32 a238, v10
  s_mul_i32 s23, s14, 4224
  s_add_u32 s23, s23, 81920
  v_add_u32 v10, s23, v9
  v_add_u32 v10, v10, v11
  v_accvgpr_write_b32 a239, v10
  s_mul_i32 s23, s15, 73728
  s_lshl_b32 s20, s11, 4
  s_add_u32 s23, s23, s20
  v_mul_u32_u24 v9, 1152, v2
  v_add_u32 v9, s23, v9
  v_accvgpr_write_b32 a242, v9
  v_accvgpr_write_b32 a244, 0
  v_accvgpr_write_b32 a245, 0
  v_accvgpr_write_b32 a246, 0
  v_accvgpr_write_b32 a247, 0
  v_accvgpr_write_b32 a248, 0
  v_accvgpr_write_b32 a249, 0
  v_accvgpr_write_b32 a250, 0
  v_accvgpr_write_b32 a252, 0
  v_accvgpr_write_b32 a253, 0
  v_accvgpr_write_b32 a254, 0
  v_lshrrev_b32 v5, 3, v3
  v_lshlrev_b32 v5, 10, v5
  v_and_b32 v6, 7, v3
  v_lshl_add_u32 v5, v6, 7, v5
  v_add_u32 v5, s22, v5
  v_lshrrev_b32 v6, 1, v3
  v_xor_b32 v6, v6, v1
  v_lshl_add_u32 v186, v6, 4, v5
  s_add_u32 m0, s22, 18432
  s_add_u32 s101, s21, 128
  buffer_load_dwordx4 v190, s[24:27], s101 offen offset:2048  lds
  buffer_load_dwordx4 v191, s[24:27], s101 offen offset:3072  lds
  s_add_u32 m0, s22, 20480
  s_add_u32 s101, s21, 256
  buffer_load_dwordx4 v190, s[24:27], s101 offen offset:2048  lds
  buffer_load_dwordx4 v191, s[24:27], s101 offen offset:3072  lds
  v_xor_b32 v187, 64, v186
  v_mov_b32 v160, 0x3f803f80
  v_mov_b32 v161, 0x3f803f80
  v_mov_b32 v162, 0x3f803f80
  v_mov_b32 v163, 0x3f803f80
  v_lshlrev_b32 v5, 3, v1
  v_sub_u32 v5, v3, v5
  v_and_b32 v6, 1, v3
  v_lshlrev_b32 v6, 4, v6
  s_movk_i32 s20, 0x3f80
  v_lshlrev_b32 v6, v6, s20
  v_ashrrev_i32 v5, 1, v5
  v_cmp_eq_i32 s[64:65], 0, v5
  s_nop 1
  v_cndmask_b32 v164, 0, v6, s[64:65]
  v_cmp_eq_i32 s[66:67], 1, v5
  s_nop 1
  v_cndmask_b32 v165, 0, v6, s[66:67]
  v_cmp_eq_i32 s[64:65], 2, v5
  s_nop 1
  v_cndmask_b32 v166, 0, v6, s[64:65]
  v_cmp_eq_i32 s[66:67], 3, v5
  s_nop 1
  v_cndmask_b32 v167, 0, v6, s[66:67]
  v_cmp_eq_i32 s[64:65], -8, v5
  s_nop 1
  v_cndmask_b32 v168, 0, v6, s[64:65]
  v_cmp_eq_i32 s[66:67], -7, v5
  s_nop 1
  v_cndmask_b32 v169, 0, v6, s[66:67]
  v_cmp_eq_i32 s[64:65], -6, v5
  s_nop 1
  v_cndmask_b32 v170, 0, v6, s[64:65]
  v_cmp_eq_i32 s[66:67], -5, v5
  s_nop 1
  v_cndmask_b32 v171, 0, v6, s[66:67]
  s_mul_i32 s67, s18, 331776
  v_accvgpr_write_b32 a196, v164
  v_accvgpr_write_b32 a197, v165
  v_accvgpr_write_b32 a198, v166
  v_accvgpr_write_b32 a199, v167
  v_accvgpr_write_b32 a200, v168
  v_accvgpr_write_b32 a201, v169
  v_accvgpr_write_b32 a202, v170
  v_accvgpr_write_b32 a203, v171
  v_lshlrev_b32 v3, 4, v2
  v_cmp_eq_u32 vcc, 0, v2
  s_nop 1
  v_cndmask_b32 v1, 0x40000000, v2, vcc
  s_waitcnt vmcnt(23)
  ds_read_b128 v[16:19], v186 offset:0
  ds_read_b128 v[20:23], v187 offset:0
  s_add_u32 m0, s22, 22528
  s_add_u32 s101, s21, 384
  buffer_load_dwordx4 v190, s[24:27], s101 offen offset:2048  lds
  buffer_load_dwordx4 v191, s[24:27], s101 offen offset:3072  lds
  s_waitcnt vmcnt(23)
  ds_read_b128 v[24:27], v186 offset:2048
  ds_read_b128 v[28:31], v187 offset:2048
  s_add_u32 m0, s22, 24576
  s_add_u32 s101, s21, 512
  buffer_load_dwordx4 v190, s[24:27], s101 offen offset:2048  lds
  buffer_load_dwordx4 v191, s[24:27], s101 offen offset:3072  lds
  s_waitcnt lgkmcnt(3)
  v_mfma_f32_16x16x32_bf16 v[172:175], v[160:163], v[16:19], 0
  s_waitcnt lgkmcnt(2)
  v_mfma_f32_16x16x32_bf16 v[172:175], v[160:163], v[20:23], v[172:175]
  s_waitcnt vmcnt(23)
  ds_read_b128 v[32:35], v186 offset:4096
  ds_read_b128 v[36:39], v187 offset:4096
  s_add_u32 m0, s22, 26624
  s_add_u32 s101, s21, 640
  buffer_load_dwordx4 v190, s[24:27], s101 offen offset:2048  lds
  buffer_load_dwordx4 v191, s[24:27], s101 offen offset:3072  lds
  s_waitcnt lgkmcnt(3)
  v_mfma_f32_16x16x32_bf16 v[172:175], v[160:163], v[24:27], v[172:175]
  s_waitcnt lgkmcnt(2)
  v_mfma_f32_16x16x32_bf16 v[172:175], v[160:163], v[28:31], v[172:175]
  s_waitcnt vmcnt(23)
  ds_read_b128 v[40:43], v186 offset:6144
  ds_read_b128 v[44:47], v187 offset:6144
  s_add_u32 m0, s22, 28672
  s_add_u32 s101, s21, 768
  buffer_load_dwordx4 v190, s[24:27], s101 offen offset:2048  lds
  buffer_load_dwordx4 v191, s[24:27], s101 offen offset:3072  lds
  s_waitcnt lgkmcnt(3)
  v_mfma_f32_16x16x32_bf16 v[172:175], v[160:163], v[32:35], v[172:175]
  s_waitcnt lgkmcnt(2)
  v_mfma_f32_16x16x32_bf16 v[172:175], v[160:163], v[36:39], v[172:175]
  s_waitcnt vmcnt(23)
  ds_read_b128 v[48:51], v186 offset:8192
  ds_read_b128 v[52:55], v187 offset:8192
  s_waitcnt lgkmcnt(3)
  v_mfma_f32_16x16x32_bf16 v[172:175], v[160:163], v[40:43], v[172:175]
  s_waitcnt lgkmcnt(2)
  v_mfma_f32_16x16x32_bf16 v[172:175], v[160:163], v[44:47], v[172:175]
  s_waitcnt vmcnt(21)
  ds_read_b128 v[56:59], v186 offset:10240
  ds_read_b128 v[60:63], v187 offset:10240
  s_add_u32 m0, s22, -2048
  s_add_u32 s101, s21, 896
  buffer_load_dwordx4 v190, s[24:27], s101 offen offset:2048  lds
  buffer_load_dwordx4 v191, s[24:27], s101 offen offset:3072  lds
  s_add_u32 m0, s22, 0
  s_add_u32 s101, s21, 1024
  buffer_load_dwordx4 v190, s[24:27], s101 offen offset:2048  lds
  buffer_load_dwordx4 v191, s[24:27], s101 offen offset:3072  lds
  s_add_u32 m0, s52, 0
  s_add_u32 s62, s54, 0
  buffer_load_dwordx4 v252, s[28:31], s62 offen  lds
  buffer_load_dwordx4 v252, s[32:35], s62 offen offset:1024  lds
  buffer_load_dwordx4 v253, s[28:31], s62 offen offset:2048  lds
  buffer_load_dwordx4 v253, s[32:35], s62 offen offset:3072  lds
  s_add_u32 m0, s52, 16384
  s_add_u32 s62, s54, 589824
  buffer_load_dwordx4 v252, s[28:31], s62 offen  lds
  buffer_load_dwordx4 v252, s[32:35], s62 offen offset:1024  lds
  buffer_load_dwordx4 v253, s[28:31], s62 offen offset:2048  lds
  buffer_load_dwordx4 v253, s[32:35], s62 offen offset:3072  lds
  s_add_u32 s66, s54, 0
  buffer_load_dword a120, v4, s[40:43], s66 offen offset:3072
  s_add_u32 s66, s54, 128
  buffer_load_dword a120, v4, s[40:43], s66 offen offset:3072
  s_mov_b32 s92, s72
  s_mov_b32 s93, s73
  s_mov_b32 s94, 4608
  s_movk_i32 s20, 0x1000
  buffer_load_dwordx2 a[216:217], v184, s[92:95], 0 offen offset:0
  buffer_load_dwordx2 a[218:219], v184, s[92:95], 0 offen offset:512
  buffer_load_dwordx2 a[220:221], v185, s[92:95], s20 offen offset:0
  s_and_b32 s20, s2, 3
  s_lshl_b32 s20, s20, 8
  s_and_b32 s23, s2, 0xfc
  s_add_u32 s20, s20, s23
  s_add_u32 s20, s20, 2428928
  s_cmp_eq_u32 s14, 0
  s_cselect_b32 s17, s20, 0x40000000
  s_waitcnt lgkmcnt(3)
  v_mfma_f32_16x16x32_bf16 v[172:175], v[160:163], v[48:51], v[172:175]
  s_waitcnt lgkmcnt(2)
  v_mfma_f32_16x16x32_bf16 v[172:175], v[160:163], v[52:55], v[172:175]
  s_waitcnt vmcnt(35)
  ds_read_b128 v[64:67], v186 offset:12288
  ds_read_b128 v[68:71], v187 offset:12288
  s_waitcnt lgkmcnt(3)
  v_mfma_f32_16x16x32_bf16 v[172:175], v[160:163], v[56:59], v[172:175]
  s_waitcnt lgkmcnt(2)
  v_mfma_f32_16x16x32_bf16 v[172:175], v[160:163], v[60:63], v[172:175]
  s_waitcnt vmcnt(33)
  ds_read_b128 v[72:75], v186 offset:14336
  ds_read_b128 v[76:79], v187 offset:14336
  s_waitcnt lgkmcnt(3)
  v_mfma_f32_16x16x32_bf16 v[172:175], v[160:163], v[64:67], v[172:175]
  s_waitcnt lgkmcnt(2)
  v_mfma_f32_16x16x32_bf16 v[172:175], v[160:163], v[68:71], v[172:175]
  s_waitcnt vmcnt(31)
  ds_read_b128 v[80:83], v186 offset:16384
  ds_read_b128 v[84:87], v187 offset:16384
  s_waitcnt lgkmcnt(3)
  v_mfma_f32_16x16x32_bf16 v[172:175], v[160:163], v[72:75], v[172:175]
  s_waitcnt lgkmcnt(2)
  v_mfma_f32_16x16x32_bf16 v[172:175], v[160:163], v[76:79], v[172:175]
  s_waitcnt lgkmcnt(1)
  v_mfma_f32_16x16x32_bf16 v[172:175], v[160:163], v[80:83], v[172:175]
  s_waitcnt lgkmcnt(0)
  v_mfma_f32_16x16x32_bf16 v[172:175], v[160:163], v[84:87], v[172:175]
  s_nop 7
  v_mul_f32 v6, 0x3ae38e39, v172
  v_cvt_pk_bf16_f32 v8, v6, v6
  v_lshlrev_b32 v8, 16, v8
  v_xor_b32 v8, 0x80000000, v8
  v_mov_b32 v9, v8
  v_mov_b32 v10, v8
  v_mov_b32 v11, v8
  s_nop 1
  v_mfma_f32_16x16x32_bf16 v[224:227], a[196:199], v[16:19], v[8:11]
  v_mfma_f32_16x16x32_bf16 v[228:231], a[200:203], v[16:19], v[8:11]
  v_mfma_f32_16x16x32_bf16 v[232:235], a[196:199], v[20:23], v[8:11]
  v_mfma_f32_16x16x32_bf16 v[236:239], a[200:203], v[20:23], v[8:11]
  s_nop 4
  v_cvt_pk_bf16_f32 v16, v224, v225
  v_cvt_pk_bf16_f32 v17, v226, v227
  v_cvt_pk_bf16_f32 v18, v228, v229
  v_cvt_pk_bf16_f32 v19, v230, v231
  v_mfma_f32_16x16x32_bf16 v[224:227], a[196:199], v[24:27], v[8:11]
  v_mfma_f32_16x16x32_bf16 v[228:231], a[200:203], v[24:27], v[8:11]
  v_cvt_pk_bf16_f32 v20, v232, v233
  v_cvt_pk_bf16_f32 v21, v234, v235
  v_cvt_pk_bf16_f32 v22, v236, v237
  v_cvt_pk_bf16_f32 v23, v238, v239
  v_mfma_f32_16x16x32_bf16 v[232:235], a[196:199], v[28:31], v[8:11]
  v_mfma_f32_16x16x32_bf16 v[236:239], a[200:203], v[28:31], v[8:11]
  s_nop 0
  v_cvt_pk_bf16_f32 v24, v224, v225
  v_cvt_pk_bf16_f32 v25, v226, v227
  v_cvt_pk_bf16_f32 v26, v228, v229
  v_cvt_pk_bf16_f32 v27, v230, v231
  v_mfma_f32_16x16x32_bf16 v[224:227], a[196:199], v[32:35], v[8:11]
  v_mfma_f32_16x16x32_bf16 v[228:231], a[200:203], v[32:35], v[8:11]
  v_cvt_pk_bf16_f32 v28, v232, v233
  v_cvt_pk_bf16_f32 v29, v234, v235
  v_cvt_pk_bf16_f32 v30, v236, v237
  v_cvt_pk_bf16_f32 v31, v238, v239
  v_mfma_f32_16x16x32_bf16 v[232:235], a[196:199], v[36:39], v[8:11]
  v_mfma_f32_16x16x32_bf16 v[236:239], a[200:203], v[36:39], v[8:11]
  s_nop 0
  v_cvt_pk_bf16_f32 v32, v224, v225
  v_cvt_pk_bf16_f32 v33, v226, v227
  v_cvt_pk_bf16_f32 v34, v228, v229
  v_cvt_pk_bf16_f32 v35, v230, v231
  v_mfma_f32_16x16x32_bf16 v[224:227], a[196:199], v[40:43], v[8:11]
  v_mfma_f32_16x16x32_bf16 v[228:231], a[200:203], v[40:43], v[8:11]
  v_cvt_pk_bf16_f32 v36, v232, v233
  v_cvt_pk_bf16_f32 v37, v234, v235
  v_cvt_pk_bf16_f32 v38, v236, v237
  v_cvt_pk_bf16_f32 v39, v238, v239
  v_mfma_f32_16x16x32_bf16 v[232:235], a[196:199], v[44:47], v[8:11]
  v_mfma_f32_16x16x32_bf16 v[236:239], a[200:203], v[44:47], v[8:11]
  s_nop 0
  v_cvt_pk_bf16_f32 v40, v224, v225
  v_cvt_pk_bf16_f32 v41, v226, v227
  v_cvt_pk_bf16_f32 v42, v228, v229
  v_cvt_pk_bf16_f32 v43, v230, v231
  v_mfma_f32_16x16x32_bf16 v[224:227], a[196:199], v[48:51], v[8:11]
  v_mfma_f32_16x16x32_bf16 v[228:231], a[200:203], v[48:51], v[8:11]
  v_cvt_pk_bf16_f32 v44, v232, v233
  v_cvt_pk_bf16_f32 v45, v234, v235
  v_cvt_pk_bf16_f32 v46, v236, v237
  v_cvt_pk_bf16_f32 v47, v238, v239
  v_mfma_f32_16x16x32_bf16 v[232:235], a[196:199], v[52:55], v[8:11]
  v_mfma_f32_16x16x32_bf16 v[236:239], a[200:203], v[52:55], v[8:11]
  s_nop 0
  v_cvt_pk_bf16_f32 v48, v224, v225
  v_cvt_pk_bf16_f32 v49, v226, v227
  v_cvt_pk_bf16_f32 v50, v228, v229
  v_cvt_pk_bf16_f32 v51, v230, v231
  v_mfma_f32_16x16x32_bf16 v[224:227], a[196:199], v[56:59], v[8:11]
  v_mfma_f32_16x16x32_bf16 v[228:231], a[200:203], v[56:59], v[8:11]
  v_cvt_pk_bf16_f32 v52, v232, v233
  v_cvt_pk_bf16_f32 v53, v234, v235
  v_cvt_pk_bf16_f32 v54, v236, v237
  v_cvt_pk_bf16_f32 v55, v238, v239
  v_mfma_f32_16x16x32_bf16 v[232:235], a[196:199], v[60:63], v[8:11]
  v_mfma_f32_16x16x32_bf16 v[236:239], a[200:203], v[60:63], v[8:11]
  s_nop 0
  v_cvt_pk_bf16_f32 v56, v224, v225
  v_cvt_pk_bf16_f32 v57, v226, v227
  v_cvt_pk_bf16_f32 v58, v228, v229
  v_cvt_pk_bf16_f32 v59, v230, v231
  v_mfma_f32_16x16x32_bf16 v[224:227], a[196:199], v[64:67], v[8:11]
  v_mfma_f32_16x16x32_bf16 v[228:231], a[200:203], v[64:67], v[8:11]
  v_cvt_pk_bf16_f32 v60, v232, v233
  v_cvt_pk_bf16_f32 v61, v234, v235
  v_cvt_pk_bf16_f32 v62, v236, v237
  v_cvt_pk_bf16_f32 v63, v238, v239
  v_mfma_f32_16x16x32_bf16 v[232:235], a[196:199], v[68:71], v[8:11]
  v_mfma_f32_16x16x32_bf16 v[236:239], a[200:203], v[68:71], v[8:11]
  s_nop 0
  v_cvt_pk_bf16_f32 v64, v224, v225
  v_cvt_pk_bf16_f32 v65, v226, v227
  v_cvt_pk_bf16_f32 v66, v228, v229
  v_cvt_pk_bf16_f32 v67, v230, v231
  v_mfma_f32_16x16x32_bf16 v[224:227], a[196:199], v[72:75], v[8:11]
  v_mfma_f32_16x16x32_bf16 v[228:231], a[200:203], v[72:75], v[8:11]
  v_cvt_pk_bf16_f32 v68, v232, v233
  v_cvt_pk_bf16_f32 v69, v234, v235
  v_cvt_pk_bf16_f32 v70, v236, v237
  v_cvt_pk_bf16_f32 v71, v238, v239
  v_mfma_f32_16x16x32_bf16 v[232:235], a[196:199], v[76:79], v[8:11]
  v_mfma_f32_16x16x32_bf16 v[236:239], a[200:203], v[76:79], v[8:11]
  s_nop 0
  v_cvt_pk_bf16_f32 v72, v224, v225
  v_cvt_pk_bf16_f32 v73, v226, v227
  v_cvt_pk_bf16_f32 v74, v228, v229
  v_cvt_pk_bf16_f32 v75, v230, v231
  v_mfma_f32_16x16x32_bf16 v[224:227], a[196:199], v[80:83], v[8:11]
  v_mfma_f32_16x16x32_bf16 v[228:231], a[200:203], v[80:83], v[8:11]
  v_cvt_pk_bf16_f32 v76, v232, v233
  v_cvt_pk_bf16_f32 v77, v234, v235
  v_cvt_pk_bf16_f32 v78, v236, v237
  v_cvt_pk_bf16_f32 v79, v238, v239
  v_mfma_f32_16x16x32_bf16 v[232:235], a[196:199], v[84:87], v[8:11]
  v_mfma_f32_16x16x32_bf16 v[236:239], a[200:203], v[84:87], v[8:11]
  s_nop 0
  v_cvt_pk_bf16_f32 v80, v224, v225
  v_cvt_pk_bf16_f32 v81, v226, v227
  v_cvt_pk_bf16_f32 v82, v228, v229
  v_cvt_pk_bf16_f32 v83, v230, v231
  s_nop 1
  v_cvt_pk_bf16_f32 v84, v232, v233
  v_cvt_pk_bf16_f32 v85, v234, v235
  v_cvt_pk_bf16_f32 v86, v236, v237
  v_cvt_pk_bf16_f32 v87, v238, v239
  s_waitcnt vmcnt(29)
  ds_read_b128 v[88:91], v186 offset:18432
  ds_read_b128 v[92:95], v187 offset:18432
  s_waitcnt vmcnt(27)
  ds_read_b128 v[96:99], v186 offset:20480
  ds_read_b128 v[100:103], v187 offset:20480
  s_waitcnt lgkmcnt(3)
  v_mfma_f32_16x16x32_bf16 v[176:179], v[160:163], v[88:91], 0
  s_waitcnt lgkmcnt(2)
  v_mfma_f32_16x16x32_bf16 v[176:179], v[160:163], v[92:95], v[176:179]
  s_waitcnt vmcnt(25)
  ds_read_b128 v[104:107], v186 offset:22528
  ds_read_b128 v[108:111], v187 offset:22528
  s_waitcnt lgkmcnt(3)
  v_mfma_f32_16x16x32_bf16 v[176:179], v[160:163], v[96:99], v[176:179]
  s_waitcnt lgkmcnt(2)
  v_mfma_f32_16x16x32_bf16 v[176:179], v[160:163], v[100:103], v[176:179]
  s_waitcnt vmcnt(23)
  ds_read_b128 v[112:115], v186 offset:24576
  ds_read_b128 v[116:119], v187 offset:24576
  s_waitcnt lgkmcnt(3)
  v_mfma_f32_16x16x32_bf16 v[176:179], v[160:163], v[104:107], v[176:179]
  s_waitcnt lgkmcnt(2)
  v_mfma_f32_16x16x32_bf16 v[176:179], v[160:163], v[108:111], v[176:179]
  s_waitcnt vmcnt(21)
  ds_read_b128 v[120:123], v186 offset:26624
  ds_read_b128 v[124:127], v187 offset:26624
  s_waitcnt lgkmcnt(3)
  v_mfma_f32_16x16x32_bf16 v[176:179], v[160:163], v[112:115], v[176:179]
  s_waitcnt lgkmcnt(2)
  v_mfma_f32_16x16x32_bf16 v[176:179], v[160:163], v[116:119], v[176:179]
  s_waitcnt vmcnt(19)
  ds_read_b128 v[128:131], v186 offset:28672
  ds_read_b128 v[132:135], v187 offset:28672
  s_waitcnt lgkmcnt(3)
  v_mfma_f32_16x16x32_bf16 v[176:179], v[160:163], v[120:123], v[176:179]
  s_waitcnt lgkmcnt(2)
  v_mfma_f32_16x16x32_bf16 v[176:179], v[160:163], v[124:127], v[176:179]
  s_waitcnt vmcnt(17)
  ds_read_b128 v[136:139], v186 offset:30720
  ds_read_b128 v[140:143], v187 offset:30720
  s_waitcnt lgkmcnt(3)
  v_mfma_f32_16x16x32_bf16 v[176:179], v[160:163], v[128:131], v[176:179]
  s_waitcnt lgkmcnt(2)
  v_mfma_f32_16x16x32_bf16 v[176:179], v[160:163], v[132:135], v[176:179]
  s_waitcnt vmcnt(15)
  ds_read_b128 v[144:147], v186 offset:0
  ds_read_b128 v[148:151], v187 offset:0
  s_waitcnt lgkmcnt(3)
  v_mfma_f32_16x16x32_bf16 v[176:179], v[160:163], v[136:139], v[176:179]
  s_waitcnt lgkmcnt(2)
  v_mfma_f32_16x16x32_bf16 v[176:179], v[160:163], v[140:143], v[176:179]
  s_waitcnt vmcnt(13)
  ds_read_b128 v[152:155], v186 offset:2048
  ds_read_b128 v[156:159], v187 offset:2048
  s_waitcnt lgkmcnt(3)
  v_mfma_f32_16x16x32_bf16 v[176:179], v[160:163], v[144:147], v[176:179]
  s_waitcnt lgkmcnt(2)
  v_mfma_f32_16x16x32_bf16 v[176:179], v[160:163], v[148:151], v[176:179]
  s_waitcnt lgkmcnt(1)
  v_mfma_f32_16x16x32_bf16 v[176:179], v[160:163], v[152:155], v[176:179]
  s_waitcnt lgkmcnt(0)
  v_mfma_f32_16x16x32_bf16 v[176:179], v[160:163], v[156:159], v[176:179]
  s_nop 7
  v_mul_f32 v7, 0x3ae38e39, v176
  v_cvt_pk_bf16_f32 v12, v7, v7
  v_lshlrev_b32 v12, 16, v12
  v_xor_b32 v12, 0x80000000, v12
  v_mov_b32 v13, v12
  v_mov_b32 v14, v12
  v_mov_b32 v15, v12
  s_nop 1
  v_mfma_f32_16x16x32_bf16 v[224:227], a[196:199], v[88:91], v[12:15]
  v_mfma_f32_16x16x32_bf16 v[228:231], a[200:203], v[88:91], v[12:15]
  v_mfma_f32_16x16x32_bf16 v[232:235], a[196:199], v[92:95], v[12:15]
  v_mfma_f32_16x16x32_bf16 v[236:239], a[200:203], v[92:95], v[12:15]
  s_nop 4
  v_cvt_pk_bf16_f32 v88, v224, v225
  v_cvt_pk_bf16_f32 v89, v226, v227
  v_cvt_pk_bf16_f32 v90, v228, v229
  v_cvt_pk_bf16_f32 v91, v230, v231
  v_mfma_f32_16x16x32_bf16 v[224:227], a[196:199], v[96:99], v[12:15]
  v_mfma_f32_16x16x32_bf16 v[228:231], a[200:203], v[96:99], v[12:15]
  v_cvt_pk_bf16_f32 v92, v232, v233
  v_cvt_pk_bf16_f32 v93, v234, v235
  v_cvt_pk_bf16_f32 v94, v236, v237
  v_cvt_pk_bf16_f32 v95, v238, v239
  v_mfma_f32_16x16x32_bf16 v[232:235], a[196:199], v[100:103], v[12:15]
  v_mfma_f32_16x16x32_bf16 v[236:239], a[200:203], v[100:103], v[12:15]
  s_nop 0
  v_cvt_pk_bf16_f32 v96, v224, v225
  v_cvt_pk_bf16_f32 v97, v226, v227
  v_cvt_pk_bf16_f32 v98, v228, v229
  v_cvt_pk_bf16_f32 v99, v230, v231
  v_mfma_f32_16x16x32_bf16 v[224:227], a[196:199], v[104:107], v[12:15]
  v_mfma_f32_16x16x32_bf16 v[228:231], a[200:203], v[104:107], v[12:15]
  v_cvt_pk_bf16_f32 v100, v232, v233
  v_cvt_pk_bf16_f32 v101, v234, v235
  v_cvt_pk_bf16_f32 v102, v236, v237
  v_cvt_pk_bf16_f32 v103, v238, v239
  v_mfma_f32_16x16x32_bf16 v[232:235], a[196:199], v[108:111], v[12:15]
  v_mfma_f32_16x16x32_bf16 v[236:239], a[200:203], v[108:111], v[12:15]
  s_nop 0
  v_cvt_pk_bf16_f32 v104, v224, v225
  v_cvt_pk_bf16_f32 v105, v226, v227
  v_cvt_pk_bf16_f32 v106, v228, v229
  v_cvt_pk_bf16_f32 v107, v230, v231
  s_waitcnt vmcnt(7)
  s_barrier
  ds_read_b64_tr_b16 a[0:1], v240 offset:0
  ds_read_b64_tr_b16 a[2:3], v240 offset:8192
  ds_read_b64_tr_b16 a[4:5], v240 offset:1024
  ds_read_b64_tr_b16 a[6:7], v240 offset:9216
  ds_read_b64_tr_b16 a[8:9], v241 offset:0
  ds_read_b64_tr_b16 a[10:11], v241 offset:8192
  ds_read_b64_tr_b16 a[12:13], v241 offset:1024
  ds_read_b64_tr_b16 a[14:15], v241 offset:9216
  ds_read_b64_tr_b16 a[16:17], v242 offset:0
  ds_read_b64_tr_b16 a[18:19], v242 offset:8192
  ds_read_b64_tr_b16 a[20:21], v242 offset:1024
  ds_read_b64_tr_b16 a[22:23], v242 offset:9216
  ds_read_b64_tr_b16 a[24:25], v243 offset:0
  ds_read_b64_tr_b16 a[26:27], v243 offset:8192
  v_cvt_pk_bf16_f32 v108, v232, v233
  v_cvt_pk_bf16_f32 v109, v234, v235
  v_cvt_pk_bf16_f32 v110, v236, v237
  v_cvt_pk_bf16_f32 v111, v238, v239
  s_waitcnt lgkmcnt(6)
  v_mfma_f32_16x16x32_bf16 v[160:163], a[0:3], v[16:19], 0
  ds_read_b64_tr_b16 a[28:29], v243 offset:1024
  s_add_u32 m0, s52, 32768
  s_add_u32 s62, s54, 1179648
  v_mfma_f32_16x16x32_bf16 v[224:227], a[196:199], v[112:115], v[12:15]
  v_mfma_f32_16x16x32_bf16 v[164:167], a[0:3], v[88:91], 0
  ds_read_b64_tr_b16 a[30:31], v243 offset:9216
  ds_read_b64_tr_b16 a[32:33], v240 offset:2048
  v_mfma_f32_16x16x32_bf16 v[168:171], a[4:7], v[16:19], 0
  buffer_load_dwordx4 v252, s[28:31], s62 offen  lds
  v_mfma_f32_16x16x32_bf16 v[228:231], a[200:203], v[112:115], v[12:15]
  v_mfma_f32_16x16x32_bf16 v[172:175], a[4:7], v[88:91], 0
  ds_read_b64_tr_b16 a[34:35], v240 offset:10240
  v_mfma_f32_16x16x32_bf16 v[176:179], a[8:11], v[16:19], 0
  ds_read_b64_tr_b16 a[36:37], v240 offset:3072
  v_mfma_f32_16x16x32_bf16 v[180:183], a[8:11], v[88:91], 0
  ds_read_b64_tr_b16 a[38:39], v240 offset:11264
  ds_read_b64_tr_b16 a[40:41], v241 offset:2048
  v_mfma_f32_16x16x32_bf16 v[184:187], a[12:15], v[16:19], 0
  buffer_load_dwordx4 v252, s[32:35], s62 offen offset:1024  lds
  v_mfma_f32_16x16x32_bf16 v[232:235], a[196:199], v[116:119], v[12:15]
  v_mfma_f32_16x16x32_bf16 v[188:191], a[12:15], v[88:91], 0
  ds_read_b64_tr_b16 a[42:43], v241 offset:10240
  v_mfma_f32_16x16x32_bf16 v[236:239], a[200:203], v[116:119], v[12:15]
  v_cvt_pk_bf16_f32 v112, v224, v225
  s_waitcnt lgkmcnt(6)
  v_mfma_f32_16x16x32_bf16 v[192:195], a[16:19], v[16:19], 0
  ds_read_b64_tr_b16 a[44:45], v241 offset:3072
  v_cvt_pk_bf16_f32 v113, v226, v227
  v_mfma_f32_16x16x32_bf16 v[196:199], a[16:19], v[88:91], 0
  ds_read_b64_tr_b16 a[46:47], v241 offset:11264
  ds_read_b64_tr_b16 a[0:1], v242 offset:2048
  v_mfma_f32_16x16x32_bf16 v[200:203], a[20:23], v[16:19], 0
  buffer_load_dwordx4 v253, s[28:31], s62 offen offset:2048  lds
  v_mfma_f32_16x16x32_bf16 v[204:207], a[20:23], v[88:91], 0
  ds_read_b64_tr_b16 a[2:3], v242 offset:10240
  v_cvt_pk_bf16_f32 v114, v228, v229
  v_mfma_f32_16x16x32_bf16 v[208:211], a[24:27], v[16:19], 0
  ds_read_b64_tr_b16 a[4:5], v242 offset:3072
  v_cvt_pk_bf16_f32 v115, v230, v231
  v_mfma_f32_16x16x32_bf16 v[212:215], a[24:27], v[88:91], 0
  ds_read_b64_tr_b16 a[6:7], v242 offset:11264
  ds_read_b64_tr_b16 a[8:9], v243 offset:2048
  v_mfma_f32_16x16x32_bf16 v[216:219], a[28:31], v[16:19], 0
  buffer_load_dwordx4 v253, s[32:35], s62 offen offset:3072  lds
  v_mfma_f32_16x16x32_bf16 v[220:223], a[28:31], v[88:91], 0
  ds_read_b64_tr_b16 a[10:11], v243 offset:10240
  s_waitcnt lgkmcnt(6)
  v_mfma_f32_16x16x32_bf16 v[160:163], a[32:35], v[20:23], v[160:163]
  ds_read_b64_tr_b16 a[12:13], v243 offset:3072
  s_add_u32 m0, s52, 49152
  s_add_u32 s62, s54, 1769472
  v_mfma_f32_16x16x32_bf16 v[164:167], a[32:35], v[92:95], v[164:167]
  ds_read_b64_tr_b16 a[14:15], v243 offset:11264
  ds_read_b64_tr_b16 a[16:17], v240 offset:16384
  v_mfma_f32_16x16x32_bf16 v[168:171], a[36:39], v[20:23], v[168:171]
  buffer_load_dwordx4 v252, s[28:31], s62 offen  lds
  v_mfma_f32_16x16x32_bf16 v[224:227], a[196:199], v[120:123], v[12:15]
  v_mfma_f32_16x16x32_bf16 v[172:175], a[36:39], v[92:95], v[172:175]
  ds_read_b64_tr_b16 a[18:19], v240 offset:24576
  v_mfma_f32_16x16x32_bf16 v[228:231], a[200:203], v[120:123], v[12:15]
  v_cvt_pk_bf16_f32 v116, v232, v233
  v_cvt_pk_bf16_f32 v117, v234, v235
  v_mfma_f32_16x16x32_bf16 v[176:179], a[40:43], v[20:23], v[176:179]
  ds_read_b64_tr_b16 a[20:21], v240 offset:17408
  v_cvt_pk_bf16_f32 v118, v236, v237
  v_mfma_f32_16x16x32_bf16 v[180:183], a[40:43], v[92:95], v[180:183]
  ds_read_b64_tr_b16 a[22:23], v240 offset:25600
  s_waitcnt vmcnt(10)
  s_barrier
  v_mfma_f32_16x16x32_bf16 v[184:187], a[44:47], v[20:23], v[184:187]
  ds_read_b64_tr_b16 a[24:25], v241 offset:16384
  buffer_load_dwordx4 v252, s[32:35], s62 offen offset:1024  lds
  v_mfma_f32_16x16x32_bf16 v[188:191], a[44:47], v[92:95], v[188:191]
  ds_read_b64_tr_b16 a[26:27], v241 offset:24576
  s_waitcnt lgkmcnt(6)
  v_mfma_f32_16x16x32_bf16 v[192:195], a[0:3], v[20:23], v[192:195]
  ds_read_b64_tr_b16 a[28:29], v241 offset:17408
  v_cvt_pk_bf16_f32 v119, v238, v239
  v_mfma_f32_16x16x32_bf16 v[196:199], a[0:3], v[92:95], v[196:199]
  ds_read_b64_tr_b16 a[30:31], v241 offset:25600
  ds_read_b64_tr_b16 a[32:33], v242 offset:16384
  v_mfma_f32_16x16x32_bf16 v[200:203], a[4:7], v[20:23], v[200:203]
  buffer_load_dwordx4 v253, s[28:31], s62 offen offset:2048  lds
  v_mfma_f32_16x16x32_bf16 v[204:207], a[4:7], v[92:95], v[204:207]
  ds_read_b64_tr_b16 a[34:35], v242 offset:24576
  v_mfma_f32_16x16x32_bf16 v[208:211], a[8:11], v[20:23], v[208:211]
  ds_read_b64_tr_b16 a[36:37], v242 offset:17408
  v_mfma_f32_16x16x32_bf16 v[212:215], a[8:11], v[92:95], v[212:215]
  ds_read_b64_tr_b16 a[38:39], v242 offset:25600
  ds_read_b64_tr_b16 a[40:41], v243 offset:16384
  v_mfma_f32_16x16x32_bf16 v[216:219], a[12:15], v[20:23], v[216:219]
  buffer_load_dwordx4 v253, s[32:35], s62 offen offset:3072  lds
  v_mfma_f32_16x16x32_bf16 v[220:223], a[12:15], v[92:95], v[220:223]
  ds_read_b64_tr_b16 a[42:43], v243 offset:24576
  v_mfma_f32_16x16x32_bf16 v[232:235], a[196:199], v[124:127], v[12:15]
  s_add_u32 m0, s52, 65536
  s_waitcnt lgkmcnt(6)
  v_mfma_f32_16x16x32_bf16 v[160:163], a[16:19], v[24:27], v[160:163]
  ds_read_b64_tr_b16 a[44:45], v243 offset:17408
  s_add_u32 s62, s54, 2359296
  v_mfma_f32_16x16x32_bf16 v[236:239], a[200:203], v[124:127], v[12:15]
  v_cvt_pk_bf16_f32 v120, v224, v225
  v_cvt_pk_bf16_f32 v121, v226, v227
  v_mfma_f32_16x16x32_bf16 v[164:167], a[16:19], v[96:99], v[164:167]
  ds_read_b64_tr_b16 a[46:47], v243 offset:25600
  ds_read_b64_tr_b16 a[0:1], v240 offset:18432
  v_mfma_f32_16x16x32_bf16 v[168:171], a[20:23], v[24:27], v[168:171]
  buffer_load_dwordx4 v252, s[28:31], s62 offen  lds
  v_mfma_f32_16x16x32_bf16 v[172:175], a[20:23], v[96:99], v[172:175]
  ds_read_b64_tr_b16 a[2:3], v240 offset:26624
  v_cvt_pk_bf16_f32 v122, v228, v229
  v_mfma_f32_16x16x32_bf16 v[176:179], a[24:27], v[24:27], v[176:179]
  ds_read_b64_tr_b16 a[4:5], v240 offset:19456
  v_cvt_pk_bf16_f32 v123, v230, v231
  v_mfma_f32_16x16x32_bf16 v[180:183], a[24:27], v[96:99], v[180:183]
  ds_read_b64_tr_b16 a[6:7], v240 offset:27648
  ds_read_b64_tr_b16 a[8:9], v241 offset:18432
  v_mfma_f32_16x16x32_bf16 v[184:187], a[28:31], v[24:27], v[184:187]
  buffer_load_dwordx4 v252, s[32:35], s62 offen offset:1024  lds
  v_mfma_f32_16x16x32_bf16 v[188:191], a[28:31], v[96:99], v[188:191]
  ds_read_b64_tr_b16 a[10:11], v241 offset:26624
  s_waitcnt lgkmcnt(6)
  v_mfma_f32_16x16x32_bf16 v[192:195], a[32:35], v[24:27], v[192:195]
  ds_read_b64_tr_b16 a[12:13], v241 offset:19456
  v_mfma_f32_16x16x32_bf16 v[196:199], a[32:35], v[96:99], v[196:199]
  ds_read_b64_tr_b16 a[14:15], v241 offset:27648
  ds_read_b64_tr_b16 a[16:17], v242 offset:18432
  v_mfma_f32_16x16x32_bf16 v[200:203], a[36:39], v[24:27], v[200:203]
  buffer_load_dwordx4 v253, s[28:31], s62 offen offset:2048  lds
  v_mfma_f32_16x16x32_bf16 v[204:207], a[36:39], v[96:99], v[204:207]
  ds_read_b64_tr_b16 a[18:19], v242 offset:26624
  v_mfma_f32_16x16x32_bf16 v[208:211], a[40:43], v[24:27], v[208:211]
  ds_read_b64_tr_b16 a[20:21], v242 offset:19456
  v_mfma_f32_16x16x32_bf16 v[224:227], a[196:199], v[128:131], v[12:15]
  v_mfma_f32_16x16x32_bf16 v[212:215], a[40:43], v[96:99], v[212:215]
  ds_read_b64_tr_b16 a[22:23], v242 offset:27648
  s_waitcnt vmcnt(3)
  s_barrier
  v_mfma_f32_16x16x32_bf16 v[216:219], a[44:47], v[24:27], v[216:219]
  ds_read_b64_tr_b16 a[24:25], v243 offset:18432
  buffer_load_dwordx4 v253, s[32:35], s62 offen offset:3072  lds
  v_mfma_f32_16x16x32_bf16 v[228:231], a[200:203], v[128:131], v[12:15]
  v_cvt_pk_bf16_f32 v124, v232, v233
  v_cvt_pk_bf16_f32 v125, v234, v235
  v_mfma_f32_16x16x32_bf16 v[220:223], a[44:47], v[96:99], v[220:223]
  ds_read_b64_tr_b16 a[26:27], v243 offset:26624
  s_waitcnt lgkmcnt(6)
  v_mfma_f32_16x16x32_bf16 v[160:163], a[0:3], v[28:31], v[160:163]
  ds_read_b64_tr_b16 a[28:29], v243 offset:19456
  s_add_u32 m0, s52, 81920
  s_add_u32 s62, s54, 2949120
  v_mfma_f32_16x16x32_bf16 v[164:167], a[0:3], v[100:103], v[164:167]
  ds_read_b64_tr_b16 a[30:31], v243 offset:27648
  ds_read_b64_tr_b16 a[32:33], v240 offset:32768
  v_mfma_f32_16x16x32_bf16 v[168:171], a[4:7], v[28:31], v[168:171]
  buffer_load_dwordx4 v252, s[28:31], s62 offen  lds
  v_mfma_f32_16x16x32_bf16 v[172:175], a[4:7], v[100:103], v[172:175]
  ds_read_b64_tr_b16 a[34:35], v240 offset:40960
  v_cvt_pk_bf16_f32 v126, v236, v237
  v_mfma_f32_16x16x32_bf16 v[176:179], a[8:11], v[28:31], v[176:179]
  ds_read_b64_tr_b16 a[36:37], v240 offset:33792
  v_cvt_pk_bf16_f32 v127, v238, v239
  v_mfma_f32_16x16x32_bf16 v[180:183], a[8:11], v[100:103], v[180:183]
  ds_read_b64_tr_b16 a[38:39], v240 offset:41984
  ds_read_b64_tr_b16 a[40:41], v241 offset:32768
  v_mfma_f32_16x16x32_bf16 v[184:187], a[12:15], v[28:31], v[184:187]
  buffer_load_dwordx4 v252, s[32:35], s62 offen offset:1024  lds
  v_mfma_f32_16x16x32_bf16 v[188:191], a[12:15], v[100:103], v[188:191]
  ds_read_b64_tr_b16 a[42:43], v241 offset:40960
  s_waitcnt lgkmcnt(6)
  v_mfma_f32_16x16x32_bf16 v[192:195], a[16:19], v[28:31], v[192:195]
  ds_read_b64_tr_b16 a[44:45], v241 offset:33792
  v_mfma_f32_16x16x32_bf16 v[196:199], a[16:19], v[100:103], v[196:199]
  ds_read_b64_tr_b16 a[46:47], v241 offset:41984
  ds_read_b64_tr_b16 a[0:1], v242 offset:32768
  v_mfma_f32_16x16x32_bf16 v[200:203], a[20:23], v[28:31], v[200:203]
  buffer_load_dwordx4 v253, s[28:31], s62 offen offset:2048  lds
  v_mfma_f32_16x16x32_bf16 v[232:235], a[196:199], v[132:135], v[12:15]
  v_mfma_f32_16x16x32_bf16 v[204:207], a[20:23], v[100:103], v[204:207]
  ds_read_b64_tr_b16 a[2:3], v242 offset:40960
  v_mfma_f32_16x16x32_bf16 v[236:239], a[200:203], v[132:135], v[12:15]
  v_cvt_pk_bf16_f32 v128, v224, v225
  v_cvt_pk_bf16_f32 v129, v226, v227
  v_mfma_f32_16x16x32_bf16 v[208:211], a[24:27], v[28:31], v[208:211]
  ds_read_b64_tr_b16 a[4:5], v242 offset:33792
  s_add_u32 s66, s54, 256
  v_mfma_f32_16x16x32_bf16 v[212:215], a[24:27], v[100:103], v[212:215]
  ds_read_b64_tr_b16 a[6:7], v242 offset:41984
  ds_read_b64_tr_b16 a[8:9], v243 offset:32768
  v_mfma_f32_16x16x32_bf16 v[216:219], a[28:31], v[28:31], v[216:219]
  buffer_load_dwordx4 v253, s[32:35], s62 offen offset:3072  lds
  v_mfma_f32_16x16x32_bf16 v[220:223], a[28:31], v[100:103], v[220:223]
  ds_read_b64_tr_b16 a[10:11], v243 offset:40960
  s_waitcnt lgkmcnt(6)
  v_mfma_f32_16x16x32_bf16 v[160:163], a[32:35], v[32:35], v[160:163]
  ds_read_b64_tr_b16 a[12:13], v243 offset:33792
  s_add_u32 m0, s52, 98304
  s_add_u32 s62, s54, 3538944
  v_mfma_f32_16x16x32_bf16 v[164:167], a[32:35], v[104:107], v[164:167]
  ds_read_b64_tr_b16 a[14:15], v243 offset:41984
  ds_read_b64_tr_b16 a[16:17], v240 offset:34816
  v_mfma_f32_16x16x32_bf16 v[168:171], a[36:39], v[32:35], v[168:171]
  ds_read_b64_tr_b16 a[18:19], v240 offset:43008
  buffer_load_dwordx4 v252, s[28:31], s62 offen  lds
  v_mfma_f32_16x16x32_bf16 v[172:175], a[36:39], v[104:107], v[172:175]
  buffer_load_dword a120, v254, s[40:43], s66 offen offset:3072
  v_mfma_f32_16x16x32_bf16 v[176:179], a[40:43], v[32:35], v[176:179]
  ds_read_b64_tr_b16 a[20:21], v240 offset:35840
  v_cvt_pk_bf16_f32 v130, v228, v229
  v_mfma_f32_16x16x32_bf16 v[180:183], a[40:43], v[104:107], v[180:183]
  ds_read_b64_tr_b16 a[22:23], v240 offset:44032
  ds_read_b64_tr_b16 a[24:25], v241 offset:34816
  v_mfma_f32_16x16x32_bf16 v[184:187], a[44:47], v[32:35], v[184:187]
  buffer_load_dwordx4 v252, s[32:35], s62 offen offset:1024  lds
  v_mfma_f32_16x16x32_bf16 v[188:191], a[44:47], v[104:107], v[188:191]
  ds_read_b64_tr_b16 a[26:27], v241 offset:43008
  s_waitcnt lgkmcnt(6)
  v_mfma_f32_16x16x32_bf16 v[192:195], a[0:3], v[32:35], v[192:195]
  ds_read_b64_tr_b16 a[28:29], v241 offset:35840
  v_cvt_pk_bf16_f32 v131, v230, v231
  v_mfma_f32_16x16x32_bf16 v[224:227], a[196:199], v[136:139], v[12:15]
  v_mfma_f32_16x16x32_bf16 v[196:199], a[0:3], v[104:107], v[196:199]
  ds_read_b64_tr_b16 a[30:31], v241 offset:44032
  ds_read_b64_tr_b16 a[32:33], v242 offset:34816
  v_mfma_f32_16x16x32_bf16 v[200:203], a[4:7], v[32:35], v[200:203]
  buffer_load_dwordx4 v253, s[28:31], s62 offen offset:2048  lds
  v_mfma_f32_16x16x32_bf16 v[228:231], a[200:203], v[136:139], v[12:15]
  v_cvt_pk_bf16_f32 v132, v232, v233
  v_cvt_pk_bf16_f32 v133, v234, v235
  v_mfma_f32_16x16x32_bf16 v[204:207], a[4:7], v[104:107], v[204:207]
  ds_read_b64_tr_b16 a[34:35], v242 offset:43008
  v_cvt_pk_bf16_f32 v134, v236, v237
  v_mfma_f32_16x16x32_bf16 v[208:211], a[8:11], v[32:35], v[208:211]
  ds_read_b64_tr_b16 a[36:37], v242 offset:35840
  v_cvt_pk_bf16_f32 v135, v238, v239
  v_mfma_f32_16x16x32_bf16 v[212:215], a[8:11], v[104:107], v[212:215]
  ds_read_b64_tr_b16 a[38:39], v242 offset:44032
  ds_read_b64_tr_b16 a[40:41], v243 offset:34816
  v_mfma_f32_16x16x32_bf16 v[216:219], a[12:15], v[32:35], v[216:219]
  buffer_load_dwordx4 v253, s[32:35], s62 offen offset:3072  lds
  v_mfma_f32_16x16x32_bf16 v[220:223], a[12:15], v[104:107], v[220:223]
  ds_read_b64_tr_b16 a[42:43], v243 offset:43008
  s_waitcnt lgkmcnt(6)
  v_mfma_f32_16x16x32_bf16 v[160:163], a[16:19], v[36:39], v[160:163]
  ds_read_b64_tr_b16 a[44:45], v243 offset:35840
  s_add_u32 m0, s52, 114688
  s_add_u32 s62, s54, 4128768
  v_mfma_f32_16x16x32_bf16 v[164:167], a[16:19], v[108:111], v[164:167]
  ds_read_b64_tr_b16 a[46:47], v243 offset:44032
  ds_read_b64_tr_b16 a[0:1], v244 offset:0
  v_mfma_f32_16x16x32_bf16 v[168:171], a[20:23], v[36:39], v[168:171]
  buffer_load_dwordx4 v252, s[28:31], s62 offen  lds
  v_mfma_f32_16x16x32_bf16 v[172:175], a[20:23], v[108:111], v[172:175]
  ds_read_b64_tr_b16 a[2:3], v244 offset:8192
  v_mfma_f32_16x16x32_bf16 v[232:235], a[196:199], v[140:143], v[12:15]
  v_mfma_f32_16x16x32_bf16 v[176:179], a[24:27], v[36:39], v[176:179]
  ds_read_b64_tr_b16 a[4:5], v244 offset:1024
  v_mfma_f32_16x16x32_bf16 v[236:239], a[200:203], v[140:143], v[12:15]
  v_cvt_pk_bf16_f32 v136, v224, v225
  v_cvt_pk_bf16_f32 v137, v226, v227
  v_mfma_f32_16x16x32_bf16 v[180:183], a[24:27], v[108:111], v[180:183]
  ds_read_b64_tr_b16 a[6:7], v244 offset:9216
  ds_read_b64_tr_b16 a[8:9], v245 offset:0
  v_mfma_f32_16x16x32_bf16 v[184:187], a[28:31], v[36:39], v[184:187]
  buffer_load_dwordx4 v252, s[32:35], s62 offen offset:1024  lds
  v_mfma_f32_16x16x32_bf16 v[188:191], a[28:31], v[108:111], v[188:191]
  ds_read_b64_tr_b16 a[10:11], v245 offset:8192
  s_waitcnt lgkmcnt(6)
  v_mfma_f32_16x16x32_bf16 v[192:195], a[32:35], v[36:39], v[192:195]
  ds_read_b64_tr_b16 a[12:13], v245 offset:1024
  v_cvt_pk_bf16_f32 v138, v228, v229
  v_mfma_f32_16x16x32_bf16 v[196:199], a[32:35], v[108:111], v[196:199]
  ds_read_b64_tr_b16 a[14:15], v245 offset:9216
  ds_read_b64_tr_b16 a[16:17], v246 offset:0
  v_mfma_f32_16x16x32_bf16 v[200:203], a[36:39], v[36:39], v[200:203]
  buffer_load_dwordx4 v253, s[28:31], s62 offen offset:2048  lds
  v_mfma_f32_16x16x32_bf16 v[204:207], a[36:39], v[108:111], v[204:207]
  ds_read_b64_tr_b16 a[18:19], v246 offset:8192
  v_cvt_pk_bf16_f32 v139, v230, v231
  v_mfma_f32_16x16x32_bf16 v[208:211], a[40:43], v[36:39], v[208:211]
  ds_read_b64_tr_b16 a[20:21], v246 offset:1024
  v_mfma_f32_16x16x32_bf16 v[212:215], a[40:43], v[108:111], v[212:215]
  ds_read_b64_tr_b16 a[22:23], v246 offset:9216
  ds_read_b64_tr_b16 a[24:25], v247 offset:0
  v_mfma_f32_16x16x32_bf16 v[216:219], a[44:47], v[36:39], v[216:219]
  buffer_load_dwordx4 v253, s[32:35], s62 offen offset:3072  lds
  v_mfma_f32_16x16x32_bf16 v[220:223], a[44:47], v[108:111], v[220:223]
  ds_read_b64_tr_b16 a[26:27], v247 offset:8192
  s_waitcnt lgkmcnt(6)
  v_mfma_f32_16x16x32_bf16 v[160:163], a[0:3], v[40:43], v[160:163]
  ds_read_b64_tr_b16 a[28:29], v247 offset:1024
  s_add_u32 m0, s52, 131072
  s_add_u32 s62, s54, 4718592
  v_mfma_f32_16x16x32_bf16 v[224:227], a[196:199], v[144:147], v[12:15]
  v_mfma_f32_16x16x32_bf16 v[164:167], a[0:3], v[112:115], v[164:167]
  ds_read_b64_tr_b16 a[30:31], v247 offset:9216
  ds_read_b64_tr_b16 a[32:33], v244 offset:2048
  v_mfma_f32_16x16x32_bf16 v[168:171], a[4:7], v[40:43], v[168:171]
  buffer_load_dwordx4 v252, s[28:31], s62 offen  lds
  v_mfma_f32_16x16x32_bf16 v[228:231], a[200:203], v[144:147], v[12:15]
  v_cvt_pk_bf16_f32 v140, v232, v233
  v_cvt_pk_bf16_f32 v141, v234, v235
  v_mfma_f32_16x16x32_bf16 v[172:175], a[4:7], v[112:115], v[172:175]
  ds_read_b64_tr_b16 a[34:35], v244 offset:10240
  v_cvt_pk_bf16_f32 v142, v236, v237
  v_mfma_f32_16x16x32_bf16 v[176:179], a[8:11], v[40:43], v[176:179]
  ds_read_b64_tr_b16 a[36:37], v244 offset:3072
  v_cvt_pk_bf16_f32 v143, v238, v239
  v_mfma_f32_16x16x32_bf16 v[180:183], a[8:11], v[112:115], v[180:183]
  ds_read_b64_tr_b16 a[38:39], v244 offset:11264
  ds_read_b64_tr_b16 a[40:41], v245 offset:2048
  v_mfma_f32_16x16x32_bf16 v[184:187], a[12:15], v[40:43], v[184:187]
  buffer_load_dwordx4 v252, s[32:35], s62 offen offset:1024  lds
  v_mfma_f32_16x16x32_bf16 v[188:191], a[12:15], v[112:115], v[188:191]
  ds_read_b64_tr_b16 a[42:43], v245 offset:10240
  s_waitcnt lgkmcnt(6)
  v_mfma_f32_16x16x32_bf16 v[192:195], a[16:19], v[40:43], v[192:195]
  ds_read_b64_tr_b16 a[44:45], v245 offset:3072
  v_mfma_f32_16x16x32_bf16 v[196:199], a[16:19], v[112:115], v[196:199]
  ds_read_b64_tr_b16 a[46:47], v245 offset:11264
  ds_read_b64_tr_b16 a[0:1], v246 offset:2048
  v_mfma_f32_16x16x32_bf16 v[200:203], a[20:23], v[40:43], v[200:203]
  buffer_load_dwordx4 v253, s[28:31], s62 offen offset:2048  lds
  v_mfma_f32_16x16x32_bf16 v[204:207], a[20:23], v[112:115], v[204:207]
  ds_read_b64_tr_b16 a[2:3], v246 offset:10240
  v_mfma_f32_16x16x32_bf16 v[208:211], a[24:27], v[40:43], v[208:211]
  ds_read_b64_tr_b16 a[4:5], v246 offset:3072
  v_mfma_f32_16x16x32_bf16 v[212:215], a[24:27], v[112:115], v[212:215]
  ds_read_b64_tr_b16 a[6:7], v246 offset:11264
  s_waitcnt vmcnt(12)
  s_barrier
  v_mfma_f32_16x16x32_bf16 v[216:219], a[28:31], v[40:43], v[216:219]
  ds_read_b64_tr_b16 a[8:9], v247 offset:2048
  buffer_load_dwordx4 v253, s[32:35], s62 offen offset:3072  lds
  v_mfma_f32_16x16x32_bf16 v[232:235], a[196:199], v[148:151], v[12:15]
  v_mfma_f32_16x16x32_bf16 v[220:223], a[28:31], v[112:115], v[220:223]
  ds_read_b64_tr_b16 a[10:11], v247 offset:10240
  v_mfma_f32_16x16x32_bf16 v[236:239], a[200:203], v[148:151], v[12:15]
  s_add_u32 m0, s52, 0
  s_waitcnt lgkmcnt(6)
  v_mfma_f32_16x16x32_bf16 v[160:163], a[32:35], v[44:47], v[160:163]
  ds_read_b64_tr_b16 a[12:13], v247 offset:3072
  s_add_u32 s62, s54, 128
  v_mfma_f32_16x16x32_bf16 v[164:167], a[32:35], v[116:119], v[164:167]
  ds_read_b64_tr_b16 a[14:15], v247 offset:11264
  ds_read_b64_tr_b16 a[16:17], v244 offset:16384
  v_mfma_f32_16x16x32_bf16 v[168:171], a[36:39], v[44:47], v[168:171]
  buffer_load_dwordx4 v252, s[28:31], s62 offen  lds
  v_mfma_f32_16x16x32_bf16 v[172:175], a[36:39], v[116:119], v[172:175]
  ds_read_b64_tr_b16 a[18:19], v244 offset:24576
  v_cvt_pk_bf16_f32 v144, v224, v225
  v_mfma_f32_16x16x32_bf16 v[176:179], a[40:43], v[44:47], v[176:179]
  ds_read_b64_tr_b16 a[20:21], v244 offset:17408
  v_cvt_pk_bf16_f32 v145, v226, v227
  v_mfma_f32_16x16x32_bf16 v[180:183], a[40:43], v[116:119], v[180:183]
  ds_read_b64_tr_b16 a[22:23], v244 offset:25600
  ds_read_b64_tr_b16 a[24:25], v245 offset:16384
  v_mfma_f32_16x16x32_bf16 v[184:187], a[44:47], v[44:47], v[184:187]
  buffer_load_dwordx4 v252, s[32:35], s62 offen offset:1024  lds
  v_mfma_f32_16x16x32_bf16 v[188:191], a[44:47], v[116:119], v[188:191]
  ds_read_b64_tr_b16 a[26:27], v245 offset:24576
  s_waitcnt lgkmcnt(6)
  v_mfma_f32_16x16x32_bf16 v[192:195], a[0:3], v[44:47], v[192:195]
  ds_read_b64_tr_b16 a[28:29], v245 offset:17408
  v_accvgpr_read_b32 v255, a234
  v_mfma_f32_16x16x32_bf16 v[196:199], a[0:3], v[116:119], v[196:199]
  ds_read_b64_tr_b16 a[30:31], v245 offset:25600
  ds_read_b64_tr_b16 a[32:33], v246 offset:16384
  v_mfma_f32_16x16x32_bf16 v[200:203], a[4:7], v[44:47], v[200:203]
  ds_read_b64_tr_b16 a[34:35], v246 offset:24576
  buffer_load_dwordx4 v253, s[28:31], s62 offen offset:2048  lds
  v_mfma_f32_16x16x32_bf16 v[204:207], a[4:7], v[116:119], v[204:207]
  ds_read_b64_tr_b16 a[36:37], v246 offset:17408
  buffer_load_dwordx4 a[222:225], v255, s[24:27], 0 offen offset:0
  v_mfma_f32_16x16x32_bf16 v[208:211], a[8:11], v[44:47], v[208:211]
  buffer_load_dwordx4 a[226:229], v255, s[24:27], 0 offen offset:512
  v_mfma_f32_16x16x32_bf16 v[212:215], a[8:11], v[116:119], v[212:215]
  ds_read_b64_tr_b16 a[38:39], v246 offset:25600
  ds_read_b64_tr_b16 a[40:41], v247 offset:16384
  v_mfma_f32_16x16x32_bf16 v[216:219], a[12:15], v[44:47], v[216:219]
  buffer_load_dwordx4 v253, s[32:35], s62 offen offset:3072  lds
  v_mfma_f32_16x16x32_bf16 v[220:223], a[12:15], v[116:119], v[220:223]
  ds_read_b64_tr_b16 a[42:43], v247 offset:24576
  s_waitcnt lgkmcnt(6)
  v_mfma_f32_16x16x32_bf16 v[160:163], a[16:19], v[48:51], v[160:163]
  ds_read_b64_tr_b16 a[44:45], v247 offset:17408
  s_add_u32 m0, s52, 16384
  s_add_u32 s62, s54, 589952
  v_mfma_f32_16x16x32_bf16 v[164:167], a[16:19], v[120:123], v[164:167]
  ds_read_b64_tr_b16 a[46:47], v247 offset:25600
  ds_read_b64_tr_b16 a[0:1], v244 offset:18432
  v_mfma_f32_16x16x32_bf16 v[168:171], a[20:23], v[48:51], v[168:171]
  ds_read_b64_tr_b16 a[2:3], v244 offset:26624
  buffer_load_dwordx4 v252, s[28:31], s62 offen  lds
  v_mfma_f32_16x16x32_bf16 v[172:175], a[20:23], v[120:123], v[172:175]
  buffer_load_dwordx4 a[230:233], v255, s[24:27], 0 offen offset:1024
  v_mfma_f32_16x16x32_bf16 v[176:179], a[24:27], v[48:51], v[176:179]
  ds_read_b64_tr_b16 a[4:5], v244 offset:19456
  s_mov_b32 s24, s78
  v_mfma_f32_16x16x32_bf16 v[180:183], a[24:27], v[120:123], v[180:183]
  ds_read_b64_tr_b16 a[6:7], v244 offset:27648
  ds_read_b64_tr_b16 a[8:9], v245 offset:18432
  v_mfma_f32_16x16x32_bf16 v[184:187], a[28:31], v[48:51], v[184:187]
  buffer_load_dwordx4 v252, s[32:35], s62 offen offset:1024  lds
  v_mfma_f32_16x16x32_bf16 v[188:191], a[28:31], v[120:123], v[188:191]
  ds_read_b64_tr_b16 a[10:11], v245 offset:26624
  s_waitcnt lgkmcnt(6)
  v_mfma_f32_16x16x32_bf16 v[192:195], a[32:35], v[48:51], v[192:195]
  ds_read_b64_tr_b16 a[12:13], v245 offset:19456
  s_mov_b32 s25, s79
  v_mfma_f32_16x16x32_bf16 v[196:199], a[32:35], v[120:123], v[196:199]
  ds_read_b64_tr_b16 a[14:15], v245 offset:27648
  ds_read_b64_tr_b16 a[16:17], v246 offset:18432
  v_mfma_f32_16x16x32_bf16 v[200:203], a[36:39], v[48:51], v[200:203]
  buffer_load_dwordx4 v253, s[28:31], s62 offen offset:2048  lds
  v_mfma_f32_16x16x32_bf16 v[204:207], a[36:39], v[120:123], v[204:207]
  ds_read_b64_tr_b16 a[18:19], v246 offset:26624
  s_mov_b32 s26, 256
  v_mfma_f32_16x16x32_bf16 v[208:211], a[40:43], v[48:51], v[208:211]
  ds_read_b64_tr_b16 a[20:21], v246 offset:19456
  v_cvt_pk_bf16_f32 v146, v228, v229
  v_mfma_f32_16x16x32_bf16 v[212:215], a[40:43], v[120:123], v[212:215]
  ds_read_b64_tr_b16 a[22:23], v246 offset:27648
  ds_read_b64_tr_b16 a[24:25], v247 offset:18432
  v_mfma_f32_16x16x32_bf16 v[216:219], a[44:47], v[48:51], v[216:219]
  buffer_load_dwordx4 v253, s[32:35], s62 offen offset:3072  lds
  v_mfma_f32_16x16x32_bf16 v[220:223], a[44:47], v[120:123], v[220:223]
  ds_read_b64_tr_b16 a[26:27], v247 offset:26624
  s_waitcnt lgkmcnt(6)
  v_mfma_f32_16x16x32_bf16 v[160:163], a[0:3], v[52:55], v[160:163]
  ds_read_b64_tr_b16 a[28:29], v247 offset:19456
  s_add_u32 m0, s52, 32768
  s_add_u32 s62, s54, 1179776
  v_mfma_f32_16x16x32_bf16 v[164:167], a[0:3], v[124:127], v[164:167]
  ds_read_b64_tr_b16 a[30:31], v247 offset:27648
  ds_read_b64_tr_b16 a[32:33], v244 offset:32768
  v_mfma_f32_16x16x32_bf16 v[168:171], a[4:7], v[52:55], v[168:171]
  buffer_load_dwordx4 v252, s[28:31], s62 offen  lds
  v_mfma_f32_16x16x32_bf16 v[172:175], a[4:7], v[124:127], v[172:175]
  ds_read_b64_tr_b16 a[34:35], v244 offset:40960
  v_cvt_pk_bf16_f32 v147, v230, v231
  v_mfma_f32_16x16x32_bf16 v[224:227], a[196:199], v[152:155], v[12:15]
  v_mfma_f32_16x16x32_bf16 v[176:179], a[8:11], v[52:55], v[176:179]
  ds_read_b64_tr_b16 a[36:37], v244 offset:33792
  v_mfma_f32_16x16x32_bf16 v[228:231], a[200:203], v[152:155], v[12:15]
  v_cvt_pk_bf16_f32 v148, v232, v233
  v_cvt_pk_bf16_f32 v149, v234, v235
  v_mfma_f32_16x16x32_bf16 v[180:183], a[8:11], v[124:127], v[180:183]
  ds_read_b64_tr_b16 a[38:39], v244 offset:41984
  ds_read_b64_tr_b16 a[40:41], v245 offset:32768
  v_mfma_f32_16x16x32_bf16 v[184:187], a[12:15], v[52:55], v[184:187]
  buffer_load_dwordx4 v252, s[32:35], s62 offen offset:1024  lds
  v_mfma_f32_16x16x32_bf16 v[188:191], a[12:15], v[124:127], v[188:191]
  ds_read_b64_tr_b16 a[42:43], v245 offset:40960
  s_waitcnt lgkmcnt(6)
  v_mfma_f32_16x16x32_bf16 v[192:195], a[16:19], v[52:55], v[192:195]
  ds_read_b64_tr_b16 a[44:45], v245 offset:33792
  v_cvt_pk_bf16_f32 v150, v236, v237
  v_mfma_f32_16x16x32_bf16 v[196:199], a[16:19], v[124:127], v[196:199]
  ds_read_b64_tr_b16 a[46:47], v245 offset:41984
  ds_read_b64_tr_b16 a[0:1], v246 offset:32768
  v_mfma_f32_16x16x32_bf16 v[200:203], a[20:23], v[52:55], v[200:203]
  buffer_load_dwordx4 v253, s[28:31], s62 offen offset:2048  lds
  v_mfma_f32_16x16x32_bf16 v[204:207], a[20:23], v[124:127], v[204:207]
  ds_read_b64_tr_b16 a[2:3], v246 offset:40960
  v_cvt_pk_bf16_f32 v151, v238, v239
  v_mfma_f32_16x16x32_bf16 v[232:235], a[196:199], v[156:159], v[12:15]
  v_mfma_f32_16x16x32_bf16 v[208:211], a[24:27], v[52:55], v[208:211]
  ds_read_b64_tr_b16 a[4:5], v246 offset:33792
  v_mfma_f32_16x16x32_bf16 v[236:239], a[200:203], v[156:159], v[12:15]
  v_cvt_pk_bf16_f32 v152, v224, v225
  v_cvt_pk_bf16_f32 v153, v226, v227
  v_mfma_f32_16x16x32_bf16 v[212:215], a[24:27], v[124:127], v[212:215]
  ds_read_b64_tr_b16 a[6:7], v246 offset:41984
  ds_read_b64_tr_b16 a[8:9], v247 offset:32768
  v_mfma_f32_16x16x32_bf16 v[216:219], a[28:31], v[52:55], v[216:219]
  buffer_load_dwordx4 v253, s[32:35], s62 offen offset:3072  lds
  v_mfma_f32_16x16x32_bf16 v[220:223], a[28:31], v[124:127], v[220:223]
  ds_read_b64_tr_b16 a[10:11], v247 offset:40960
  s_waitcnt lgkmcnt(6)
  v_mfma_f32_16x16x32_bf16 v[160:163], a[32:35], v[56:59], v[160:163]
  ds_read_b64_tr_b16 a[12:13], v247 offset:33792
  s_add_u32 m0, s52, 49152
  v_mfma_f32_16x16x32_bf16 v[164:167], a[32:35], v[128:131], v[164:167]
  ds_read_b64_tr_b16 a[14:15], v247 offset:41984
  s_add_u32 s62, s54, 1769600
  v_mfma_f32_16x16x32_bf16 v[168:171], a[36:39], v[56:59], v[168:171]
  ds_read_b64_tr_b16 a[16:17], v244 offset:34816
  v_cvt_pk_bf16_f32 v154, v228, v229
  v_mfma_f32_16x16x32_bf16 v[172:175], a[36:39], v[128:131], v[172:175]
  ds_read_b64_tr_b16 a[18:19], v244 offset:43008
  v_cvt_pk_bf16_f32 v155, v230, v231
  v_mfma_f32_16x16x32_bf16 v[176:179], a[40:43], v[56:59], v[176:179]
  ds_read_b64_tr_b16 a[20:21], v244 offset:35840
  v_cvt_pk_bf16_f32 v156, v232, v233
  v_mfma_f32_16x16x32_bf16 v[180:183], a[40:43], v[128:131], v[180:183]
  ds_read_b64_tr_b16 a[22:23], v244 offset:44032
  ds_read_b64_tr_b16 a[24:25], v245 offset:34816
  v_mfma_f32_16x16x32_bf16 v[184:187], a[44:47], v[56:59], v[184:187]
  buffer_load_dwordx4 v252, s[28:31], s62 offen  lds
  v_mfma_f32_16x16x32_bf16 v[188:191], a[44:47], v[128:131], v[188:191]
  ds_read_b64_tr_b16 a[26:27], v245 offset:43008
  s_waitcnt lgkmcnt(6)
  v_mfma_f32_16x16x32_bf16 v[192:195], a[0:3], v[56:59], v[192:195]
  ds_read_b64_tr_b16 a[28:29], v245 offset:35840
  v_cvt_pk_bf16_f32 v157, v234, v235
  v_mfma_f32_16x16x32_bf16 v[196:199], a[0:3], v[128:131], v[196:199]
  ds_read_b64_tr_b16 a[30:31], v245 offset:44032
  v_cvt_pk_bf16_f32 v158, v236, v237
  v_mfma_f32_16x16x32_bf16 v[200:203], a[4:7], v[56:59], v[200:203]
  ds_read_b64_tr_b16 a[32:33], v246 offset:34816
  v_cvt_pk_bf16_f32 v159, v238, v239
  v_mfma_f32_16x16x32_bf16 v[204:207], a[4:7], v[128:131], v[204:207]
  ds_read_b64_tr_b16 a[34:35], v246 offset:43008
  s_cmp_lt_u32 s18, 2
  s_cbranch_scc1 K1_stat
K1_statback:
  v_mfma_f32_16x16x32_bf16 v[208:211], a[8:11], v[56:59], v[208:211]
  ds_read_b64_tr_b16 a[36:37], v246 offset:35840
  v_mfma_f32_16x16x32_bf16 v[212:215], a[8:11], v[128:131], v[212:215]
  ds_read_b64_tr_b16 a[38:39], v246 offset:44032
  s_waitcnt vmcnt(16)
  s_barrier
  v_mfma_f32_16x16x32_bf16 v[216:219], a[12:15], v[56:59], v[216:219]
  ds_read_b64_tr_b16 a[40:41], v247 offset:34816
  v_mfma_f32_16x16x32_bf16 v[220:223], a[12:15], v[128:131], v[220:223]
  ds_read_b64_tr_b16 a[42:43], v247 offset:43008
  s_waitcnt lgkmcnt(6)
  v_mfma_f32_16x16x32_bf16 v[160:163], a[16:19], v[60:63], v[160:163]
  ds_read_b64_tr_b16 a[44:45], v247 offset:35840
  v_mfma_f32_16x16x32_bf16 v[164:167], a[16:19], v[132:135], v[164:167]
  ds_read_b64_tr_b16 a[46:47], v247 offset:44032
  ds_read_b64_tr_b16 a[0:1], v248 offset:0
  v_mfma_f32_16x16x32_bf16 v[168:171], a[20:23], v[60:63], v[168:171]
  buffer_load_dwordx4 v252, s[32:35], s62 offen offset:1024  lds
  v_mfma_f32_16x16x32_bf16 v[172:175], a[20:23], v[132:135], v[172:175]
  ds_read_b64_tr_b16 a[2:3], v248 offset:8192
  v_mfma_f32_16x16x32_bf16 v[176:179], a[24:27], v[60:63], v[176:179]
  ds_read_b64_tr_b16 a[4:5], v248 offset:1024
  v_mfma_f32_16x16x32_bf16 v[180:183], a[24:27], v[132:135], v[180:183]
  ds_read_b64_tr_b16 a[6:7], v248 offset:9216
  ds_read_b64_tr_b16 a[8:9], v249 offset:0
  v_mfma_f32_16x16x32_bf16 v[184:187], a[28:31], v[60:63], v[184:187]
  buffer_load_dwordx4 v253, s[28:31], s62 offen offset:2048  lds
  v_mfma_f32_16x16x32_bf16 v[188:191], a[28:31], v[132:135], v[188:191]
  ds_read_b64_tr_b16 a[10:11], v249 offset:8192
  s_waitcnt lgkmcnt(6)
  v_mfma_f32_16x16x32_bf16 v[192:195], a[32:35], v[60:63], v[192:195]
  ds_read_b64_tr_b16 a[12:13], v249 offset:1024
  v_mfma_f32_16x16x32_bf16 v[196:199], a[32:35], v[132:135], v[196:199]
  ds_read_b64_tr_b16 a[14:15], v249 offset:9216
  v_mfma_f32_16x16x32_bf16 v[200:203], a[36:39], v[60:63], v[200:203]
  ds_read_b64_tr_b16 a[16:17], v250 offset:0
  v_mfma_f32_16x16x32_bf16 v[204:207], a[36:39], v[132:135], v[204:207]
  ds_read_b64_tr_b16 a[18:19], v250 offset:8192
  v_mfma_f32_16x16x32_bf16 v[208:211], a[40:43], v[60:63], v[208:211]
  ds_read_b64_tr_b16 a[20:21], v250 offset:1024
  v_mfma_f32_16x16x32_bf16 v[212:215], a[40:43], v[132:135], v[212:215]
  ds_read_b64_tr_b16 a[22:23], v250 offset:9216
  ds_read_b64_tr_b16 a[24:25], v251 offset:0
  v_mfma_f32_16x16x32_bf16 v[216:219], a[44:47], v[60:63], v[216:219]
  buffer_load_dwordx4 v253, s[32:35], s62 offen offset:3072  lds
  v_mfma_f32_16x16x32_bf16 v[220:223], a[44:47], v[132:135], v[220:223]
  ds_read_b64_tr_b16 a[26:27], v251 offset:8192
  s_waitcnt lgkmcnt(6)
  v_mfma_f32_16x16x32_bf16 v[160:163], a[0:3], v[64:67], v[160:163]
  ds_read_b64_tr_b16 a[28:29], v251 offset:1024
  s_add_u32 m0, s52, 65536
  v_mfma_f32_16x16x32_bf16 v[164:167], a[0:3], v[136:139], v[164:167]
  ds_read_b64_tr_b16 a[30:31], v251 offset:9216
  s_add_u32 s62, s54, 2359424
  v_mfma_f32_16x16x32_bf16 v[168:171], a[4:7], v[64:67], v[168:171]
  ds_read_b64_tr_b16 a[32:33], v248 offset:2048
  ds_read_b64_tr_b16 a[34:35], v248 offset:10240
  v_mfma_f32_16x16x32_bf16 v[172:175], a[4:7], v[136:139], v[172:175]
  buffer_load_dword v5, off, s[24:27], 0 sc1
  v_mfma_f32_16x16x32_bf16 v[176:179], a[8:11], v[64:67], v[176:179]
  ds_read_b64_tr_b16 a[36:37], v248 offset:3072
  v_mfma_f32_16x16x32_bf16 v[180:183], a[8:11], v[136:139], v[180:183]
  ds_read_b64_tr_b16 a[38:39], v248 offset:11264
  ds_read_b64_tr_b16 a[40:41], v249 offset:2048
  v_mfma_f32_16x16x32_bf16 v[184:187], a[12:15], v[64:67], v[184:187]
  buffer_load_dwordx4 v252, s[28:31], s62 offen  lds
  v_mfma_f32_16x16x32_bf16 v[188:191], a[12:15], v[136:139], v[188:191]
  ds_read_b64_tr_b16 a[42:43], v249 offset:10240
  s_waitcnt lgkmcnt(6)
  v_mfma_f32_16x16x32_bf16 v[192:195], a[16:19], v[64:67], v[192:195]
  ds_read_b64_tr_b16 a[44:45], v249 offset:3072
  v_mfma_f32_16x16x32_bf16 v[196:199], a[16:19], v[136:139], v[196:199]
  ds_read_b64_tr_b16 a[46:47], v249 offset:11264
  v_mfma_f32_16x16x32_bf16 v[200:203], a[20:23], v[64:67], v[200:203]
  ds_read_b64_tr_b16 a[0:1], v250 offset:2048
  v_mfma_f32_16x16x32_bf16 v[204:207], a[20:23], v[136:139], v[204:207]
  ds_read_b64_tr_b16 a[2:3], v250 offset:10240
  v_mfma_f32_16x16x32_bf16 v[208:211], a[24:27], v[64:67], v[208:211]
  ds_read_b64_tr_b16 a[4:5], v250 offset:3072
  v_mfma_f32_16x16x32_bf16 v[212:215], a[24:27], v[136:139], v[212:215]
  ds_read_b64_tr_b16 a[6:7], v250 offset:11264
  ds_read_b64_tr_b16 a[8:9], v251 offset:2048
  v_mfma_f32_16x16x32_bf16 v[216:219], a[28:31], v[64:67], v[216:219]
  buffer_load_dwordx4 v252, s[32:35], s62 offen offset:1024  lds
  v_mfma_f32_16x16x32_bf16 v[220:223], a[28:31], v[136:139], v[220:223]
  ds_read_b64_tr_b16 a[10:11], v251 offset:10240
  s_waitcnt lgkmcnt(6)
  v_mfma_f32_16x16x32_bf16 v[160:163], a[32:35], v[68:71], v[160:163]
  ds_read_b64_tr_b16 a[12:13], v251 offset:3072
  v_mfma_f32_16x16x32_bf16 v[164:167], a[32:35], v[140:143], v[164:167]
  ds_read_b64_tr_b16 a[14:15], v251 offset:11264
  v_mfma_f32_16x16x32_bf16 v[168:171], a[36:39], v[68:71], v[168:171]
  ds_read_b64_tr_b16 a[16:17], v248 offset:16384
  v_mfma_f32_16x16x32_bf16 v[172:175], a[36:39], v[140:143], v[172:175]
  ds_read_b64_tr_b16 a[18:19], v248 offset:24576
  v_mfma_f32_16x16x32_bf16 v[176:179], a[40:43], v[68:71], v[176:179]
  ds_read_b64_tr_b16 a[20:21], v248 offset:17408
  v_mfma_f32_16x16x32_bf16 v[180:183], a[40:43], v[140:143], v[180:183]
  ds_read_b64_tr_b16 a[22:23], v248 offset:25600
  ds_read_b64_tr_b16 a[24:25], v248 offset:18432
  v_mfma_f32_16x16x32_bf16 v[184:187], a[44:47], v[68:71], v[184:187]
  buffer_load_dwordx4 v253, s[28:31], s62 offen offset:2048  lds
  v_mfma_f32_16x16x32_bf16 v[188:191], a[44:47], v[140:143], v[188:191]
  ds_read_b64_tr_b16 a[26:27], v248 offset:26624
  s_waitcnt lgkmcnt(6)
  v_mfma_f32_16x16x32_bf16 v[192:195], a[0:3], v[68:71], v[192:195]
  ds_read_b64_tr_b16 a[28:29], v248 offset:19456
  v_mfma_f32_16x16x32_bf16 v[196:199], a[0:3], v[140:143], v[196:199]
  ds_read_b64_tr_b16 a[30:31], v248 offset:27648
  v_mfma_f32_16x16x32_bf16 v[200:203], a[4:7], v[68:71], v[200:203]
  ds_read_b64_tr_b16 a[32:33], v248 offset:32768
  v_mfma_f32_16x16x32_bf16 v[204:207], a[4:7], v[140:143], v[204:207]
  ds_read_b64_tr_b16 a[34:35], v248 offset:40960
  v_mfma_f32_16x16x32_bf16 v[208:211], a[8:11], v[68:71], v[208:211]
  ds_read_b64_tr_b16 a[36:37], v248 offset:33792
  v_mfma_f32_16x16x32_bf16 v[212:215], a[8:11], v[140:143], v[212:215]
  ds_read_b64_tr_b16 a[38:39], v248 offset:41984
  ds_read_b64_tr_b16 a[40:41], v248 offset:34816
  v_mfma_f32_16x16x32_bf16 v[216:219], a[12:15], v[68:71], v[216:219]
  buffer_load_dwordx4 v253, s[32:35], s62 offen offset:3072  lds
  v_mfma_f32_16x16x32_bf16 v[220:223], a[12:15], v[140:143], v[220:223]
  ds_read_b64_tr_b16 a[42:43], v248 offset:43008
  s_waitcnt lgkmcnt(6)
  v_mfma_f32_16x16x32_bf16 v[160:163], a[16:19], v[72:75], v[160:163]
  ds_read_b64_tr_b16 a[44:45], v248 offset:35840
  s_add_u32 m0, s52, 81920
  v_mfma_f32_16x16x32_bf16 v[164:167], a[16:19], v[144:147], v[164:167]
  ds_read_b64_tr_b16 a[46:47], v248 offset:44032
  s_add_u32 s62, s54, 2949248
  v_mfma_f32_16x16x32_bf16 v[168:171], a[20:23], v[72:75], v[168:171]
  ds_read_b64_tr_b16 a[0:1], v249 offset:16384
  v_mfma_f32_16x16x32_bf16 v[172:175], a[20:23], v[144:147], v[172:175]
  ds_read_b64_tr_b16 a[2:3], v249 offset:24576
  v_mfma_f32_16x16x32_bf16 v[160:163], a[24:27], v[76:79], v[160:163]
  ds_read_b64_tr_b16 a[4:5], v249 offset:17408
  v_mfma_f32_16x16x32_bf16 v[164:167], a[24:27], v[148:151], v[164:167]
  ds_read_b64_tr_b16 a[6:7], v249 offset:25600
  ds_read_b64_tr_b16 a[8:9], v249 offset:18432
  v_mfma_f32_16x16x32_bf16 v[168:171], a[28:31], v[76:79], v[168:171]
  buffer_load_dwordx4 v252, s[28:31], s62 offen  lds
  v_mfma_f32_16x16x32_bf16 v[172:175], a[28:31], v[148:151], v[172:175]
  ds_read_b64_tr_b16 a[10:11], v249 offset:26624
  s_waitcnt lgkmcnt(6)
  v_mfma_f32_16x16x32_bf16 v[160:163], a[32:35], v[80:83], v[160:163]
  ds_read_b64_tr_b16 a[12:13], v249 offset:19456
  v_mfma_f32_16x16x32_bf16 v[164:167], a[32:35], v[152:155], v[164:167]
  ds_read_b64_tr_b16 a[14:15], v249 offset:27648
  v_mfma_f32_16x16x32_bf16 v[168:171], a[36:39], v[80:83], v[168:171]
  ds_read_b64_tr_b16 a[16:17], v249 offset:32768
  v_mfma_f32_16x16x32_bf16 v[172:175], a[36:39], v[152:155], v[172:175]
  ds_read_b64_tr_b16 a[18:19], v249 offset:40960
  v_mfma_f32_16x16x32_bf16 v[160:163], a[40:43], v[84:87], v[160:163]
  ds_read_b64_tr_b16 a[20:21], v249 offset:33792
  v_mfma_f32_16x16x32_bf16 v[164:167], a[40:43], v[156:159], v[164:167]
  ds_read_b64_tr_b16 a[22:23], v249 offset:41984
  s_waitcnt vmcnt(14)
  s_barrier
  v_mfma_f32_16x16x32_bf16 v[168:171], a[44:47], v[84:87], v[168:171]
  ds_read_b64_tr_b16 a[24:25], v249 offset:34816
  v_mfma_f32_16x16x32_bf16 v[172:175], a[44:47], v[156:159], v[172:175]
  ds_read_b64_tr_b16 a[26:27], v249 offset:43008
  s_waitcnt lgkmcnt(6)
  v_mfma_f32_16x16x32_bf16 v[176:179], a[0:3], v[72:75], v[176:179]
  ds_read_b64_tr_b16 a[28:29], v249 offset:35840
  v_mfma_f32_16x16x32_bf16 v[180:183], a[0:3], v[144:147], v[180:183]
  ds_read_b64_tr_b16 a[30:31], v249 offset:44032
  ds_read_b64_tr_b16 a[32:33], v250 offset:16384
  v_mfma_f32_16x16x32_bf16 v[184:187], a[4:7], v[72:75], v[184:187]
  buffer_load_dwordx4 v252, s[32:35], s62 offen offset:1024  lds
  v_mfma_f32_16x16x32_bf16 v[188:191], a[4:7], v[144:147], v[188:191]
  ds_read_b64_tr_b16 a[34:35], v250 offset:24576
  v_mul_f32 v224, v160, v168
  v_mfma_f32_16x16x32_bf16 v[176:179], a[8:11], v[76:79], v[176:179]
  ds_read_b64_tr_b16 a[36:37], v250 offset:17408
  v_mul_f32 v225, v161, v169
  v_mfma_f32_16x16x32_bf16 v[180:183], a[8:11], v[148:151], v[180:183]
  ds_read_b64_tr_b16 a[38:39], v250 offset:25600
  ds_read_b64_tr_b16 a[40:41], v250 offset:18432
  v_mfma_f32_16x16x32_bf16 v[184:187], a[12:15], v[76:79], v[184:187]
  buffer_load_dwordx4 v253, s[28:31], s62 offen offset:2048  lds
  v_mfma_f32_16x16x32_bf16 v[188:191], a[12:15], v[148:151], v[188:191]
  ds_read_b64_tr_b16 a[42:43], v250 offset:26624
  s_waitcnt lgkmcnt(6)
  v_mfma_f32_16x16x32_bf16 v[176:179], a[16:19], v[80:83], v[176:179]
  ds_read_b64_tr_b16 a[44:45], v250 offset:19456
  v_mul_f32 v226, v162, v170
  v_mfma_f32_16x16x32_bf16 v[180:183], a[16:19], v[152:155], v[180:183]
  ds_read_b64_tr_b16 a[46:47], v250 offset:27648
  v_mul_f32 v227, v163, v171
  v_mfma_f32_16x16x32_bf16 v[184:187], a[20:23], v[80:83], v[184:187]
  ds_read_b64_tr_b16 a[0:1], v250 offset:32768
  v_mul_f32 v228, v164, v172
  v_mfma_f32_16x16x32_bf16 v[188:191], a[20:23], v[152:155], v[188:191]
  ds_read_b64_tr_b16 a[2:3], v250 offset:40960
  v_mul_f32 v229, v165, v173
  v_mfma_f32_16x16x32_bf16 v[176:179], a[24:27], v[84:87], v[176:179]
  ds_read_b64_tr_b16 a[4:5], v250 offset:33792
  v_mul_f32 v230, v166, v174
  v_mfma_f32_16x16x32_bf16 v[180:183], a[24:27], v[156:159], v[180:183]
  ds_read_b64_tr_b16 a[6:7], v250 offset:41984
  ds_read_b64_tr_b16 a[8:9], v250 offset:34816
  v_mfma_f32_16x16x32_bf16 v[184:187], a[28:31], v[84:87], v[184:187]
  buffer_load_dwordx4 v253, s[32:35], s62 offen offset:3072  lds
  v_mfma_f32_16x16x32_bf16 v[188:191], a[28:31], v[156:159], v[188:191]
  ds_read_b64_tr_b16 a[10:11], v250 offset:43008
  v_accvgpr_read_b32 v255, a211
  s_waitcnt lgkmcnt(6)
  v_mfma_f32_16x16x32_bf16 v[192:195], a[32:35], v[72:75], v[192:195]
  ds_read_b64_tr_b16 a[12:13], v250 offset:35840
  s_mov_b32 m0, s96
  v_mfma_f32_16x16x32_bf16 v[196:199], a[32:35], v[144:147], v[196:199]
  ds_read_b64_tr_b16 a[14:15], v250 offset:44032
  v_mul_f32 v231, v167, v175
  v_mfma_f32_16x16x32_bf16 v[200:203], a[36:39], v[72:75], v[200:203]
  ds_read_b64_tr_b16 a[16:17], v251 offset:16384
  v_cvt_pk_bf16_f32 v224, v224, v225
  v_mfma_f32_16x16x32_bf16 v[204:207], a[36:39], v[144:147], v[204:207]
  ds_read_b64_tr_b16 a[18:19], v251 offset:24576
  v_cvt_pk_bf16_f32 v226, v226, v227
  v_mfma_f32_16x16x32_bf16 v[192:195], a[40:43], v[76:79], v[192:195]
  ds_read_b64_tr_b16 a[20:21], v251 offset:17408
  buffer_load_dwordx4 v255, s[48:51], s70 offen  lds
  v_add_u32 v255, 4608, v255
  buffer_load_dwordx4 v255, s[84:87], s70 offen offset:1024  lds
  s_mov_b32 m0, 155648
  v_add_u32 v255, s71, v255
  buffer_load_dwordx4 v255, s[48:51], s70 offen  lds
  s_add_u32 m0, s52, 98304
  s_add_u32 s62, s54, 3539072
  v_mfma_f32_16x16x32_bf16 v[196:199], a[40:43], v[148:151], v[196:199]
  ds_read_b64_tr_b16 a[22:23], v251 offset:25600
  ds_read_b64_tr_b16 a[24:25], v251 offset:18432
  v_mfma_f32_16x16x32_bf16 v[200:203], a[44:47], v[76:79], v[200:203]
  buffer_load_dwordx4 v252, s[28:31], s62 offen  lds
  v_mfma_f32_16x16x32_bf16 v[204:207], a[44:47], v[148:151], v[204:207]
  ds_read_b64_tr_b16 a[26:27], v251 offset:26624
  s_waitcnt lgkmcnt(6)
  v_mfma_f32_16x16x32_bf16 v[192:195], a[0:3], v[80:83], v[192:195]
  ds_read_b64_tr_b16 a[28:29], v251 offset:19456
  s_add_u32 s66, s54, 384
  v_mfma_f32_16x16x32_bf16 v[196:199], a[0:3], v[152:155], v[196:199]
  ds_read_b64_tr_b16 a[30:31], v251 offset:27648
  v_cvt_pk_bf16_f32 v228, v228, v229
  v_mfma_f32_16x16x32_bf16 v[200:203], a[4:7], v[80:83], v[200:203]
  ds_read_b64_tr_b16 a[32:33], v251 offset:32768
  v_cvt_pk_bf16_f32 v230, v230, v231
  v_mfma_f32_16x16x32_bf16 v[204:207], a[4:7], v[152:155], v[204:207]
  ds_read_b64_tr_b16 a[34:35], v251 offset:40960
  v_accvgpr_write_b32 a48, v224
  v_mfma_f32_16x16x32_bf16 v[192:195], a[8:11], v[84:87], v[192:195]
  ds_read_b64_tr_b16 a[36:37], v251 offset:33792
  v_accvgpr_write_b32 a49, v226
  v_mfma_f32_16x16x32_bf16 v[196:199], a[8:11], v[156:159], v[196:199]
  ds_read_b64_tr_b16 a[38:39], v251 offset:41984
  ds_read_b64_tr_b16 a[40:41], v251 offset:34816
  v_mfma_f32_16x16x32_bf16 v[200:203], a[12:15], v[84:87], v[200:203]
  buffer_load_dwordx4 v252, s[32:35], s62 offen offset:1024  lds
  v_mfma_f32_16x16x32_bf16 v[204:207], a[12:15], v[156:159], v[204:207]
  ds_read_b64_tr_b16 a[42:43], v251 offset:43008
  s_waitcnt lgkmcnt(6)
  v_mfma_f32_16x16x32_bf16 v[208:211], a[16:19], v[72:75], v[208:211]
  ds_read_b64_tr_b16 a[44:45], v251 offset:35840
  buffer_load_dword a120, v254, s[40:43], s66 offen offset:3072
  v_mfma_f32_16x16x32_bf16 v[212:215], a[16:19], v[144:147], v[212:215]
  ds_read_b64_tr_b16 a[46:47], v251 offset:44032
  v_accvgpr_write_b32 a84, v228
  v_mfma_f32_16x16x32_bf16 v[216:219], a[20:23], v[72:75], v[216:219]
  ds_read_b64_tr_b16 a[0:1], v240 offset:0
  v_accvgpr_write_b32 a85, v230
  v_mfma_f32_16x16x32_bf16 v[220:223], a[20:23], v[144:147], v[220:223]
  ds_read_b64_tr_b16 a[2:3], v240 offset:8192
  v_mul_f32 v232, v176, v184
  v_mfma_f32_16x16x32_bf16 v[208:211], a[24:27], v[76:79], v[208:211]
  ds_read_b64_tr_b16 a[4:5], v240 offset:1024
  v_mul_f32 v233, v177, v185
  v_mfma_f32_16x16x32_bf16 v[212:215], a[24:27], v[148:151], v[212:215]
  ds_read_b64_tr_b16 a[6:7], v240 offset:9216
  ds_read_b64_tr_b16 a[8:9], v240 offset:2048
  v_mfma_f32_16x16x32_bf16 v[216:219], a[28:31], v[76:79], v[216:219]
  buffer_load_dwordx4 v253, s[28:31], s62 offen offset:2048  lds
  v_mfma_f32_16x16x32_bf16 v[220:223], a[28:31], v[148:151], v[220:223]
  ds_read_b64_tr_b16 a[10:11], v240 offset:10240
  s_waitcnt lgkmcnt(6)
  v_mfma_f32_16x16x32_bf16 v[208:211], a[32:35], v[80:83], v[208:211]
  ds_read_b64_tr_b16 a[12:13], v240 offset:3072
  v_mul_f32 v234, v178, v186
  v_mfma_f32_16x16x32_bf16 v[212:215], a[32:35], v[152:155], v[212:215]
  ds_read_b64_tr_b16 a[14:15], v240 offset:11264
  v_mul_f32 v235, v179, v187
  v_mfma_f32_16x16x32_bf16 v[216:219], a[36:39], v[80:83], v[216:219]
  ds_read_b64_tr_b16 a[16:17], v240 offset:16384
  v_mul_f32 v236, v180, v188
  v_mfma_f32_16x16x32_bf16 v[220:223], a[36:39], v[152:155], v[220:223]
  ds_read_b64_tr_b16 a[18:19], v240 offset:24576
  v_mul_f32 v237, v181, v189
  v_mfma_f32_16x16x32_bf16 v[208:211], a[40:43], v[84:87], v[208:211]
  ds_read_b64_tr_b16 a[20:21], v240 offset:17408
  v_mul_f32 v238, v182, v190
  v_mfma_f32_16x16x32_bf16 v[212:215], a[40:43], v[156:159], v[212:215]
  ds_read_b64_tr_b16 a[22:23], v240 offset:25600
  ds_read_b64_tr_b16 a[24:25], v240 offset:18432
  v_mfma_f32_16x16x32_bf16 v[216:219], a[44:47], v[84:87], v[216:219]
  buffer_load_dwordx4 v253, s[32:35], s62 offen offset:3072  lds
  v_mfma_f32_16x16x32_bf16 v[220:223], a[44:47], v[156:159], v[220:223]
  ds_read_b64_tr_b16 a[26:27], v240 offset:26624
  s_waitcnt lgkmcnt(6)
  v_mfma_f32_16x16x32_bf16 v[160:163], a[0:3], v[16:19], 0
  ds_read_b64_tr_b16 a[28:29], v240 offset:19456
  v_mul_f32 v239, v183, v191
  v_mfma_f32_16x16x32_bf16 v[164:167], a[0:3], v[88:91], 0
  ds_read_b64_tr_b16 a[30:31], v240 offset:27648
  v_cvt_pk_bf16_f32 v232, v232, v233
  v_mfma_f32_16x16x32_bf16 v[168:171], a[4:7], v[16:19], 0
  ds_read_b64_tr_b16 a[32:33], v241 offset:0
  v_cvt_pk_bf16_f32 v234, v234, v235
  v_mfma_f32_16x16x32_bf16 v[172:175], a[4:7], v[88:91], 0
  ds_read_b64_tr_b16 a[34:35], v241 offset:8192
  v_cvt_pk_bf16_f32 v236, v236, v237
  v_mfma_f32_16x16x32_bf16 v[160:163], a[8:11], v[20:23], v[160:163]
  ds_read_b64_tr_b16 a[36:37], v241 offset:1024
  v_cvt_pk_bf16_f32 v238, v238, v239
  v_mfma_f32_16x16x32_bf16 v[164:167], a[8:11], v[92:95], v[164:167]
  ds_read_b64_tr_b16 a[38:39], v241 offset:9216
  v_accvgpr_write_b32 a50, v232
  v_mfma_f32_16x16x32_bf16 v[168:171], a[12:15], v[20:23], v[168:171]
  ds_read_b64_tr_b16 a[40:41], v241 offset:2048
  v_accvgpr_write_b32 a51, v234
  v_mfma_f32_16x16x32_bf16 v[172:175], a[12:15], v[92:95], v[172:175]
  ds_read_b64_tr_b16 a[42:43], v241 offset:10240
  s_waitcnt lgkmcnt(6)
  v_mfma_f32_16x16x32_bf16 v[160:163], a[16:19], v[24:27], v[160:163]
  ds_read_b64_tr_b16 a[44:45], v241 offset:3072
  v_accvgpr_write_b32 a86, v236
  v_mfma_f32_16x16x32_bf16 v[164:167], a[16:19], v[96:99], v[164:167]
  ds_read_b64_tr_b16 a[46:47], v241 offset:11264
  v_accvgpr_write_b32 a87, v238
  v_mfma_f32_16x16x32_bf16 v[168:171], a[20:23], v[24:27], v[168:171]
  ds_read_b64_tr_b16 a[0:1], v241 offset:16384
  v_mul_f32 v224, v192, v200
  v_mfma_f32_16x16x32_bf16 v[172:175], a[20:23], v[96:99], v[172:175]
  ds_read_b64_tr_b16 a[2:3], v241 offset:24576
  v_mul_f32 v225, v193, v201
  v_mfma_f32_16x16x32_bf16 v[160:163], a[24:27], v[28:31], v[160:163]
  ds_read_b64_tr_b16 a[4:5], v241 offset:17408
  v_mul_f32 v226, v194, v202
  v_mfma_f32_16x16x32_bf16 v[164:167], a[24:27], v[100:103], v[164:167]
  ds_read_b64_tr_b16 a[6:7], v241 offset:25600
  s_waitcnt vmcnt(21)
  s_barrier
  v_mfma_f32_16x16x32_bf16 v[168:171], a[28:31], v[28:31], v[168:171]
  ds_read_b64_tr_b16 a[8:9], v241 offset:18432
  s_add_u32 m0, s52, 114688
  v_mfma_f32_16x16x32_bf16 v[172:175], a[28:31], v[100:103], v[172:175]
  ds_read_b64_tr_b16 a[10:11], v241 offset:26624
  s_waitcnt lgkmcnt(6)
  v_mfma_f32_16x16x32_bf16 v[176:179], a[32:35], v[16:19], 0
  ds_read_b64_tr_b16 a[12:13], v241 offset:19456
  s_add_u32 s62, s54, 4128896
  v_mfma_f32_16x16x32_bf16 v[180:183], a[32:35], v[88:91], 0
  ds_read_b64_tr_b16 a[14:15], v241 offset:27648
  ds_read_b64_tr_b16 a[16:17], v242 offset:0
  v_mfma_f32_16x16x32_bf16 v[184:187], a[36:39], v[16:19], 0
  buffer_load_dwordx4 v252, s[28:31], s62 offen  lds
  v_mfma_f32_16x16x32_bf16 v[188:191], a[36:39], v[88:91], 0
  ds_read_b64_tr_b16 a[18:19], v242 offset:8192
  v_mul_f32 v227, v195, v203
  v_mfma_f32_16x16x32_bf16 v[176:179], a[40:43], v[20:23], v[176:179]
  ds_read_b64_tr_b16 a[20:21], v242 offset:1024
  v_mul_f32 v228, v196, v204
  v_mfma_f32_16x16x32_bf16 v[180:183], a[40:43], v[92:95], v[180:183]
  ds_read_b64_tr_b16 a[22:23], v242 offset:9216
  ds_read_b64_tr_b16 a[24:25], v242 offset:2048
  v_mfma_f32_16x16x32_bf16 v[184:187], a[44:47], v[20:23], v[184:187]
  buffer_load_dwordx4 v252, s[32:35], s62 offen offset:1024  lds
  v_mfma_f32_16x16x32_bf16 v[188:191], a[44:47], v[92:95], v[188:191]
  ds_read_b64_tr_b16 a[26:27], v242 offset:10240
  s_waitcnt lgkmcnt(6)
  v_mfma_f32_16x16x32_bf16 v[176:179], a[0:3], v[24:27], v[176:179]
  ds_read_b64_tr_b16 a[28:29], v242 offset:3072
  v_mul_f32 v229, v197, v205
  v_mfma_f32_16x16x32_bf16 v[180:183], a[0:3], v[96:99], v[180:183]
  ds_read_b64_tr_b16 a[30:31], v242 offset:11264
  ds_read_b64_tr_b16 a[32:33], v242 offset:16384
  v_mfma_f32_16x16x32_bf16 v[184:187], a[4:7], v[24:27], v[184:187]
  buffer_load_dwordx4 v253, s[28:31], s62 offen offset:2048  lds
  v_mfma_f32_16x16x32_bf16 v[188:191], a[4:7], v[96:99], v[188:191]
  ds_read_b64_tr_b16 a[34:35], v242 offset:24576
  v_mul_f32 v230, v198, v206
  v_mfma_f32_16x16x32_bf16 v[176:179], a[8:11], v[28:31], v[176:179]
  ds_read_b64_tr_b16 a[36:37], v242 offset:17408
  v_mul_f32 v231, v199, v207
  v_mfma_f32_16x16x32_bf16 v[180:183], a[8:11], v[100:103], v[180:183]
  ds_read_b64_tr_b16 a[38:39], v242 offset:25600
  ds_read_b64_tr_b16 a[40:41], v242 offset:18432
  v_mfma_f32_16x16x32_bf16 v[184:187], a[12:15], v[28:31], v[184:187]
  buffer_load_dwordx4 v253, s[32:35], s62 offen offset:3072  lds
  v_mfma_f32_16x16x32_bf16 v[188:191], a[12:15], v[100:103], v[188:191]
  ds_read_b64_tr_b16 a[42:43], v242 offset:26624
  s_waitcnt lgkmcnt(6)
  v_mfma_f32_16x16x32_bf16 v[192:195], a[16:19], v[16:19], 0
  ds_read_b64_tr_b16 a[44:45], v242 offset:19456
  v_cvt_pk_bf16_f32 v224, v224, v225
  v_mfma_f32_16x16x32_bf16 v[196:199], a[16:19], v[88:91], 0
  ds_read_b64_tr_b16 a[46:47], v242 offset:27648
  v_cvt_pk_bf16_f32 v226, v226, v227
  v_mfma_f32_16x16x32_bf16 v[200:203], a[20:23], v[16:19], 0
  ds_read_b64_tr_b16 a[0:1], v243 offset:0
  v_cvt_pk_bf16_f32 v228, v228, v229
  v_mfma_f32_16x16x32_bf16 v[204:207], a[20:23], v[88:91], 0
  ds_read_b64_tr_b16 a[2:3], v243 offset:8192
  v_cvt_pk_bf16_f32 v230, v230, v231
  v_mfma_f32_16x16x32_bf16 v[192:195], a[24:27], v[20:23], v[192:195]
  ds_read_b64_tr_b16 a[4:5], v243 offset:1024
  s_add_u32 m0, s52, 131072
  s_add_u32 s62, s54, 4718720
  v_mfma_f32_16x16x32_bf16 v[196:199], a[24:27], v[92:95], v[196:199]
  ds_read_b64_tr_b16 a[6:7], v243 offset:9216
  v_accvgpr_write_b32 a52, v224
  v_mfma_f32_16x16x32_bf16 v[200:203], a[28:31], v[20:23], v[200:203]
  ds_read_b64_tr_b16 a[8:9], v243 offset:2048
  buffer_load_dwordx4 v252, s[28:31], s62 offen  lds
  v_mfma_f32_16x16x32_bf16 v[204:207], a[28:31], v[92:95], v[204:207]
  ds_read_b64_tr_b16 a[10:11], v243 offset:10240
  v_accvgpr_write_b32 a53, v226
  s_waitcnt lgkmcnt(6)
  v_mfma_f32_16x16x32_bf16 v[192:195], a[32:35], v[24:27], v[192:195]
  ds_read_b64_tr_b16 a[12:13], v243 offset:3072
  v_accvgpr_write_b32 a88, v228
  v_accvgpr_write_b32 a89, v230
  v_mfma_f32_16x16x32_bf16 v[196:199], a[32:35], v[96:99], v[196:199]
  ds_read_b64_tr_b16 a[14:15], v243 offset:11264
  v_mul_f32 v232, v208, v216
  v_mul_f32 v233, v209, v217
  v_mfma_f32_16x16x32_bf16 v[200:203], a[36:39], v[24:27], v[200:203]
  ds_read_b64_tr_b16 a[16:17], v243 offset:16384
  v_mul_f32 v234, v210, v218
  v_mfma_f32_16x16x32_bf16 v[204:207], a[36:39], v[96:99], v[204:207]
  ds_read_b64_tr_b16 a[18:19], v243 offset:24576
  v_mul_f32 v235, v211, v219
  v_mfma_f32_16x16x32_bf16 v[192:195], a[40:43], v[28:31], v[192:195]
  ds_read_b64_tr_b16 a[20:21], v243 offset:17408
  s_add_u32 s68, s88, 0
  v_mul_f32 v236, v212, v220
  v_mfma_f32_16x16x32_bf16 v[196:199], a[40:43], v[100:103], v[196:199]
  ds_read_b64_tr_b16 a[22:23], v243 offset:25600
  v_mul_f32 v237, v213, v221
  v_mfma_f32_16x16x32_bf16 v[200:203], a[44:47], v[28:31], v[200:203]
  ds_read_b64_tr_b16 a[24:25], v243 offset:18432
  buffer_load_dwordx4 v252, s[32:35], s62 offen offset:1024  lds
  v_mul_f32 v238, v214, v222
  v_mul_f32 v239, v215, v223
  v_mfma_f32_16x16x32_bf16 v[204:207], a[44:47], v[100:103], v[204:207]
  ds_read_b64_tr_b16 a[26:27], v243 offset:26624
  s_waitcnt lgkmcnt(6)
  v_mfma_f32_16x16x32_bf16 v[208:211], a[0:3], v[16:19], 0
  ds_read_b64_tr_b16 a[28:29], v243 offset:19456
  v_cvt_pk_bf16_f32 v232, v232, v233
  v_mfma_f32_16x16x32_bf16 v[212:215], a[0:3], v[88:91], 0
  ds_read_b64_tr_b16 a[30:31], v243 offset:27648
  v_cvt_pk_bf16_f32 v234, v234, v235
  v_mfma_f32_16x16x32_bf16 v[216:219], a[4:7], v[16:19], 0
  ds_read_b64_tr_b16 a[32:33], v240 offset:32768
  v_cvt_pk_bf16_f32 v236, v236, v237
  v_mfma_f32_16x16x32_bf16 v[220:223], a[4:7], v[88:91], 0
  ds_read_b64_tr_b16 a[34:35], v240 offset:40960
  v_cvt_pk_bf16_f32 v238, v238, v239
  v_mfma_f32_16x16x32_bf16 v[208:211], a[8:11], v[20:23], v[208:211]
  ds_read_b64_tr_b16 a[36:37], v240 offset:33792
  v_accvgpr_write_b32 a54, v232
  v_mfma_f32_16x16x32_bf16 v[212:215], a[8:11], v[92:95], v[212:215]
  ds_read_b64_tr_b16 a[38:39], v240 offset:41984
  ds_read_b64_tr_b16 a[40:41], v241 offset:32768
  v_mfma_f32_16x16x32_bf16 v[216:219], a[12:15], v[20:23], v[216:219]
  buffer_load_dwordx4 v253, s[28:31], s62 offen offset:2048  lds
  buffer_store_dwordx4 a[48:51], v3, s[44:47], s68 offen offset:0 sc1
  buffer_store_dwordx4 a[84:87], v3, s[44:47], s68 offen offset:1024 sc1
  v_mfma_f32_16x16x32_bf16 v[220:223], a[12:15], v[92:95], v[220:223]
  ds_read_b64_tr_b16 a[42:43], v241 offset:40960
  s_waitcnt lgkmcnt(6)
  v_mfma_f32_16x16x32_bf16 v[208:211], a[16:19], v[24:27], v[208:211]
  ds_read_b64_tr_b16 a[44:45], v241 offset:33792
  v_accvgpr_write_b32 a55, v234
  v_mfma_f32_16x16x32_bf16 v[212:215], a[16:19], v[96:99], v[212:215]
  ds_read_b64_tr_b16 a[46:47], v241 offset:41984
  v_accvgpr_write_b32 a90, v236
  v_mfma_f32_16x16x32_bf16 v[216:219], a[20:23], v[24:27], v[216:219]
  ds_read_b64_tr_b16 a[0:1], v242 offset:32768
  v_accvgpr_write_b32 a91, v238
  v_mfma_f32_16x16x32_bf16 v[220:223], a[20:23], v[96:99], v[220:223]
  ds_read_b64_tr_b16 a[2:3], v242 offset:40960
  v_mfma_f32_16x16x32_bf16 v[208:211], a[24:27], v[28:31], v[208:211]
  ds_read_b64_tr_b16 a[4:5], v242 offset:33792
  v_mfma_f32_16x16x32_bf16 v[212:215], a[24:27], v[100:103], v[212:215]
  ds_read_b64_tr_b16 a[6:7], v242 offset:41984
  ds_read_b64_tr_b16 a[8:9], v243 offset:32768
  v_mfma_f32_16x16x32_bf16 v[216:219], a[28:31], v[28:31], v[216:219]
  buffer_load_dwordx4 v253, s[32:35], s62 offen offset:3072  lds
  v_mfma_f32_16x16x32_bf16 v[220:223], a[28:31], v[100:103], v[220:223]
  ds_read_b64_tr_b16 a[10:11], v243 offset:40960
  s_waitcnt lgkmcnt(6)
  v_mfma_f32_16x16x32_bf16 v[160:163], a[32:35], v[32:35], v[160:163]
  ds_read_b64_tr_b16 a[12:13], v243 offset:33792
  v_mfma_f32_16x16x32_bf16 v[164:167], a[32:35], v[104:107], v[164:167]
  ds_read_b64_tr_b16 a[14:15], v243 offset:41984
  v_mfma_f32_16x16x32_bf16 v[168:171], a[36:39], v[32:35], v[168:171]
  ds_read_b64_tr_b16 a[16:17], v240 offset:34816
  v_mfma_f32_16x16x32_bf16 v[172:175], a[36:39], v[104:107], v[172:175]
  ds_read_b64_tr_b16 a[18:19], v240 offset:43008
  v_mfma_f32_16x16x32_bf16 v[176:179], a[40:43], v[32:35], v[176:179]
  ds_read_b64_tr_b16 a[20:21], v240 offset:35840
  v_mfma_f32_16x16x32_bf16 v[180:183], a[40:43], v[104:107], v[180:183]
  ds_read_b64_tr_b16 a[22:23], v240 offset:44032
  v_mfma_f32_16x16x32_bf16 v[184:187], a[44:47], v[32:35], v[184:187]
  ds_read_b64_tr_b16 a[24:25], v241 offset:34816
  v_mfma_f32_16x16x32_bf16 v[188:191], a[44:47], v[104:107], v[188:191]
  ds_read_b64_tr_b16 a[26:27], v241 offset:43008
  s_waitcnt lgkmcnt(6)
  v_mfma_f32_16x16x32_bf16 v[192:195], a[0:3], v[32:35], v[192:195]
  ds_read_b64_tr_b16 a[28:29], v241 offset:35840
  v_mfma_f32_16x16x32_bf16 v[196:199], a[0:3], v[104:107], v[196:199]
  ds_read_b64_tr_b16 a[30:31], v241 offset:44032
  v_mfma_f32_16x16x32_bf16 v[200:203], a[4:7], v[32:35], v[200:203]
  ds_read_b64_tr_b16 a[32:33], v242 offset:34816
  v_mfma_f32_16x16x32_bf16 v[204:207], a[4:7], v[104:107], v[204:207]
  ds_read_b64_tr_b16 a[34:35], v242 offset:43008
  v_mfma_f32_16x16x32_bf16 v[208:211], a[8:11], v[32:35], v[208:211]
  ds_read_b64_tr_b16 a[36:37], v242 offset:35840
  v_mfma_f32_16x16x32_bf16 v[212:215], a[8:11], v[104:107], v[212:215]
  ds_read_b64_tr_b16 a[38:39], v242 offset:44032
  s_waitcnt vmcnt(15)
  s_barrier
  v_mfma_f32_16x16x32_bf16 v[216:219], a[12:15], v[32:35], v[216:219]
  ds_read_b64_tr_b16 a[40:41], v243 offset:34816
  s_add_u32 m0, s52, 0
  v_mfma_f32_16x16x32_bf16 v[220:223], a[12:15], v[104:107], v[220:223]
  ds_read_b64_tr_b16 a[42:43], v243 offset:43008
  s_waitcnt lgkmcnt(6)
  v_mfma_f32_16x16x32_bf16 v[160:163], a[16:19], v[36:39], v[160:163]
  ds_read_b64_tr_b16 a[44:45], v243 offset:35840
  s_add_u32 s62, s54, 256
  v_mfma_f32_16x16x32_bf16 v[164:167], a[16:19], v[108:111], v[164:167]
  ds_read_b64_tr_b16 a[46:47], v243 offset:44032
  ds_read_b64_tr_b16 a[0:1], v244 offset:0
  v_mfma_f32_16x16x32_bf16 v[168:171], a[20:23], v[36:39], v[168:171]
  ds_read_b64_tr_b16 a[2:3], v244 offset:8192
  buffer_load_dwordx4 v252, s[28:31], s62 offen  lds
  v_mfma_f32_16x16x32_bf16 v[172:175], a[20:23], v[108:111], v[172:175]
  buffer_store_dwordx4 a[52:55], v3, s[44:47], s68 offen offset:2048 sc1
  v_mfma_f32_16x16x32_bf16 v[176:179], a[24:27], v[36:39], v[176:179]
  ds_read_b64_tr_b16 a[4:5], v244 offset:1024
  v_accvgpr_read_b32 v8, a212
  v_mfma_f32_16x16x32_bf16 v[180:183], a[24:27], v[108:111], v[180:183]
  ds_read_b64_tr_b16 a[6:7], v244 offset:9216
  ds_read_b64_tr_b16 a[8:9], v245 offset:0
  v_mfma_f32_16x16x32_bf16 v[184:187], a[28:31], v[36:39], v[184:187]
  buffer_load_dwordx4 v252, s[32:35], s62 offen offset:1024  lds
  v_mfma_f32_16x16x32_bf16 v[188:191], a[28:31], v[108:111], v[188:191]
  ds_read_b64_tr_b16 a[10:11], v245 offset:8192
  s_waitcnt lgkmcnt(6)
  v_mfma_f32_16x16x32_bf16 v[192:195], a[32:35], v[36:39], v[192:195]
  ds_read_b64_tr_b16 a[12:13], v245 offset:1024
  ds_read_b64_tr_b16 v[10:11], v8 offset:0
  v_mfma_f32_16x16x32_bf16 v[196:199], a[32:35], v[108:111], v[196:199]
  ds_read_b64_tr_b16 a[14:15], v245 offset:9216
  ds_read_b64_tr_b16 a[16:17], v246 offset:0
  v_mfma_f32_16x16x32_bf16 v[200:203], a[36:39], v[36:39], v[200:203]
  buffer_load_dwordx4 v253, s[28:31], s62 offen offset:2048  lds
  v_mfma_f32_16x16x32_bf16 v[204:207], a[36:39], v[108:111], v[204:207]
  ds_read_b64_tr_b16 a[18:19], v246 offset:8192
  ds_read_b64_tr_b16 v[12:13], v8 offset:512
  v_mfma_f32_16x16x32_bf16 v[208:211], a[40:43], v[36:39], v[208:211]
  ds_read_b64_tr_b16 a[20:21], v246 offset:1024
  ds_read_b64_tr_b16 v[14:15], v8 offset:2048
  v_mfma_f32_16x16x32_bf16 v[212:215], a[40:43], v[108:111], v[212:215]
  ds_read_b64_tr_b16 a[22:23], v246 offset:9216
  ds_read_b64_tr_b16 a[24:25], v247 offset:0
  v_mfma_f32_16x16x32_bf16 v[216:219], a[44:47], v[36:39], v[216:219]
  buffer_load_dwordx4 v253, s[32:35], s62 offen offset:3072  lds
  v_mfma_f32_16x16x32_bf16 v[220:223], a[44:47], v[108:111], v[220:223]
  ds_read_b64_tr_b16 a[26:27], v247 offset:8192
  s_waitcnt lgkmcnt(8)
  v_mfma_f32_16x16x32_bf16 v[160:163], a[0:3], v[40:43], v[160:163]
  ds_read_b64_tr_b16 a[28:29], v247 offset:1024
  s_add_u32 m0, s52, 16384
  v_mfma_f32_16x16x32_bf16 v[164:167], a[0:3], v[112:115], v[164:167]
  ds_read_b64_tr_b16 a[30:31], v247 offset:9216
  s_add_u32 s62, s54, 590080
  v_mfma_f32_16x16x32_bf16 v[168:171], a[4:7], v[40:43], v[168:171]
  ds_read_b64_tr_b16 a[32:33], v244 offset:2048
  ds_read_b64_tr_b16 v[224:225], v8 offset:1024
  v_mfma_f32_16x16x32_bf16 v[172:175], a[4:7], v[112:115], v[172:175]
  ds_read_b64_tr_b16 a[34:35], v244 offset:10240
  ds_read_b64_tr_b16 v[226:227], v8 offset:1536
  v_mfma_f32_16x16x32_bf16 v[176:179], a[8:11], v[40:43], v[176:179]
  ds_read_b64_tr_b16 a[36:37], v244 offset:3072
  v_accvgpr_read_b32 v228, a216
  v_mfma_f32_16x16x32_bf16 v[180:183], a[8:11], v[112:115], v[180:183]
  ds_read_b64_tr_b16 a[38:39], v244 offset:11264
  ds_read_b64_tr_b16 a[40:41], v245 offset:2048
  v_mfma_f32_16x16x32_bf16 v[184:187], a[12:15], v[40:43], v[184:187]
  buffer_load_dwordx4 v252, s[28:31], s62 offen  lds
  v_mfma_f32_16x16x32_bf16 v[188:191], a[12:15], v[112:115], v[188:191]
  ds_read_b64_tr_b16 a[42:43], v245 offset:10240
  s_waitcnt lgkmcnt(8)
  v_mfma_f32_16x16x32_bf16 v[192:195], a[16:19], v[40:43], v[192:195]
  ds_read_b64_tr_b16 a[44:45], v245 offset:3072
  v_accvgpr_read_b32 v229, a217
  v_mfma_f32_16x16x32_bf16 v[196:199], a[16:19], v[112:115], v[196:199]
  ds_read_b64_tr_b16 a[46:47], v245 offset:11264
  v_lshlrev_b32 v230, 16, v228
  v_mfma_f32_16x16x32_bf16 v[200:203], a[20:23], v[40:43], v[200:203]
  ds_read_b64_tr_b16 a[0:1], v246 offset:2048
  v_and_b32 v231, 0xffff0000, v228
  v_mfma_f32_16x16x32_bf16 v[204:207], a[20:23], v[112:115], v[204:207]
  ds_read_b64_tr_b16 a[2:3], v246 offset:10240
  v_lshlrev_b32 v232, 16, v229
  v_mfma_f32_16x16x32_bf16 v[208:211], a[24:27], v[40:43], v[208:211]
  ds_read_b64_tr_b16 a[4:5], v246 offset:3072
  v_and_b32 v233, 0xffff0000, v229
  v_mfma_f32_16x16x32_bf16 v[212:215], a[24:27], v[112:115], v[212:215]
  ds_read_b64_tr_b16 a[6:7], v246 offset:11264
  ds_read_b64_tr_b16 a[8:9], v247 offset:2048
  v_mfma_f32_16x16x32_bf16 v[216:219], a[28:31], v[40:43], v[216:219]
  buffer_load_dwordx4 v252, s[32:35], s62 offen offset:1024  lds
  v_mfma_f32_16x16x32_bf16 v[220:223], a[28:31], v[112:115], v[220:223]
  ds_read_b64_tr_b16 a[10:11], v247 offset:10240
  s_waitcnt lgkmcnt(6)
  v_mfma_f32_16x16x32_bf16 v[160:163], a[32:35], v[44:47], v[160:163]
  ds_read_b64_tr_b16 a[12:13], v247 offset:3072
  v_readfirstlane_b32 s78, v5
  v_mfma_f32_16x16x32_bf16 v[164:167], a[32:35], v[116:119], v[164:167]
  ds_read_b64_tr_b16 a[14:15], v247 offset:11264
  s_cmp_eq_u32 s78, 0
  s_cbranch_scc1 K1_slowN
K1_backN:
  v_mfma_f32_16x16x32_bf16 v[168:171], a[36:39], v[44:47], v[168:171]
  ds_read_b64_tr_b16 a[16:17], v244 offset:16384
  v_mfma_f32_16x16x32_bf16 v[172:175], a[36:39], v[116:119], v[172:175]
  ds_read_b64_tr_b16 a[18:19], v244 offset:24576
  v_and_b32 v235, 0xffff0000, v10
  v_mfma_f32_16x16x32_bf16 v[176:179], a[40:43], v[44:47], v[176:179]
  ds_read_b64_tr_b16 a[20:21], v244 offset:17408
  v_lshlrev_b32 v236, 16, v11
  v_mfma_f32_16x16x32_bf16 v[180:183], a[40:43], v[116:119], v[180:183]
  ds_read_b64_tr_b16 a[22:23], v244 offset:25600
  ds_read_b64_tr_b16 a[24:25], v245 offset:16384
  v_mfma_f32_16x16x32_bf16 v[184:187], a[44:47], v[44:47], v[184:187]
  buffer_load_dwordx4 v253, s[28:31], s62 offen offset:2048  lds
  v_mfma_f32_16x16x32_bf16 v[188:191], a[44:47], v[116:119], v[188:191]
  ds_read_b64_tr_b16 a[26:27], v245 offset:24576
  s_waitcnt lgkmcnt(6)
  v_mfma_f32_16x16x32_bf16 v[192:195], a[0:3], v[44:47], v[192:195]
  ds_read_b64_tr_b16 a[28:29], v245 offset:17408
  v_and_b32 v237, 0xffff0000, v11
  v_mfma_f32_16x16x32_bf16 v[196:199], a[0:3], v[116:119], v[196:199]
  ds_read_b64_tr_b16 a[30:31], v245 offset:25600
  v_lshlrev_b32 v238, 16, v12
  v_mfma_f32_16x16x32_bf16 v[200:203], a[4:7], v[44:47], v[200:203]
  ds_read_b64_tr_b16 a[32:33], v246 offset:16384
  v_mul_f32 v228, v233, v235
  v_mfma_f32_16x16x32_bf16 v[204:207], a[4:7], v[116:119], v[204:207]
  ds_read_b64_tr_b16 a[34:35], v246 offset:24576
  v_fmac_f32 v228, v232, v236
  v_mfma_f32_16x16x32_bf16 v[208:211], a[8:11], v[44:47], v[208:211]
  ds_read_b64_tr_b16 a[36:37], v246 offset:17408
  buffer_store_dwordx4 a[88:91], v3, s[44:47], s68 offen offset:3072 sc1
  v_mfma_f32_16x16x32_bf16 v[212:215], a[8:11], v[116:119], v[212:215]
  ds_read_b64_tr_b16 a[38:39], v246 offset:25600
  ds_read_b64_tr_b16 a[40:41], v247 offset:16384
  v_mfma_f32_16x16x32_bf16 v[216:219], a[12:15], v[44:47], v[216:219]
  buffer_load_dwordx4 v253, s[32:35], s62 offen offset:3072  lds
  v_mfma_f32_16x16x32_bf16 v[220:223], a[12:15], v[116:119], v[220:223]
  ds_read_b64_tr_b16 a[42:43], v247 offset:24576
  s_waitcnt lgkmcnt(6)
  v_mfma_f32_16x16x32_bf16 v[160:163], a[16:19], v[48:51], v[160:163]
  ds_read_b64_tr_b16 a[44:45], v247 offset:17408
  s_add_u32 m0, s52, 32768
  v_mfma_f32_16x16x32_bf16 v[164:167], a[16:19], v[120:123], v[164:167]
  ds_read_b64_tr_b16 a[46:47], v247 offset:25600
  s_add_u32 s62, s54, 1179904
  v_mfma_f32_16x16x32_bf16 v[168:171], a[20:23], v[48:51], v[168:171]
  ds_read_b64_tr_b16 a[0:1], v244 offset:18432
  v_fmac_f32 v228, v231, v237
  v_mfma_f32_16x16x32_bf16 v[172:175], a[20:23], v[120:123], v[172:175]
  ds_read_b64_tr_b16 a[2:3], v244 offset:26624
  v_lshlrev_b32 v239, 16, v224
  v_mfma_f32_16x16x32_bf16 v[176:179], a[24:27], v[48:51], v[176:179]
  ds_read_b64_tr_b16 a[4:5], v244 offset:19456
  v_fmac_f32 v228, v230, v238
  v_mfma_f32_16x16x32_bf16 v[180:183], a[24:27], v[120:123], v[180:183]
  ds_read_b64_tr_b16 a[6:7], v244 offset:27648
  ds_read_b64_tr_b16 a[8:9], v245 offset:18432
  v_mfma_f32_16x16x32_bf16 v[184:187], a[28:31], v[48:51], v[184:187]
  buffer_load_dwordx4 v252, s[28:31], s62 offen  lds
  v_mfma_f32_16x16x32_bf16 v[188:191], a[28:31], v[120:123], v[188:191]
  ds_read_b64_tr_b16 a[10:11], v245 offset:26624
  s_waitcnt lgkmcnt(6)
  v_mfma_f32_16x16x32_bf16 v[192:195], a[32:35], v[48:51], v[192:195]
  ds_read_b64_tr_b16 a[12:13], v245 offset:19456
  v_mul_f32 v228, v228, v239
  v_mfma_f32_16x16x32_bf16 v[196:199], a[32:35], v[120:123], v[196:199]
  ds_read_b64_tr_b16 a[14:15], v245 offset:27648
  v_and_b32 v234, 0xffff0000, v12
  v_mfma_f32_16x16x32_bf16 v[200:203], a[36:39], v[48:51], v[200:203]
  ds_read_b64_tr_b16 a[16:17], v246 offset:18432
  v_mul_f32 v229, v233, v236
  v_mfma_f32_16x16x32_bf16 v[204:207], a[36:39], v[120:123], v[204:207]
  ds_read_b64_tr_b16 a[18:19], v246 offset:26624
  v_fmac_f32 v229, v232, v237
  v_mfma_f32_16x16x32_bf16 v[208:211], a[40:43], v[48:51], v[208:211]
  ds_read_b64_tr_b16 a[20:21], v246 offset:19456
  v_fmac_f32 v229, v231, v238
  v_mfma_f32_16x16x32_bf16 v[212:215], a[40:43], v[120:123], v[212:215]
  ds_read_b64_tr_b16 a[22:23], v246 offset:27648
  s_waitcnt vmcnt(21)
  s_barrier
  v_mfma_f32_16x16x32_bf16 v[216:219], a[44:47], v[48:51], v[216:219]
  ds_read_b64_tr_b16 a[24:25], v247 offset:18432
  v_and_b32 v239, 0xffff0000, v224
  v_mfma_f32_16x16x32_bf16 v[220:223], a[44:47], v[120:123], v[220:223]
  ds_read_b64_tr_b16 a[26:27], v247 offset:26624
  s_waitcnt lgkmcnt(6)
  v_mfma_f32_16x16x32_bf16 v[160:163], a[0:3], v[52:55], v[160:163]
  ds_read_b64_tr_b16 a[28:29], v247 offset:19456
  v_fmac_f32 v229, v230, v234
  v_mfma_f32_16x16x32_bf16 v[164:167], a[0:3], v[124:127], v[164:167]
  ds_read_b64_tr_b16 a[30:31], v247 offset:27648
  ds_read_b64_tr_b16 a[32:33], v244 offset:32768
  v_mfma_f32_16x16x32_bf16 v[168:171], a[4:7], v[52:55], v[168:171]
  buffer_load_dwordx4 v252, s[32:35], s62 offen offset:1024  lds
  v_mfma_f32_16x16x32_bf16 v[172:175], a[4:7], v[124:127], v[172:175]
  ds_read_b64_tr_b16 a[34:35], v244 offset:40960
  v_mul_f32 v229, v229, v239
  v_mfma_f32_16x16x32_bf16 v[176:179], a[8:11], v[52:55], v[176:179]
  ds_read_b64_tr_b16 a[36:37], v244 offset:33792
  v_cvt_pk_bf16_f32 v11, v229, v228
  v_mfma_f32_16x16x32_bf16 v[180:183], a[8:11], v[124:127], v[180:183]
  ds_read_b64_tr_b16 a[38:39], v244 offset:41984
  ds_read_b64_tr_b16 a[40:41], v245 offset:32768
  v_mfma_f32_16x16x32_bf16 v[184:187], a[12:15], v[52:55], v[184:187]
  buffer_load_dwordx4 v253, s[28:31], s62 offen offset:2048  lds
  v_mfma_f32_16x16x32_bf16 v[188:191], a[12:15], v[124:127], v[188:191]
  ds_read_b64_tr_b16 a[42:43], v245 offset:40960
  s_waitcnt lgkmcnt(6)
  v_mfma_f32_16x16x32_bf16 v[192:195], a[16:19], v[52:55], v[192:195]
  ds_read_b64_tr_b16 a[44:45], v245 offset:33792
  v_lshlrev_b32 v235, 16, v13
  v_mfma_f32_16x16x32_bf16 v[196:199], a[16:19], v[124:127], v[196:199]
  ds_read_b64_tr_b16 a[46:47], v245 offset:41984
  v_mul_f32 v228, v233, v237
  v_mfma_f32_16x16x32_bf16 v[200:203], a[20:23], v[52:55], v[200:203]
  ds_read_b64_tr_b16 a[0:1], v246 offset:32768
  v_fmac_f32 v228, v232, v238
  v_mfma_f32_16x16x32_bf16 v[204:207], a[20:23], v[124:127], v[204:207]
  ds_read_b64_tr_b16 a[2:3], v246 offset:40960
  v_fmac_f32 v228, v231, v234
  v_mfma_f32_16x16x32_bf16 v[208:211], a[24:27], v[52:55], v[208:211]
  ds_read_b64_tr_b16 a[4:5], v246 offset:33792
  v_lshlrev_b32 v239, 16, v225
  v_mfma_f32_16x16x32_bf16 v[212:215], a[24:27], v[124:127], v[212:215]
  ds_read_b64_tr_b16 a[6:7], v246 offset:41984
  ds_read_b64_tr_b16 a[8:9], v247 offset:32768
  v_mfma_f32_16x16x32_bf16 v[216:219], a[28:31], v[52:55], v[216:219]
  buffer_load_dwordx4 v253, s[32:35], s62 offen offset:3072  lds
  v_mfma_f32_16x16x32_bf16 v[220:223], a[28:31], v[124:127], v[220:223]
  ds_read_b64_tr_b16 a[10:11], v247 offset:40960
  v_accvgpr_read_b32 v255, a211
  s_waitcnt lgkmcnt(6)
  v_mfma_f32_16x16x32_bf16 v[160:163], a[32:35], v[56:59], v[160:163]
  ds_read_b64_tr_b16 a[12:13], v247 offset:33792
  v_fmac_f32 v228, v230, v235
  s_mov_b32 m0, s96
  v_mfma_f32_16x16x32_bf16 v[164:167], a[32:35], v[128:131], v[164:167]
  ds_read_b64_tr_b16 a[14:15], v247 offset:41984
  v_mul_f32 v228, v228, v239
  s_add_u32 s70, s70, 128
  v_mfma_f32_16x16x32_bf16 v[168:171], a[36:39], v[56:59], v[168:171]
  ds_read_b64_tr_b16 a[16:17], v244 offset:34816
  v_and_b32 v236, 0xffff0000, v13
  v_mfma_f32_16x16x32_bf16 v[172:175], a[36:39], v[128:131], v[172:175]
  ds_read_b64_tr_b16 a[18:19], v244 offset:43008
  v_mul_f32 v229, v233, v238
  v_mfma_f32_16x16x32_bf16 v[176:179], a[40:43], v[56:59], v[176:179]
  ds_read_b64_tr_b16 a[20:21], v244 offset:35840
  buffer_load_dwordx4 v255, s[48:51], s70 offen  lds
  v_add_u32 v255, 4608, v255
  buffer_load_dwordx4 v255, s[84:87], s70 offen offset:1024  lds
  s_mov_b32 m0, 155648
  v_add_u32 v255, s71, v255
  buffer_load_dwordx4 v255, s[48:51], s70 offen  lds
  s_add_u32 m0, s52, 49152
  s_add_u32 s62, s54, 1769728
  v_mfma_f32_16x16x32_bf16 v[180:183], a[40:43], v[128:131], v[180:183]
  ds_read_b64_tr_b16 a[22:23], v244 offset:44032
  ds_read_b64_tr_b16 a[24:25], v245 offset:34816
  v_mfma_f32_16x16x32_bf16 v[184:187], a[44:47], v[56:59], v[184:187]
  buffer_load_dwordx4 v252, s[28:31], s62 offen  lds
  v_mfma_f32_16x16x32_bf16 v[188:191], a[44:47], v[128:131], v[188:191]
  ds_read_b64_tr_b16 a[26:27], v245 offset:43008
  v_fmac_f32 v229, v232, v234
  s_waitcnt lgkmcnt(6)
  v_mfma_f32_16x16x32_bf16 v[192:195], a[0:3], v[56:59], v[192:195]
  ds_read_b64_tr_b16 a[28:29], v245 offset:35840
  v_fmac_f32 v229, v231, v235
  v_mfma_f32_16x16x32_bf16 v[196:199], a[0:3], v[128:131], v[196:199]
  ds_read_b64_tr_b16 a[30:31], v245 offset:44032
  v_and_b32 v239, 0xffff0000, v225
  v_mfma_f32_16x16x32_bf16 v[200:203], a[4:7], v[56:59], v[200:203]
  ds_read_b64_tr_b16 a[32:33], v246 offset:34816
  v_fmac_f32 v229, v230, v236
  v_mfma_f32_16x16x32_bf16 v[204:207], a[4:7], v[128:131], v[204:207]
  ds_read_b64_tr_b16 a[34:35], v246 offset:43008
  v_mul_f32 v229, v229, v239
  v_mfma_f32_16x16x32_bf16 v[208:211], a[8:11], v[56:59], v[208:211]
  ds_read_b64_tr_b16 a[36:37], v246 offset:35840
  v_cvt_pk_bf16_f32 v10, v229, v228
  v_mfma_f32_16x16x32_bf16 v[212:215], a[8:11], v[128:131], v[212:215]
  ds_read_b64_tr_b16 a[38:39], v246 offset:44032
  v_lshlrev_b32 v237, 16, v14
  v_mfma_f32_16x16x32_bf16 v[216:219], a[12:15], v[56:59], v[216:219]
  ds_read_b64_tr_b16 a[40:41], v247 offset:34816
  buffer_load_dwordx4 v252, s[32:35], s62 offen offset:1024  lds
  v_mfma_f32_16x16x32_bf16 v[220:223], a[12:15], v[128:131], v[220:223]
  ds_read_b64_tr_b16 a[42:43], v247 offset:43008
  v_mul_f32 v228, v233, v234
  s_waitcnt lgkmcnt(6)
  v_mfma_f32_16x16x32_bf16 v[160:163], a[16:19], v[60:63], v[160:163]
  ds_read_b64_tr_b16 a[44:45], v247 offset:35840
  v_fmac_f32 v228, v232, v235
  v_fmac_f32 v228, v231, v236
  v_mfma_f32_16x16x32_bf16 v[164:167], a[16:19], v[132:135], v[164:167]
  ds_read_b64_tr_b16 a[46:47], v247 offset:44032
  v_lshlrev_b32 v239, 16, v226
  v_mfma_f32_16x16x32_bf16 v[168:171], a[20:23], v[60:63], v[168:171]
  ds_read_b64_tr_b16 a[0:1], v248 offset:0
  v_fmac_f32 v228, v230, v237
  v_mfma_f32_16x16x32_bf16 v[172:175], a[20:23], v[132:135], v[172:175]
  ds_read_b64_tr_b16 a[2:3], v248 offset:8192
  v_mul_f32 v228, v228, v239
  v_mfma_f32_16x16x32_bf16 v[176:179], a[24:27], v[60:63], v[176:179]
  ds_read_b64_tr_b16 a[4:5], v248 offset:1024
  v_and_b32 v238, 0xffff0000, v14
  v_mfma_f32_16x16x32_bf16 v[180:183], a[24:27], v[132:135], v[180:183]
  ds_read_b64_tr_b16 a[6:7], v248 offset:9216
  v_mul_f32 v229, v233, v235
  v_mfma_f32_16x16x32_bf16 v[184:187], a[28:31], v[60:63], v[184:187]
  ds_read_b64_tr_b16 a[8:9], v249 offset:0
  buffer_load_dwordx4 v253, s[28:31], s62 offen offset:2048  lds
  v_mfma_f32_16x16x32_bf16 v[188:191], a[28:31], v[132:135], v[188:191]
  ds_read_b64_tr_b16 a[10:11], v249 offset:8192
  v_fmac_f32 v229, v232, v236
  s_waitcnt lgkmcnt(6)
  v_mfma_f32_16x16x32_bf16 v[192:195], a[32:35], v[60:63], v[192:195]
  ds_read_b64_tr_b16 a[12:13], v249 offset:1024
  s_add_u32 s66, s55, 0
  buffer_load_dword a120, v254, s[40:43], s66 offen offset:3072
  v_mfma_f32_16x16x32_bf16 v[196:199], a[32:35], v[132:135], v[196:199]
  ds_read_b64_tr_b16 a[14:15], v249 offset:9216
  v_fmac_f32 v229, v231, v237
  v_and_b32 v239, 0xffff0000, v226
  v_mfma_f32_16x16x32_bf16 v[200:203], a[36:39], v[60:63], v[200:203]
  ds_read_b64_tr_b16 a[16:17], v250 offset:0
  v_accvgpr_read_b32 v255, a235
  s_movk_i32 s3, 0x2000
  v_mfma_f32_16x16x32_bf16 v[204:207], a[36:39], v[132:135], v[204:207]
  ds_read_b64_tr_b16 a[18:19], v250 offset:8192
  v_fmac_f32 v229, v230, v238
  v_mul_f32 v229, v229, v239
  v_mfma_f32_16x16x32_bf16 v[208:211], a[40:43], v[60:63], v[208:211]
  ds_read_b64_tr_b16 a[20:21], v250 offset:1024
  s_cmp_eq_u32 s14, 0
  s_cselect_b32 s23, 0x4000, 0x40000000
  v_mfma_f32_16x16x32_bf16 v[212:215], a[40:43], v[132:135], v[212:215]
  ds_read_b64_tr_b16 a[22:23], v250 offset:9216
  v_cvt_pk_bf16_f32 v9, v229, v228
  v_mfma_f32_16x16x32_bf16 v[216:219], a[44:47], v[60:63], v[216:219]
  ds_read_b64_tr_b16 a[24:25], v251 offset:0
  buffer_load_dwordx4 v253, s[32:35], s62 offen offset:3072  lds
  v_mfma_f32_16x16x32_bf16 v[220:223], a[44:47], v[132:135], v[220:223]
  ds_read_b64_tr_b16 a[26:27], v251 offset:8192
  v_lshlrev_b32 v234, 16, v15
  s_waitcnt lgkmcnt(6)
  v_mfma_f32_16x16x32_bf16 v[160:163], a[0:3], v[64:67], v[160:163]
  ds_read_b64_tr_b16 a[28:29], v251 offset:1024
  buffer_store_dwordx4 a[222:225], v255, s[44:47], 0 offen sc1
  v_mfma_f32_16x16x32_bf16 v[164:167], a[0:3], v[136:139], v[164:167]
  ds_read_b64_tr_b16 a[30:31], v251 offset:9216
  v_mul_f32 v228, v233, v236
  v_fmac_f32 v228, v232, v237
  v_mfma_f32_16x16x32_bf16 v[168:171], a[4:7], v[64:67], v[168:171]
  ds_read_b64_tr_b16 a[32:33], v248 offset:2048
  v_fmac_f32 v228, v231, v238
  v_lshlrev_b32 v239, 16, v227
  v_mfma_f32_16x16x32_bf16 v[172:175], a[4:7], v[136:139], v[172:175]
  ds_read_b64_tr_b16 a[34:35], v248 offset:10240
  v_fmac_f32 v228, v230, v234
  v_mul_f32 v228, v228, v239
  v_mfma_f32_16x16x32_bf16 v[176:179], a[8:11], v[64:67], v[176:179]
  ds_read_b64_tr_b16 a[36:37], v248 offset:3072
  s_add_u32 m0, s52, 65536
  s_add_u32 s62, s54, 2359552
  v_mfma_f32_16x16x32_bf16 v[180:183], a[8:11], v[136:139], v[180:183]
  ds_read_b64_tr_b16 a[38:39], v248 offset:11264
  v_and_b32 v235, 0xffff0000, v15
  v_mfma_f32_16x16x32_bf16 v[184:187], a[12:15], v[64:67], v[184:187]
  ds_read_b64_tr_b16 a[40:41], v249 offset:2048
  buffer_load_dwordx4 v252, s[28:31], s62 offen  lds
  v_mfma_f32_16x16x32_bf16 v[188:191], a[12:15], v[136:139], v[188:191]
  ds_read_b64_tr_b16 a[42:43], v249 offset:10240
  v_mul_f32 v229, v233, v237
  s_waitcnt lgkmcnt(6)
  v_mfma_f32_16x16x32_bf16 v[192:195], a[16:19], v[64:67], v[192:195]
  ds_read_b64_tr_b16 a[44:45], v249 offset:3072
  v_fmac_f32 v229, v232, v238
  v_fmac_f32 v229, v231, v234
  v_mfma_f32_16x16x32_bf16 v[196:199], a[16:19], v[136:139], v[196:199]
  ds_read_b64_tr_b16 a[46:47], v249 offset:11264
  v_and_b32 v239, 0xffff0000, v227
  v_fmac_f32 v229, v230, v235
  v_mfma_f32_16x16x32_bf16 v[200:203], a[20:23], v[64:67], v[200:203]
  ds_read_b64_tr_b16 a[0:1], v250 offset:2048
  v_mul_f32 v229, v229, v239
  v_cvt_pk_bf16_f32 v8, v229, v228
  v_mfma_f32_16x16x32_bf16 v[204:207], a[20:23], v[136:139], v[204:207]
  ds_read_b64_tr_b16 a[2:3], v250 offset:10240
  v_accvgpr_read_b32 v239, a213
  buffer_store_dwordx4 v[8:11], v239, s[44:47], 0 offen sc1
  v_mfma_f32_16x16x32_bf16 v[208:211], a[24:27], v[64:67], v[208:211]
  ds_read_b64_tr_b16 a[4:5], v250 offset:3072
  v_mfma_f32_16x16x32_bf16 v[212:215], a[24:27], v[136:139], v[212:215]
  ds_read_b64_tr_b16 a[6:7], v250 offset:11264
  s_waitcnt vmcnt(25)
  s_barrier
  v_mfma_f32_16x16x32_bf16 v[216:219], a[28:31], v[64:67], v[216:219]
  ds_read_b64_tr_b16 a[8:9], v251 offset:2048
  v_mfma_f32_16x16x32_bf16 v[220:223], a[28:31], v[136:139], v[220:223]
  ds_read_b64_tr_b16 a[10:11], v251 offset:10240
  s_waitcnt lgkmcnt(6)
  v_mfma_f32_16x16x32_bf16 v[160:163], a[32:35], v[68:71], v[160:163]
  ds_read_b64_tr_b16 a[12:13], v251 offset:3072
  v_mfma_f32_16x16x32_bf16 v[164:167], a[32:35], v[140:143], v[164:167]
  ds_read_b64_tr_b16 a[14:15], v251 offset:11264
  ds_read_b64_tr_b16 a[16:17], v248 offset:16384
  v_mfma_f32_16x16x32_bf16 v[168:171], a[36:39], v[68:71], v[168:171]
  buffer_load_dwordx4 v252, s[32:35], s62 offen offset:1024  lds
  v_mfma_f32_16x16x32_bf16 v[172:175], a[36:39], v[140:143], v[172:175]
  ds_read_b64_tr_b16 a[18:19], v248 offset:24576
  ds_read_b64_tr_b16 a[20:21], v248 offset:17408
  v_mfma_f32_16x16x32_bf16 v[176:179], a[40:43], v[68:71], v[176:179]
  buffer_store_dwordx4 a[226:229], v255, s[44:47], s3 offen sc1
  v_mfma_f32_16x16x32_bf16 v[180:183], a[40:43], v[140:143], v[180:183]
  ds_read_b64_tr_b16 a[22:23], v248 offset:25600
  ds_read_b64_tr_b16 a[24:25], v248 offset:18432
  v_mfma_f32_16x16x32_bf16 v[184:187], a[44:47], v[68:71], v[184:187]
  buffer_load_dwordx4 v253, s[28:31], s62 offen offset:2048  lds
  v_mfma_f32_16x16x32_bf16 v[188:191], a[44:47], v[140:143], v[188:191]
  ds_read_b64_tr_b16 a[26:27], v248 offset:26624
  s_waitcnt lgkmcnt(6)
  v_mfma_f32_16x16x32_bf16 v[192:195], a[0:3], v[68:71], v[192:195]
  ds_read_b64_tr_b16 a[28:29], v248 offset:19456
  v_mfma_f32_16x16x32_bf16 v[196:199], a[0:3], v[140:143], v[196:199]
  ds_read_b64_tr_b16 a[30:31], v248 offset:27648
  v_mfma_f32_16x16x32_bf16 v[200:203], a[4:7], v[68:71], v[200:203]
  ds_read_b64_tr_b16 a[32:33], v248 offset:32768
  v_mfma_f32_16x16x32_bf16 v[204:207], a[4:7], v[140:143], v[204:207]
  ds_read_b64_tr_b16 a[34:35], v248 offset:40960
  v_mfma_f32_16x16x32_bf16 v[208:211], a[8:11], v[68:71], v[208:211]
  ds_read_b64_tr_b16 a[36:37], v248 offset:33792
  v_mfma_f32_16x16x32_bf16 v[212:215], a[8:11], v[140:143], v[212:215]
  ds_read_b64_tr_b16 a[38:39], v248 offset:41984
  ds_read_b64_tr_b16 a[40:41], v248 offset:34816
  v_mfma_f32_16x16x32_bf16 v[216:219], a[12:15], v[68:71], v[216:219]
  buffer_load_dwordx4 v253, s[32:35], s62 offen offset:3072  lds
  v_mfma_f32_16x16x32_bf16 v[220:223], a[12:15], v[140:143], v[220:223]
  ds_read_b64_tr_b16 a[42:43], v248 offset:43008
  s_waitcnt lgkmcnt(6)
  v_mfma_f32_16x16x32_bf16 v[160:163], a[16:19], v[72:75], v[160:163]
  ds_read_b64_tr_b16 a[44:45], v248 offset:35840
  s_add_u32 m0, s52, 81920
  v_mfma_f32_16x16x32_bf16 v[164:167], a[16:19], v[144:147], v[164:167]
  ds_read_b64_tr_b16 a[46:47], v248 offset:44032
  s_add_u32 s62, s54, 2949376
  v_mfma_f32_16x16x32_bf16 v[168:171], a[20:23], v[72:75], v[168:171]
  ds_read_b64_tr_b16 a[0:1], v249 offset:16384
  v_mfma_f32_16x16x32_bf16 v[172:175], a[20:23], v[144:147], v[172:175]
  ds_read_b64_tr_b16 a[2:3], v249 offset:24576
  v_mfma_f32_16x16x32_bf16 v[160:163], a[24:27], v[76:79], v[160:163]
  ds_read_b64_tr_b16 a[4:5], v249 offset:17408
  v_mfma_f32_16x16x32_bf16 v[164:167], a[24:27], v[148:151], v[164:167]
  ds_read_b64_tr_b16 a[6:7], v249 offset:25600
  ds_read_b64_tr_b16 a[8:9], v249 offset:18432
  v_mfma_f32_16x16x32_bf16 v[168:171], a[28:31], v[76:79], v[168:171]
  buffer_load_dwordx4 v252, s[28:31], s62 offen  lds
  v_mfma_f32_16x16x32_bf16 v[172:175], a[28:31], v[148:151], v[172:175]
  ds_read_b64_tr_b16 a[10:11], v249 offset:26624
  s_waitcnt lgkmcnt(6)
  v_mfma_f32_16x16x32_bf16 v[160:163], a[32:35], v[80:83], v[160:163]
  ds_read_b64_tr_b16 a[12:13], v249 offset:19456
  v_mfma_f32_16x16x32_bf16 v[164:167], a[32:35], v[152:155], v[164:167]
  ds_read_b64_tr_b16 a[14:15], v249 offset:27648
  v_mfma_f32_16x16x32_bf16 v[168:171], a[36:39], v[80:83], v[168:171]
  ds_read_b64_tr_b16 a[16:17], v249 offset:32768
  v_mfma_f32_16x16x32_bf16 v[172:175], a[36:39], v[152:155], v[172:175]
  ds_read_b64_tr_b16 a[18:19], v249 offset:40960
  v_mfma_f32_16x16x32_bf16 v[160:163], a[40:43], v[84:87], v[160:163]
  ds_read_b64_tr_b16 a[20:21], v249 offset:33792
  v_mfma_f32_16x16x32_bf16 v[164:167], a[40:43], v[156:159], v[164:167]
  ds_read_b64_tr_b16 a[22:23], v249 offset:41984
  ds_read_b64_tr_b16 a[24:25], v249 offset:34816
  v_mfma_f32_16x16x32_bf16 v[168:171], a[44:47], v[84:87], v[168:171]
  buffer_load_dwordx4 v252, s[32:35], s62 offen offset:1024  lds
  v_mfma_f32_16x16x32_bf16 v[172:175], a[44:47], v[156:159], v[172:175]
  ds_read_b64_tr_b16 a[26:27], v249 offset:43008
  s_waitcnt lgkmcnt(6)
  v_mfma_f32_16x16x32_bf16 v[176:179], a[0:3], v[72:75], v[176:179]
  ds_read_b64_tr_b16 a[28:29], v249 offset:35840
  v_mfma_f32_16x16x32_bf16 v[180:183], a[0:3], v[144:147], v[180:183]
  ds_read_b64_tr_b16 a[30:31], v249 offset:44032
  ds_read_b64_tr_b16 a[32:33], v250 offset:16384
  v_mfma_f32_16x16x32_bf16 v[184:187], a[4:7], v[72:75], v[184:187]
  buffer_store_dwordx4 a[230:233], v255, s[44:47], s23 offen sc1
  v_mfma_f32_16x16x32_bf16 v[188:191], a[4:7], v[144:147], v[188:191]
  ds_read_b64_tr_b16 a[34:35], v250 offset:24576
  v_mul_f32 v224, v160, v168
  v_mfma_f32_16x16x32_bf16 v[176:179], a[8:11], v[76:79], v[176:179]
  ds_read_b64_tr_b16 a[36:37], v250 offset:17408
  v_mul_f32 v225, v161, v169
  v_mfma_f32_16x16x32_bf16 v[180:183], a[8:11], v[148:151], v[180:183]
  ds_read_b64_tr_b16 a[38:39], v250 offset:25600
  ds_read_b64_tr_b16 a[40:41], v250 offset:18432
  v_mfma_f32_16x16x32_bf16 v[184:187], a[12:15], v[76:79], v[184:187]
  buffer_load_dwordx4 v253, s[28:31], s62 offen offset:2048  lds
  v_mfma_f32_16x16x32_bf16 v[188:191], a[12:15], v[148:151], v[188:191]
  ds_read_b64_tr_b16 a[42:43], v250 offset:26624
  s_waitcnt lgkmcnt(6)
  v_mfma_f32_16x16x32_bf16 v[176:179], a[16:19], v[80:83], v[176:179]
  ds_read_b64_tr_b16 a[44:45], v250 offset:19456
  v_mul_f32 v226, v162, v170
  v_mfma_f32_16x16x32_bf16 v[180:183], a[16:19], v[152:155], v[180:183]
  ds_read_b64_tr_b16 a[46:47], v250 offset:27648
  v_mul_f32 v227, v163, v171
  v_mfma_f32_16x16x32_bf16 v[184:187], a[20:23], v[80:83], v[184:187]
  ds_read_b64_tr_b16 a[0:1], v250 offset:32768
  v_mul_f32 v228, v164, v172
  v_mfma_f32_16x16x32_bf16 v[188:191], a[20:23], v[152:155], v[188:191]
  ds_read_b64_tr_b16 a[2:3], v250 offset:40960
  v_mul_f32 v229, v165, v173
  v_mfma_f32_16x16x32_bf16 v[176:179], a[24:27], v[84:87], v[176:179]
  ds_read_b64_tr_b16 a[4:5], v250 offset:33792
  v_mul_f32 v230, v166, v174
  v_mfma_f32_16x16x32_bf16 v[180:183], a[24:27], v[156:159], v[180:183]
  ds_read_b64_tr_b16 a[6:7], v250 offset:41984
  ds_read_b64_tr_b16 a[8:9], v250 offset:34816
  v_mfma_f32_16x16x32_bf16 v[184:187], a[28:31], v[84:87], v[184:187]
  buffer_load_dwordx4 v253, s[32:35], s62 offen offset:3072  lds
  v_mfma_f32_16x16x32_bf16 v[188:191], a[28:31], v[156:159], v[188:191]
  ds_read_b64_tr_b16 a[10:11], v250 offset:43008
  s_waitcnt lgkmcnt(6)
  v_mfma_f32_16x16x32_bf16 v[192:195], a[32:35], v[72:75], v[192:195]
  ds_read_b64_tr_b16 a[12:13], v250 offset:35840
  s_add_u32 m0, s52, 98304
  v_mfma_f32_16x16x32_bf16 v[196:199], a[32:35], v[144:147], v[196:199]
  ds_read_b64_tr_b16 a[14:15], v250 offset:44032
  s_add_u32 s62, s54, 3539200
  v_mfma_f32_16x16x32_bf16 v[200:203], a[36:39], v[72:75], v[200:203]
  ds_read_b64_tr_b16 a[16:17], v251 offset:16384
  v_mul_f32 v231, v167, v175
  v_mfma_f32_16x16x32_bf16 v[204:207], a[36:39], v[144:147], v[204:207]
  ds_read_b64_tr_b16 a[18:19], v251 offset:24576
  v_cvt_pk_bf16_f32 v224, v224, v225
  v_mfma_f32_16x16x32_bf16 v[192:195], a[40:43], v[76:79], v[192:195]
  ds_read_b64_tr_b16 a[20:21], v251 offset:17408
  v_cvt_pk_bf16_f32 v226, v226, v227
  v_mfma_f32_16x16x32_bf16 v[196:199], a[40:43], v[148:151], v[196:199]
  ds_read_b64_tr_b16 a[22:23], v251 offset:25600
  ds_read_b64_tr_b16 a[24:25], v251 offset:18432
  v_mfma_f32_16x16x32_bf16 v[200:203], a[44:47], v[76:79], v[200:203]
  buffer_load_dwordx4 v252, s[28:31], s62 offen  lds
  v_mfma_f32_16x16x32_bf16 v[204:207], a[44:47], v[148:151], v[204:207]
  ds_read_b64_tr_b16 a[26:27], v251 offset:26624
  s_waitcnt lgkmcnt(6)
  v_mfma_f32_16x16x32_bf16 v[192:195], a[0:3], v[80:83], v[192:195]
  ds_read_b64_tr_b16 a[28:29], v251 offset:19456
  v_cvt_pk_bf16_f32 v228, v228, v229
  v_mfma_f32_16x16x32_bf16 v[196:199], a[0:3], v[152:155], v[196:199]
  ds_read_b64_tr_b16 a[30:31], v251 offset:27648
  v_cvt_pk_bf16_f32 v230, v230, v231
  v_mfma_f32_16x16x32_bf16 v[200:203], a[4:7], v[80:83], v[200:203]
  ds_read_b64_tr_b16 a[32:33], v251 offset:32768
  v_accvgpr_write_b32 a56, v224
  v_mfma_f32_16x16x32_bf16 v[204:207], a[4:7], v[152:155], v[204:207]
  ds_read_b64_tr_b16 a[34:35], v251 offset:40960
  v_accvgpr_write_b32 a57, v226
  v_mfma_f32_16x16x32_bf16 v[192:195], a[8:11], v[84:87], v[192:195]
  ds_read_b64_tr_b16 a[36:37], v251 offset:33792
  v_accvgpr_write_b32 a92, v228
  v_mfma_f32_16x16x32_bf16 v[196:199], a[8:11], v[156:159], v[196:199]
  ds_read_b64_tr_b16 a[38:39], v251 offset:41984
  s_waitcnt vmcnt(25)
  s_barrier
  v_mfma_f32_16x16x32_bf16 v[200:203], a[12:15], v[84:87], v[200:203]
  ds_read_b64_tr_b16 a[40:41], v251 offset:34816
  v_accvgpr_write_b32 a93, v230
  v_mfma_f32_16x16x32_bf16 v[204:207], a[12:15], v[156:159], v[204:207]
  ds_read_b64_tr_b16 a[42:43], v251 offset:43008
  s_waitcnt lgkmcnt(6)
  v_mfma_f32_16x16x32_bf16 v[208:211], a[16:19], v[72:75], v[208:211]
  ds_read_b64_tr_b16 a[44:45], v251 offset:35840
  v_mul_f32 v232, v176, v184
  v_mfma_f32_16x16x32_bf16 v[212:215], a[16:19], v[144:147], v[212:215]
  ds_read_b64_tr_b16 a[46:47], v251 offset:44032
  ds_read_b64_tr_b16 a[0:1], v240 offset:0
  v_mfma_f32_16x16x32_bf16 v[216:219], a[20:23], v[72:75], v[216:219]
  buffer_load_dwordx4 v252, s[32:35], s62 offen offset:1024  lds
  v_mfma_f32_16x16x32_bf16 v[220:223], a[20:23], v[144:147], v[220:223]
  ds_read_b64_tr_b16 a[2:3], v240 offset:8192
  v_mul_f32 v233, v177, v185
  v_mfma_f32_16x16x32_bf16 v[208:211], a[24:27], v[76:79], v[208:211]
  ds_read_b64_tr_b16 a[4:5], v240 offset:1024
  v_mul_f32 v234, v178, v186
  v_mfma_f32_16x16x32_bf16 v[212:215], a[24:27], v[148:151], v[212:215]
  ds_read_b64_tr_b16 a[6:7], v240 offset:9216
  ds_read_b64_tr_b16 a[8:9], v240 offset:2048
  v_mfma_f32_16x16x32_bf16 v[216:219], a[28:31], v[76:79], v[216:219]
  buffer_load_dwordx4 v253, s[28:31], s62 offen offset:2048  lds
  v_mfma_f32_16x16x32_bf16 v[220:223], a[28:31], v[148:151], v[220:223]
  ds_read_b64_tr_b16 a[10:11], v240 offset:10240
  s_waitcnt lgkmcnt(6)
  v_mfma_f32_16x16x32_bf16 v[208:211], a[32:35], v[80:83], v[208:211]
  ds_read_b64_tr_b16 a[12:13], v240 offset:3072
  v_mul_f32 v235, v179, v187
  v_mfma_f32_16x16x32_bf16 v[212:215], a[32:35], v[152:155], v[212:215]
  ds_read_b64_tr_b16 a[14:15], v240 offset:11264
  v_mul_f32 v236, v180, v188
  v_mfma_f32_16x16x32_bf16 v[216:219], a[36:39], v[80:83], v[216:219]
  ds_read_b64_tr_b16 a[16:17], v240 offset:16384
  v_mul_f32 v237, v181, v189
  v_mfma_f32_16x16x32_bf16 v[220:223], a[36:39], v[152:155], v[220:223]
  ds_read_b64_tr_b16 a[18:19], v240 offset:24576
  v_mul_f32 v238, v182, v190
  v_mfma_f32_16x16x32_bf16 v[208:211], a[40:43], v[84:87], v[208:211]
  ds_read_b64_tr_b16 a[20:21], v240 offset:17408
  v_mul_f32 v239, v183, v191
  v_mfma_f32_16x16x32_bf16 v[212:215], a[40:43], v[156:159], v[212:215]
  ds_read_b64_tr_b16 a[22:23], v240 offset:25600
  ds_read_b64_tr_b16 a[24:25], v240 offset:18432
  v_mfma_f32_16x16x32_bf16 v[216:219], a[44:47], v[84:87], v[216:219]
  buffer_load_dwordx4 v253, s[32:35], s62 offen offset:3072  lds
  v_mfma_f32_16x16x32_bf16 v[220:223], a[44:47], v[156:159], v[220:223]
  ds_read_b64_tr_b16 a[26:27], v240 offset:26624
  s_waitcnt lgkmcnt(6)
  v_mfma_f32_16x16x32_bf16 v[160:163], a[0:3], v[16:19], 0
  ds_read_b64_tr_b16 a[28:29], v240 offset:19456
  v_cvt_pk_bf16_f32 v232, v232, v233
  v_mfma_f32_16x16x32_bf16 v[164:167], a[0:3], v[88:91], 0
  ds_read_b64_tr_b16 a[30:31], v240 offset:27648
  v_cvt_pk_bf16_f32 v234, v234, v235
  v_mfma_f32_16x16x32_bf16 v[168:171], a[4:7], v[16:19], 0
  ds_read_b64_tr_b16 a[32:33], v241 offset:0
  v_cvt_pk_bf16_f32 v236, v236, v237
  v_mfma_f32_16x16x32_bf16 v[172:175], a[4:7], v[88:91], 0
  ds_read_b64_tr_b16 a[34:35], v241 offset:8192
  v_cvt_pk_bf16_f32 v238, v238, v239
  v_mfma_f32_16x16x32_bf16 v[160:163], a[8:11], v[20:23], v[160:163]
  ds_read_b64_tr_b16 a[36:37], v241 offset:1024
  v_accvgpr_write_b32 a58, v232
  v_mfma_f32_16x16x32_bf16 v[164:167], a[8:11], v[92:95], v[164:167]
  ds_read_b64_tr_b16 a[38:39], v241 offset:9216
  v_accvgpr_read_b32 v255, a210
  v_mfma_f32_16x16x32_bf16 v[168:171], a[12:15], v[20:23], v[168:171]
  ds_read_b64_tr_b16 a[40:41], v241 offset:2048
  v_accvgpr_write_b32 a59, v234
  v_mfma_f32_16x16x32_bf16 v[172:175], a[12:15], v[92:95], v[172:175]
  ds_read_b64_tr_b16 a[42:43], v241 offset:10240
  s_waitcnt lgkmcnt(6)
  v_mfma_f32_16x16x32_bf16 v[160:163], a[16:19], v[24:27], v[160:163]
  ds_read_b64_tr_b16 a[44:45], v241 offset:3072
  s_add_u32 s3, s67, 0
  v_mfma_f32_16x16x32_bf16 v[164:167], a[16:19], v[96:99], v[164:167]
  ds_read_b64_tr_b16 a[46:47], v241 offset:11264
  v_accvgpr_write_b32 a94, v236
  v_mfma_f32_16x16x32_bf16 v[168:171], a[20:23], v[24:27], v[168:171]
  ds_read_b64_tr_b16 a[0:1], v241 offset:16384
  v_accvgpr_write_b32 a95, v238
  v_mfma_f32_16x16x32_bf16 v[172:175], a[20:23], v[96:99], v[172:175]
  ds_read_b64_tr_b16 a[2:3], v241 offset:24576
  v_mul_f32 v224, v192, v200
  v_mfma_f32_16x16x32_bf16 v[160:163], a[24:27], v[28:31], v[160:163]
  ds_read_b64_tr_b16 a[4:5], v241 offset:17408
  buffer_load_dword a120, v255, s[36:39], s3 offen offset:3072
  v_mfma_f32_16x16x32_bf16 v[164:167], a[24:27], v[100:103], v[164:167]
  ds_read_b64_tr_b16 a[6:7], v241 offset:25600
  v_mul_f32 v225, v193, v201
  v_mfma_f32_16x16x32_bf16 v[168:171], a[28:31], v[28:31], v[168:171]
  ds_read_b64_tr_b16 a[8:9], v241 offset:18432
  v_mul_f32 v226, v194, v202
  v_mfma_f32_16x16x32_bf16 v[172:175], a[28:31], v[100:103], v[172:175]
  ds_read_b64_tr_b16 a[10:11], v241 offset:26624
  s_waitcnt lgkmcnt(6)
  v_mfma_f32_16x16x32_bf16 v[176:179], a[32:35], v[16:19], 0
  ds_read_b64_tr_b16 a[12:13], v241 offset:19456
  v_mul_f32 v227, v195, v203
  v_mfma_f32_16x16x32_bf16 v[180:183], a[32:35], v[88:91], 0
  ds_read_b64_tr_b16 a[14:15], v241 offset:27648
  v_mul_f32 v228, v196, v204
  v_mfma_f32_16x16x32_bf16 v[184:187], a[36:39], v[16:19], 0
  ds_read_b64_tr_b16 a[16:17], v242 offset:0
  v_mul_f32 v229, v197, v205
  v_mfma_f32_16x16x32_bf16 v[188:191], a[36:39], v[88:91], 0
  ds_read_b64_tr_b16 a[18:19], v242 offset:8192
  v_mul_f32 v230, v198, v206
  v_mfma_f32_16x16x32_bf16 v[176:179], a[40:43], v[20:23], v[176:179]
  ds_read_b64_tr_b16 a[20:21], v242 offset:1024
  v_mul_f32 v231, v199, v207
  v_mfma_f32_16x16x32_bf16 v[180:183], a[40:43], v[92:95], v[180:183]
  ds_read_b64_tr_b16 a[22:23], v242 offset:9216
  v_cvt_pk_bf16_f32 v224, v224, v225
  v_mfma_f32_16x16x32_bf16 v[184:187], a[44:47], v[20:23], v[184:187]
  ds_read_b64_tr_b16 a[24:25], v242 offset:2048
  v_cvt_pk_bf16_f32 v226, v226, v227
  v_mfma_f32_16x16x32_bf16 v[188:191], a[44:47], v[92:95], v[188:191]
  ds_read_b64_tr_b16 a[26:27], v242 offset:10240
  s_waitcnt lgkmcnt(6)
  v_mfma_f32_16x16x32_bf16 v[176:179], a[0:3], v[24:27], v[176:179]
  ds_read_b64_tr_b16 a[28:29], v242 offset:3072
  v_cvt_pk_bf16_f32 v228, v228, v229
  v_mfma_f32_16x16x32_bf16 v[180:183], a[0:3], v[96:99], v[180:183]
  ds_read_b64_tr_b16 a[30:31], v242 offset:11264
  v_cvt_pk_bf16_f32 v230, v230, v231
  v_mfma_f32_16x16x32_bf16 v[184:187], a[4:7], v[24:27], v[184:187]
  ds_read_b64_tr_b16 a[32:33], v242 offset:16384
  v_accvgpr_write_b32 a60, v224
  v_mfma_f32_16x16x32_bf16 v[188:191], a[4:7], v[96:99], v[188:191]
  ds_read_b64_tr_b16 a[34:35], v242 offset:24576
  v_accvgpr_write_b32 a61, v226
  v_mfma_f32_16x16x32_bf16 v[176:179], a[8:11], v[28:31], v[176:179]
  ds_read_b64_tr_b16 a[36:37], v242 offset:17408
  v_accvgpr_write_b32 a96, v228
  v_mfma_f32_16x16x32_bf16 v[180:183], a[8:11], v[100:103], v[180:183]
  ds_read_b64_tr_b16 a[38:39], v242 offset:25600
  v_accvgpr_write_b32 a97, v230
  v_mfma_f32_16x16x32_bf16 v[184:187], a[12:15], v[28:31], v[184:187]
  ds_read_b64_tr_b16 a[40:41], v242 offset:18432
  v_mul_f32 v232, v208, v216
  v_mfma_f32_16x16x32_bf16 v[188:191], a[12:15], v[100:103], v[188:191]
  ds_read_b64_tr_b16 a[42:43], v242 offset:26624
  s_waitcnt lgkmcnt(6)
  v_mfma_f32_16x16x32_bf16 v[192:195], a[16:19], v[16:19], 0
  ds_read_b64_tr_b16 a[44:45], v242 offset:19456
  v_mul_f32 v233, v209, v217
  v_mfma_f32_16x16x32_bf16 v[196:199], a[16:19], v[88:91], 0
  ds_read_b64_tr_b16 a[46:47], v242 offset:27648
  v_mul_f32 v234, v210, v218
  v_mfma_f32_16x16x32_bf16 v[200:203], a[20:23], v[16:19], 0
  ds_read_b64_tr_b16 a[0:1], v243 offset:0
  v_mul_f32 v235, v211, v219
  v_mfma_f32_16x16x32_bf16 v[204:207], a[20:23], v[88:91], 0
  ds_read_b64_tr_b16 a[2:3], v243 offset:8192
  v_mul_f32 v236, v212, v220
  v_mfma_f32_16x16x32_bf16 v[192:195], a[24:27], v[20:23], v[192:195]
  ds_read_b64_tr_b16 a[4:5], v243 offset:1024
  v_mul_f32 v237, v213, v221
  v_mfma_f32_16x16x32_bf16 v[196:199], a[24:27], v[92:95], v[196:199]
  ds_read_b64_tr_b16 a[6:7], v243 offset:9216
  s_add_u32 s68, s88, 4096
  v_mfma_f32_16x16x32_bf16 v[200:203], a[28:31], v[20:23], v[200:203]
  ds_read_b64_tr_b16 a[8:9], v243 offset:2048
  v_mul_f32 v238, v214, v222
  v_mfma_f32_16x16x32_bf16 v[204:207], a[28:31], v[92:95], v[204:207]
  ds_read_b64_tr_b16 a[10:11], v243 offset:10240
  s_waitcnt lgkmcnt(6)
  v_mfma_f32_16x16x32_bf16 v[192:195], a[32:35], v[24:27], v[192:195]
  ds_read_b64_tr_b16 a[12:13], v243 offset:3072
  v_mul_f32 v239, v215, v223
  v_mfma_f32_16x16x32_bf16 v[196:199], a[32:35], v[96:99], v[196:199]
  ds_read_b64_tr_b16 a[14:15], v243 offset:11264
  v_cvt_pk_bf16_f32 v232, v232, v233
  v_mfma_f32_16x16x32_bf16 v[200:203], a[36:39], v[24:27], v[200:203]
  ds_read_b64_tr_b16 a[16:17], v243 offset:16384
  v_cvt_pk_bf16_f32 v234, v234, v235
  v_mfma_f32_16x16x32_bf16 v[204:207], a[36:39], v[96:99], v[204:207]
  ds_read_b64_tr_b16 a[18:19], v243 offset:24576
  v_cvt_pk_bf16_f32 v236, v236, v237
  v_mfma_f32_16x16x32_bf16 v[192:195], a[40:43], v[28:31], v[192:195]
  ds_read_b64_tr_b16 a[20:21], v243 offset:17408
  v_cvt_pk_bf16_f32 v238, v238, v239
  v_mfma_f32_16x16x32_bf16 v[196:199], a[40:43], v[100:103], v[196:199]
  ds_read_b64_tr_b16 a[22:23], v243 offset:25600
  s_waitcnt vmcnt(17)
  s_barrier
  v_mfma_f32_16x16x32_bf16 v[200:203], a[44:47], v[28:31], v[200:203]
  ds_read_b64_tr_b16 a[24:25], v243 offset:18432
  s_add_u32 m0, s52, 114688
  v_mfma_f32_16x16x32_bf16 v[204:207], a[44:47], v[100:103], v[204:207]
  ds_read_b64_tr_b16 a[26:27], v243 offset:26624
  s_waitcnt lgkmcnt(6)
  v_mfma_f32_16x16x32_bf16 v[208:211], a[0:3], v[16:19], 0
  ds_read_b64_tr_b16 a[28:29], v243 offset:19456
  s_add_u32 s62, s54, 4129024
  v_mfma_f32_16x16x32_bf16 v[212:215], a[0:3], v[88:91], 0
  ds_read_b64_tr_b16 a[30:31], v243 offset:27648
  ds_read_b64_tr_b16 a[32:33], v240 offset:32768
  v_mfma_f32_16x16x32_bf16 v[216:219], a[4:7], v[16:19], 0
  ds_read_b64_tr_b16 a[34:35], v240 offset:40960
  buffer_load_dwordx4 v252, s[28:31], s62 offen  lds
  v_mfma_f32_16x16x32_bf16 v[220:223], a[4:7], v[88:91], 0
  ds_read_b64_tr_b16 a[36:37], v240 offset:33792
  buffer_store_dwordx4 a[56:59], v3, s[44:47], s68 offen offset:0 sc1
  v_mfma_f32_16x16x32_bf16 v[208:211], a[8:11], v[20:23], v[208:211]
  buffer_store_dwordx4 a[92:95], v3, s[44:47], s68 offen offset:1024 sc1
  v_mfma_f32_16x16x32_bf16 v[212:215], a[8:11], v[92:95], v[212:215]
  ds_read_b64_tr_b16 a[38:39], v240 offset:41984
  ds_read_b64_tr_b16 a[40:41], v241 offset:32768
  v_mfma_f32_16x16x32_bf16 v[216:219], a[12:15], v[20:23], v[216:219]
  buffer_load_dwordx4 v252, s[32:35], s62 offen offset:1024  lds
  v_mfma_f32_16x16x32_bf16 v[220:223], a[12:15], v[92:95], v[220:223]
  ds_read_b64_tr_b16 a[42:43], v241 offset:40960
  s_waitcnt lgkmcnt(6)
  v_mfma_f32_16x16x32_bf16 v[208:211], a[16:19], v[24:27], v[208:211]
  ds_read_b64_tr_b16 a[44:45], v241 offset:33792
  v_accvgpr_write_b32 a62, v232
  v_mfma_f32_16x16x32_bf16 v[212:215], a[16:19], v[96:99], v[212:215]
  ds_read_b64_tr_b16 a[46:47], v241 offset:41984
  ds_read_b64_tr_b16 a[0:1], v242 offset:32768
  v_mfma_f32_16x16x32_bf16 v[216:219], a[20:23], v[24:27], v[216:219]
  buffer_load_dwordx4 v253, s[28:31], s62 offen offset:2048  lds
  v_mfma_f32_16x16x32_bf16 v[220:223], a[20:23], v[96:99], v[220:223]
  ds_read_b64_tr_b16 a[2:3], v242 offset:40960
  v_accvgpr_write_b32 a63, v234
  v_mfma_f32_16x16x32_bf16 v[208:211], a[24:27], v[28:31], v[208:211]
  ds_read_b64_tr_b16 a[4:5], v242 offset:33792
  v_accvgpr_write_b32 a98, v236
  v_mfma_f32_16x16x32_bf16 v[212:215], a[24:27], v[100:103], v[212:215]
  ds_read_b64_tr_b16 a[6:7], v242 offset:41984
  ds_read_b64_tr_b16 a[8:9], v243 offset:32768
  v_mfma_f32_16x16x32_bf16 v[216:219], a[28:31], v[28:31], v[216:219]
  buffer_load_dwordx4 v253, s[32:35], s62 offen offset:3072  lds
  v_mfma_f32_16x16x32_bf16 v[220:223], a[28:31], v[100:103], v[220:223]
  ds_read_b64_tr_b16 a[10:11], v243 offset:40960
  s_waitcnt lgkmcnt(6)
  v_mfma_f32_16x16x32_bf16 v[160:163], a[32:35], v[32:35], v[160:163]
  ds_read_b64_tr_b16 a[12:13], v243 offset:33792
  s_add_u32 m0, s52, 131072
  s_add_u32 s62, s54, 4718848
  v_mfma_f32_16x16x32_bf16 v[164:167], a[32:35], v[104:107], v[164:167]
  ds_read_b64_tr_b16 a[14:15], v243 offset:41984
  ds_read_b64_tr_b16 a[16:17], v240 offset:34816
  v_mfma_f32_16x16x32_bf16 v[168:171], a[36:39], v[32:35], v[168:171]
  buffer_load_dwordx4 v252, s[28:31], s62 offen  lds
  v_mfma_f32_16x16x32_bf16 v[172:175], a[36:39], v[104:107], v[172:175]
  ds_read_b64_tr_b16 a[18:19], v240 offset:43008
  v_accvgpr_write_b32 a99, v238
  v_mfma_f32_16x16x32_bf16 v[176:179], a[40:43], v[32:35], v[176:179]
  ds_read_b64_tr_b16 a[20:21], v240 offset:35840
  v_mfma_f32_16x16x32_bf16 v[180:183], a[40:43], v[104:107], v[180:183]
  ds_read_b64_tr_b16 a[22:23], v240 offset:44032
  ds_read_b64_tr_b16 a[24:25], v241 offset:34816
  v_mfma_f32_16x16x32_bf16 v[184:187], a[44:47], v[32:35], v[184:187]
  buffer_load_dwordx4 v252, s[32:35], s62 offen offset:1024  lds
  v_mfma_f32_16x16x32_bf16 v[188:191], a[44:47], v[104:107], v[188:191]
  ds_read_b64_tr_b16 a[26:27], v241 offset:43008
  s_waitcnt lgkmcnt(6)
  v_mfma_f32_16x16x32_bf16 v[192:195], a[0:3], v[32:35], v[192:195]
  ds_read_b64_tr_b16 a[28:29], v241 offset:35840
  v_mfma_f32_16x16x32_bf16 v[196:199], a[0:3], v[104:107], v[196:199]
  ds_read_b64_tr_b16 a[30:31], v241 offset:44032
  ds_read_b64_tr_b16 a[32:33], v242 offset:34816
  v_mfma_f32_16x16x32_bf16 v[200:203], a[4:7], v[32:35], v[200:203]
  buffer_load_dwordx4 v253, s[28:31], s62 offen offset:2048  lds
  v_mfma_f32_16x16x32_bf16 v[204:207], a[4:7], v[104:107], v[204:207]
  ds_read_b64_tr_b16 a[34:35], v242 offset:43008
  v_mfma_f32_16x16x32_bf16 v[208:211], a[8:11], v[32:35], v[208:211]
  ds_read_b64_tr_b16 a[36:37], v242 offset:35840
  v_mfma_f32_16x16x32_bf16 v[212:215], a[8:11], v[104:107], v[212:215]
  ds_read_b64_tr_b16 a[38:39], v242 offset:44032
  ds_read_b64_tr_b16 a[40:41], v243 offset:34816
  v_mfma_f32_16x16x32_bf16 v[216:219], a[12:15], v[32:35], v[216:219]
  buffer_load_dwordx4 v253, s[32:35], s62 offen offset:3072  lds
  v_mfma_f32_16x16x32_bf16 v[220:223], a[12:15], v[104:107], v[220:223]
  ds_read_b64_tr_b16 a[42:43], v243 offset:43008
  s_waitcnt lgkmcnt(6)
  v_mfma_f32_16x16x32_bf16 v[160:163], a[16:19], v[36:39], v[160:163]
  ds_read_b64_tr_b16 a[44:45], v243 offset:35840
  ds_read_b64_tr_b16 a[46:47], v243 offset:44032
  v_mfma_f32_16x16x32_bf16 v[164:167], a[16:19], v[108:111], v[164:167]
  buffer_store_dwordx4 a[60:63], v3, s[44:47], s68 offen offset:2048 sc1
  v_mfma_f32_16x16x32_bf16 v[168:171], a[20:23], v[36:39], v[168:171]
  ds_read_b64_tr_b16 a[0:1], v244 offset:0
  v_mfma_f32_16x16x32_bf16 v[172:175], a[20:23], v[108:111], v[172:175]
  ds_read_b64_tr_b16 a[2:3], v244 offset:8192
  v_mfma_f32_16x16x32_bf16 v[176:179], a[24:27], v[36:39], v[176:179]
  ds_read_b64_tr_b16 a[4:5], v244 offset:1024
  v_mfma_f32_16x16x32_bf16 v[180:183], a[24:27], v[108:111], v[180:183]
  ds_read_b64_tr_b16 a[6:7], v244 offset:9216
  v_mfma_f32_16x16x32_bf16 v[184:187], a[28:31], v[36:39], v[184:187]
  ds_read_b64_tr_b16 a[8:9], v245 offset:0
  v_mfma_f32_16x16x32_bf16 v[188:191], a[28:31], v[108:111], v[188:191]
  ds_read_b64_tr_b16 a[10:11], v245 offset:8192
  s_waitcnt lgkmcnt(6)
  v_mfma_f32_16x16x32_bf16 v[192:195], a[32:35], v[36:39], v[192:195]
  ds_read_b64_tr_b16 a[12:13], v245 offset:1024
  v_mfma_f32_16x16x32_bf16 v[196:199], a[32:35], v[108:111], v[196:199]
  ds_read_b64_tr_b16 a[14:15], v245 offset:9216
  v_mfma_f32_16x16x32_bf16 v[200:203], a[36:39], v[36:39], v[200:203]
  ds_read_b64_tr_b16 a[16:17], v246 offset:0
  v_mfma_f32_16x16x32_bf16 v[204:207], a[36:39], v[108:111], v[204:207]
  ds_read_b64_tr_b16 a[18:19], v246 offset:8192
  v_mfma_f32_16x16x32_bf16 v[208:211], a[40:43], v[36:39], v[208:211]
  ds_read_b64_tr_b16 a[20:21], v246 offset:1024
  v_mfma_f32_16x16x32_bf16 v[212:215], a[40:43], v[108:111], v[212:215]
  ds_read_b64_tr_b16 a[22:23], v246 offset:9216
  v_mfma_f32_16x16x32_bf16 v[216:219], a[44:47], v[36:39], v[216:219]
  ds_read_b64_tr_b16 a[24:25], v247 offset:0
  v_mfma_f32_16x16x32_bf16 v[220:223], a[44:47], v[108:111], v[220:223]
  ds_read_b64_tr_b16 a[26:27], v247 offset:8192
  s_waitcnt lgkmcnt(6)
  v_mfma_f32_16x16x32_bf16 v[160:163], a[0:3], v[40:43], v[160:163]
  ds_read_b64_tr_b16 a[28:29], v247 offset:1024
  v_mfma_f32_16x16x32_bf16 v[164:167], a[0:3], v[112:115], v[164:167]
  ds_read_b64_tr_b16 a[30:31], v247 offset:9216
  v_mfma_f32_16x16x32_bf16 v[168:171], a[4:7], v[40:43], v[168:171]
  ds_read_b64_tr_b16 a[32:33], v244 offset:2048
  v_mfma_f32_16x16x32_bf16 v[172:175], a[4:7], v[112:115], v[172:175]
  ds_read_b64_tr_b16 a[34:35], v244 offset:10240
  v_mfma_f32_16x16x32_bf16 v[176:179], a[8:11], v[40:43], v[176:179]
  ds_read_b64_tr_b16 a[36:37], v244 offset:3072
  v_mfma_f32_16x16x32_bf16 v[180:183], a[8:11], v[112:115], v[180:183]
  ds_read_b64_tr_b16 a[38:39], v244 offset:11264
  v_mfma_f32_16x16x32_bf16 v[184:187], a[12:15], v[40:43], v[184:187]
  ds_read_b64_tr_b16 a[40:41], v245 offset:2048
  v_mfma_f32_16x16x32_bf16 v[188:191], a[12:15], v[112:115], v[188:191]
  ds_read_b64_tr_b16 a[42:43], v245 offset:10240
  s_waitcnt lgkmcnt(6)
  v_mfma_f32_16x16x32_bf16 v[192:195], a[16:19], v[40:43], v[192:195]
  ds_read_b64_tr_b16 a[44:45], v245 offset:3072
  v_mfma_f32_16x16x32_bf16 v[196:199], a[16:19], v[112:115], v[196:199]
  ds_read_b64_tr_b16 a[46:47], v245 offset:11264
  v_mfma_f32_16x16x32_bf16 v[200:203], a[20:23], v[40:43], v[200:203]
  ds_read_b64_tr_b16 a[0:1], v246 offset:2048
  v_mfma_f32_16x16x32_bf16 v[204:207], a[20:23], v[112:115], v[204:207]
  ds_read_b64_tr_b16 a[2:3], v246 offset:10240
  v_mfma_f32_16x16x32_bf16 v[208:211], a[24:27], v[40:43], v[208:211]
  ds_read_b64_tr_b16 a[4:5], v246 offset:3072
  v_mfma_f32_16x16x32_bf16 v[212:215], a[24:27], v[112:115], v[212:215]
  ds_read_b64_tr_b16 a[6:7], v246 offset:11264
  s_waitcnt vmcnt(16)
  s_barrier
  v_mfma_f32_16x16x32_bf16 v[216:219], a[28:31], v[40:43], v[216:219]
  ds_read_b64_tr_b16 a[8:9], v247 offset:2048
  s_add_u32 m0, s52, 0
  v_mfma_f32_16x16x32_bf16 v[220:223], a[28:31], v[112:115], v[220:223]
  ds_read_b64_tr_b16 a[10:11], v247 offset:10240
  s_waitcnt lgkmcnt(6)
  v_mfma_f32_16x16x32_bf16 v[160:163], a[32:35], v[44:47], v[160:163]
  ds_read_b64_tr_b16 a[12:13], v247 offset:3072
  s_add_u32 s62, s54, 384
  v_mfma_f32_16x16x32_bf16 v[164:167], a[32:35], v[116:119], v[164:167]
  ds_read_b64_tr_b16 a[14:15], v247 offset:11264
  ds_read_b64_tr_b16 a[16:17], v244 offset:16384
  v_mfma_f32_16x16x32_bf16 v[168:171], a[36:39], v[44:47], v[168:171]
  buffer_load_dwordx4 v252, s[28:31], s62 offen  lds
  v_mfma_f32_16x16x32_bf16 v[172:175], a[36:39], v[116:119], v[172:175]
  ds_read_b64_tr_b16 a[18:19], v244 offset:24576
  v_accvgpr_read_b32 v8, a212
  v_mfma_f32_16x16x32_bf16 v[176:179], a[40:43], v[44:47], v[176:179]
  ds_read_b64_tr_b16 a[20:21], v244 offset:17408
  ds_read_b64_tr_b16 v[10:11], v8 offset:0
  v_mfma_f32_16x16x32_bf16 v[180:183], a[40:43], v[116:119], v[180:183]
  ds_read_b64_tr_b16 a[22:23], v244 offset:25600
  ds_read_b64_tr_b16 a[24:25], v245 offset:16384
  v_mfma_f32_16x16x32_bf16 v[184:187], a[44:47], v[44:47], v[184:187]
  buffer_load_dwordx4 v252, s[32:35], s62 offen offset:1024  lds
  v_mfma_f32_16x16x32_bf16 v[188:191], a[44:47], v[116:119], v[188:191]
  ds_read_b64_tr_b16 a[26:27], v245 offset:24576
  s_waitcnt lgkmcnt(7)
  v_mfma_f32_16x16x32_bf16 v[192:195], a[0:3], v[44:47], v[192:195]
  ds_read_b64_tr_b16 a[28:29], v245 offset:17408
  ds_read_b64_tr_b16 v[12:13], v8 offset:512
  v_mfma_f32_16x16x32_bf16 v[196:199], a[0:3], v[116:119], v[196:199]
  ds_read_b64_tr_b16 a[30:31], v245 offset:25600
  ds_read_b64_tr_b16 a[32:33], v246 offset:16384
  v_mfma_f32_16x16x32_bf16 v[200:203], a[4:7], v[44:47], v[200:203]
  ds_read_b64_tr_b16 a[34:35], v246 offset:24576
  buffer_load_dwordx4 v253, s[28:31], s62 offen offset:2048  lds
  v_mfma_f32_16x16x32_bf16 v[204:207], a[4:7], v[116:119], v[204:207]
  buffer_store_dwordx4 a[96:99], v3, s[44:47], s68 offen offset:3072 sc1
  v_mfma_f32_16x16x32_bf16 v[208:211], a[8:11], v[44:47], v[208:211]
  ds_read_b64_tr_b16 a[36:37], v246 offset:17408
  ds_read_b64_tr_b16 v[14:15], v8 offset:2048
  v_mfma_f32_16x16x32_bf16 v[212:215], a[8:11], v[116:119], v[212:215]
  ds_read_b64_tr_b16 a[38:39], v246 offset:25600
  ds_read_b64_tr_b16 a[40:41], v247 offset:16384
  v_mfma_f32_16x16x32_bf16 v[216:219], a[12:15], v[44:47], v[216:219]
  buffer_load_dwordx4 v253, s[32:35], s62 offen offset:3072  lds
  v_mfma_f32_16x16x32_bf16 v[220:223], a[12:15], v[116:119], v[220:223]
  ds_read_b64_tr_b16 a[42:43], v247 offset:24576
  s_waitcnt lgkmcnt(7)
  v_mfma_f32_16x16x32_bf16 v[160:163], a[16:19], v[48:51], v[160:163]
  ds_read_b64_tr_b16 a[44:45], v247 offset:17408
  s_add_u32 m0, s52, 16384
  s_add_u32 s62, s54, 590208
  v_mfma_f32_16x16x32_bf16 v[164:167], a[16:19], v[120:123], v[164:167]
  ds_read_b64_tr_b16 a[46:47], v247 offset:25600
  ds_read_b64_tr_b16 a[0:1], v244 offset:18432
  v_mfma_f32_16x16x32_bf16 v[168:171], a[20:23], v[48:51], v[168:171]
  buffer_load_dwordx4 v252, s[28:31], s62 offen  lds
  v_mfma_f32_16x16x32_bf16 v[172:175], a[20:23], v[120:123], v[172:175]
  ds_read_b64_tr_b16 a[2:3], v244 offset:26624
  ds_read_b64_tr_b16 v[224:225], v8 offset:1024
  v_mfma_f32_16x16x32_bf16 v[176:179], a[24:27], v[48:51], v[176:179]
  ds_read_b64_tr_b16 a[4:5], v244 offset:19456
  ds_read_b64_tr_b16 v[226:227], v8 offset:1536
  v_mfma_f32_16x16x32_bf16 v[180:183], a[24:27], v[120:123], v[180:183]
  ds_read_b64_tr_b16 a[6:7], v244 offset:27648
  ds_read_b64_tr_b16 a[8:9], v245 offset:18432
  v_mfma_f32_16x16x32_bf16 v[184:187], a[28:31], v[48:51], v[184:187]
  buffer_load_dwordx4 v252, s[32:35], s62 offen offset:1024  lds
  v_mfma_f32_16x16x32_bf16 v[188:191], a[28:31], v[120:123], v[188:191]
  ds_read_b64_tr_b16 a[10:11], v245 offset:26624
  s_waitcnt lgkmcnt(8)
  v_mfma_f32_16x16x32_bf16 v[192:195], a[32:35], v[48:51], v[192:195]
  ds_read_b64_tr_b16 a[12:13], v245 offset:19456
  v_accvgpr_read_b32 v228, a218
  v_mfma_f32_16x16x32_bf16 v[196:199], a[32:35], v[120:123], v[196:199]
  ds_read_b64_tr_b16 a[14:15], v245 offset:27648
  ds_read_b64_tr_b16 a[16:17], v246 offset:18432
  v_mfma_f32_16x16x32_bf16 v[200:203], a[36:39], v[48:51], v[200:203]
  buffer_load_dwordx4 v253, s[28:31], s62 offen offset:2048  lds
  v_mfma_f32_16x16x32_bf16 v[204:207], a[36:39], v[120:123], v[204:207]
  ds_read_b64_tr_b16 a[18:19], v246 offset:26624
  v_accvgpr_read_b32 v229, a219
  v_mfma_f32_16x16x32_bf16 v[208:211], a[40:43], v[48:51], v[208:211]
  ds_read_b64_tr_b16 a[20:21], v246 offset:19456
  v_lshlrev_b32 v230, 16, v228
  v_mfma_f32_16x16x32_bf16 v[212:215], a[40:43], v[120:123], v[212:215]
  ds_read_b64_tr_b16 a[22:23], v246 offset:27648
  ds_read_b64_tr_b16 a[24:25], v247 offset:18432
  v_mfma_f32_16x16x32_bf16 v[216:219], a[44:47], v[48:51], v[216:219]
  buffer_load_dwordx4 v253, s[32:35], s62 offen offset:3072  lds
  v_mfma_f32_16x16x32_bf16 v[220:223], a[44:47], v[120:123], v[220:223]
  ds_read_b64_tr_b16 a[26:27], v247 offset:26624
  s_waitcnt lgkmcnt(6)
  v_mfma_f32_16x16x32_bf16 v[160:163], a[0:3], v[52:55], v[160:163]
  ds_read_b64_tr_b16 a[28:29], v247 offset:19456
  s_add_u32 m0, s52, 32768
  s_add_u32 s62, s54, 1180032
  v_mfma_f32_16x16x32_bf16 v[164:167], a[0:3], v[124:127], v[164:167]
  ds_read_b64_tr_b16 a[30:31], v247 offset:27648
  ds_read_b64_tr_b16 a[32:33], v244 offset:32768
  v_mfma_f32_16x16x32_bf16 v[168:171], a[4:7], v[52:55], v[168:171]
  buffer_load_dwordx4 v252, s[28:31], s62 offen  lds
  v_mfma_f32_16x16x32_bf16 v[172:175], a[4:7], v[124:127], v[172:175]
  ds_read_b64_tr_b16 a[34:35], v244 offset:40960
  v_and_b32 v231, 0xffff0000, v228
  v_mfma_f32_16x16x32_bf16 v[176:179], a[8:11], v[52:55], v[176:179]
  ds_read_b64_tr_b16 a[36:37], v244 offset:33792
  v_lshlrev_b32 v232, 16, v229
  v_mfma_f32_16x16x32_bf16 v[180:183], a[8:11], v[124:127], v[180:183]
  ds_read_b64_tr_b16 a[38:39], v244 offset:41984
  ds_read_b64_tr_b16 a[40:41], v245 offset:32768
  v_mfma_f32_16x16x32_bf16 v[184:187], a[12:15], v[52:55], v[184:187]
  buffer_load_dwordx4 v252, s[32:35], s62 offen offset:1024  lds
  v_mfma_f32_16x16x32_bf16 v[188:191], a[12:15], v[124:127], v[188:191]
  ds_read_b64_tr_b16 a[42:43], v245 offset:40960
  s_waitcnt lgkmcnt(6)
  v_mfma_f32_16x16x32_bf16 v[192:195], a[16:19], v[52:55], v[192:195]
  ds_read_b64_tr_b16 a[44:45], v245 offset:33792
  v_and_b32 v233, 0xffff0000, v229
  v_mfma_f32_16x16x32_bf16 v[196:199], a[16:19], v[124:127], v[196:199]
  ds_read_b64_tr_b16 a[46:47], v245 offset:41984
  ds_read_b64_tr_b16 a[0:1], v246 offset:32768
  v_mfma_f32_16x16x32_bf16 v[200:203], a[20:23], v[52:55], v[200:203]
  buffer_load_dwordx4 v253, s[28:31], s62 offen offset:2048  lds
  v_mfma_f32_16x16x32_bf16 v[204:207], a[20:23], v[124:127], v[204:207]
  ds_read_b64_tr_b16 a[2:3], v246 offset:40960
  v_mfma_f32_16x16x32_bf16 v[208:211], a[24:27], v[52:55], v[208:211]
  ds_read_b64_tr_b16 a[4:5], v246 offset:33792
  v_and_b32 v235, 0xffff0000, v10
  v_mfma_f32_16x16x32_bf16 v[212:215], a[24:27], v[124:127], v[212:215]
  ds_read_b64_tr_b16 a[6:7], v246 offset:41984
  ds_read_b64_tr_b16 a[8:9], v247 offset:32768
  v_mfma_f32_16x16x32_bf16 v[216:219], a[28:31], v[52:55], v[216:219]
  buffer_load_dwordx4 v253, s[32:35], s62 offen offset:3072  lds
  v_mfma_f32_16x16x32_bf16 v[220:223], a[28:31], v[124:127], v[220:223]
  ds_read_b64_tr_b16 a[10:11], v247 offset:40960
  s_waitcnt lgkmcnt(6)
  v_mfma_f32_16x16x32_bf16 v[160:163], a[32:35], v[56:59], v[160:163]
  ds_read_b64_tr_b16 a[12:13], v247 offset:33792
  s_add_u32 m0, s52, 49152
  v_mfma_f32_16x16x32_bf16 v[164:167], a[32:35], v[128:131], v[164:167]
  ds_read_b64_tr_b16 a[14:15], v247 offset:41984
  s_add_u32 s62, s54, 1769856
  v_mfma_f32_16x16x32_bf16 v[168:171], a[36:39], v[56:59], v[168:171]
  ds_read_b64_tr_b16 a[16:17], v244 offset:34816
  v_lshlrev_b32 v236, 16, v11
  v_mfma_f32_16x16x32_bf16 v[172:175], a[36:39], v[128:131], v[172:175]
  ds_read_b64_tr_b16 a[18:19], v244 offset:43008
  v_and_b32 v237, 0xffff0000, v11
  v_mfma_f32_16x16x32_bf16 v[176:179], a[40:43], v[56:59], v[176:179]
  ds_read_b64_tr_b16 a[20:21], v244 offset:35840
  v_lshlrev_b32 v238, 16, v12
  v_mfma_f32_16x16x32_bf16 v[180:183], a[40:43], v[128:131], v[180:183]
  ds_read_b64_tr_b16 a[22:23], v244 offset:44032
  ds_read_b64_tr_b16 a[24:25], v245 offset:34816
  v_mfma_f32_16x16x32_bf16 v[184:187], a[44:47], v[56:59], v[184:187]
  buffer_load_dwordx4 v252, s[28:31], s62 offen  lds
  v_mfma_f32_16x16x32_bf16 v[188:191], a[44:47], v[128:131], v[188:191]
  ds_read_b64_tr_b16 a[26:27], v245 offset:43008
  s_waitcnt lgkmcnt(6)
  v_mfma_f32_16x16x32_bf16 v[192:195], a[0:3], v[56:59], v[192:195]
  ds_read_b64_tr_b16 a[28:29], v245 offset:35840
  v_mul_f32 v228, v233, v235
  v_mfma_f32_16x16x32_bf16 v[196:199], a[0:3], v[128:131], v[196:199]
  ds_read_b64_tr_b16 a[30:31], v245 offset:44032
  v_fmac_f32 v228, v232, v236
  v_mfma_f32_16x16x32_bf16 v[200:203], a[4:7], v[56:59], v[200:203]
  ds_read_b64_tr_b16 a[32:33], v246 offset:34816
  v_fmac_f32 v228, v231, v237
  v_mfma_f32_16x16x32_bf16 v[204:207], a[4:7], v[128:131], v[204:207]
  ds_read_b64_tr_b16 a[34:35], v246 offset:43008
  v_lshlrev_b32 v239, 16, v224
  v_mfma_f32_16x16x32_bf16 v[208:211], a[8:11], v[56:59], v[208:211]
  ds_read_b64_tr_b16 a[36:37], v246 offset:35840
  v_fmac_f32 v228, v230, v238
  v_mfma_f32_16x16x32_bf16 v[212:215], a[8:11], v[128:131], v[212:215]
  ds_read_b64_tr_b16 a[38:39], v246 offset:44032
  s_waitcnt vmcnt(15)
  s_barrier
  v_mfma_f32_16x16x32_bf16 v[216:219], a[12:15], v[56:59], v[216:219]
  ds_read_b64_tr_b16 a[40:41], v247 offset:34816
  v_mul_f32 v228, v228, v239
  v_mfma_f32_16x16x32_bf16 v[220:223], a[12:15], v[128:131], v[220:223]
  ds_read_b64_tr_b16 a[42:43], v247 offset:43008
  s_waitcnt lgkmcnt(6)
  v_mfma_f32_16x16x32_bf16 v[160:163], a[16:19], v[60:63], v[160:163]
  ds_read_b64_tr_b16 a[44:45], v247 offset:35840
  v_and_b32 v234, 0xffff0000, v12
  v_mfma_f32_16x16x32_bf16 v[164:167], a[16:19], v[132:135], v[164:167]
  ds_read_b64_tr_b16 a[46:47], v247 offset:44032
  ds_read_b64_tr_b16 a[0:1], v248 offset:0
  v_mfma_f32_16x16x32_bf16 v[168:171], a[20:23], v[60:63], v[168:171]
  buffer_load_dwordx4 v252, s[32:35], s62 offen offset:1024  lds
  v_mfma_f32_16x16x32_bf16 v[172:175], a[20:23], v[132:135], v[172:175]
  ds_read_b64_tr_b16 a[2:3], v248 offset:8192
  v_mul_f32 v229, v233, v236
  v_mfma_f32_16x16x32_bf16 v[176:179], a[24:27], v[60:63], v[176:179]
  ds_read_b64_tr_b16 a[4:5], v248 offset:1024
  v_fmac_f32 v229, v232, v237
  v_mfma_f32_16x16x32_bf16 v[180:183], a[24:27], v[132:135], v[180:183]
  ds_read_b64_tr_b16 a[6:7], v248 offset:9216
  ds_read_b64_tr_b16 a[8:9], v249 offset:0
  v_mfma_f32_16x16x32_bf16 v[184:187], a[28:31], v[60:63], v[184:187]
  buffer_load_dwordx4 v253, s[28:31], s62 offen offset:2048  lds
  v_mfma_f32_16x16x32_bf16 v[188:191], a[28:31], v[132:135], v[188:191]
  ds_read_b64_tr_b16 a[10:11], v249 offset:8192
  s_waitcnt lgkmcnt(6)
  v_mfma_f32_16x16x32_bf16 v[192:195], a[32:35], v[60:63], v[192:195]
  ds_read_b64_tr_b16 a[12:13], v249 offset:1024
  v_fmac_f32 v229, v231, v238
  v_mfma_f32_16x16x32_bf16 v[196:199], a[32:35], v[132:135], v[196:199]
  ds_read_b64_tr_b16 a[14:15], v249 offset:9216
  v_and_b32 v239, 0xffff0000, v224
  v_mfma_f32_16x16x32_bf16 v[200:203], a[36:39], v[60:63], v[200:203]
  ds_read_b64_tr_b16 a[16:17], v250 offset:0
  v_fmac_f32 v229, v230, v234
  v_mfma_f32_16x16x32_bf16 v[204:207], a[36:39], v[132:135], v[204:207]
  ds_read_b64_tr_b16 a[18:19], v250 offset:8192
  v_mul_f32 v229, v229, v239
  v_mfma_f32_16x16x32_bf16 v[208:211], a[40:43], v[60:63], v[208:211]
  ds_read_b64_tr_b16 a[20:21], v250 offset:1024
  v_cvt_pk_bf16_f32 v11, v229, v228
  v_mfma_f32_16x16x32_bf16 v[212:215], a[40:43], v[132:135], v[212:215]
  ds_read_b64_tr_b16 a[22:23], v250 offset:9216
  ds_read_b64_tr_b16 a[24:25], v251 offset:0
  v_mfma_f32_16x16x32_bf16 v[216:219], a[44:47], v[60:63], v[216:219]
  buffer_load_dwordx4 v253, s[32:35], s62 offen offset:3072  lds
  v_mfma_f32_16x16x32_bf16 v[220:223], a[44:47], v[132:135], v[220:223]
  ds_read_b64_tr_b16 a[26:27], v251 offset:8192
  v_accvgpr_read_b32 v255, a211
  s_waitcnt lgkmcnt(6)
  v_mfma_f32_16x16x32_bf16 v[160:163], a[0:3], v[64:67], v[160:163]
  ds_read_b64_tr_b16 a[28:29], v251 offset:1024
  v_lshlrev_b32 v235, 16, v13
  s_mov_b32 m0, s96
  v_mfma_f32_16x16x32_bf16 v[164:167], a[0:3], v[136:139], v[164:167]
  ds_read_b64_tr_b16 a[30:31], v251 offset:9216
  v_mul_f32 v228, v233, v237
  v_mfma_f32_16x16x32_bf16 v[168:171], a[4:7], v[64:67], v[168:171]
  ds_read_b64_tr_b16 a[32:33], v248 offset:2048
  v_fmac_f32 v228, v232, v238
  v_mfma_f32_16x16x32_bf16 v[172:175], a[4:7], v[136:139], v[172:175]
  ds_read_b64_tr_b16 a[34:35], v248 offset:10240
  v_fmac_f32 v228, v231, v234
  v_mfma_f32_16x16x32_bf16 v[176:179], a[8:11], v[64:67], v[176:179]
  ds_read_b64_tr_b16 a[36:37], v248 offset:3072
  buffer_load_dwordx4 v255, s[48:51], s10 offen  lds
  v_add_u32 v255, 4608, v255
  buffer_load_dwordx4 v255, s[84:87], s10 offen offset:1024  lds
  s_mov_b32 m0, 155648
  v_add_u32 v255, s71, v255
  buffer_load_dwordx4 v255, s[48:51], s10 offen  lds
  s_add_u32 m0, s52, 65536
  s_add_u32 s62, s54, 2359680
  v_mfma_f32_16x16x32_bf16 v[180:183], a[8:11], v[136:139], v[180:183]
  ds_read_b64_tr_b16 a[38:39], v248 offset:11264
  v_lshlrev_b32 v239, 16, v225
  v_mfma_f32_16x16x32_bf16 v[184:187], a[12:15], v[64:67], v[184:187]
  ds_read_b64_tr_b16 a[40:41], v249 offset:2048
  buffer_load_dwordx4 v252, s[28:31], s62 offen  lds
  v_mfma_f32_16x16x32_bf16 v[188:191], a[12:15], v[136:139], v[188:191]
  ds_read_b64_tr_b16 a[42:43], v249 offset:10240
  v_fmac_f32 v228, v230, v235
  s_waitcnt lgkmcnt(6)
  v_mfma_f32_16x16x32_bf16 v[192:195], a[16:19], v[64:67], v[192:195]
  ds_read_b64_tr_b16 a[44:45], v249 offset:3072
  v_mul_f32 v228, v228, v239
  v_and_b32 v236, 0xffff0000, v13
  v_mfma_f32_16x16x32_bf16 v[196:199], a[16:19], v[136:139], v[196:199]
  ds_read_b64_tr_b16 a[46:47], v249 offset:11264
  v_mul_f32 v229, v233, v238
  v_fmac_f32 v229, v232, v234
  v_mfma_f32_16x16x32_bf16 v[200:203], a[20:23], v[64:67], v[200:203]
  ds_read_b64_tr_b16 a[0:1], v250 offset:2048
  v_fmac_f32 v229, v231, v235
  v_and_b32 v239, 0xffff0000, v225
  v_mfma_f32_16x16x32_bf16 v[204:207], a[20:23], v[136:139], v[204:207]
  ds_read_b64_tr_b16 a[2:3], v250 offset:10240
  v_fmac_f32 v229, v230, v236
  v_mul_f32 v229, v229, v239
  v_mfma_f32_16x16x32_bf16 v[208:211], a[24:27], v[64:67], v[208:211]
  ds_read_b64_tr_b16 a[4:5], v250 offset:3072
  v_cvt_pk_bf16_f32 v10, v229, v228
  v_mfma_f32_16x16x32_bf16 v[212:215], a[24:27], v[136:139], v[212:215]
  ds_read_b64_tr_b16 a[6:7], v250 offset:11264
  v_lshlrev_b32 v237, 16, v14
  v_mfma_f32_16x16x32_bf16 v[216:219], a[28:31], v[64:67], v[216:219]
  ds_read_b64_tr_b16 a[8:9], v251 offset:2048
  buffer_load_dwordx4 v252, s[32:35], s62 offen offset:1024  lds
  v_mfma_f32_16x16x32_bf16 v[220:223], a[28:31], v[136:139], v[220:223]
  ds_read_b64_tr_b16 a[10:11], v251 offset:10240
  v_mul_f32 v228, v233, v234
  s_waitcnt lgkmcnt(6)
  v_mfma_f32_16x16x32_bf16 v[160:163], a[32:35], v[68:71], v[160:163]
  ds_read_b64_tr_b16 a[12:13], v251 offset:3072
  v_fmac_f32 v228, v232, v235
  v_fmac_f32 v228, v231, v236
  v_mfma_f32_16x16x32_bf16 v[164:167], a[32:35], v[140:143], v[164:167]
  ds_read_b64_tr_b16 a[14:15], v251 offset:11264
  v_lshlrev_b32 v239, 16, v226
  v_mfma_f32_16x16x32_bf16 v[168:171], a[36:39], v[68:71], v[168:171]
  ds_read_b64_tr_b16 a[16:17], v248 offset:16384
  v_fmac_f32 v228, v230, v237
  v_mfma_f32_16x16x32_bf16 v[172:175], a[36:39], v[140:143], v[172:175]
  ds_read_b64_tr_b16 a[18:19], v248 offset:24576
  v_mul_f32 v228, v228, v239
  v_mfma_f32_16x16x32_bf16 v[176:179], a[40:43], v[68:71], v[176:179]
  ds_read_b64_tr_b16 a[20:21], v248 offset:17408
  v_and_b32 v238, 0xffff0000, v14
  v_mfma_f32_16x16x32_bf16 v[180:183], a[40:43], v[140:143], v[180:183]
  ds_read_b64_tr_b16 a[22:23], v248 offset:25600
  v_mul_f32 v229, v233, v235
  v_mfma_f32_16x16x32_bf16 v[184:187], a[44:47], v[68:71], v[184:187]
  ds_read_b64_tr_b16 a[24:25], v248 offset:18432
  buffer_load_dwordx4 v253, s[28:31], s62 offen offset:2048  lds
  v_mfma_f32_16x16x32_bf16 v[188:191], a[44:47], v[140:143], v[188:191]
  ds_read_b64_tr_b16 a[26:27], v248 offset:26624
  v_fmac_f32 v229, v232, v236
  s_waitcnt lgkmcnt(6)
  v_mfma_f32_16x16x32_bf16 v[192:195], a[0:3], v[68:71], v[192:195]
  ds_read_b64_tr_b16 a[28:29], v248 offset:19456
  v_fmac_f32 v229, v231, v237
  v_and_b32 v239, 0xffff0000, v226
  v_mfma_f32_16x16x32_bf16 v[196:199], a[0:3], v[140:143], v[196:199]
  ds_read_b64_tr_b16 a[30:31], v248 offset:27648
  v_fmac_f32 v229, v230, v238
  v_mfma_f32_16x16x32_bf16 v[200:203], a[4:7], v[68:71], v[200:203]
  ds_read_b64_tr_b16 a[32:33], v248 offset:32768
  v_mul_f32 v229, v229, v239
  v_mfma_f32_16x16x32_bf16 v[204:207], a[4:7], v[140:143], v[204:207]
  ds_read_b64_tr_b16 a[34:35], v248 offset:40960
  v_cvt_pk_bf16_f32 v9, v229, v228
  v_mfma_f32_16x16x32_bf16 v[208:211], a[8:11], v[68:71], v[208:211]
  ds_read_b64_tr_b16 a[36:37], v248 offset:33792
  v_lshlrev_b32 v234, 16, v15
  v_mfma_f32_16x16x32_bf16 v[212:215], a[8:11], v[140:143], v[212:215]
  ds_read_b64_tr_b16 a[38:39], v248 offset:41984
  v_mul_f32 v228, v233, v236
  v_mfma_f32_16x16x32_bf16 v[216:219], a[12:15], v[68:71], v[216:219]
  ds_read_b64_tr_b16 a[40:41], v248 offset:34816
  buffer_load_dwordx4 v253, s[32:35], s62 offen offset:3072  lds
  v_mfma_f32_16x16x32_bf16 v[220:223], a[12:15], v[140:143], v[220:223]
  ds_read_b64_tr_b16 a[42:43], v248 offset:43008
  v_fmac_f32 v228, v232, v237
  s_waitcnt lgkmcnt(6)
  v_mfma_f32_16x16x32_bf16 v[160:163], a[16:19], v[72:75], v[160:163]
  ds_read_b64_tr_b16 a[44:45], v248 offset:35840
  v_fmac_f32 v228, v231, v238
  v_lshlrev_b32 v239, 16, v227
  v_mfma_f32_16x16x32_bf16 v[164:167], a[16:19], v[144:147], v[164:167]
  ds_read_b64_tr_b16 a[46:47], v248 offset:44032
  v_fmac_f32 v228, v230, v234
  v_mfma_f32_16x16x32_bf16 v[168:171], a[20:23], v[72:75], v[168:171]
  ds_read_b64_tr_b16 a[0:1], v249 offset:16384
  v_mul_f32 v228, v228, v239
  v_mfma_f32_16x16x32_bf16 v[172:175], a[20:23], v[144:147], v[172:175]
  ds_read_b64_tr_b16 a[2:3], v249 offset:24576
  v_and_b32 v235, 0xffff0000, v15
  v_mfma_f32_16x16x32_bf16 v[160:163], a[24:27], v[76:79], v[160:163]
  ds_read_b64_tr_b16 a[4:5], v249 offset:17408
  s_add_u32 m0, s52, 81920
  s_add_u32 s62, s54, 2949504
  v_mfma_f32_16x16x32_bf16 v[164:167], a[24:27], v[148:151], v[164:167]
  ds_read_b64_tr_b16 a[6:7], v249 offset:25600
  v_mul_f32 v229, v233, v237
  v_mfma_f32_16x16x32_bf16 v[168:171], a[28:31], v[76:79], v[168:171]
  ds_read_b64_tr_b16 a[8:9], v249 offset:18432
  buffer_load_dwordx4 v252, s[28:31], s62 offen  lds
  v_mfma_f32_16x16x32_bf16 v[172:175], a[28:31], v[148:151], v[172:175]
  ds_read_b64_tr_b16 a[10:11], v249 offset:26624
  v_fmac_f32 v229, v232, v238
  s_waitcnt lgkmcnt(6)
  v_mfma_f32_16x16x32_bf16 v[160:163], a[32:35], v[80:83], v[160:163]
  ds_read_b64_tr_b16 a[12:13], v249 offset:19456
  v_fmac_f32 v229, v231, v234
  v_and_b32 v239, 0xffff0000, v227
  v_mfma_f32_16x16x32_bf16 v[164:167], a[32:35], v[152:155], v[164:167]
  ds_read_b64_tr_b16 a[14:15], v249 offset:27648
  v_fmac_f32 v229, v230, v235
  v_mul_f32 v229, v229, v239
  v_mfma_f32_16x16x32_bf16 v[168:171], a[36:39], v[80:83], v[168:171]
  ds_read_b64_tr_b16 a[16:17], v249 offset:32768
  v_cvt_pk_bf16_f32 v8, v229, v228
  v_mfma_f32_16x16x32_bf16 v[172:175], a[36:39], v[152:155], v[172:175]
  ds_read_b64_tr_b16 a[18:19], v249 offset:40960
  v_accvgpr_read_b32 v239, a213
  buffer_store_dwordx4 v[8:11], v239, s[44:47], s74 offen sc1
  v_mfma_f32_16x16x32_bf16 v[160:163], a[40:43], v[84:87], v[160:163]
  ds_read_b64_tr_b16 a[20:21], v249 offset:33792
  v_add_u32 v5, 1, v5
  v_mfma_f32_16x16x32_bf16 v[164:167], a[40:43], v[156:159], v[164:167]
  ds_read_b64_tr_b16 a[22:23], v249 offset:41984
  s_waitcnt vmcnt(22)
  s_waitcnt vmcnt(17)
  s_barrier
  v_mfma_f32_16x16x32_bf16 v[168:171], a[44:47], v[84:87], v[168:171]
  ds_read_b64_tr_b16 a[24:25], v249 offset:34816
  v_accvgpr_read_b32 v254, a204
  v_mfma_f32_16x16x32_bf16 v[172:175], a[44:47], v[156:159], v[172:175]
  ds_read_b64_tr_b16 a[26:27], v249 offset:43008
  s_waitcnt lgkmcnt(6)
  v_mfma_f32_16x16x32_bf16 v[176:179], a[0:3], v[72:75], v[176:179]
  ds_read_b64_tr_b16 a[28:29], v249 offset:35840
  v_mfma_f32_16x16x32_bf16 v[180:183], a[0:3], v[144:147], v[180:183]
  ds_read_b64_tr_b16 a[30:31], v249 offset:44032
  ds_read_b64_tr_b16 a[32:33], v250 offset:16384
  v_mfma_f32_16x16x32_bf16 v[184:187], a[4:7], v[72:75], v[184:187]
  ds_read_b64_tr_b16 a[34:35], v250 offset:24576
  buffer_load_dwordx4 v252, s[32:35], s62 offen offset:1024  lds
  v_mfma_f32_16x16x32_bf16 v[188:191], a[4:7], v[144:147], v[188:191]
  buffer_store_dword v5, v1, s[44:47], s90 offen sc1
  v_mfma_f32_16x16x32_bf16 v[176:179], a[8:11], v[76:79], v[176:179]
  ds_read_b64_tr_b16 a[36:37], v250 offset:17408
  v_mul_f32 v224, v160, v168
  v_mfma_f32_16x16x32_bf16 v[180:183], a[8:11], v[148:151], v[180:183]
  ds_read_b64_tr_b16 a[38:39], v250 offset:25600
  ds_read_b64_tr_b16 a[40:41], v250 offset:18432
  v_mfma_f32_16x16x32_bf16 v[184:187], a[12:15], v[76:79], v[184:187]
  buffer_load_dwordx4 v253, s[28:31], s62 offen offset:2048  lds
  v_mfma_f32_16x16x32_bf16 v[188:191], a[12:15], v[148:151], v[188:191]
  ds_read_b64_tr_b16 a[42:43], v250 offset:26624
  s_waitcnt lgkmcnt(6)
  v_mfma_f32_16x16x32_bf16 v[176:179], a[16:19], v[80:83], v[176:179]
  ds_read_b64_tr_b16 a[44:45], v250 offset:19456
  v_mul_f32 v225, v161, v169
  v_mfma_f32_16x16x32_bf16 v[180:183], a[16:19], v[152:155], v[180:183]
  ds_read_b64_tr_b16 a[46:47], v250 offset:27648
  v_mul_f32 v226, v162, v170
  v_mfma_f32_16x16x32_bf16 v[184:187], a[20:23], v[80:83], v[184:187]
  ds_read_b64_tr_b16 a[0:1], v250 offset:32768
  v_mul_f32 v227, v163, v171
  v_mfma_f32_16x16x32_bf16 v[188:191], a[20:23], v[152:155], v[188:191]
  ds_read_b64_tr_b16 a[2:3], v250 offset:40960
  v_mul_f32 v228, v164, v172
  v_mfma_f32_16x16x32_bf16 v[176:179], a[24:27], v[84:87], v[176:179]
  ds_read_b64_tr_b16 a[4:5], v250 offset:33792
  v_mul_f32 v229, v165, v173
  v_mfma_f32_16x16x32_bf16 v[180:183], a[24:27], v[156:159], v[180:183]
  ds_read_b64_tr_b16 a[6:7], v250 offset:41984
  ds_read_b64_tr_b16 a[8:9], v250 offset:34816
  v_mfma_f32_16x16x32_bf16 v[184:187], a[28:31], v[84:87], v[184:187]
  buffer_load_dwordx4 v253, s[32:35], s62 offen offset:3072  lds
  v_mfma_f32_16x16x32_bf16 v[188:191], a[28:31], v[156:159], v[188:191]
  ds_read_b64_tr_b16 a[10:11], v250 offset:43008
  s_waitcnt lgkmcnt(6)
  v_mfma_f32_16x16x32_bf16 v[192:195], a[32:35], v[72:75], v[192:195]
  ds_read_b64_tr_b16 a[12:13], v250 offset:35840
  s_add_u32 m0, s52, 98304
  v_mfma_f32_16x16x32_bf16 v[196:199], a[32:35], v[144:147], v[196:199]
  ds_read_b64_tr_b16 a[14:15], v250 offset:44032
  s_add_u32 s62, s54, 3539328
  v_mfma_f32_16x16x32_bf16 v[200:203], a[36:39], v[72:75], v[200:203]
  ds_read_b64_tr_b16 a[16:17], v251 offset:16384
  v_mul_f32 v230, v166, v174
  v_mfma_f32_16x16x32_bf16 v[204:207], a[36:39], v[144:147], v[204:207]
  ds_read_b64_tr_b16 a[18:19], v251 offset:24576
  v_mul_f32 v231, v167, v175
  v_mfma_f32_16x16x32_bf16 v[192:195], a[40:43], v[76:79], v[192:195]
  ds_read_b64_tr_b16 a[20:21], v251 offset:17408
  v_cvt_pk_bf16_f32 v224, v224, v225
  v_mfma_f32_16x16x32_bf16 v[196:199], a[40:43], v[148:151], v[196:199]
  ds_read_b64_tr_b16 a[22:23], v251 offset:25600
  ds_read_b64_tr_b16 a[24:25], v251 offset:18432
  v_mfma_f32_16x16x32_bf16 v[200:203], a[44:47], v[76:79], v[200:203]
  buffer_load_dwordx4 v252, s[28:31], s62 offen  lds
  v_mfma_f32_16x16x32_bf16 v[204:207], a[44:47], v[148:151], v[204:207]
  ds_read_b64_tr_b16 a[26:27], v251 offset:26624
  s_waitcnt lgkmcnt(6)
  v_mfma_f32_16x16x32_bf16 v[192:195], a[0:3], v[80:83], v[192:195]
  ds_read_b64_tr_b16 a[28:29], v251 offset:19456
  v_cvt_pk_bf16_f32 v226, v226, v227
  v_mfma_f32_16x16x32_bf16 v[196:199], a[0:3], v[152:155], v[196:199]
  ds_read_b64_tr_b16 a[30:31], v251 offset:27648
  v_cvt_pk_bf16_f32 v228, v228, v229
  v_mfma_f32_16x16x32_bf16 v[200:203], a[4:7], v[80:83], v[200:203]
  ds_read_b64_tr_b16 a[32:33], v251 offset:32768
  v_cvt_pk_bf16_f32 v230, v230, v231
  v_mfma_f32_16x16x32_bf16 v[204:207], a[4:7], v[152:155], v[204:207]
  ds_read_b64_tr_b16 a[34:35], v251 offset:40960
  v_accvgpr_write_b32 a64, v224
  v_mfma_f32_16x16x32_bf16 v[192:195], a[8:11], v[84:87], v[192:195]
  ds_read_b64_tr_b16 a[36:37], v251 offset:33792
  v_accvgpr_write_b32 a65, v226
  v_mfma_f32_16x16x32_bf16 v[196:199], a[8:11], v[156:159], v[196:199]
  ds_read_b64_tr_b16 a[38:39], v251 offset:41984
  ds_read_b64_tr_b16 a[40:41], v251 offset:34816
  v_mfma_f32_16x16x32_bf16 v[200:203], a[12:15], v[84:87], v[200:203]
  buffer_load_dwordx4 v252, s[32:35], s62 offen offset:1024  lds
  v_mfma_f32_16x16x32_bf16 v[204:207], a[12:15], v[156:159], v[204:207]
  ds_read_b64_tr_b16 a[42:43], v251 offset:43008
  s_waitcnt lgkmcnt(6)
  v_mfma_f32_16x16x32_bf16 v[208:211], a[16:19], v[72:75], v[208:211]
  ds_read_b64_tr_b16 a[44:45], v251 offset:35840
  v_accvgpr_write_b32 a100, v228
  v_mfma_f32_16x16x32_bf16 v[212:215], a[16:19], v[144:147], v[212:215]
  ds_read_b64_tr_b16 a[46:47], v251 offset:44032
  v_accvgpr_write_b32 a101, v230
  v_mfma_f32_16x16x32_bf16 v[216:219], a[20:23], v[72:75], v[216:219]
  ds_read_b64_tr_b16 a[0:1], v240 offset:0
  v_mul_f32 v232, v176, v184
  v_mfma_f32_16x16x32_bf16 v[220:223], a[20:23], v[144:147], v[220:223]
  ds_read_b64_tr_b16 a[2:3], v240 offset:8192
  v_mul_f32 v233, v177, v185
  v_mfma_f32_16x16x32_bf16 v[208:211], a[24:27], v[76:79], v[208:211]
  ds_read_b64_tr_b16 a[4:5], v240 offset:1024
  v_mul_f32 v234, v178, v186
  v_mfma_f32_16x16x32_bf16 v[212:215], a[24:27], v[148:151], v[212:215]
  ds_read_b64_tr_b16 a[6:7], v240 offset:9216
  ds_read_b64_tr_b16 a[8:9], v240 offset:2048
  v_mfma_f32_16x16x32_bf16 v[216:219], a[28:31], v[76:79], v[216:219]
  buffer_load_dwordx4 v253, s[28:31], s62 offen offset:2048  lds
  v_mfma_f32_16x16x32_bf16 v[220:223], a[28:31], v[148:151], v[220:223]
  ds_read_b64_tr_b16 a[10:11], v240 offset:10240
  s_waitcnt lgkmcnt(6)
  v_mfma_f32_16x16x32_bf16 v[208:211], a[32:35], v[80:83], v[208:211]
  ds_read_b64_tr_b16 a[12:13], v240 offset:3072
  v_mul_f32 v235, v179, v187
  v_mfma_f32_16x16x32_bf16 v[212:215], a[32:35], v[152:155], v[212:215]
  ds_read_b64_tr_b16 a[14:15], v240 offset:11264
  v_mul_f32 v236, v180, v188
  v_mfma_f32_16x16x32_bf16 v[216:219], a[36:39], v[80:83], v[216:219]
  ds_read_b64_tr_b16 a[16:17], v240 offset:16384
  v_mul_f32 v237, v181, v189
  v_mfma_f32_16x16x32_bf16 v[220:223], a[36:39], v[152:155], v[220:223]
  ds_read_b64_tr_b16 a[18:19], v240 offset:24576
  v_mul_f32 v238, v182, v190
  v_mfma_f32_16x16x32_bf16 v[208:211], a[40:43], v[84:87], v[208:211]
  ds_read_b64_tr_b16 a[20:21], v240 offset:17408
  v_mul_f32 v239, v183, v191
  v_mfma_f32_16x16x32_bf16 v[212:215], a[40:43], v[156:159], v[212:215]
  ds_read_b64_tr_b16 a[22:23], v240 offset:25600
  ds_read_b64_tr_b16 a[24:25], v240 offset:18432
  v_mfma_f32_16x16x32_bf16 v[216:219], a[44:47], v[84:87], v[216:219]
  buffer_load_dwordx4 v253, s[32:35], s62 offen offset:3072  lds
  v_mfma_f32_16x16x32_bf16 v[220:223], a[44:47], v[156:159], v[220:223]
  ds_read_b64_tr_b16 a[26:27], v240 offset:26624
  s_waitcnt lgkmcnt(6)
  v_mfma_f32_16x16x32_bf16 v[160:163], a[0:3], v[16:19], 0
  ds_read_b64_tr_b16 a[28:29], v240 offset:19456
  v_cvt_pk_bf16_f32 v232, v232, v233
  v_mfma_f32_16x16x32_bf16 v[164:167], a[0:3], v[88:91], 0
  ds_read_b64_tr_b16 a[30:31], v240 offset:27648
  v_cvt_pk_bf16_f32 v234, v234, v235
  v_mfma_f32_16x16x32_bf16 v[168:171], a[4:7], v[16:19], 0
  ds_read_b64_tr_b16 a[32:33], v241 offset:0
  v_cvt_pk_bf16_f32 v236, v236, v237
  v_mfma_f32_16x16x32_bf16 v[172:175], a[4:7], v[88:91], 0
  ds_read_b64_tr_b16 a[34:35], v241 offset:8192
  v_cvt_pk_bf16_f32 v238, v238, v239
  v_mfma_f32_16x16x32_bf16 v[160:163], a[8:11], v[20:23], v[160:163]
  ds_read_b64_tr_b16 a[36:37], v241 offset:1024
  v_accvgpr_write_b32 a66, v232
  v_mfma_f32_16x16x32_bf16 v[164:167], a[8:11], v[92:95], v[164:167]
  ds_read_b64_tr_b16 a[38:39], v241 offset:9216
  v_accvgpr_write_b32 a67, v234
  v_mfma_f32_16x16x32_bf16 v[168:171], a[12:15], v[20:23], v[168:171]
  ds_read_b64_tr_b16 a[40:41], v241 offset:2048
  v_accvgpr_write_b32 a102, v236
  v_mfma_f32_16x16x32_bf16 v[172:175], a[12:15], v[92:95], v[172:175]
  ds_read_b64_tr_b16 a[42:43], v241 offset:10240
  s_waitcnt lgkmcnt(6)
  v_mfma_f32_16x16x32_bf16 v[160:163], a[16:19], v[24:27], v[160:163]
  ds_read_b64_tr_b16 a[44:45], v241 offset:3072
  v_accvgpr_write_b32 a103, v238
  v_mfma_f32_16x16x32_bf16 v[164:167], a[16:19], v[96:99], v[164:167]
  ds_read_b64_tr_b16 a[46:47], v241 offset:11264
  v_mul_f32 v224, v192, v200
  v_mfma_f32_16x16x32_bf16 v[168:171], a[20:23], v[24:27], v[168:171]
  ds_read_b64_tr_b16 a[0:1], v241 offset:16384
  v_mul_f32 v225, v193, v201
  v_mfma_f32_16x16x32_bf16 v[172:175], a[20:23], v[96:99], v[172:175]
  ds_read_b64_tr_b16 a[2:3], v241 offset:24576
  v_mul_f32 v226, v194, v202
  v_mfma_f32_16x16x32_bf16 v[160:163], a[24:27], v[28:31], v[160:163]
  ds_read_b64_tr_b16 a[4:5], v241 offset:17408
  v_mul_f32 v227, v195, v203
  v_mfma_f32_16x16x32_bf16 v[164:167], a[24:27], v[100:103], v[164:167]
  ds_read_b64_tr_b16 a[6:7], v241 offset:25600
  s_waitcnt vmcnt(21)
  s_barrier
  v_mfma_f32_16x16x32_bf16 v[168:171], a[28:31], v[28:31], v[168:171]
  ds_read_b64_tr_b16 a[8:9], v241 offset:18432
  s_add_u32 m0, s52, 114688
  v_mfma_f32_16x16x32_bf16 v[172:175], a[28:31], v[100:103], v[172:175]
  ds_read_b64_tr_b16 a[10:11], v241 offset:26624
  s_waitcnt lgkmcnt(6)
  v_mfma_f32_16x16x32_bf16 v[176:179], a[32:35], v[16:19], 0
  ds_read_b64_tr_b16 a[12:13], v241 offset:19456
  s_add_u32 s62, s54, 4129152
  v_mfma_f32_16x16x32_bf16 v[180:183], a[32:35], v[88:91], 0
  ds_read_b64_tr_b16 a[14:15], v241 offset:27648
  ds_read_b64_tr_b16 a[16:17], v242 offset:0
  v_mfma_f32_16x16x32_bf16 v[184:187], a[36:39], v[16:19], 0
  buffer_load_dwordx4 v252, s[28:31], s62 offen  lds
  v_mfma_f32_16x16x32_bf16 v[188:191], a[36:39], v[88:91], 0
  ds_read_b64_tr_b16 a[18:19], v242 offset:8192
  v_mul_f32 v228, v196, v204
  v_mfma_f32_16x16x32_bf16 v[176:179], a[40:43], v[20:23], v[176:179]
  ds_read_b64_tr_b16 a[20:21], v242 offset:1024
  v_mul_f32 v229, v197, v205
  v_mfma_f32_16x16x32_bf16 v[180:183], a[40:43], v[92:95], v[180:183]
  ds_read_b64_tr_b16 a[22:23], v242 offset:9216
  ds_read_b64_tr_b16 a[24:25], v242 offset:2048
  v_mfma_f32_16x16x32_bf16 v[184:187], a[44:47], v[20:23], v[184:187]
  buffer_load_dwordx4 v252, s[32:35], s62 offen offset:1024  lds
  v_mfma_f32_16x16x32_bf16 v[188:191], a[44:47], v[92:95], v[188:191]
  ds_read_b64_tr_b16 a[26:27], v242 offset:10240
  s_waitcnt lgkmcnt(6)
  v_mfma_f32_16x16x32_bf16 v[176:179], a[0:3], v[24:27], v[176:179]
  ds_read_b64_tr_b16 a[28:29], v242 offset:3072
  v_mul_f32 v230, v198, v206
  v_mfma_f32_16x16x32_bf16 v[180:183], a[0:3], v[96:99], v[180:183]
  ds_read_b64_tr_b16 a[30:31], v242 offset:11264
  ds_read_b64_tr_b16 a[32:33], v242 offset:16384
  v_mfma_f32_16x16x32_bf16 v[184:187], a[4:7], v[24:27], v[184:187]
  buffer_load_dwordx4 v253, s[28:31], s62 offen offset:2048  lds
  v_mfma_f32_16x16x32_bf16 v[188:191], a[4:7], v[96:99], v[188:191]
  ds_read_b64_tr_b16 a[34:35], v242 offset:24576
  v_mul_f32 v231, v199, v207
  v_mfma_f32_16x16x32_bf16 v[176:179], a[8:11], v[28:31], v[176:179]
  ds_read_b64_tr_b16 a[36:37], v242 offset:17408
  v_cvt_pk_bf16_f32 v224, v224, v225
  v_mfma_f32_16x16x32_bf16 v[180:183], a[8:11], v[100:103], v[180:183]
  ds_read_b64_tr_b16 a[38:39], v242 offset:25600
  ds_read_b64_tr_b16 a[40:41], v242 offset:18432
  v_mfma_f32_16x16x32_bf16 v[184:187], a[12:15], v[28:31], v[184:187]
  buffer_load_dwordx4 v253, s[32:35], s62 offen offset:3072  lds
  v_mfma_f32_16x16x32_bf16 v[188:191], a[12:15], v[100:103], v[188:191]
  ds_read_b64_tr_b16 a[42:43], v242 offset:26624
  s_waitcnt lgkmcnt(6)
  v_mfma_f32_16x16x32_bf16 v[192:195], a[16:19], v[16:19], 0
  ds_read_b64_tr_b16 a[44:45], v242 offset:19456
  v_cvt_pk_bf16_f32 v226, v226, v227
  v_mfma_f32_16x16x32_bf16 v[196:199], a[16:19], v[88:91], 0
  ds_read_b64_tr_b16 a[46:47], v242 offset:27648
  v_cvt_pk_bf16_f32 v228, v228, v229
  v_mfma_f32_16x16x32_bf16 v[200:203], a[20:23], v[16:19], 0
  ds_read_b64_tr_b16 a[0:1], v243 offset:0
  v_cvt_pk_bf16_f32 v230, v230, v231
  v_mfma_f32_16x16x32_bf16 v[204:207], a[20:23], v[88:91], 0
  ds_read_b64_tr_b16 a[2:3], v243 offset:8192
  v_accvgpr_write_b32 a68, v224
  v_mfma_f32_16x16x32_bf16 v[192:195], a[24:27], v[20:23], v[192:195]
  ds_read_b64_tr_b16 a[4:5], v243 offset:1024
  s_add_u32 m0, s52, 131072
  s_add_u32 s62, s54, 4718976
  v_mfma_f32_16x16x32_bf16 v[196:199], a[24:27], v[92:95], v[196:199]
  ds_read_b64_tr_b16 a[6:7], v243 offset:9216
  v_accvgpr_write_b32 a69, v226
  v_mfma_f32_16x16x32_bf16 v[200:203], a[28:31], v[20:23], v[200:203]
  ds_read_b64_tr_b16 a[8:9], v243 offset:2048
  buffer_load_dwordx4 v252, s[28:31], s62 offen  lds
  v_mfma_f32_16x16x32_bf16 v[204:207], a[28:31], v[92:95], v[204:207]
  ds_read_b64_tr_b16 a[10:11], v243 offset:10240
  v_accvgpr_write_b32 a104, v228
  s_waitcnt lgkmcnt(6)
  v_mfma_f32_16x16x32_bf16 v[192:195], a[32:35], v[24:27], v[192:195]
  ds_read_b64_tr_b16 a[12:13], v243 offset:3072
  v_accvgpr_write_b32 a105, v230
  v_mul_f32 v232, v208, v216
  v_mfma_f32_16x16x32_bf16 v[196:199], a[32:35], v[96:99], v[196:199]
  ds_read_b64_tr_b16 a[14:15], v243 offset:11264
  v_mul_f32 v233, v209, v217
  v_mfma_f32_16x16x32_bf16 v[200:203], a[36:39], v[24:27], v[200:203]
  ds_read_b64_tr_b16 a[16:17], v243 offset:16384
  v_mul_f32 v234, v210, v218
  v_mfma_f32_16x16x32_bf16 v[204:207], a[36:39], v[96:99], v[204:207]
  ds_read_b64_tr_b16 a[18:19], v243 offset:24576
  v_mul_f32 v235, v211, v219
  v_mfma_f32_16x16x32_bf16 v[192:195], a[40:43], v[28:31], v[192:195]
  ds_read_b64_tr_b16 a[20:21], v243 offset:17408
  s_add_u32 s68, s88, 8192
  v_mul_f32 v236, v212, v220
  v_mfma_f32_16x16x32_bf16 v[196:199], a[40:43], v[100:103], v[196:199]
  ds_read_b64_tr_b16 a[22:23], v243 offset:25600
  v_mul_f32 v237, v213, v221
  v_mfma_f32_16x16x32_bf16 v[200:203], a[44:47], v[28:31], v[200:203]
  ds_read_b64_tr_b16 a[24:25], v243 offset:18432
  buffer_load_dwordx4 v252, s[32:35], s62 offen offset:1024  lds
  v_mul_f32 v238, v214, v222
  v_mul_f32 v239, v215, v223
  v_mfma_f32_16x16x32_bf16 v[204:207], a[44:47], v[100:103], v[204:207]
  ds_read_b64_tr_b16 a[26:27], v243 offset:26624
  s_waitcnt lgkmcnt(6)
  v_mfma_f32_16x16x32_bf16 v[208:211], a[0:3], v[16:19], 0
  ds_read_b64_tr_b16 a[28:29], v243 offset:19456
  v_cvt_pk_bf16_f32 v232, v232, v233
  v_mfma_f32_16x16x32_bf16 v[212:215], a[0:3], v[88:91], 0
  ds_read_b64_tr_b16 a[30:31], v243 offset:27648
  v_cvt_pk_bf16_f32 v234, v234, v235
  v_mfma_f32_16x16x32_bf16 v[216:219], a[4:7], v[16:19], 0
  ds_read_b64_tr_b16 a[32:33], v240 offset:32768
  v_cvt_pk_bf16_f32 v236, v236, v237
  v_mfma_f32_16x16x32_bf16 v[220:223], a[4:7], v[88:91], 0
  ds_read_b64_tr_b16 a[34:35], v240 offset:40960
  v_cvt_pk_bf16_f32 v238, v238, v239
  v_mfma_f32_16x16x32_bf16 v[208:211], a[8:11], v[20:23], v[208:211]
  ds_read_b64_tr_b16 a[36:37], v240 offset:33792
  v_accvgpr_write_b32 a70, v232
  v_mfma_f32_16x16x32_bf16 v[212:215], a[8:11], v[92:95], v[212:215]
  ds_read_b64_tr_b16 a[38:39], v240 offset:41984
  ds_read_b64_tr_b16 a[40:41], v241 offset:32768
  v_mfma_f32_16x16x32_bf16 v[216:219], a[12:15], v[20:23], v[216:219]
  buffer_load_dwordx4 v253, s[28:31], s62 offen offset:2048  lds
  buffer_store_dwordx4 a[64:67], v3, s[44:47], s68 offen offset:0 sc1
  buffer_store_dwordx4 a[100:103], v3, s[44:47], s68 offen offset:1024 sc1
  v_mfma_f32_16x16x32_bf16 v[220:223], a[12:15], v[92:95], v[220:223]
  ds_read_b64_tr_b16 a[42:43], v241 offset:40960
  buffer_load_dword v4, off, s[44:47], s91 sc1
  s_waitcnt lgkmcnt(6)
  v_mfma_f32_16x16x32_bf16 v[208:211], a[16:19], v[24:27], v[208:211]
  ds_read_b64_tr_b16 a[44:45], v241 offset:33792
  v_accvgpr_write_b32 a71, v234
  v_mfma_f32_16x16x32_bf16 v[212:215], a[16:19], v[96:99], v[212:215]
  ds_read_b64_tr_b16 a[46:47], v241 offset:41984
  v_accvgpr_write_b32 a106, v236
  v_mfma_f32_16x16x32_bf16 v[216:219], a[20:23], v[24:27], v[216:219]
  ds_read_b64_tr_b16 a[0:1], v242 offset:32768
  v_accvgpr_write_b32 a107, v238
  v_mfma_f32_16x16x32_bf16 v[220:223], a[20:23], v[96:99], v[220:223]
  ds_read_b64_tr_b16 a[2:3], v242 offset:40960
  v_mfma_f32_16x16x32_bf16 v[208:211], a[24:27], v[28:31], v[208:211]
  ds_read_b64_tr_b16 a[4:5], v242 offset:33792
  v_mfma_f32_16x16x32_bf16 v[212:215], a[24:27], v[100:103], v[212:215]
  ds_read_b64_tr_b16 a[6:7], v242 offset:41984
  ds_read_b64_tr_b16 a[8:9], v243 offset:32768
  v_mfma_f32_16x16x32_bf16 v[216:219], a[28:31], v[28:31], v[216:219]
  buffer_load_dwordx4 v253, s[32:35], s62 offen offset:3072  lds
  v_mfma_f32_16x16x32_bf16 v[220:223], a[28:31], v[100:103], v[220:223]
  ds_read_b64_tr_b16 a[10:11], v243 offset:40960
  s_waitcnt lgkmcnt(6)
  v_mfma_f32_16x16x32_bf16 v[160:163], a[32:35], v[32:35], v[160:163]
  ds_read_b64_tr_b16 a[12:13], v243 offset:33792
  v_mfma_f32_16x16x32_bf16 v[164:167], a[32:35], v[104:107], v[164:167]
  ds_read_b64_tr_b16 a[14:15], v243 offset:41984
  v_mfma_f32_16x16x32_bf16 v[168:171], a[36:39], v[32:35], v[168:171]
  ds_read_b64_tr_b16 a[16:17], v240 offset:34816
  v_mfma_f32_16x16x32_bf16 v[172:175], a[36:39], v[104:107], v[172:175]
  ds_read_b64_tr_b16 a[18:19], v240 offset:43008
  v_mfma_f32_16x16x32_bf16 v[176:179], a[40:43], v[32:35], v[176:179]
  ds_read_b64_tr_b16 a[20:21], v240 offset:35840
  v_mfma_f32_16x16x32_bf16 v[180:183], a[40:43], v[104:107], v[180:183]
  ds_read_b64_tr_b16 a[22:23], v240 offset:44032
  v_mfma_f32_16x16x32_bf16 v[184:187], a[44:47], v[32:35], v[184:187]
  ds_read_b64_tr_b16 a[24:25], v241 offset:34816
  v_mfma_f32_16x16x32_bf16 v[188:191], a[44:47], v[104:107], v[188:191]
  ds_read_b64_tr_b16 a[26:27], v241 offset:43008
  s_waitcnt lgkmcnt(6)
  v_mfma_f32_16x16x32_bf16 v[192:195], a[0:3], v[32:35], v[192:195]
  ds_read_b64_tr_b16 a[28:29], v241 offset:35840
  v_mfma_f32_16x16x32_bf16 v[196:199], a[0:3], v[104:107], v[196:199]
  ds_read_b64_tr_b16 a[30:31], v241 offset:44032
  v_mfma_f32_16x16x32_bf16 v[200:203], a[4:7], v[32:35], v[200:203]
  ds_read_b64_tr_b16 a[32:33], v242 offset:34816
  v_mfma_f32_16x16x32_bf16 v[204:207], a[4:7], v[104:107], v[204:207]
  ds_read_b64_tr_b16 a[34:35], v242 offset:43008
  v_mfma_f32_16x16x32_bf16 v[208:211], a[8:11], v[32:35], v[208:211]
  ds_read_b64_tr_b16 a[36:37], v242 offset:35840
  v_mfma_f32_16x16x32_bf16 v[212:215], a[8:11], v[104:107], v[212:215]
  ds_read_b64_tr_b16 a[38:39], v242 offset:44032
  s_waitcnt vmcnt(25)
  s_waitcnt vmcnt(21)
  s_barrier
  v_mfma_f32_16x16x32_bf16 v[216:219], a[12:15], v[32:35], v[216:219]
  ds_read_b64_tr_b16 a[40:41], v243 offset:34816
  s_add_u32 m0, s52, 0
  v_mfma_f32_16x16x32_bf16 v[220:223], a[12:15], v[104:107], v[220:223]
  ds_read_b64_tr_b16 a[42:43], v243 offset:43008
  s_waitcnt lgkmcnt(6)
  v_mfma_f32_16x16x32_bf16 v[160:163], a[16:19], v[36:39], v[160:163]
  ds_read_b64_tr_b16 a[44:45], v243 offset:35840
  s_add_u32 s62, s55, 3072
  v_mfma_f32_16x16x32_bf16 v[164:167], a[16:19], v[108:111], v[164:167]
  ds_read_b64_tr_b16 a[46:47], v243 offset:44032
  ds_read_b64_tr_b16 a[0:1], v244 offset:0
  v_mfma_f32_16x16x32_bf16 v[168:171], a[20:23], v[36:39], v[168:171]
  buffer_load_dwordx4 v254, s[40:43], s62 offen  lds
  v_mfma_f32_16x16x32_bf16 v[172:175], a[20:23], v[108:111], v[172:175]
  ds_read_b64_tr_b16 a[2:3], v244 offset:8192
  s_add_u32 s62, s55, 296960
  v_mfma_f32_16x16x32_bf16 v[176:179], a[24:27], v[36:39], v[176:179]
  ds_read_b64_tr_b16 a[4:5], v244 offset:1024
  v_accvgpr_read_b32 v8, a212
  v_mfma_f32_16x16x32_bf16 v[180:183], a[24:27], v[108:111], v[180:183]
  ds_read_b64_tr_b16 a[6:7], v244 offset:9216
  ds_read_b64_tr_b16 a[8:9], v245 offset:0
  v_mfma_f32_16x16x32_bf16 v[184:187], a[28:31], v[36:39], v[184:187]
  buffer_load_dwordx4 v254, s[40:43], s62 offen offset:1024  lds
  buffer_store_dwordx4 a[68:71], v3, s[44:47], s68 offen offset:2048 sc1
  v_mfma_f32_16x16x32_bf16 v[188:191], a[28:31], v[108:111], v[188:191]
  ds_read_b64_tr_b16 a[10:11], v245 offset:8192
  s_waitcnt lgkmcnt(6)
  v_mfma_f32_16x16x32_bf16 v[192:195], a[32:35], v[36:39], v[192:195]
  ds_read_b64_tr_b16 a[12:13], v245 offset:1024
  s_add_u32 s62, s55, 590848
  v_mfma_f32_16x16x32_bf16 v[196:199], a[32:35], v[108:111], v[196:199]
  ds_read_b64_tr_b16 a[14:15], v245 offset:9216
  ds_read_b64_tr_b16 a[16:17], v246 offset:0
  v_mfma_f32_16x16x32_bf16 v[200:203], a[36:39], v[36:39], v[200:203]
  buffer_load_dwordx4 v254, s[40:43], s62 offen offset:2048  lds
  v_mfma_f32_16x16x32_bf16 v[204:207], a[36:39], v[108:111], v[204:207]
  ds_read_b64_tr_b16 a[18:19], v246 offset:8192
  s_add_u32 s62, s55, 884736
  v_mfma_f32_16x16x32_bf16 v[208:211], a[40:43], v[36:39], v[208:211]
  ds_read_b64_tr_b16 a[20:21], v246 offset:1024
  ds_read_b64_tr_b16 v[10:11], v8 offset:0
  v_mfma_f32_16x16x32_bf16 v[212:215], a[40:43], v[108:111], v[212:215]
  ds_read_b64_tr_b16 a[22:23], v246 offset:9216
  ds_read_b64_tr_b16 a[24:25], v247 offset:0
  v_mfma_f32_16x16x32_bf16 v[216:219], a[44:47], v[36:39], v[216:219]
  buffer_load_dwordx4 v254, s[40:43], s62 offen offset:3072  lds
  v_mfma_f32_16x16x32_bf16 v[220:223], a[44:47], v[108:111], v[220:223]
  ds_read_b64_tr_b16 a[26:27], v247 offset:8192
  s_waitcnt lgkmcnt(7)
  v_mfma_f32_16x16x32_bf16 v[160:163], a[0:3], v[40:43], v[160:163]
  ds_read_b64_tr_b16 a[28:29], v247 offset:1024
  s_add_u32 m0, s52, 16384
  v_mfma_f32_16x16x32_bf16 v[164:167], a[0:3], v[112:115], v[164:167]
  ds_read_b64_tr_b16 a[30:31], v247 offset:9216
  s_add_u32 s62, s55, 1182720
  v_mfma_f32_16x16x32_bf16 v[168:171], a[4:7], v[40:43], v[168:171]
  ds_read_b64_tr_b16 a[32:33], v244 offset:2048
  ds_read_b64_tr_b16 v[12:13], v8 offset:512
  v_mfma_f32_16x16x32_bf16 v[172:175], a[4:7], v[112:115], v[172:175]
  ds_read_b64_tr_b16 a[34:35], v244 offset:10240
  ds_read_b64_tr_b16 v[14:15], v8 offset:2048
  v_mfma_f32_16x16x32_bf16 v[176:179], a[8:11], v[40:43], v[176:179]
  ds_read_b64_tr_b16 a[36:37], v244 offset:3072
  ds_read_b64_tr_b16 v[224:225], v8 offset:1024
  v_mfma_f32_16x16x32_bf16 v[180:183], a[8:11], v[112:115], v[180:183]
  ds_read_b64_tr_b16 a[38:39], v244 offset:11264
  ds_read_b64_tr_b16 a[40:41], v245 offset:2048
  v_mfma_f32_16x16x32_bf16 v[184:187], a[12:15], v[40:43], v[184:187]
  buffer_load_dwordx4 v254, s[40:43], s62 offen  lds
  v_mfma_f32_16x16x32_bf16 v[188:191], a[12:15], v[112:115], v[188:191]
  ds_read_b64_tr_b16 a[42:43], v245 offset:10240
  s_waitcnt lgkmcnt(9)
  v_mfma_f32_16x16x32_bf16 v[192:195], a[16:19], v[40:43], v[192:195]
  ds_read_b64_tr_b16 a[44:45], v245 offset:3072
  s_add_u32 s62, s55, 1476608
  v_mfma_f32_16x16x32_bf16 v[196:199], a[16:19], v[112:115], v[196:199]
  ds_read_b64_tr_b16 a[46:47], v245 offset:11264
  ds_read_b64_tr_b16 v[226:227], v8 offset:1536
  v_mfma_f32_16x16x32_bf16 v[200:203], a[20:23], v[40:43], v[200:203]
  ds_read_b64_tr_b16 a[0:1], v246 offset:2048
  v_accvgpr_read_b32 v228, a220
  v_mfma_f32_16x16x32_bf16 v[204:207], a[20:23], v[112:115], v[204:207]
  ds_read_b64_tr_b16 a[2:3], v246 offset:10240
  v_accvgpr_read_b32 v229, a221
  v_mfma_f32_16x16x32_bf16 v[208:211], a[24:27], v[40:43], v[208:211]
  ds_read_b64_tr_b16 a[4:5], v246 offset:3072
  v_lshlrev_b32 v230, 16, v228
  v_mfma_f32_16x16x32_bf16 v[212:215], a[24:27], v[112:115], v[212:215]
  ds_read_b64_tr_b16 a[6:7], v246 offset:11264
  ds_read_b64_tr_b16 a[8:9], v247 offset:2048
  v_mfma_f32_16x16x32_bf16 v[216:219], a[28:31], v[40:43], v[216:219]
  buffer_load_dwordx4 v254, s[40:43], s62 offen offset:1024  lds
  v_mfma_f32_16x16x32_bf16 v[220:223], a[28:31], v[112:115], v[220:223]
  ds_read_b64_tr_b16 a[10:11], v247 offset:10240
  s_waitcnt lgkmcnt(7)
  v_mfma_f32_16x16x32_bf16 v[160:163], a[32:35], v[44:47], v[160:163]
  ds_read_b64_tr_b16 a[12:13], v247 offset:3072
  s_add_u32 s62, s55, 1770496
  v_mfma_f32_16x16x32_bf16 v[164:167], a[32:35], v[116:119], v[164:167]
  ds_read_b64_tr_b16 a[14:15], v247 offset:11264
  v_and_b32 v231, 0xffff0000, v228
  v_mfma_f32_16x16x32_bf16 v[168:171], a[36:39], v[44:47], v[168:171]
  ds_read_b64_tr_b16 a[16:17], v244 offset:16384
  v_lshlrev_b32 v232, 16, v229
  v_mfma_f32_16x16x32_bf16 v[172:175], a[36:39], v[116:119], v[172:175]
  ds_read_b64_tr_b16 a[18:19], v244 offset:24576
  v_and_b32 v233, 0xffff0000, v229
  v_mfma_f32_16x16x32_bf16 v[176:179], a[40:43], v[44:47], v[176:179]
  ds_read_b64_tr_b16 a[20:21], v244 offset:17408
  s_waitcnt lgkmcnt(11)
  v_mfma_f32_16x16x32_bf16 v[180:183], a[40:43], v[116:119], v[180:183]
  ds_read_b64_tr_b16 a[22:23], v244 offset:25600
  ds_read_b64_tr_b16 a[24:25], v245 offset:16384
  v_mfma_f32_16x16x32_bf16 v[184:187], a[44:47], v[44:47], v[184:187]
  buffer_load_dwordx4 v254, s[40:43], s62 offen offset:2048  lds
  v_mfma_f32_16x16x32_bf16 v[188:191], a[44:47], v[116:119], v[188:191]
  ds_read_b64_tr_b16 a[26:27], v245 offset:24576
  s_waitcnt lgkmcnt(6)
  v_mfma_f32_16x16x32_bf16 v[192:195], a[0:3], v[44:47], v[192:195]
  ds_read_b64_tr_b16 a[28:29], v245 offset:17408
  s_add_u32 s62, s55, 2064384
  v_mfma_f32_16x16x32_bf16 v[196:199], a[0:3], v[116:119], v[196:199]
  ds_read_b64_tr_b16 a[30:31], v245 offset:25600
  v_and_b32 v235, 0xffff0000, v10
  v_mfma_f32_16x16x32_bf16 v[200:203], a[4:7], v[44:47], v[200:203]
  ds_read_b64_tr_b16 a[32:33], v246 offset:16384
  v_lshlrev_b32 v236, 16, v11
  v_mfma_f32_16x16x32_bf16 v[204:207], a[4:7], v[116:119], v[204:207]
  ds_read_b64_tr_b16 a[34:35], v246 offset:24576
  v_and_b32 v237, 0xffff0000, v11
  v_mfma_f32_16x16x32_bf16 v[208:211], a[8:11], v[44:47], v[208:211]
  ds_read_b64_tr_b16 a[36:37], v246 offset:17408
  buffer_store_dwordx4 a[104:107], v3, s[44:47], s68 offen offset:3072 sc1
  v_mfma_f32_16x16x32_bf16 v[212:215], a[8:11], v[116:119], v[212:215]
  ds_read_b64_tr_b16 a[38:39], v246 offset:25600
  ds_read_b64_tr_b16 a[40:41], v247 offset:16384
  v_mfma_f32_16x16x32_bf16 v[216:219], a[12:15], v[44:47], v[216:219]
  buffer_load_dwordx4 v254, s[40:43], s62 offen offset:3072  lds
  v_mfma_f32_16x16x32_bf16 v[220:223], a[12:15], v[116:119], v[220:223]
  ds_read_b64_tr_b16 a[42:43], v247 offset:24576
  s_waitcnt lgkmcnt(6)
  v_mfma_f32_16x16x32_bf16 v[160:163], a[16:19], v[48:51], v[160:163]
  ds_read_b64_tr_b16 a[44:45], v247 offset:17408
  s_add_u32 m0, s52, 32768
  v_mfma_f32_16x16x32_bf16 v[164:167], a[16:19], v[120:123], v[164:167]
  ds_read_b64_tr_b16 a[46:47], v247 offset:25600
  s_add_u32 s62, s55, 2362368
  v_mfma_f32_16x16x32_bf16 v[168:171], a[20:23], v[48:51], v[168:171]
  ds_read_b64_tr_b16 a[0:1], v244 offset:18432
  v_lshlrev_b32 v238, 16, v12
  v_mfma_f32_16x16x32_bf16 v[172:175], a[20:23], v[120:123], v[172:175]
  ds_read_b64_tr_b16 a[2:3], v244 offset:26624
  v_mul_f32 v228, v233, v235
  v_mfma_f32_16x16x32_bf16 v[176:179], a[24:27], v[48:51], v[176:179]
  ds_read_b64_tr_b16 a[4:5], v244 offset:19456
  v_fmac_f32 v228, v232, v236
  v_mfma_f32_16x16x32_bf16 v[180:183], a[24:27], v[120:123], v[180:183]
  ds_read_b64_tr_b16 a[6:7], v244 offset:27648
  ds_read_b64_tr_b16 a[8:9], v245 offset:18432
  v_mfma_f32_16x16x32_bf16 v[184:187], a[28:31], v[48:51], v[184:187]
  buffer_load_dwordx4 v254, s[40:43], s62 offen  lds
  v_mfma_f32_16x16x32_bf16 v[188:191], a[28:31], v[120:123], v[188:191]
  ds_read_b64_tr_b16 a[10:11], v245 offset:26624
  s_waitcnt lgkmcnt(6)
  v_mfma_f32_16x16x32_bf16 v[192:195], a[32:35], v[48:51], v[192:195]
  ds_read_b64_tr_b16 a[12:13], v245 offset:19456
  v_fmac_f32 v228, v231, v237
  v_mfma_f32_16x16x32_bf16 v[196:199], a[32:35], v[120:123], v[196:199]
  ds_read_b64_tr_b16 a[14:15], v245 offset:27648
  v_lshlrev_b32 v239, 16, v224
  v_mfma_f32_16x16x32_bf16 v[200:203], a[36:39], v[48:51], v[200:203]
  ds_read_b64_tr_b16 a[16:17], v246 offset:18432
  v_fmac_f32 v228, v230, v238
  v_mfma_f32_16x16x32_bf16 v[204:207], a[36:39], v[120:123], v[204:207]
  ds_read_b64_tr_b16 a[18:19], v246 offset:26624
  v_mul_f32 v228, v228, v239
  v_mfma_f32_16x16x32_bf16 v[208:211], a[40:43], v[48:51], v[208:211]
  ds_read_b64_tr_b16 a[20:21], v246 offset:19456
  v_and_b32 v234, 0xffff0000, v12
  v_mfma_f32_16x16x32_bf16 v[212:215], a[40:43], v[120:123], v[212:215]
  ds_read_b64_tr_b16 a[22:23], v246 offset:27648
  s_waitcnt vmcnt(22)
  s_barrier
  v_mfma_f32_16x16x32_bf16 v[216:219], a[44:47], v[48:51], v[216:219]
  ds_read_b64_tr_b16 a[24:25], v247 offset:18432
  s_add_u32 s62, s55, 2656256
  v_mfma_f32_16x16x32_bf16 v[220:223], a[44:47], v[120:123], v[220:223]
  ds_read_b64_tr_b16 a[26:27], v247 offset:26624
  s_waitcnt lgkmcnt(6)
  v_mfma_f32_16x16x32_bf16 v[160:163], a[0:3], v[52:55], v[160:163]
  ds_read_b64_tr_b16 a[28:29], v247 offset:19456
  v_mul_f32 v229, v233, v236
  v_mfma_f32_16x16x32_bf16 v[164:167], a[0:3], v[124:127], v[164:167]
  ds_read_b64_tr_b16 a[30:31], v247 offset:27648
  ds_read_b64_tr_b16 a[32:33], v244 offset:32768
  v_mfma_f32_16x16x32_bf16 v[168:171], a[4:7], v[52:55], v[168:171]
  buffer_load_dwordx4 v254, s[40:43], s62 offen offset:1024  lds
  v_mfma_f32_16x16x32_bf16 v[172:175], a[4:7], v[124:127], v[172:175]
  ds_read_b64_tr_b16 a[34:35], v244 offset:40960
  v_fmac_f32 v229, v232, v237
  v_mfma_f32_16x16x32_bf16 v[176:179], a[8:11], v[52:55], v[176:179]
  ds_read_b64_tr_b16 a[36:37], v244 offset:33792
  s_add_u32 s62, s55, 2950144
  v_mfma_f32_16x16x32_bf16 v[180:183], a[8:11], v[124:127], v[180:183]
  ds_read_b64_tr_b16 a[38:39], v244 offset:41984
  ds_read_b64_tr_b16 a[40:41], v245 offset:32768
  v_mfma_f32_16x16x32_bf16 v[184:187], a[12:15], v[52:55], v[184:187]
  buffer_load_dwordx4 v254, s[40:43], s62 offen offset:2048  lds
  v_mfma_f32_16x16x32_bf16 v[188:191], a[12:15], v[124:127], v[188:191]
  ds_read_b64_tr_b16 a[42:43], v245 offset:40960
  s_waitcnt lgkmcnt(6)
  v_mfma_f32_16x16x32_bf16 v[192:195], a[16:19], v[52:55], v[192:195]
  ds_read_b64_tr_b16 a[44:45], v245 offset:33792
  v_fmac_f32 v229, v231, v238
  v_mfma_f32_16x16x32_bf16 v[196:199], a[16:19], v[124:127], v[196:199]
  ds_read_b64_tr_b16 a[46:47], v245 offset:41984
  v_and_b32 v239, 0xffff0000, v224
  v_mfma_f32_16x16x32_bf16 v[200:203], a[20:23], v[52:55], v[200:203]
  ds_read_b64_tr_b16 a[0:1], v246 offset:32768
  v_fmac_f32 v229, v230, v234
  v_mfma_f32_16x16x32_bf16 v[204:207], a[20:23], v[124:127], v[204:207]
  ds_read_b64_tr_b16 a[2:3], v246 offset:40960
  v_mul_f32 v229, v229, v239
  v_mfma_f32_16x16x32_bf16 v[208:211], a[24:27], v[52:55], v[208:211]
  ds_read_b64_tr_b16 a[4:5], v246 offset:33792
  s_add_u32 s62, s55, 3244032
  v_mfma_f32_16x16x32_bf16 v[212:215], a[24:27], v[124:127], v[212:215]
  ds_read_b64_tr_b16 a[6:7], v246 offset:41984
  ds_read_b64_tr_b16 a[8:9], v247 offset:32768
  v_mfma_f32_16x16x32_bf16 v[216:219], a[28:31], v[52:55], v[216:219]
  buffer_load_dwordx4 v254, s[40:43], s62 offen offset:3072  lds
  v_mfma_f32_16x16x32_bf16 v[220:223], a[28:31], v[124:127], v[220:223]
  ds_read_b64_tr_b16 a[10:11], v247 offset:40960
  s_waitcnt lgkmcnt(6)
  v_mfma_f32_16x16x32_bf16 v[160:163], a[32:35], v[56:59], v[160:163]
  ds_read_b64_tr_b16 a[12:13], v247 offset:33792
  v_cvt_pk_bf16_f32 v11, v229, v228
  v_mfma_f32_16x16x32_bf16 v[164:167], a[32:35], v[128:131], v[164:167]
  ds_read_b64_tr_b16 a[14:15], v247 offset:41984
  v_lshlrev_b32 v235, 16, v13
  v_mfma_f32_16x16x32_bf16 v[168:171], a[36:39], v[56:59], v[168:171]
  ds_read_b64_tr_b16 a[16:17], v244 offset:34816
  v_mul_f32 v228, v233, v237
  v_mfma_f32_16x16x32_bf16 v[172:175], a[36:39], v[128:131], v[172:175]
  ds_read_b64_tr_b16 a[18:19], v244 offset:43008
  v_fmac_f32 v228, v232, v238
  v_mfma_f32_16x16x32_bf16 v[176:179], a[40:43], v[56:59], v[176:179]
  ds_read_b64_tr_b16 a[20:21], v244 offset:35840
  s_add_u32 m0, s52, 49152
  s_add_u32 s62, s55, 3542016
  v_mfma_f32_16x16x32_bf16 v[180:183], a[40:43], v[128:131], v[180:183]
  ds_read_b64_tr_b16 a[22:23], v244 offset:44032
  v_fmac_f32 v228, v231, v234
  v_mfma_f32_16x16x32_bf16 v[184:187], a[44:47], v[56:59], v[184:187]
  ds_read_b64_tr_b16 a[24:25], v245 offset:34816
  buffer_load_dwordx4 v254, s[40:43], s62 offen  lds
  v_mfma_f32_16x16x32_bf16 v[188:191], a[44:47], v[128:131], v[188:191]
  ds_read_b64_tr_b16 a[26:27], v245 offset:43008
  v_lshlrev_b32 v239, 16, v225
  s_waitcnt lgkmcnt(6)
  v_mfma_f32_16x16x32_bf16 v[192:195], a[0:3], v[56:59], v[192:195]
  ds_read_b64_tr_b16 a[28:29], v245 offset:35840
  v_fmac_f32 v228, v230, v235
  v_mul_f32 v228, v228, v239
  v_mfma_f32_16x16x32_bf16 v[196:199], a[0:3], v[128:131], v[196:199]
  ds_read_b64_tr_b16 a[30:31], v245 offset:44032
  v_and_b32 v236, 0xffff0000, v13
  v_mul_f32 v229, v233, v238
  v_mfma_f32_16x16x32_bf16 v[200:203], a[4:7], v[56:59], v[200:203]
  ds_read_b64_tr_b16 a[32:33], v246 offset:34816
  v_fmac_f32 v229, v232, v234
  v_fmac_f32 v229, v231, v235
  v_mfma_f32_16x16x32_bf16 v[204:207], a[4:7], v[128:131], v[204:207]
  ds_read_b64_tr_b16 a[34:35], v246 offset:43008
  v_and_b32 v239, 0xffff0000, v225
  v_fmac_f32 v229, v230, v236
  v_mfma_f32_16x16x32_bf16 v[208:211], a[8:11], v[56:59], v[208:211]
  ds_read_b64_tr_b16 a[36:37], v246 offset:35840
  s_add_u32 s62, s55, 3835904
  v_mul_f32 v229, v229, v239
  v_mfma_f32_16x16x32_bf16 v[212:215], a[8:11], v[128:131], v[212:215]
  ds_read_b64_tr_b16 a[38:39], v246 offset:44032
  v_cvt_pk_bf16_f32 v10, v229, v228
  v_mfma_f32_16x16x32_bf16 v[216:219], a[12:15], v[56:59], v[216:219]
  ds_read_b64_tr_b16 a[40:41], v247 offset:34816
  buffer_load_dwordx4 v254, s[40:43], s62 offen offset:1024  lds
  v_mfma_f32_16x16x32_bf16 v[220:223], a[12:15], v[128:131], v[220:223]
  ds_read_b64_tr_b16 a[42:43], v247 offset:43008
  v_lshlrev_b32 v237, 16, v14
  s_waitcnt lgkmcnt(6)
  v_mfma_f32_16x16x32_bf16 v[160:163], a[16:19], v[60:63], v[160:163]
  ds_read_b64_tr_b16 a[44:45], v247 offset:35840
  v_mul_f32 v228, v233, v234
  v_fmac_f32 v228, v232, v235
  v_mfma_f32_16x16x32_bf16 v[164:167], a[16:19], v[132:135], v[164:167]
  ds_read_b64_tr_b16 a[46:47], v247 offset:44032
  v_fmac_f32 v228, v231, v236
  v_lshlrev_b32 v239, 16, v226
  v_mfma_f32_16x16x32_bf16 v[168:171], a[20:23], v[60:63], v[168:171]
  ds_read_b64_tr_b16 a[0:1], v248 offset:0
  v_fmac_f32 v228, v230, v237
  v_mfma_f32_16x16x32_bf16 v[172:175], a[20:23], v[132:135], v[172:175]
  ds_read_b64_tr_b16 a[2:3], v248 offset:8192
  v_mul_f32 v228, v228, v239
  v_mfma_f32_16x16x32_bf16 v[176:179], a[24:27], v[60:63], v[176:179]
  ds_read_b64_tr_b16 a[4:5], v248 offset:1024
  s_add_u32 s62, s55, 4129792
  v_and_b32 v238, 0xffff0000, v14
  v_mfma_f32_16x16x32_bf16 v[180:183], a[24:27], v[132:135], v[180:183]
  ds_read_b64_tr_b16 a[6:7], v248 offset:9216
  s_waitcnt vmcnt(17)
  v_readfirstlane_b32 s69, v4
  s_add_u32 s79, s78, 1
  v_mfma_f32_16x16x32_bf16 v[184:187], a[28:31], v[60:63], v[184:187]
  ds_read_b64_tr_b16 a[8:9], v249 offset:0
  buffer_load_dwordx4 v254, s[40:43], s62 offen offset:2048  lds
  s_sub_u32 s69, s69, s79
  s_cmp_gt_u32 s69, 3
  s_cbranch_scc1 K1_slow0
K1_back0:
  v_mfma_f32_16x16x32_bf16 v[188:191], a[28:31], v[132:135], v[188:191]
  ds_read_b64_tr_b16 a[10:11], v249 offset:8192
  s_add_u32 s69, s89, 0
  s_waitcnt lgkmcnt(6)
  v_mfma_f32_16x16x32_bf16 v[192:195], a[32:35], v[60:63], v[192:195]
  ds_read_b64_tr_b16 a[12:13], v249 offset:1024
  v_mul_f32 v229, v233, v235
  v_fmac_f32 v229, v232, v236
  v_mfma_f32_16x16x32_bf16 v[196:199], a[32:35], v[132:135], v[196:199]
  ds_read_b64_tr_b16 a[14:15], v249 offset:9216
  v_fmac_f32 v229, v231, v237
  v_and_b32 v239, 0xffff0000, v226
  v_mfma_f32_16x16x32_bf16 v[200:203], a[36:39], v[60:63], v[200:203]
  ds_read_b64_tr_b16 a[16:17], v250 offset:0
  v_fmac_f32 v229, v230, v238
  v_mul_f32 v229, v229, v239
  v_mfma_f32_16x16x32_bf16 v[204:207], a[36:39], v[132:135], v[204:207]
  ds_read_b64_tr_b16 a[18:19], v250 offset:8192
  buffer_load_dwordx4 a[124:127], v3, s[44:47], s69 offen offset:0 sc1
  v_mfma_f32_16x16x32_bf16 v[208:211], a[40:43], v[60:63], v[208:211]
  ds_read_b64_tr_b16 a[20:21], v250 offset:1024
  s_add_u32 s62, s55, 4423680
  v_cvt_pk_bf16_f32 v9, v229, v228
  v_mfma_f32_16x16x32_bf16 v[212:215], a[40:43], v[132:135], v[212:215]
  ds_read_b64_tr_b16 a[22:23], v250 offset:9216
  v_lshlrev_b32 v234, 16, v15
  v_mfma_f32_16x16x32_bf16 v[216:219], a[44:47], v[60:63], v[216:219]
  ds_read_b64_tr_b16 a[24:25], v251 offset:0
  buffer_load_dwordx4 v254, s[40:43], s62 offen offset:3072  lds
  v_mfma_f32_16x16x32_bf16 v[220:223], a[44:47], v[132:135], v[220:223]
  ds_read_b64_tr_b16 a[26:27], v251 offset:8192
  v_mul_f32 v228, v233, v236
  s_waitcnt lgkmcnt(6)
  v_mfma_f32_16x16x32_bf16 v[160:163], a[0:3], v[64:67], v[160:163]
  ds_read_b64_tr_b16 a[28:29], v251 offset:1024
  v_fmac_f32 v228, v232, v237
  v_fmac_f32 v228, v231, v238
  v_mfma_f32_16x16x32_bf16 v[164:167], a[0:3], v[136:139], v[164:167]
  ds_read_b64_tr_b16 a[30:31], v251 offset:9216
  v_lshlrev_b32 v239, 16, v227
  v_fmac_f32 v228, v230, v234
  v_mfma_f32_16x16x32_bf16 v[168:171], a[4:7], v[64:67], v[168:171]
  ds_read_b64_tr_b16 a[32:33], v248 offset:2048
  v_mul_f32 v228, v228, v239
  v_mfma_f32_16x16x32_bf16 v[172:175], a[4:7], v[136:139], v[172:175]
  ds_read_b64_tr_b16 a[34:35], v248 offset:10240
  v_and_b32 v235, 0xffff0000, v15
  v_mfma_f32_16x16x32_bf16 v[176:179], a[8:11], v[64:67], v[176:179]
  ds_read_b64_tr_b16 a[36:37], v248 offset:3072
  s_add_u32 m0, s52, 65536
  s_add_u32 s62, s55, 4721664
  v_mfma_f32_16x16x32_bf16 v[180:183], a[8:11], v[136:139], v[180:183]
  ds_read_b64_tr_b16 a[38:39], v248 offset:11264
  v_mul_f32 v229, v233, v237
  v_mfma_f32_16x16x32_bf16 v[184:187], a[12:15], v[64:67], v[184:187]
  ds_read_b64_tr_b16 a[40:41], v249 offset:2048
  buffer_load_dwordx4 v254, s[40:43], s62 offen  lds
  v_mfma_f32_16x16x32_bf16 v[188:191], a[12:15], v[136:139], v[188:191]
  ds_read_b64_tr_b16 a[42:43], v249 offset:10240
  v_fmac_f32 v229, v232, v238
  s_waitcnt lgkmcnt(6)
  v_mfma_f32_16x16x32_bf16 v[192:195], a[16:19], v[64:67], v[192:195]
  ds_read_b64_tr_b16 a[44:45], v249 offset:3072
  v_fmac_f32 v229, v231, v234
  v_and_b32 v239, 0xffff0000, v227
  v_mfma_f32_16x16x32_bf16 v[196:199], a[16:19], v[136:139], v[196:199]
  ds_read_b64_tr_b16 a[46:47], v249 offset:11264
  v_fmac_f32 v229, v230, v235
  v_mul_f32 v229, v229, v239
  v_mfma_f32_16x16x32_bf16 v[200:203], a[20:23], v[64:67], v[200:203]
  ds_read_b64_tr_b16 a[0:1], v250 offset:2048
  v_cvt_pk_bf16_f32 v8, v229, v228
  v_mfma_f32_16x16x32_bf16 v[204:207], a[20:23], v[136:139], v[204:207]
  ds_read_b64_tr_b16 a[2:3], v250 offset:10240
  v_accvgpr_read_b32 v239, a213
  buffer_store_dwordx4 v[8:11], v239, s[44:47], s75 offen sc1
  v_mfma_f32_16x16x32_bf16 v[208:211], a[24:27], v[64:67], v[208:211]
  ds_read_b64_tr_b16 a[4:5], v250 offset:3072
  v_accvgpr_read_b32 v255, a205
  v_mfma_f32_16x16x32_bf16 v[212:215], a[24:27], v[136:139], v[212:215]
  ds_read_b64_tr_b16 a[6:7], v250 offset:11264
  s_waitcnt vmcnt(21)
  s_barrier
  v_mfma_f32_16x16x32_bf16 v[216:219], a[28:31], v[64:67], v[216:219]
  ds_read_b64_tr_b16 a[8:9], v251 offset:2048
  s_add_u32 s62, s55, 5015552
  v_mfma_f32_16x16x32_bf16 v[220:223], a[28:31], v[136:139], v[220:223]
  ds_read_b64_tr_b16 a[10:11], v251 offset:10240
  s_waitcnt lgkmcnt(6)
  v_mfma_f32_16x16x32_bf16 v[160:163], a[32:35], v[68:71], v[160:163]
  ds_read_b64_tr_b16 a[12:13], v251 offset:3072
  v_accvgpr_read_b32 v6, a206
  v_mfma_f32_16x16x32_bf16 v[164:167], a[32:35], v[140:143], v[164:167]
  ds_read_b64_tr_b16 a[14:15], v251 offset:11264
  ds_read_b64_tr_b16 a[16:17], v248 offset:16384
  v_mfma_f32_16x16x32_bf16 v[168:171], a[36:39], v[68:71], v[168:171]
  buffer_load_dwordx4 v254, s[40:43], s62 offen offset:1024  lds
  v_accvgpr_read_b32 v7, a207
  v_mfma_f32_16x16x32_bf16 v[172:175], a[36:39], v[140:143], v[172:175]
  ds_read_b64_tr_b16 a[18:19], v248 offset:24576
  s_add_u32 s62, s56, 1024
  v_mfma_f32_16x16x32_bf16 v[176:179], a[40:43], v[68:71], v[176:179]
  ds_read_b64_tr_b16 a[20:21], v248 offset:17408
  buffer_load_dwordx4 a[160:163], v3, s[44:47], s69 offen offset:1024 sc1
  v_mfma_f32_16x16x32_bf16 v[180:183], a[40:43], v[140:143], v[180:183]
  ds_read_b64_tr_b16 a[22:23], v248 offset:25600
  ds_read_b64_tr_b16 a[24:25], v248 offset:18432
  v_mfma_f32_16x16x32_bf16 v[184:187], a[44:47], v[68:71], v[184:187]
  buffer_load_dwordx4 v255, s[36:39], s62 offen offset:2048  lds
  v_mfma_f32_16x16x32_bf16 v[188:191], a[44:47], v[140:143], v[188:191]
  ds_read_b64_tr_b16 a[26:27], v248 offset:26624
  s_waitcnt lgkmcnt(6)
  v_mfma_f32_16x16x32_bf16 v[192:195], a[0:3], v[68:71], v[192:195]
  ds_read_b64_tr_b16 a[28:29], v248 offset:19456
  s_add_u32 s62, s56, 128
  v_mfma_f32_16x16x32_bf16 v[196:199], a[0:3], v[140:143], v[196:199]
  ds_read_b64_tr_b16 a[30:31], v248 offset:27648
  v_mfma_f32_16x16x32_bf16 v[200:203], a[4:7], v[68:71], v[200:203]
  ds_read_b64_tr_b16 a[32:33], v248 offset:32768
  v_mfma_f32_16x16x32_bf16 v[204:207], a[4:7], v[140:143], v[204:207]
  ds_read_b64_tr_b16 a[34:35], v248 offset:40960
  v_mfma_f32_16x16x32_bf16 v[208:211], a[8:11], v[68:71], v[208:211]
  ds_read_b64_tr_b16 a[36:37], v248 offset:33792
  v_mfma_f32_16x16x32_bf16 v[212:215], a[8:11], v[140:143], v[212:215]
  ds_read_b64_tr_b16 a[38:39], v248 offset:41984
  ds_read_b64_tr_b16 a[40:41], v248 offset:34816
  v_mfma_f32_16x16x32_bf16 v[216:219], a[12:15], v[68:71], v[216:219]
  buffer_load_dwordx4 v255, s[36:39], s62 offen offset:3072  lds
  v_mfma_f32_16x16x32_bf16 v[220:223], a[12:15], v[140:143], v[220:223]
  ds_read_b64_tr_b16 a[42:43], v248 offset:43008
  s_waitcnt lgkmcnt(6)
  v_mfma_f32_16x16x32_bf16 v[160:163], a[16:19], v[72:75], v[160:163]
  ds_read_b64_tr_b16 a[44:45], v248 offset:35840
  s_add_u32 m0, s52, 81920
  v_mfma_f32_16x16x32_bf16 v[164:167], a[16:19], v[144:147], v[164:167]
  ds_read_b64_tr_b16 a[46:47], v248 offset:44032
  s_add_u32 s62, s56, 3328
  v_mfma_f32_16x16x32_bf16 v[168:171], a[20:23], v[72:75], v[168:171]
  ds_read_b64_tr_b16 a[0:1], v249 offset:16384
  v_mfma_f32_16x16x32_bf16 v[172:175], a[20:23], v[144:147], v[172:175]
  ds_read_b64_tr_b16 a[2:3], v249 offset:24576
  v_mfma_f32_16x16x32_bf16 v[160:163], a[24:27], v[76:79], v[160:163]
  ds_read_b64_tr_b16 a[4:5], v249 offset:17408
  v_mfma_f32_16x16x32_bf16 v[164:167], a[24:27], v[148:151], v[164:167]
  ds_read_b64_tr_b16 a[6:7], v249 offset:25600
  ds_read_b64_tr_b16 a[8:9], v249 offset:18432
  v_mfma_f32_16x16x32_bf16 v[168:171], a[28:31], v[76:79], v[168:171]
  buffer_load_dwordx4 v255, s[36:39], s62 offen  lds
  v_mfma_f32_16x16x32_bf16 v[172:175], a[28:31], v[148:151], v[172:175]
  ds_read_b64_tr_b16 a[10:11], v249 offset:26624
  s_waitcnt lgkmcnt(6)
  v_mfma_f32_16x16x32_bf16 v[160:163], a[32:35], v[80:83], v[160:163]
  ds_read_b64_tr_b16 a[12:13], v249 offset:19456
  s_add_u32 s62, s56, 2432
  v_mfma_f32_16x16x32_bf16 v[164:167], a[32:35], v[152:155], v[164:167]
  ds_read_b64_tr_b16 a[14:15], v249 offset:27648
  ds_read_b64_tr_b16 a[16:17], v249 offset:32768
  v_mfma_f32_16x16x32_bf16 v[168:171], a[36:39], v[80:83], v[168:171]
  buffer_load_dwordx4 a[128:131], v3, s[44:47], s69 offen offset:2048 sc1
  v_mfma_f32_16x16x32_bf16 v[172:175], a[36:39], v[152:155], v[172:175]
  ds_read_b64_tr_b16 a[18:19], v249 offset:40960
  v_mfma_f32_16x16x32_bf16 v[160:163], a[40:43], v[84:87], v[160:163]
  ds_read_b64_tr_b16 a[20:21], v249 offset:33792
  v_mfma_f32_16x16x32_bf16 v[164:167], a[40:43], v[156:159], v[164:167]
  ds_read_b64_tr_b16 a[22:23], v249 offset:41984
  ds_read_b64_tr_b16 a[24:25], v249 offset:34816
  v_mfma_f32_16x16x32_bf16 v[168:171], a[44:47], v[84:87], v[168:171]
  buffer_load_dwordx4 v255, s[36:39], s62 offen offset:1024  lds
  v_mfma_f32_16x16x32_bf16 v[172:175], a[44:47], v[156:159], v[172:175]
  ds_read_b64_tr_b16 a[26:27], v249 offset:43008
  s_waitcnt lgkmcnt(6)
  v_mfma_f32_16x16x32_bf16 v[176:179], a[0:3], v[72:75], v[176:179]
  ds_read_b64_tr_b16 a[28:29], v249 offset:35840
  s_add_u32 s62, s56, 37888
  v_mfma_f32_16x16x32_bf16 v[180:183], a[0:3], v[144:147], v[180:183]
  ds_read_b64_tr_b16 a[30:31], v249 offset:44032
  v_mfma_f32_16x16x32_bf16 v[184:187], a[4:7], v[72:75], v[184:187]
  ds_read_b64_tr_b16 a[32:33], v250 offset:16384
  v_mul_f32 v224, v160, v168
  v_mfma_f32_16x16x32_bf16 v[188:191], a[4:7], v[144:147], v[188:191]
  ds_read_b64_tr_b16 a[34:35], v250 offset:24576
  v_mul_f32 v225, v161, v169
  v_mfma_f32_16x16x32_bf16 v[176:179], a[8:11], v[76:79], v[176:179]
  ds_read_b64_tr_b16 a[36:37], v250 offset:17408
  v_mul_f32 v226, v162, v170
  v_mfma_f32_16x16x32_bf16 v[180:183], a[8:11], v[148:151], v[180:183]
  ds_read_b64_tr_b16 a[38:39], v250 offset:25600
  ds_read_b64_tr_b16 a[40:41], v250 offset:18432
  v_mfma_f32_16x16x32_bf16 v[184:187], a[12:15], v[76:79], v[184:187]
  buffer_load_dwordx4 v255, s[36:39], s62 offen offset:2048  lds
  v_mfma_f32_16x16x32_bf16 v[188:191], a[12:15], v[148:151], v[188:191]
  ds_read_b64_tr_b16 a[42:43], v250 offset:26624
  s_waitcnt lgkmcnt(6)
  v_mfma_f32_16x16x32_bf16 v[176:179], a[16:19], v[80:83], v[176:179]
  ds_read_b64_tr_b16 a[44:45], v250 offset:19456
  s_add_u32 s62, s56, 36992
  v_mfma_f32_16x16x32_bf16 v[180:183], a[16:19], v[152:155], v[180:183]
  ds_read_b64_tr_b16 a[46:47], v250 offset:27648
  v_accvgpr_read_b32 v8, a208
  v_mfma_f32_16x16x32_bf16 v[184:187], a[20:23], v[80:83], v[184:187]
  ds_read_b64_tr_b16 a[0:1], v250 offset:32768
  v_accvgpr_read_b32 v9, a209
  v_mfma_f32_16x16x32_bf16 v[188:191], a[20:23], v[152:155], v[188:191]
  ds_read_b64_tr_b16 a[2:3], v250 offset:40960
  v_add_u32 v10, 49152, v8
  v_mfma_f32_16x16x32_bf16 v[176:179], a[24:27], v[84:87], v[176:179]
  ds_read_b64_tr_b16 a[4:5], v250 offset:33792
  v_add_u32 v11, 49152, v9
  v_mfma_f32_16x16x32_bf16 v[180:183], a[24:27], v[156:159], v[180:183]
  ds_read_b64_tr_b16 a[6:7], v250 offset:41984
  ds_read_b64_tr_b16 a[8:9], v250 offset:34816
  v_mfma_f32_16x16x32_bf16 v[184:187], a[28:31], v[84:87], v[184:187]
  buffer_load_dwordx4 v255, s[36:39], s62 offen offset:3072  lds
  v_mfma_f32_16x16x32_bf16 v[188:191], a[28:31], v[156:159], v[188:191]
  ds_read_b64_tr_b16 a[10:11], v250 offset:43008
  s_waitcnt lgkmcnt(6)
  v_mfma_f32_16x16x32_bf16 v[192:195], a[32:35], v[72:75], v[192:195]
  ds_read_b64_tr_b16 a[12:13], v250 offset:35840
  s_add_u32 m0, s52, 98304
  v_mfma_f32_16x16x32_bf16 v[196:199], a[32:35], v[144:147], v[196:199]
  ds_read_b64_tr_b16 a[14:15], v250 offset:44032
  s_add_u32 s62, s56, 40192
  v_mfma_f32_16x16x32_bf16 v[200:203], a[36:39], v[72:75], v[200:203]
  ds_read_b64_tr_b16 a[16:17], v251 offset:16384
  v_add_u32 v12, 98304, v8
  v_mfma_f32_16x16x32_bf16 v[204:207], a[36:39], v[144:147], v[204:207]
  ds_read_b64_tr_b16 a[18:19], v251 offset:24576
  v_add_u32 v5, 1, v5
  v_mfma_f32_16x16x32_bf16 v[192:195], a[40:43], v[76:79], v[192:195]
  ds_read_b64_tr_b16 a[20:21], v251 offset:17408
  v_add_u32 v13, 98304, v9
  v_mfma_f32_16x16x32_bf16 v[196:199], a[40:43], v[148:151], v[196:199]
  ds_read_b64_tr_b16 a[22:23], v251 offset:25600
  ds_read_b64_tr_b16 a[24:25], v251 offset:18432
  v_mfma_f32_16x16x32_bf16 v[200:203], a[44:47], v[76:79], v[200:203]
  buffer_load_dwordx4 v255, s[36:39], s62 offen  lds
  buffer_load_dwordx4 a[164:167], v3, s[44:47], s69 offen offset:3072 sc1
  v_mfma_f32_16x16x32_bf16 v[204:207], a[44:47], v[148:151], v[204:207]
  ds_read_b64_tr_b16 a[26:27], v251 offset:26624
  s_waitcnt lgkmcnt(6)
  v_mfma_f32_16x16x32_bf16 v[192:195], a[0:3], v[80:83], v[192:195]
  ds_read_b64_tr_b16 a[28:29], v251 offset:19456
  v_mul_f32 v227, v163, v171
  v_mfma_f32_16x16x32_bf16 v[196:199], a[0:3], v[152:155], v[196:199]
  ds_read_b64_tr_b16 a[30:31], v251 offset:27648
  v_mul_f32 v228, v164, v172
  v_mfma_f32_16x16x32_bf16 v[200:203], a[4:7], v[80:83], v[200:203]
  ds_read_b64_tr_b16 a[32:33], v251 offset:32768
  v_mul_f32 v229, v165, v173
  v_mfma_f32_16x16x32_bf16 v[204:207], a[4:7], v[152:155], v[204:207]
  ds_read_b64_tr_b16 a[34:35], v251 offset:40960
  v_mul_f32 v230, v166, v174
  v_mfma_f32_16x16x32_bf16 v[192:195], a[8:11], v[84:87], v[192:195]
  ds_read_b64_tr_b16 a[36:37], v251 offset:33792
  v_mul_f32 v231, v167, v175
  v_mfma_f32_16x16x32_bf16 v[196:199], a[8:11], v[156:159], v[196:199]
  ds_read_b64_tr_b16 a[38:39], v251 offset:41984
  s_waitcnt vmcnt(11)
  s_barrier
  v_mfma_f32_16x16x32_bf16 v[200:203], a[12:15], v[84:87], v[200:203]
  ds_read_b64_tr_b16 a[40:41], v251 offset:34816
  s_add_u32 s62, s56, 39296
  v_mfma_f32_16x16x32_bf16 v[204:207], a[12:15], v[156:159], v[204:207]
  ds_read_b64_tr_b16 a[42:43], v251 offset:43008
  s_waitcnt lgkmcnt(6)
  v_mfma_f32_16x16x32_bf16 v[208:211], a[16:19], v[72:75], v[208:211]
  ds_read_b64_tr_b16 a[44:45], v251 offset:35840
  v_cvt_pk_bf16_f32 v224, v224, v225
  v_mfma_f32_16x16x32_bf16 v[212:215], a[16:19], v[144:147], v[212:215]
  ds_read_b64_tr_b16 a[46:47], v251 offset:44032
  ds_read_b64_tr_b16 a[0:1], v8 offset:0
  v_mfma_f32_16x16x32_bf16 v[216:219], a[20:23], v[72:75], v[216:219]
  ds_read_b64_tr_b16 a[2:3], v8 offset:4096
  buffer_load_dwordx4 v255, s[36:39], s62 offen offset:1024  lds
  v_mfma_f32_16x16x32_bf16 v[220:223], a[20:23], v[144:147], v[220:223]
  buffer_store_dword v5, v1, s[44:47], s90 offen sc1
  v_mfma_f32_16x16x32_bf16 v[208:211], a[24:27], v[76:79], v[208:211]
  ds_read_b64_tr_b16 a[4:5], v8 offset:8192
  s_add_u32 s62, s61, 1024
  v_mfma_f32_16x16x32_bf16 v[212:215], a[24:27], v[148:151], v[212:215]
  ds_read_b64_tr_b16 a[6:7], v8 offset:12288
  ds_read_b64_tr_b16 a[8:9], v8 offset:1024
  v_mfma_f32_16x16x32_bf16 v[216:219], a[28:31], v[76:79], v[216:219]
  buffer_load_dwordx4 v6, s[36:39], s62 offen offset:2048  lds
  v_mfma_f32_16x16x32_bf16 v[220:223], a[28:31], v[148:151], v[220:223]
  ds_read_b64_tr_b16 a[10:11], v8 offset:5120
  s_waitcnt lgkmcnt(6)
  v_mfma_f32_16x16x32_bf16 v[208:211], a[32:35], v[80:83], v[208:211]
  ds_read_b64_tr_b16 a[12:13], v8 offset:9216
  v_cvt_pk_bf16_f32 v226, v226, v227
  v_mfma_f32_16x16x32_bf16 v[212:215], a[32:35], v[152:155], v[212:215]
  ds_read_b64_tr_b16 a[14:15], v8 offset:13312
  buffer_store_dword v5, v1, s[44:47], s17 offen sc1
  v_mfma_f32_16x16x32_bf16 v[216:219], a[36:39], v[80:83], v[216:219]
  ds_read_b64_tr_b16 a[16:17], v8 offset:2048
  v_cvt_pk_bf16_f32 v228, v228, v229
  v_mfma_f32_16x16x32_bf16 v[220:223], a[36:39], v[152:155], v[220:223]
  ds_read_b64_tr_b16 a[18:19], v8 offset:6144
  s_add_u32 s69, s89, 4096
  v_mfma_f32_16x16x32_bf16 v[208:211], a[40:43], v[84:87], v[208:211]
  ds_read_b64_tr_b16 a[20:21], v8 offset:10240
  s_add_u32 s62, s56, 73728
  v_mfma_f32_16x16x32_bf16 v[212:215], a[40:43], v[156:159], v[212:215]
  ds_read_b64_tr_b16 a[22:23], v8 offset:14336
  ds_read_b64_tr_b16 a[24:25], v8 offset:3072
  v_mfma_f32_16x16x32_bf16 v[216:219], a[44:47], v[84:87], v[216:219]
  ds_read_b64_tr_b16 a[26:27], v8 offset:7168
  buffer_load_dwordx4 v255, s[36:39], s62 offen offset:3072  lds
  v_mfma_f32_16x16x32_bf16 v[220:223], a[44:47], v[156:159], v[220:223]
  buffer_load_dwordx4 a[132:135], v3, s[44:47], s69 offen offset:0 sc1
  s_waitcnt lgkmcnt(6)
  v_mfma_f32_16x16x32_bf16 v[160:163], a[0:3], v[16:19], 0
  ds_read_b64_tr_b16 a[28:29], v8 offset:11264
  v_cvt_pk_bf16_f32 v230, v230, v231
  v_mfma_f32_16x16x32_bf16 v[164:167], a[0:3], v[88:91], 0
  ds_read_b64_tr_b16 a[30:31], v8 offset:15360
  v_accvgpr_write_b32 a72, v224
  v_mfma_f32_16x16x32_bf16 v[168:171], a[4:7], v[16:19], 0
  ds_read_b64_tr_b16 a[32:33], v9 offset:0
  v_accvgpr_write_b32 a73, v226
  v_mfma_f32_16x16x32_bf16 v[172:175], a[4:7], v[88:91], 0
  ds_read_b64_tr_b16 a[34:35], v9 offset:4096
  v_accvgpr_write_b32 a108, v228
  v_mfma_f32_16x16x32_bf16 v[160:163], a[8:11], v[20:23], v[160:163]
  ds_read_b64_tr_b16 a[36:37], v9 offset:8192
  v_accvgpr_write_b32 a109, v230
  v_mfma_f32_16x16x32_bf16 v[164:167], a[8:11], v[92:95], v[164:167]
  ds_read_b64_tr_b16 a[38:39], v9 offset:12288
  v_mul_f32 v232, v176, v184
  v_mfma_f32_16x16x32_bf16 v[168:171], a[12:15], v[20:23], v[168:171]
  ds_read_b64_tr_b16 a[40:41], v9 offset:1024
  v_mul_f32 v233, v177, v185
  v_mfma_f32_16x16x32_bf16 v[172:175], a[12:15], v[92:95], v[172:175]
  ds_read_b64_tr_b16 a[42:43], v9 offset:5120
  s_waitcnt lgkmcnt(6)
  v_mfma_f32_16x16x32_bf16 v[160:163], a[16:19], v[24:27], v[160:163]
  ds_read_b64_tr_b16 a[44:45], v9 offset:9216
  v_mul_f32 v234, v178, v186
  v_mfma_f32_16x16x32_bf16 v[164:167], a[16:19], v[96:99], v[164:167]
  ds_read_b64_tr_b16 a[46:47], v9 offset:13312
  v_mul_f32 v235, v179, v187
  v_mfma_f32_16x16x32_bf16 v[168:171], a[20:23], v[24:27], v[168:171]
  ds_read_b64_tr_b16 a[0:1], v9 offset:2048
  v_mul_f32 v236, v180, v188
  v_mfma_f32_16x16x32_bf16 v[172:175], a[20:23], v[96:99], v[172:175]
  ds_read_b64_tr_b16 a[2:3], v9 offset:6144
  v_mul_f32 v237, v181, v189
  v_mfma_f32_16x16x32_bf16 v[160:163], a[24:27], v[28:31], v[160:163]
  ds_read_b64_tr_b16 a[4:5], v9 offset:10240
  v_mul_f32 v238, v182, v190
  v_mfma_f32_16x16x32_bf16 v[164:167], a[24:27], v[100:103], v[164:167]
  ds_read_b64_tr_b16 a[6:7], v9 offset:14336
  v_mul_f32 v239, v183, v191
  v_mfma_f32_16x16x32_bf16 v[168:171], a[28:31], v[28:31], v[168:171]
  ds_read_b64_tr_b16 a[8:9], v9 offset:3072
  v_cvt_pk_bf16_f32 v232, v232, v233
  v_mfma_f32_16x16x32_bf16 v[172:175], a[28:31], v[100:103], v[172:175]
  ds_read_b64_tr_b16 a[10:11], v9 offset:7168
  s_waitcnt lgkmcnt(6)
  v_mfma_f32_16x16x32_bf16 v[176:179], a[32:35], v[16:19], 0
  ds_read_b64_tr_b16 a[12:13], v9 offset:11264
  v_cvt_pk_bf16_f32 v234, v234, v235
  v_mfma_f32_16x16x32_bf16 v[180:183], a[32:35], v[88:91], 0
  ds_read_b64_tr_b16 a[14:15], v9 offset:15360
  v_cvt_pk_bf16_f32 v236, v236, v237
  v_mfma_f32_16x16x32_bf16 v[184:187], a[36:39], v[16:19], 0
  ds_read_b64_tr_b16 a[16:17], v8 offset:16384
  v_cvt_pk_bf16_f32 v238, v238, v239
  v_mfma_f32_16x16x32_bf16 v[188:191], a[36:39], v[88:91], 0
  ds_read_b64_tr_b16 a[18:19], v8 offset:20480
  v_accvgpr_write_b32 a74, v232
  v_mfma_f32_16x16x32_bf16 v[176:179], a[40:43], v[20:23], v[176:179]
  ds_read_b64_tr_b16 a[20:21], v8 offset:24576
  v_accvgpr_write_b32 a75, v234
  v_mfma_f32_16x16x32_bf16 v[180:183], a[40:43], v[92:95], v[180:183]
  ds_read_b64_tr_b16 a[22:23], v8 offset:28672
  v_accvgpr_write_b32 a110, v236
  v_mfma_f32_16x16x32_bf16 v[184:187], a[44:47], v[20:23], v[184:187]
  ds_read_b64_tr_b16 a[24:25], v9 offset:16384
  v_accvgpr_write_b32 a111, v238
  v_mfma_f32_16x16x32_bf16 v[188:191], a[44:47], v[92:95], v[188:191]
  ds_read_b64_tr_b16 a[26:27], v9 offset:20480
  s_waitcnt lgkmcnt(6)
  v_mfma_f32_16x16x32_bf16 v[176:179], a[0:3], v[24:27], v[176:179]
  ds_read_b64_tr_b16 a[28:29], v9 offset:24576
  buffer_load_dwordx4 a[168:171], v3, s[44:47], s69 offen offset:1024 sc1
  v_mfma_f32_16x16x32_bf16 v[180:183], a[0:3], v[96:99], v[180:183]
  ds_read_b64_tr_b16 a[30:31], v9 offset:28672
  v_mul_f32 v224, v192, v200
  v_mfma_f32_16x16x32_bf16 v[184:187], a[4:7], v[24:27], v[184:187]
  ds_read_b64_tr_b16 a[32:33], v8 offset:17408
  v_mul_f32 v225, v193, v201
  v_mfma_f32_16x16x32_bf16 v[188:191], a[4:7], v[96:99], v[188:191]
  ds_read_b64_tr_b16 a[34:35], v8 offset:21504
  v_mul_f32 v226, v194, v202
  v_mfma_f32_16x16x32_bf16 v[176:179], a[8:11], v[28:31], v[176:179]
  ds_read_b64_tr_b16 a[36:37], v8 offset:25600
  v_mul_f32 v227, v195, v203
  v_mfma_f32_16x16x32_bf16 v[180:183], a[8:11], v[100:103], v[180:183]
  ds_read_b64_tr_b16 a[38:39], v8 offset:29696
  v_mul_f32 v228, v196, v204
  v_mfma_f32_16x16x32_bf16 v[184:187], a[12:15], v[28:31], v[184:187]
  ds_read_b64_tr_b16 a[40:41], v9 offset:17408
  v_mul_f32 v229, v197, v205
  v_mfma_f32_16x16x32_bf16 v[188:191], a[12:15], v[100:103], v[188:191]
  ds_read_b64_tr_b16 a[42:43], v9 offset:21504
  s_waitcnt lgkmcnt(6)
  v_mfma_f32_16x16x32_bf16 v[160:163], a[16:19], v[32:35], v[160:163]
  ds_read_b64_tr_b16 a[44:45], v9 offset:25600
  v_mul_f32 v230, v198, v206
  v_mfma_f32_16x16x32_bf16 v[164:167], a[16:19], v[104:107], v[164:167]
  ds_read_b64_tr_b16 a[46:47], v9 offset:29696
  v_mul_f32 v231, v199, v207
  v_mfma_f32_16x16x32_bf16 v[168:171], a[20:23], v[32:35], v[168:171]
  ds_read_b64_tr_b16 a[0:1], v8 offset:18432
  v_cvt_pk_bf16_f32 v224, v224, v225
  v_mfma_f32_16x16x32_bf16 v[172:175], a[20:23], v[104:107], v[172:175]
  ds_read_b64_tr_b16 a[2:3], v8 offset:22528
  v_cvt_pk_bf16_f32 v226, v226, v227
  v_mfma_f32_16x16x32_bf16 v[176:179], a[24:27], v[32:35], v[176:179]
  ds_read_b64_tr_b16 a[4:5], v8 offset:26624
  v_cvt_pk_bf16_f32 v228, v228, v229
  v_mfma_f32_16x16x32_bf16 v[180:183], a[24:27], v[104:107], v[180:183]
  ds_read_b64_tr_b16 a[6:7], v8 offset:30720
  v_cvt_pk_bf16_f32 v230, v230, v231
  v_mfma_f32_16x16x32_bf16 v[184:187], a[28:31], v[32:35], v[184:187]
  ds_read_b64_tr_b16 a[8:9], v9 offset:18432
  s_add_u32 s68, s88, 12288
  v_mfma_f32_16x16x32_bf16 v[188:191], a[28:31], v[104:107], v[188:191]
  ds_read_b64_tr_b16 a[10:11], v9 offset:22528
  s_waitcnt lgkmcnt(6)
  v_mfma_f32_16x16x32_bf16 v[160:163], a[32:35], v[36:39], v[160:163]
  ds_read_b64_tr_b16 a[12:13], v9 offset:26624
  v_accvgpr_write_b32 a76, v224
  v_mfma_f32_16x16x32_bf16 v[164:167], a[32:35], v[108:111], v[164:167]
  ds_read_b64_tr_b16 a[14:15], v9 offset:30720
  v_accvgpr_write_b32 a77, v226
  v_mfma_f32_16x16x32_bf16 v[168:171], a[36:39], v[36:39], v[168:171]
  ds_read_b64_tr_b16 a[16:17], v8 offset:19456
  v_accvgpr_write_b32 a112, v228
  v_mfma_f32_16x16x32_bf16 v[172:175], a[36:39], v[108:111], v[172:175]
  ds_read_b64_tr_b16 a[18:19], v8 offset:23552
  v_accvgpr_write_b32 a113, v230
  v_mfma_f32_16x16x32_bf16 v[176:179], a[40:43], v[36:39], v[176:179]
  ds_read_b64_tr_b16 a[20:21], v8 offset:27648
  v_mul_f32 v232, v208, v216
  v_mfma_f32_16x16x32_bf16 v[180:183], a[40:43], v[108:111], v[180:183]
  ds_read_b64_tr_b16 a[22:23], v8 offset:31744
  s_waitcnt vmcnt(17)
  s_barrier
  v_mfma_f32_16x16x32_bf16 v[184:187], a[44:47], v[36:39], v[184:187]
  ds_read_b64_tr_b16 a[24:25], v9 offset:19456
  s_add_u32 m0, s52, 114688
  v_mfma_f32_16x16x32_bf16 v[188:191], a[44:47], v[108:111], v[188:191]
  ds_read_b64_tr_b16 a[26:27], v9 offset:23552
  s_waitcnt lgkmcnt(6)
  v_mfma_f32_16x16x32_bf16 v[160:163], a[0:3], v[40:43], v[160:163]
  ds_read_b64_tr_b16 a[28:29], v9 offset:27648
  s_add_u32 s62, s56, 76928
  v_mfma_f32_16x16x32_bf16 v[164:167], a[0:3], v[112:115], v[164:167]
  ds_read_b64_tr_b16 a[30:31], v9 offset:31744
  buffer_load_dwordx4 a[136:139], v3, s[44:47], s69 offen offset:2048 sc1
  v_mfma_f32_16x16x32_bf16 v[168:171], a[4:7], v[40:43], v[168:171]
  ds_read_b64_tr_b16 a[32:33], v8 offset:32768
  buffer_load_dwordx4 v255, s[36:39], s62 offen  lds
  v_mfma_f32_16x16x32_bf16 v[172:175], a[4:7], v[112:115], v[172:175]
  ds_read_b64_tr_b16 a[34:35], v8 offset:36864
  s_add_u32 s62, s56, 76032
  v_mfma_f32_16x16x32_bf16 v[176:179], a[8:11], v[40:43], v[176:179]
  ds_read_b64_tr_b16 a[36:37], v8 offset:40960
  v_mul_f32 v233, v209, v217
  v_mfma_f32_16x16x32_bf16 v[180:183], a[8:11], v[112:115], v[180:183]
  ds_read_b64_tr_b16 a[38:39], v8 offset:45056
  ds_read_b64_tr_b16 a[40:41], v9 offset:32768
  v_mfma_f32_16x16x32_bf16 v[184:187], a[12:15], v[40:43], v[184:187]
  buffer_load_dwordx4 v255, s[36:39], s62 offen offset:1024  lds
  buffer_store_dwordx4 a[72:75], v3, s[44:47], s68 offen offset:0 sc1
  buffer_store_dwordx4 a[108:111], v3, s[44:47], s68 offen offset:1024 sc1
  v_mfma_f32_16x16x32_bf16 v[188:191], a[12:15], v[112:115], v[188:191]
  ds_read_b64_tr_b16 a[42:43], v9 offset:36864
  s_waitcnt lgkmcnt(6)
  v_mfma_f32_16x16x32_bf16 v[160:163], a[16:19], v[44:47], v[160:163]
  ds_read_b64_tr_b16 a[44:45], v9 offset:40960
  s_add_u32 s62, s56, 75136
  v_mfma_f32_16x16x32_bf16 v[164:167], a[16:19], v[116:119], v[164:167]
  ds_read_b64_tr_b16 a[46:47], v9 offset:45056
  ds_read_b64_tr_b16 a[0:1], v8 offset:33792
  v_mfma_f32_16x16x32_bf16 v[168:171], a[20:23], v[44:47], v[168:171]
  buffer_load_dwordx4 v255, s[36:39], s62 offen offset:2048  lds
  v_mul_f32 v234, v210, v218
  v_mfma_f32_16x16x32_bf16 v[172:175], a[20:23], v[116:119], v[172:175]
  ds_read_b64_tr_b16 a[2:3], v8 offset:37888
  v_mul_f32 v235, v211, v219
  v_mfma_f32_16x16x32_bf16 v[176:179], a[24:27], v[44:47], v[176:179]
  ds_read_b64_tr_b16 a[4:5], v8 offset:41984
  s_add_u32 s62, s56, 110592
  v_mul_f32 v236, v212, v220
  v_mfma_f32_16x16x32_bf16 v[180:183], a[24:27], v[116:119], v[180:183]
  ds_read_b64_tr_b16 a[6:7], v8 offset:46080
  v_mul_f32 v237, v213, v221
  v_mfma_f32_16x16x32_bf16 v[184:187], a[28:31], v[44:47], v[184:187]
  ds_read_b64_tr_b16 a[8:9], v9 offset:33792
  buffer_load_dwordx4 v255, s[36:39], s62 offen offset:3072  lds
  v_mul_f32 v238, v214, v222
  v_mul_f32 v239, v215, v223
  v_mfma_f32_16x16x32_bf16 v[188:191], a[28:31], v[116:119], v[188:191]
  ds_read_b64_tr_b16 a[10:11], v9 offset:37888
  s_waitcnt lgkmcnt(6)
  v_mfma_f32_16x16x32_bf16 v[160:163], a[32:35], v[48:51], v[160:163]
  ds_read_b64_tr_b16 a[12:13], v9 offset:41984
  s_add_u32 m0, s52, 131072
  s_add_u32 s62, s56, 113792
  v_mfma_f32_16x16x32_bf16 v[164:167], a[32:35], v[120:123], v[164:167]
  ds_read_b64_tr_b16 a[14:15], v9 offset:46080
  ds_read_b64_tr_b16 a[16:17], v8 offset:34816
  v_mfma_f32_16x16x32_bf16 v[168:171], a[36:39], v[48:51], v[168:171]
  buffer_load_dwordx4 v255, s[36:39], s62 offen  lds
  v_mfma_f32_16x16x32_bf16 v[172:175], a[36:39], v[120:123], v[172:175]
  ds_read_b64_tr_b16 a[18:19], v8 offset:38912
  s_add_u32 s62, s56, 112896
  v_mfma_f32_16x16x32_bf16 v[176:179], a[40:43], v[48:51], v[176:179]
  ds_read_b64_tr_b16 a[20:21], v8 offset:43008
  v_cvt_pk_bf16_f32 v232, v232, v233
  v_mfma_f32_16x16x32_bf16 v[180:183], a[40:43], v[120:123], v[180:183]
  ds_read_b64_tr_b16 a[22:23], v8 offset:47104
  ds_read_b64_tr_b16 a[24:25], v9 offset:34816
  v_mfma_f32_16x16x32_bf16 v[184:187], a[44:47], v[48:51], v[184:187]
  buffer_load_dwordx4 v255, s[36:39], s62 offen offset:1024  lds
  v_mfma_f32_16x16x32_bf16 v[188:191], a[44:47], v[120:123], v[188:191]
  ds_read_b64_tr_b16 a[26:27], v9 offset:38912
  s_waitcnt lgkmcnt(6)
  v_mfma_f32_16x16x32_bf16 v[160:163], a[0:3], v[52:55], v[160:163]
  ds_read_b64_tr_b16 a[28:29], v9 offset:43008
  s_add_u32 s62, s56, 112000
  v_mfma_f32_16x16x32_bf16 v[164:167], a[0:3], v[124:127], v[164:167]
  ds_read_b64_tr_b16 a[30:31], v9 offset:47104
  ds_read_b64_tr_b16 a[32:33], v8 offset:35840
  v_mfma_f32_16x16x32_bf16 v[168:171], a[4:7], v[52:55], v[168:171]
  buffer_load_dwordx4 v255, s[36:39], s62 offen offset:2048  lds
  buffer_load_dwordx4 a[172:175], v3, s[44:47], s69 offen offset:3072 sc1
  v_mfma_f32_16x16x32_bf16 v[172:175], a[4:7], v[124:127], v[172:175]
  ds_read_b64_tr_b16 a[34:35], v8 offset:39936
  s_add_u32 s62, s61, 73728
  v_mfma_f32_16x16x32_bf16 v[176:179], a[8:11], v[52:55], v[176:179]
  ds_read_b64_tr_b16 a[36:37], v8 offset:44032
  v_cvt_pk_bf16_f32 v234, v234, v235
  v_mfma_f32_16x16x32_bf16 v[180:183], a[8:11], v[124:127], v[180:183]
  ds_read_b64_tr_b16 a[38:39], v8 offset:48128
  ds_read_b64_tr_b16 a[40:41], v9 offset:35840
  v_mfma_f32_16x16x32_bf16 v[184:187], a[12:15], v[52:55], v[184:187]
  buffer_load_dwordx4 v6, s[36:39], s62 offen offset:3072  lds
  v_mfma_f32_16x16x32_bf16 v[188:191], a[12:15], v[124:127], v[188:191]
  ds_read_b64_tr_b16 a[42:43], v9 offset:39936
  s_waitcnt lgkmcnt(6)
  v_mfma_f32_16x16x32_bf16 v[160:163], a[16:19], v[56:59], v[160:163]
  ds_read_b64_tr_b16 a[44:45], v9 offset:44032
  s_add_u32 m0, s52, 0
  s_add_u32 s62, s56, 150528
  v_mfma_f32_16x16x32_bf16 v[164:167], a[16:19], v[128:131], v[164:167]
  ds_read_b64_tr_b16 a[46:47], v9 offset:48128
  ds_read_b64_tr_b16 a[0:1], v10 offset:0
  v_mfma_f32_16x16x32_bf16 v[168:171], a[20:23], v[56:59], v[168:171]
  buffer_load_dwordx4 v255, s[36:39], s62 offen  lds
  v_mfma_f32_16x16x32_bf16 v[172:175], a[20:23], v[128:131], v[172:175]
  ds_read_b64_tr_b16 a[2:3], v10 offset:4096
  s_add_u32 s62, s56, 149632
  v_mfma_f32_16x16x32_bf16 v[176:179], a[24:27], v[56:59], v[176:179]
  ds_read_b64_tr_b16 a[4:5], v10 offset:8192
  v_cvt_pk_bf16_f32 v236, v236, v237
  v_mfma_f32_16x16x32_bf16 v[180:183], a[24:27], v[128:131], v[180:183]
  ds_read_b64_tr_b16 a[6:7], v10 offset:12288
  ds_read_b64_tr_b16 a[8:9], v11 offset:0
  v_mfma_f32_16x16x32_bf16 v[184:187], a[28:31], v[56:59], v[184:187]
  ds_read_b64_tr_b16 a[10:11], v11 offset:4096
  buffer_load_dwordx4 v255, s[36:39], s62 offen offset:1024  lds
  v_mfma_f32_16x16x32_bf16 v[188:191], a[28:31], v[128:131], v[188:191]
  buffer_load_dword v4, off, s[44:47], s91 sc1
  s_waitcnt lgkmcnt(6)
  v_mfma_f32_16x16x32_bf16 v[160:163], a[32:35], v[60:63], v[160:163]
  ds_read_b64_tr_b16 a[12:13], v11 offset:8192
  s_add_u32 s62, s56, 148736
  v_mfma_f32_16x16x32_bf16 v[164:167], a[32:35], v[132:135], v[164:167]
  ds_read_b64_tr_b16 a[14:15], v11 offset:12288
  v_cvt_pk_bf16_f32 v238, v238, v239
  v_mfma_f32_16x16x32_bf16 v[168:171], a[36:39], v[60:63], v[168:171]
  ds_read_b64_tr_b16 a[16:17], v10 offset:1024
  buffer_load_dwordx4 v255, s[36:39], s62 offen offset:2048  lds
  v_mfma_f32_16x16x32_bf16 v[172:175], a[36:39], v[132:135], v[172:175]
  ds_read_b64_tr_b16 a[18:19], v10 offset:5120
  v_accvgpr_write_b32 a78, v232
  v_accvgpr_write_b32 a79, v234
  v_mfma_f32_16x16x32_bf16 v[176:179], a[40:43], v[60:63], v[176:179]
  ds_read_b64_tr_b16 a[20:21], v10 offset:9216
  s_add_u32 s62, s56, 147840
  v_accvgpr_write_b32 a114, v236
  v_accvgpr_write_b32 a115, v238
  v_mfma_f32_16x16x32_bf16 v[180:183], a[40:43], v[132:135], v[180:183]
  ds_read_b64_tr_b16 a[22:23], v10 offset:13312
  ds_read_b64_tr_b16 a[24:25], v11 offset:1024
  v_mfma_f32_16x16x32_bf16 v[184:187], a[44:47], v[60:63], v[184:187]
  buffer_load_dwordx4 v255, s[36:39], s62 offen offset:3072  lds
  v_mfma_f32_16x16x32_bf16 v[188:191], a[44:47], v[132:135], v[188:191]
  ds_read_b64_tr_b16 a[26:27], v11 offset:5120
  s_waitcnt lgkmcnt(6)
  v_mfma_f32_16x16x32_bf16 v[160:163], a[0:3], v[64:67], v[160:163]
  ds_read_b64_tr_b16 a[28:29], v11 offset:9216
  s_add_u32 m0, s52, 16384
  v_mfma_f32_16x16x32_bf16 v[164:167], a[0:3], v[136:139], v[164:167]
  ds_read_b64_tr_b16 a[30:31], v11 offset:13312
  s_add_u32 s62, s56, 187392
  v_mfma_f32_16x16x32_bf16 v[168:171], a[4:7], v[64:67], v[168:171]
  ds_read_b64_tr_b16 a[32:33], v10 offset:2048
  ds_read_b64_tr_b16 a[34:35], v10 offset:6144
  v_mfma_f32_16x16x32_bf16 v[172:175], a[4:7], v[136:139], v[172:175]
  ds_read_b64_tr_b16 a[36:37], v10 offset:10240
  buffer_store_dwordx4 a[76:79], v3, s[44:47], s68 offen offset:2048 sc1
  v_mfma_f32_16x16x32_bf16 v[176:179], a[8:11], v[64:67], v[176:179]
  buffer_store_dwordx4 a[112:115], v3, s[44:47], s68 offen offset:3072 sc1
  v_mfma_f32_16x16x32_bf16 v[180:183], a[8:11], v[136:139], v[180:183]
  ds_read_b64_tr_b16 a[38:39], v10 offset:14336
  ds_read_b64_tr_b16 a[40:41], v10 offset:3072
  v_mfma_f32_16x16x32_bf16 v[184:187], a[12:15], v[64:67], v[184:187]
  buffer_load_dwordx4 v255, s[36:39], s62 offen  lds
  v_mfma_f32_16x16x32_bf16 v[188:191], a[12:15], v[136:139], v[188:191]
  ds_read_b64_tr_b16 a[42:43], v10 offset:7168
  s_waitcnt lgkmcnt(6)
  v_mfma_f32_16x16x32_bf16 v[160:163], a[16:19], v[68:71], v[160:163]
  ds_read_b64_tr_b16 a[44:45], v10 offset:11264
  v_mfma_f32_16x16x32_bf16 v[164:167], a[16:19], v[140:143], v[164:167]
  ds_read_b64_tr_b16 a[46:47], v10 offset:15360
  v_mfma_f32_16x16x32_bf16 v[168:171], a[20:23], v[68:71], v[168:171]
  ds_read_b64_tr_b16 a[0:1], v10 offset:16384
  v_mfma_f32_16x16x32_bf16 v[172:175], a[20:23], v[140:143], v[172:175]
  ds_read_b64_tr_b16 a[2:3], v10 offset:20480
  v_mfma_f32_16x16x32_bf16 v[176:179], a[24:27], v[68:71], v[176:179]
  ds_read_b64_tr_b16 a[4:5], v10 offset:24576
  v_mfma_f32_16x16x32_bf16 v[180:183], a[24:27], v[140:143], v[180:183]
  ds_read_b64_tr_b16 a[6:7], v10 offset:28672
  s_waitcnt vmcnt(29)
  s_barrier
  v_mfma_f32_16x16x32_bf16 v[184:187], a[28:31], v[68:71], v[184:187]
  ds_read_b64_tr_b16 a[8:9], v10 offset:17408
  s_add_u32 s62, s56, 186496
  v_mfma_f32_16x16x32_bf16 v[188:191], a[28:31], v[140:143], v[188:191]
  ds_read_b64_tr_b16 a[10:11], v10 offset:21504
  s_waitcnt lgkmcnt(6)
  v_mfma_f32_16x16x32_bf16 v[160:163], a[32:35], v[72:75], v[160:163]
  ds_read_b64_tr_b16 a[12:13], v10 offset:25600
  v_mfma_f32_16x16x32_bf16 v[164:167], a[32:35], v[144:147], v[164:167]
  ds_read_b64_tr_b16 a[14:15], v10 offset:29696
  ds_read_b64_tr_b16 a[16:17], v11 offset:2048
  v_mfma_f32_16x16x32_bf16 v[168:171], a[36:39], v[72:75], v[168:171]
  buffer_load_dwordx4 v255, s[36:39], s62 offen offset:1024  lds
  v_mfma_f32_16x16x32_bf16 v[172:175], a[36:39], v[144:147], v[172:175]
  ds_read_b64_tr_b16 a[18:19], v11 offset:6144
  s_add_u32 s62, s56, 185600
  v_mfma_f32_16x16x32_bf16 v[160:163], a[40:43], v[76:79], v[160:163]
  ds_read_b64_tr_b16 a[20:21], v11 offset:10240
  v_mfma_f32_16x16x32_bf16 v[164:167], a[40:43], v[148:151], v[164:167]
  ds_read_b64_tr_b16 a[22:23], v11 offset:14336
  ds_read_b64_tr_b16 a[24:25], v11 offset:3072
  v_mfma_f32_16x16x32_bf16 v[168:171], a[44:47], v[76:79], v[168:171]
  buffer_load_dwordx4 v255, s[36:39], s62 offen offset:2048  lds
  v_mfma_f32_16x16x32_bf16 v[172:175], a[44:47], v[148:151], v[172:175]
  ds_read_b64_tr_b16 a[26:27], v11 offset:7168
  s_waitcnt lgkmcnt(6)
  v_mfma_f32_16x16x32_bf16 v[160:163], a[0:3], v[80:83], v[160:163]
  ds_read_b64_tr_b16 a[28:29], v11 offset:11264
  s_add_u32 s62, s56, 184704
  v_mfma_f32_16x16x32_bf16 v[164:167], a[0:3], v[152:155], v[164:167]
  ds_read_b64_tr_b16 a[30:31], v11 offset:15360
  v_mfma_f32_16x16x32_bf16 v[168:171], a[4:7], v[80:83], v[168:171]
  ds_read_b64_tr_b16 a[32:33], v11 offset:16384
  v_mfma_f32_16x16x32_bf16 v[172:175], a[4:7], v[152:155], v[172:175]
  ds_read_b64_tr_b16 a[34:35], v11 offset:20480
  v_mfma_f32_16x16x32_bf16 v[160:163], a[8:11], v[84:87], v[160:163]
  ds_read_b64_tr_b16 a[36:37], v11 offset:24576
  v_mfma_f32_16x16x32_bf16 v[164:167], a[8:11], v[156:159], v[164:167]
  ds_read_b64_tr_b16 a[38:39], v11 offset:28672
  ds_read_b64_tr_b16 a[40:41], v11 offset:17408
  v_mfma_f32_16x16x32_bf16 v[168:171], a[12:15], v[84:87], v[168:171]
  buffer_load_dwordx4 v255, s[36:39], s62 offen offset:3072  lds
  v_mfma_f32_16x16x32_bf16 v[172:175], a[12:15], v[156:159], v[172:175]
  ds_read_b64_tr_b16 a[42:43], v11 offset:21504
  s_waitcnt lgkmcnt(6)
  v_mfma_f32_16x16x32_bf16 v[176:179], a[16:19], v[72:75], v[176:179]
  ds_read_b64_tr_b16 a[44:45], v11 offset:25600
  s_add_u32 m0, s52, 32768
  v_mfma_f32_16x16x32_bf16 v[180:183], a[16:19], v[144:147], v[180:183]
  ds_read_b64_tr_b16 a[46:47], v11 offset:29696
  s_add_u32 s62, s61, 150528
  v_mfma_f32_16x16x32_bf16 v[184:187], a[20:23], v[72:75], v[184:187]
  ds_read_b64_tr_b16 a[0:1], v244 offset:18432
  v_mul_f32 v224, v160, v168
  v_mfma_f32_16x16x32_bf16 v[188:191], a[20:23], v[144:147], v[188:191]
  ds_read_b64_tr_b16 a[2:3], v244 offset:26624
  v_mul_f32 v225, v161, v169
  v_mfma_f32_16x16x32_bf16 v[176:179], a[24:27], v[76:79], v[176:179]
  ds_read_b64_tr_b16 a[4:5], v245 offset:18432
  v_mul_f32 v226, v162, v170
  v_mfma_f32_16x16x32_bf16 v[180:183], a[24:27], v[148:151], v[180:183]
  ds_read_b64_tr_b16 a[6:7], v245 offset:26624
  ds_read_b64_tr_b16 a[8:9], v246 offset:18432
  v_mfma_f32_16x16x32_bf16 v[184:187], a[28:31], v[76:79], v[184:187]
  buffer_load_dwordx4 v6, s[36:39], s62 offen  lds
  v_mfma_f32_16x16x32_bf16 v[188:191], a[28:31], v[148:151], v[188:191]
  ds_read_b64_tr_b16 a[10:11], v246 offset:26624
  s_waitcnt lgkmcnt(6)
  v_mfma_f32_16x16x32_bf16 v[176:179], a[32:35], v[80:83], v[176:179]
  ds_read_b64_tr_b16 a[12:13], v247 offset:18432
  s_add_u32 s62, s56, 223232
  v_mfma_f32_16x16x32_bf16 v[180:183], a[32:35], v[152:155], v[180:183]
  ds_read_b64_tr_b16 a[14:15], v247 offset:26624
  v_mul_f32 v227, v163, v171
  v_mfma_f32_16x16x32_bf16 v[184:187], a[36:39], v[80:83], v[184:187]
  ds_read_b64_tr_b16 a[16:17], v244 offset:19456
  v_mul_f32 v228, v164, v172
  v_mfma_f32_16x16x32_bf16 v[188:191], a[36:39], v[152:155], v[188:191]
  ds_read_b64_tr_b16 a[18:19], v244 offset:27648
  v_mul_f32 v229, v165, v173
  v_mfma_f32_16x16x32_bf16 v[176:179], a[40:43], v[84:87], v[176:179]
  ds_read_b64_tr_b16 a[20:21], v245 offset:19456
  v_mul_f32 v230, v166, v174
  v_mfma_f32_16x16x32_bf16 v[180:183], a[40:43], v[156:159], v[180:183]
  ds_read_b64_tr_b16 a[22:23], v245 offset:27648
  ds_read_b64_tr_b16 a[24:25], v246 offset:19456
  v_mfma_f32_16x16x32_bf16 v[184:187], a[44:47], v[84:87], v[184:187]
  buffer_load_dwordx4 v255, s[36:39], s62 offen offset:1024  lds
  v_mfma_f32_16x16x32_bf16 v[188:191], a[44:47], v[156:159], v[188:191]
  ds_read_b64_tr_b16 a[26:27], v246 offset:27648
  s_waitcnt lgkmcnt(6)
  v_mfma_f32_16x16x32_bf16 v[16:19], a[0:3], a[48:51], 0
  ds_read_b64_tr_b16 a[28:29], v247 offset:19456
  s_add_u32 s62, s56, 259072
  v_mfma_f32_16x16x32_bf16 v[20:23], a[0:3], a[84:87], 0
  ds_read_b64_tr_b16 a[30:31], v247 offset:27648
  v_mul_f32 v231, v167, v175
  v_mfma_f32_16x16x32_bf16 v[24:27], a[4:7], a[48:51], 0
  ds_read_b64_tr_b16 a[32:33], v244 offset:32768
  v_cvt_pk_bf16_f32 v224, v224, v225
  v_mfma_f32_16x16x32_bf16 v[28:31], a[4:7], a[84:87], 0
  ds_read_b64_tr_b16 a[34:35], v244 offset:40960
  v_cvt_pk_bf16_f32 v226, v226, v227
  v_mfma_f32_16x16x32_bf16 v[32:35], a[8:11], a[48:51], 0
  ds_read_b64_tr_b16 a[36:37], v245 offset:32768
  v_cvt_pk_bf16_f32 v228, v228, v229
  v_mfma_f32_16x16x32_bf16 v[36:39], a[8:11], a[84:87], 0
  ds_read_b64_tr_b16 a[38:39], v245 offset:40960
  ds_read_b64_tr_b16 a[40:41], v246 offset:32768
  v_mfma_f32_16x16x32_bf16 v[40:43], a[12:15], a[48:51], 0
  buffer_load_dwordx4 v255, s[36:39], s62 offen offset:2048  lds
  v_mfma_f32_16x16x32_bf16 v[44:47], a[12:15], a[84:87], 0
  ds_read_b64_tr_b16 a[42:43], v246 offset:40960
  s_waitcnt lgkmcnt(6)
  v_mfma_f32_16x16x32_bf16 v[48:51], a[16:19], a[48:51], 0
  ds_read_b64_tr_b16 a[44:45], v247 offset:32768
  s_add_u32 s62, s76, 0
  v_mfma_f32_16x16x32_bf16 v[52:55], a[16:19], a[84:87], 0
  ds_read_b64_tr_b16 a[46:47], v247 offset:40960
  v_cvt_pk_bf16_f32 v230, v230, v231
  v_mfma_f32_16x16x32_bf16 v[56:59], a[20:23], a[48:51], 0
  ds_read_b64_tr_b16 a[0:1], v244 offset:33792
  v_accvgpr_write_b32 a80, v224
  v_mfma_f32_16x16x32_bf16 v[60:63], a[20:23], a[84:87], 0
  ds_read_b64_tr_b16 a[2:3], v244 offset:41984
  v_accvgpr_write_b32 a81, v226
  v_mfma_f32_16x16x32_bf16 v[64:67], a[24:27], a[48:51], 0
  ds_read_b64_tr_b16 a[4:5], v245 offset:33792
  v_accvgpr_write_b32 a116, v228
  v_mfma_f32_16x16x32_bf16 v[68:71], a[24:27], a[84:87], 0
  ds_read_b64_tr_b16 a[6:7], v245 offset:41984
  ds_read_b64_tr_b16 a[8:9], v246 offset:33792
  v_mfma_f32_16x16x32_bf16 v[72:75], a[28:31], a[48:51], 0
  buffer_load_dwordx4 v255, s[36:39], s62 offen offset:3072  lds
  v_mfma_f32_16x16x32_bf16 v[76:79], a[28:31], a[84:87], 0
  ds_read_b64_tr_b16 a[10:11], v246 offset:41984
  s_waitcnt lgkmcnt(6)
  v_mfma_f32_16x16x32_bf16 v[80:83], a[32:35], a[48:51], 0
  ds_read_b64_tr_b16 a[12:13], v247 offset:33792
  s_add_u32 m0, s52, 49152
  v_mfma_f32_16x16x32_bf16 v[84:87], a[32:35], a[84:87], 0
  ds_read_b64_tr_b16 a[14:15], v247 offset:41984
  s_add_u32 s62, s76, 39936
  v_mfma_f32_16x16x32_bf16 v[88:91], a[36:39], a[48:51], 0
  ds_read_b64_tr_b16 a[16:17], v244 offset:34816
  v_accvgpr_write_b32 a117, v230
  v_mfma_f32_16x16x32_bf16 v[92:95], a[36:39], a[84:87], 0
  ds_read_b64_tr_b16 a[18:19], v244 offset:43008
  v_mul_f32 v232, v176, v184
  v_mfma_f32_16x16x32_bf16 v[96:99], a[40:43], a[48:51], 0
  ds_read_b64_tr_b16 a[20:21], v245 offset:34816
  v_mul_f32 v233, v177, v185
  v_mfma_f32_16x16x32_bf16 v[100:103], a[40:43], a[84:87], 0
  ds_read_b64_tr_b16 a[22:23], v245 offset:43008
  ds_read_b64_tr_b16 a[24:25], v246 offset:34816
  v_mfma_f32_16x16x32_bf16 v[104:107], a[44:47], a[48:51], 0
  buffer_load_dwordx4 v255, s[36:39], s62 offen  lds
  v_mfma_f32_16x16x32_bf16 v[108:111], a[44:47], a[84:87], 0
  ds_read_b64_tr_b16 a[26:27], v246 offset:43008
  s_waitcnt lgkmcnt(6)
  v_mfma_f32_16x16x32_bf16 v[112:115], a[0:3], a[48:51], 0
  ds_read_b64_tr_b16 a[28:29], v247 offset:34816
  v_mul_f32 v234, v178, v186
  v_mfma_f32_16x16x32_bf16 v[116:119], a[0:3], a[84:87], 0
  ds_read_b64_tr_b16 a[30:31], v247 offset:43008
  v_mul_f32 v235, v179, v187
  v_mfma_f32_16x16x32_bf16 v[120:123], a[4:7], a[48:51], 0
  ds_read_b64_tr_b16 a[32:33], v244 offset:35840
  v_mul_f32 v236, v180, v188
  v_mfma_f32_16x16x32_bf16 v[124:127], a[4:7], a[84:87], 0
  ds_read_b64_tr_b16 a[34:35], v244 offset:44032
  v_mul_f32 v237, v181, v189
  v_mfma_f32_16x16x32_bf16 v[128:131], a[8:11], a[48:51], 0
  ds_read_b64_tr_b16 a[36:37], v245 offset:35840
  v_mul_f32 v238, v182, v190
  v_mfma_f32_16x16x32_bf16 v[132:135], a[8:11], a[84:87], 0
  ds_read_b64_tr_b16 a[38:39], v245 offset:44032
  s_waitcnt vmcnt(21)
  s_barrier
  v_mfma_f32_16x16x32_bf16 v[136:139], a[12:15], a[48:51], 0
  ds_read_b64_tr_b16 a[40:41], v246 offset:35840
  s_add_u32 s62, s57, 2048
  v_mfma_f32_16x16x32_bf16 v[140:143], a[12:15], a[84:87], 0
  ds_read_b64_tr_b16 a[42:43], v246 offset:44032
  s_waitcnt lgkmcnt(6)
  v_mfma_f32_16x16x32_bf16 v[16:19], a[16:19], a[52:55], v[16:19]
  ds_read_b64_tr_b16 a[44:45], v247 offset:35840
  v_mul_f32 v239, v183, v191
  v_mfma_f32_16x16x32_bf16 v[20:23], a[16:19], a[88:91], v[20:23]
  ds_read_b64_tr_b16 a[46:47], v247 offset:44032
  ds_read_b64_tr_b16 a[0:1], v248 offset:0
  v_mfma_f32_16x16x32_bf16 v[24:27], a[20:23], a[52:55], v[24:27]
  buffer_load_dwordx4 v255, s[36:39], s62 offen offset:1024  lds
  v_mfma_f32_16x16x32_bf16 v[28:31], a[20:23], a[88:91], v[28:31]
  ds_read_b64_tr_b16 a[2:3], v248 offset:8192
  v_cvt_pk_bf16_f32 v232, v232, v233
  v_mfma_f32_16x16x32_bf16 v[32:35], a[24:27], a[52:55], v[32:35]
  ds_read_b64_tr_b16 a[4:5], v249 offset:0
  s_add_u32 s62, s76, 74752
  v_mfma_f32_16x16x32_bf16 v[36:39], a[24:27], a[88:91], v[36:39]
  ds_read_b64_tr_b16 a[6:7], v249 offset:8192
  ds_read_b64_tr_b16 a[8:9], v250 offset:0
  v_mfma_f32_16x16x32_bf16 v[40:43], a[28:31], a[52:55], v[40:43]
  buffer_load_dwordx4 v255, s[36:39], s62 offen offset:2048  lds
  v_mfma_f32_16x16x32_bf16 v[44:47], a[28:31], a[88:91], v[44:47]
  ds_read_b64_tr_b16 a[10:11], v250 offset:8192
  s_waitcnt lgkmcnt(6)
  v_mfma_f32_16x16x32_bf16 v[48:51], a[32:35], a[52:55], v[48:51]
  ds_read_b64_tr_b16 a[12:13], v251 offset:0
  v_cvt_pk_bf16_f32 v234, v234, v235
  v_mfma_f32_16x16x32_bf16 v[52:55], a[32:35], a[88:91], v[52:55]
  ds_read_b64_tr_b16 a[14:15], v251 offset:8192
  v_cvt_pk_bf16_f32 v236, v236, v237
  v_mfma_f32_16x16x32_bf16 v[56:59], a[36:39], a[52:55], v[56:59]
  ds_read_b64_tr_b16 a[16:17], v248 offset:1024
  v_cvt_pk_bf16_f32 v238, v238, v239
  v_mfma_f32_16x16x32_bf16 v[60:63], a[36:39], a[88:91], v[60:63]
  ds_read_b64_tr_b16 a[18:19], v248 offset:9216
  v_accvgpr_write_b32 a82, v232
  v_mfma_f32_16x16x32_bf16 v[64:67], a[40:43], a[52:55], v[64:67]
  ds_read_b64_tr_b16 a[20:21], v249 offset:1024
  s_add_u32 s62, s76, 110592
  v_mfma_f32_16x16x32_bf16 v[68:71], a[40:43], a[88:91], v[68:71]
  ds_read_b64_tr_b16 a[22:23], v249 offset:9216
  v_accvgpr_write_b32 a83, v234
  v_mfma_f32_16x16x32_bf16 v[72:75], a[44:47], a[52:55], v[72:75]
  ds_read_b64_tr_b16 a[24:25], v250 offset:1024
  buffer_load_dwordx4 v255, s[36:39], s62 offen offset:3072  lds
  v_accvgpr_write_b32 a118, v236
  v_accvgpr_write_b32 a119, v238
  s_add_u32 s68, s88, 16384
  v_mfma_f32_16x16x32_bf16 v[76:79], a[44:47], a[88:91], v[76:79]
  ds_read_b64_tr_b16 a[26:27], v250 offset:9216
  s_waitcnt lgkmcnt(6)
  v_mfma_f32_16x16x32_bf16 v[80:83], a[0:3], a[52:55], v[80:83]
  ds_read_b64_tr_b16 a[28:29], v251 offset:1024
  s_add_u32 m0, s52, 65536
  v_mfma_f32_16x16x32_bf16 v[84:87], a[0:3], a[88:91], v[84:87]
  ds_read_b64_tr_b16 a[30:31], v251 offset:9216
  s_add_u32 s62, s76, 150528
  v_mfma_f32_16x16x32_bf16 v[88:91], a[4:7], a[52:55], v[88:91]
  ds_read_b64_tr_b16 a[32:33], v12 offset:2048
  v_accvgpr_read_b32 v254, a214
  v_mfma_f32_16x16x32_bf16 v[92:95], a[4:7], a[88:91], v[92:95]
  ds_read_b64_tr_b16 a[34:35], v12 offset:6144
  ds_read_b64_tr_b16 a[36:37], v13 offset:2048
  v_mfma_f32_16x16x32_bf16 v[96:99], a[8:11], a[52:55], v[96:99]
  buffer_store_dwordx4 a[80:83], v3, s[44:47], s68 offen offset:0 sc1
  v_mfma_f32_16x16x32_bf16 v[100:103], a[8:11], a[88:91], v[100:103]
  ds_read_b64_tr_b16 a[38:39], v13 offset:6144
  ds_read_b64_tr_b16 a[40:41], v12 offset:10240
  v_mfma_f32_16x16x32_bf16 v[104:107], a[12:15], a[52:55], v[104:107]
  buffer_load_dwordx4 v255, s[36:39], s62 offen  lds
  v_mfma_f32_16x16x32_bf16 v[108:111], a[12:15], a[88:91], v[108:111]
  ds_read_b64_tr_b16 a[42:43], v12 offset:14336
  s_waitcnt lgkmcnt(6)
  v_mfma_f32_16x16x32_bf16 v[112:115], a[16:19], a[52:55], v[112:115]
  ds_read_b64_tr_b16 a[44:45], v13 offset:10240
  buffer_store_dwordx4 a[116:119], v3, s[44:47], s68 offen offset:1024 sc1
  v_mfma_f32_16x16x32_bf16 v[116:119], a[16:19], a[88:91], v[116:119]
  ds_read_b64_tr_b16 a[46:47], v13 offset:14336
  s_add_u32 s62, s76, 186368
  v_mfma_f32_16x16x32_bf16 v[120:123], a[20:23], a[52:55], v[120:123]
  ds_read_b64_tr_b16 a[0:1], v248 offset:3072
  ds_read_b64_tr_b16 a[2:3], v248 offset:11264
  v_mfma_f32_16x16x32_bf16 v[124:127], a[20:23], a[88:91], v[124:127]
  buffer_load_dword v252, v254, s[44:47], 0 offen sc1
  v_mfma_f32_16x16x32_bf16 v[128:131], a[24:27], a[52:55], v[128:131]
  ds_read_b64_tr_b16 a[4:5], v249 offset:3072
  v_mfma_f32_16x16x32_bf16 v[132:135], a[24:27], a[88:91], v[132:135]
  ds_read_b64_tr_b16 a[6:7], v249 offset:11264
  ds_read_b64_tr_b16 a[8:9], v250 offset:3072
  v_mfma_f32_16x16x32_bf16 v[136:139], a[28:31], a[52:55], v[136:139]
  buffer_load_dwordx4 v255, s[36:39], s62 offen offset:1024  lds
  v_mfma_f32_16x16x32_bf16 v[140:143], a[28:31], a[88:91], v[140:143]
  ds_read_b64_tr_b16 a[10:11], v250 offset:11264
  s_waitcnt lgkmcnt(6)
  v_mfma_f32_16x16x32_bf16 v[144:147], a[32:35], a[48:51], 0
  ds_read_b64_tr_b16 a[12:13], v251 offset:3072
  s_add_u32 s62, s56, 222336
  v_mfma_f32_16x16x32_bf16 v[148:151], a[32:35], a[84:87], 0
  ds_read_b64_tr_b16 a[14:15], v251 offset:11264
  v_mfma_f32_16x16x32_bf16 v[152:155], a[36:39], a[48:51], 0
  ds_read_b64_tr_b16 a[16:17], v248 offset:16384
  v_mfma_f32_16x16x32_bf16 v[156:159], a[36:39], a[84:87], 0
  ds_read_b64_tr_b16 a[18:19], v248 offset:24576
  s_waitcnt vmcnt(21)
  v_readfirstlane_b32 s69, v4
  v_mfma_f32_16x16x32_bf16 v[144:147], a[40:43], a[52:55], v[144:147]
  ds_read_b64_tr_b16 a[20:21], v249 offset:16384
  s_add_u32 s79, s78, 2
  v_mfma_f32_16x16x32_bf16 v[148:151], a[40:43], a[88:91], v[148:151]
  ds_read_b64_tr_b16 a[22:23], v249 offset:24576
  ds_read_b64_tr_b16 a[24:25], v250 offset:16384
  v_mfma_f32_16x16x32_bf16 v[152:155], a[44:47], a[52:55], v[152:155]
  buffer_load_dwordx4 v255, s[36:39], s62 offen offset:2048  lds
  s_sub_u32 s69, s69, s79
  s_cmp_gt_u32 s69, 2
  s_cbranch_scc1 K1_slow1
K1_back1:
  v_mfma_f32_16x16x32_bf16 v[156:159], a[44:47], a[88:91], v[156:159]
  ds_read_b64_tr_b16 a[26:27], v250 offset:24576
  s_add_u32 s69, s89, 8192
  s_waitcnt lgkmcnt(6)
  v_mfma_f32_16x16x32_bf16 v[16:19], a[0:3], a[56:59], v[16:19]
  ds_read_b64_tr_b16 a[28:29], v251 offset:16384
  s_add_u32 s62, s56, 258176
  v_mfma_f32_16x16x32_bf16 v[20:23], a[0:3], a[92:95], v[20:23]
  ds_read_b64_tr_b16 a[30:31], v251 offset:24576
  ds_read_b64_tr_b16 a[32:33], v248 offset:17408
  v_mfma_f32_16x16x32_bf16 v[24:27], a[4:7], a[56:59], v[24:27]
  buffer_load_dwordx4 a[140:143], v3, s[44:47], s69 offen offset:0 sc1
  v_mfma_f32_16x16x32_bf16 v[28:31], a[4:7], a[92:95], v[28:31]
  ds_read_b64_tr_b16 a[34:35], v248 offset:25600
  v_mfma_f32_16x16x32_bf16 v[32:35], a[8:11], a[56:59], v[32:35]
  ds_read_b64_tr_b16 a[36:37], v249 offset:17408
  v_mfma_f32_16x16x32_bf16 v[36:39], a[8:11], a[92:95], v[36:39]
  ds_read_b64_tr_b16 a[38:39], v249 offset:25600
  ds_read_b64_tr_b16 a[40:41], v250 offset:17408
  v_mfma_f32_16x16x32_bf16 v[40:43], a[12:15], a[56:59], v[40:43]
  buffer_load_dwordx4 v255, s[36:39], s62 offen offset:3072  lds
  v_mfma_f32_16x16x32_bf16 v[44:47], a[12:15], a[92:95], v[44:47]
  ds_read_b64_tr_b16 a[42:43], v250 offset:25600
  s_waitcnt lgkmcnt(6)
  v_mfma_f32_16x16x32_bf16 v[48:51], a[16:19], a[56:59], v[48:51]
  ds_read_b64_tr_b16 a[44:45], v251 offset:17408
  s_add_u32 m0, s52, 81920
  v_mfma_f32_16x16x32_bf16 v[52:55], a[16:19], a[92:95], v[52:55]
  ds_read_b64_tr_b16 a[46:47], v251 offset:25600
  s_add_u32 s62, s76, 3200
  v_mfma_f32_16x16x32_bf16 v[56:59], a[20:23], a[56:59], v[56:59]
  ds_read_b64_tr_b16 a[0:1], v248 offset:18432
  v_mfma_f32_16x16x32_bf16 v[60:63], a[20:23], a[92:95], v[60:63]
  ds_read_b64_tr_b16 a[2:3], v248 offset:26624
  v_mfma_f32_16x16x32_bf16 v[64:67], a[24:27], a[56:59], v[64:67]
  ds_read_b64_tr_b16 a[4:5], v249 offset:18432
  v_mfma_f32_16x16x32_bf16 v[68:71], a[24:27], a[92:95], v[68:71]
  ds_read_b64_tr_b16 a[6:7], v249 offset:26624
  ds_read_b64_tr_b16 a[8:9], v250 offset:18432
  v_mfma_f32_16x16x32_bf16 v[72:75], a[28:31], a[56:59], v[72:75]
  buffer_load_dwordx4 v255, s[36:39], s62 offen  lds
  v_mfma_f32_16x16x32_bf16 v[76:79], a[28:31], a[92:95], v[76:79]
  ds_read_b64_tr_b16 a[10:11], v250 offset:26624
  s_waitcnt lgkmcnt(6)
  v_mfma_f32_16x16x32_bf16 v[80:83], a[32:35], a[56:59], v[80:83]
  ds_read_b64_tr_b16 a[12:13], v251 offset:18432
  v_mfma_f32_16x16x32_bf16 v[84:87], a[32:35], a[92:95], v[84:87]
  ds_read_b64_tr_b16 a[14:15], v251 offset:26624
  v_mfma_f32_16x16x32_bf16 v[88:91], a[36:39], a[56:59], v[88:91]
  ds_read_b64_tr_b16 a[16:17], v248 offset:19456
  v_mfma_f32_16x16x32_bf16 v[92:95], a[36:39], a[92:95], v[92:95]
  ds_read_b64_tr_b16 a[18:19], v248 offset:27648
  v_mfma_f32_16x16x32_bf16 v[96:99], a[40:43], a[56:59], v[96:99]
  ds_read_b64_tr_b16 a[20:21], v249 offset:19456
  v_mfma_f32_16x16x32_bf16 v[100:103], a[40:43], a[92:95], v[100:103]
  ds_read_b64_tr_b16 a[22:23], v249 offset:27648
  s_waitcnt vmcnt(23)
  s_barrier
  v_mfma_f32_16x16x32_bf16 v[104:107], a[44:47], a[56:59], v[104:107]
  ds_read_b64_tr_b16 a[24:25], v250 offset:19456
  s_add_u32 s62, s76, 39040
  v_mfma_f32_16x16x32_bf16 v[108:111], a[44:47], a[92:95], v[108:111]
  ds_read_b64_tr_b16 a[26:27], v250 offset:27648
  s_waitcnt lgkmcnt(6)
  v_mfma_f32_16x16x32_bf16 v[112:115], a[0:3], a[56:59], v[112:115]
  ds_read_b64_tr_b16 a[28:29], v251 offset:19456
  s_add_u32 s3, s97, 4096
  v_mfma_f32_16x16x32_bf16 v[116:119], a[0:3], a[92:95], v[116:119]
  ds_read_b64_tr_b16 a[30:31], v251 offset:27648
  ds_read_b64_tr_b16 a[32:33], v248 offset:32768
  v_mfma_f32_16x16x32_bf16 v[120:123], a[4:7], a[56:59], v[120:123]
  buffer_load_dwordx4 v255, s[36:39], s62 offen offset:1024  lds
  v_mfma_f32_16x16x32_bf16 v[124:127], a[4:7], a[92:95], v[124:127]
  ds_read_b64_tr_b16 a[34:35], v248 offset:40960
  s_add_u32 s62, s57, 1152
  v_mfma_f32_16x16x32_bf16 v[128:131], a[8:11], a[56:59], v[128:131]
  ds_read_b64_tr_b16 a[36:37], v249 offset:32768
  buffer_load_dwordx4 a[176:179], v3, s[44:47], s69 offen offset:1024 sc1
  v_mfma_f32_16x16x32_bf16 v[132:135], a[8:11], a[92:95], v[132:135]
  ds_read_b64_tr_b16 a[38:39], v249 offset:40960
  ds_read_b64_tr_b16 a[40:41], v250 offset:32768
  v_mfma_f32_16x16x32_bf16 v[136:139], a[12:15], a[56:59], v[136:139]
  buffer_load_dwordx4 v255, s[36:39], s62 offen offset:2048  lds
  v_mfma_f32_16x16x32_bf16 v[140:143], a[12:15], a[92:95], v[140:143]
  ds_read_b64_tr_b16 a[42:43], v250 offset:40960
  s_waitcnt lgkmcnt(6)
  v_mfma_f32_16x16x32_bf16 v[16:19], a[16:19], a[60:63], v[16:19]
  ds_read_b64_tr_b16 a[44:45], v251 offset:32768
  s_add_u32 s62, s76, 73856
  v_mfma_f32_16x16x32_bf16 v[20:23], a[16:19], a[96:99], v[20:23]
  ds_read_b64_tr_b16 a[46:47], v251 offset:40960
  ds_read_b64_tr_b16 a[0:1], v248 offset:33792
  v_mfma_f32_16x16x32_bf16 v[24:27], a[20:23], a[60:63], v[24:27]
  buffer_load_dwordx4 v[160:163], v3, s[80:83], s97 offen offset:0
  v_mfma_f32_16x16x32_bf16 v[28:31], a[20:23], a[96:99], v[28:31]
  ds_read_b64_tr_b16 a[2:3], v248 offset:41984
  v_mfma_f32_16x16x32_bf16 v[32:35], a[24:27], a[60:63], v[32:35]
  ds_read_b64_tr_b16 a[4:5], v249 offset:33792
  v_mfma_f32_16x16x32_bf16 v[36:39], a[24:27], a[96:99], v[36:39]
  ds_read_b64_tr_b16 a[6:7], v249 offset:41984
  ds_read_b64_tr_b16 a[8:9], v250 offset:33792
  v_mfma_f32_16x16x32_bf16 v[40:43], a[28:31], a[60:63], v[40:43]
  buffer_load_dwordx4 v255, s[36:39], s62 offen offset:3072  lds
  v_mfma_f32_16x16x32_bf16 v[44:47], a[28:31], a[96:99], v[44:47]
  ds_read_b64_tr_b16 a[10:11], v250 offset:41984
  s_waitcnt lgkmcnt(6)
  v_mfma_f32_16x16x32_bf16 v[48:51], a[32:35], a[60:63], v[48:51]
  ds_read_b64_tr_b16 a[12:13], v251 offset:33792
  s_add_u32 m0, s52, 98304
  v_mfma_f32_16x16x32_bf16 v[52:55], a[32:35], a[96:99], v[52:55]
  ds_read_b64_tr_b16 a[14:15], v251 offset:41984
  s_add_u32 s62, s76, 113792
  v_mfma_f32_16x16x32_bf16 v[56:59], a[36:39], a[60:63], v[56:59]
  ds_read_b64_tr_b16 a[16:17], v248 offset:34816
  v_mfma_f32_16x16x32_bf16 v[60:63], a[36:39], a[96:99], v[60:63]
  ds_read_b64_tr_b16 a[18:19], v248 offset:43008
  v_mfma_f32_16x16x32_bf16 v[64:67], a[40:43], a[60:63], v[64:67]
  ds_read_b64_tr_b16 a[20:21], v249 offset:34816
  v_mfma_f32_16x16x32_bf16 v[68:71], a[40:43], a[96:99], v[68:71]
  ds_read_b64_tr_b16 a[22:23], v249 offset:43008
  ds_read_b64_tr_b16 a[24:25], v250 offset:34816
  v_mfma_f32_16x16x32_bf16 v[72:75], a[44:47], a[60:63], v[72:75]
  buffer_load_dwordx4 v255, s[36:39], s62 offen  lds
  v_mfma_f32_16x16x32_bf16 v[76:79], a[44:47], a[96:99], v[76:79]
  ds_read_b64_tr_b16 a[26:27], v250 offset:43008
  s_waitcnt lgkmcnt(6)
  v_mfma_f32_16x16x32_bf16 v[80:83], a[0:3], a[60:63], v[80:83]
  ds_read_b64_tr_b16 a[28:29], v251 offset:34816
  s_add_u32 s62, s76, 149632
  v_mfma_f32_16x16x32_bf16 v[84:87], a[0:3], a[96:99], v[84:87]
  ds_read_b64_tr_b16 a[30:31], v251 offset:43008
  ds_read_b64_tr_b16 a[32:33], v12 offset:35840
  v_mfma_f32_16x16x32_bf16 v[88:91], a[4:7], a[60:63], v[88:91]
  ds_read_b64_tr_b16 a[34:35], v12 offset:39936
  buffer_load_dwordx4 a[144:147], v3, s[44:47], s69 offen offset:2048 sc1
  v_mfma_f32_16x16x32_bf16 v[92:95], a[4:7], a[96:99], v[92:95]
  buffer_load_dwordx4 v[164:167], v3, s[80:83], s97 offen offset:1024
  v_mfma_f32_16x16x32_bf16 v[96:99], a[8:11], a[60:63], v[96:99]
  ds_read_b64_tr_b16 a[36:37], v13 offset:35840
  v_mfma_f32_16x16x32_bf16 v[100:103], a[8:11], a[96:99], v[100:103]
  ds_read_b64_tr_b16 a[38:39], v13 offset:39936
  ds_read_b64_tr_b16 a[40:41], v12 offset:44032
  v_mfma_f32_16x16x32_bf16 v[104:107], a[12:15], a[60:63], v[104:107]
  buffer_load_dwordx4 v255, s[36:39], s62 offen offset:1024  lds
  v_mfma_f32_16x16x32_bf16 v[108:111], a[12:15], a[96:99], v[108:111]
  ds_read_b64_tr_b16 a[42:43], v12 offset:48128
  s_waitcnt lgkmcnt(6)
  v_mfma_f32_16x16x32_bf16 v[112:115], a[16:19], a[60:63], v[112:115]
  ds_read_b64_tr_b16 a[44:45], v13 offset:44032
  s_add_u32 s62, s76, 185472
  v_mfma_f32_16x16x32_bf16 v[116:119], a[16:19], a[96:99], v[116:119]
  ds_read_b64_tr_b16 a[46:47], v13 offset:48128
  v_mfma_f32_16x16x32_bf16 v[120:123], a[20:23], a[60:63], v[120:123]
  ds_read_b64_tr_b16 a[0:1], v240 offset:0
  v_mfma_f32_16x16x32_bf16 v[124:127], a[20:23], a[96:99], v[124:127]
  ds_read_b64_tr_b16 a[2:3], v240 offset:8192
  v_mfma_f32_16x16x32_bf16 v[128:131], a[24:27], a[60:63], v[128:131]
  ds_read_b64_tr_b16 a[4:5], v241 offset:0
  v_mfma_f32_16x16x32_bf16 v[132:135], a[24:27], a[96:99], v[132:135]
  ds_read_b64_tr_b16 a[6:7], v241 offset:8192
  ds_read_b64_tr_b16 a[8:9], v242 offset:0
  v_mfma_f32_16x16x32_bf16 v[136:139], a[28:31], a[60:63], v[136:139]
  buffer_load_dwordx4 v255, s[36:39], s62 offen offset:2048  lds
  v_mfma_f32_16x16x32_bf16 v[140:143], a[28:31], a[96:99], v[140:143]
  ds_read_b64_tr_b16 a[10:11], v242 offset:8192
  s_waitcnt lgkmcnt(6)
  v_mfma_f32_16x16x32_bf16 v[144:147], a[32:35], a[56:59], v[144:147]
  ds_read_b64_tr_b16 a[12:13], v243 offset:0
  s_add_u32 s62, s76, 221184
  v_mfma_f32_16x16x32_bf16 v[148:151], a[32:35], a[92:95], v[148:151]
  ds_read_b64_tr_b16 a[14:15], v243 offset:8192
  v_add_u32 v5, 1, v5
  v_mfma_f32_16x16x32_bf16 v[152:155], a[36:39], a[56:59], v[152:155]
  ds_read_b64_tr_b16 a[16:17], v240 offset:1024
  ds_read_b64_tr_b16 a[18:19], v240 offset:9216
  v_mfma_f32_16x16x32_bf16 v[156:159], a[36:39], a[92:95], v[156:159]
  buffer_load_dwordx4 v[168:171], v3, s[80:83], s97 offen offset:2048
  v_mfma_f32_16x16x32_bf16 v[144:147], a[40:43], a[60:63], v[144:147]
  ds_read_b64_tr_b16 a[20:21], v241 offset:1024
  v_mfma_f32_16x16x32_bf16 v[148:151], a[40:43], a[96:99], v[148:151]
  ds_read_b64_tr_b16 a[22:23], v241 offset:9216
  ds_read_b64_tr_b16 a[24:25], v242 offset:1024
  v_mfma_f32_16x16x32_bf16 v[152:155], a[44:47], a[60:63], v[152:155]
  buffer_load_dwordx4 v255, s[36:39], s62 offen offset:3072  lds
  v_mfma_f32_16x16x32_bf16 v[156:159], a[44:47], a[96:99], v[156:159]
  ds_read_b64_tr_b16 a[26:27], v242 offset:9216
  s_waitcnt lgkmcnt(6)
  v_mfma_f32_16x16x32_bf16 v[16:19], a[0:3], a[64:67], v[16:19]
  ds_read_b64_tr_b16 a[28:29], v243 offset:1024
  s_add_u32 m0, s52, 114688
  v_mfma_f32_16x16x32_bf16 v[20:23], a[0:3], a[100:103], v[20:23]
  ds_read_b64_tr_b16 a[30:31], v243 offset:9216
  s_add_u32 s62, s76, 261120
  v_mfma_f32_16x16x32_bf16 v[24:27], a[4:7], a[64:67], v[24:27]
  ds_read_b64_tr_b16 a[32:33], v240 offset:2048
  ds_read_b64_tr_b16 a[34:35], v240 offset:10240
  v_mfma_f32_16x16x32_bf16 v[28:31], a[4:7], a[100:103], v[28:31]
  buffer_load_dwordx4 a[180:183], v3, s[44:47], s69 offen offset:3072 sc1
  v_mfma_f32_16x16x32_bf16 v[32:35], a[8:11], a[64:67], v[32:35]
  ds_read_b64_tr_b16 a[36:37], v241 offset:2048
  v_mfma_f32_16x16x32_bf16 v[36:39], a[8:11], a[100:103], v[36:39]
  ds_read_b64_tr_b16 a[38:39], v241 offset:10240
  ds_read_b64_tr_b16 a[40:41], v242 offset:2048
  v_mfma_f32_16x16x32_bf16 v[40:43], a[12:15], a[64:67], v[40:43]
  buffer_load_dwordx4 v255, s[36:39], s62 offen  lds
  v_mfma_f32_16x16x32_bf16 v[44:47], a[12:15], a[100:103], v[44:47]
  ds_read_b64_tr_b16 a[42:43], v242 offset:10240
  s_waitcnt lgkmcnt(6)
  v_mfma_f32_16x16x32_bf16 v[48:51], a[16:19], a[64:67], v[48:51]
  ds_read_b64_tr_b16 a[44:45], v243 offset:2048
  ds_read_b64_tr_b16 a[46:47], v243 offset:10240
  v_mfma_f32_16x16x32_bf16 v[52:55], a[16:19], a[100:103], v[52:55]
  buffer_load_dwordx4 v[172:175], v3, s[80:83], s97 offen offset:3072
  v_mfma_f32_16x16x32_bf16 v[56:59], a[20:23], a[64:67], v[56:59]
  ds_read_b64_tr_b16 a[0:1], v240 offset:3072
  v_mfma_f32_16x16x32_bf16 v[60:63], a[20:23], a[100:103], v[60:63]
  ds_read_b64_tr_b16 a[2:3], v240 offset:11264
  v_mfma_f32_16x16x32_bf16 v[64:67], a[24:27], a[64:67], v[64:67]
  ds_read_b64_tr_b16 a[4:5], v241 offset:3072
  v_mfma_f32_16x16x32_bf16 v[68:71], a[24:27], a[100:103], v[68:71]
  ds_read_b64_tr_b16 a[6:7], v241 offset:11264
  s_waitcnt vmcnt(21)
  s_barrier
  v_mfma_f32_16x16x32_bf16 v[72:75], a[28:31], a[64:67], v[72:75]
  ds_read_b64_tr_b16 a[8:9], v242 offset:3072
  s_add_u32 s62, s77, 2048
  v_mfma_f32_16x16x32_bf16 v[76:79], a[28:31], a[100:103], v[76:79]
  ds_read_b64_tr_b16 a[10:11], v242 offset:11264
  s_waitcnt lgkmcnt(6)
  v_mfma_f32_16x16x32_bf16 v[80:83], a[32:35], a[64:67], v[80:83]
  ds_read_b64_tr_b16 a[12:13], v243 offset:3072
  v_mfma_f32_16x16x32_bf16 v[84:87], a[32:35], a[100:103], v[84:87]
  ds_read_b64_tr_b16 a[14:15], v243 offset:11264
  ds_read_b64_tr_b16 a[16:17], v240 offset:16384
  v_mfma_f32_16x16x32_bf16 v[88:91], a[36:39], a[64:67], v[88:91]
  ds_read_b64_tr_b16 a[18:19], v240 offset:24576
  buffer_load_dwordx4 v255, s[36:39], s62 offen offset:1024  lds
  v_mfma_f32_16x16x32_bf16 v[92:95], a[36:39], a[100:103], v[92:95]
  buffer_store_dword v5, v1, s[44:47], s90 offen sc1
  v_mfma_f32_16x16x32_bf16 v[96:99], a[40:43], a[64:67], v[96:99]
  ds_read_b64_tr_b16 a[20:21], v241 offset:16384
  s_add_u32 s62, s76, 222336
  v_mfma_f32_16x16x32_bf16 v[100:103], a[40:43], a[100:103], v[100:103]
  ds_read_b64_tr_b16 a[22:23], v241 offset:24576
  ds_read_b64_tr_b16 a[24:25], v242 offset:16384
  v_mfma_f32_16x16x32_bf16 v[104:107], a[44:47], a[64:67], v[104:107]
  buffer_load_dwordx4 v255, s[36:39], s62 offen offset:2048  lds
  v_mfma_f32_16x16x32_bf16 v[108:111], a[44:47], a[100:103], v[108:111]
  ds_read_b64_tr_b16 a[26:27], v242 offset:24576
  s_waitcnt lgkmcnt(6)
  v_mfma_f32_16x16x32_bf16 v[112:115], a[0:3], a[64:67], v[112:115]
  ds_read_b64_tr_b16 a[28:29], v243 offset:16384
  s_add_u32 s62, s76, 258176
  v_mfma_f32_16x16x32_bf16 v[116:119], a[0:3], a[100:103], v[116:119]
  ds_read_b64_tr_b16 a[30:31], v243 offset:24576
  ds_read_b64_tr_b16 a[32:33], v240 offset:17408
  v_mfma_f32_16x16x32_bf16 v[120:123], a[4:7], a[64:67], v[120:123]
  buffer_load_dwordx4 v[176:179], v3, s[80:83], s3 offen offset:0
  v_mfma_f32_16x16x32_bf16 v[124:127], a[4:7], a[100:103], v[124:127]
  ds_read_b64_tr_b16 a[34:35], v240 offset:25600
  v_mfma_f32_16x16x32_bf16 v[128:131], a[8:11], a[64:67], v[128:131]
  ds_read_b64_tr_b16 a[36:37], v241 offset:17408
  v_mfma_f32_16x16x32_bf16 v[132:135], a[8:11], a[100:103], v[132:135]
  ds_read_b64_tr_b16 a[38:39], v241 offset:25600
  ds_read_b64_tr_b16 a[40:41], v242 offset:17408
  v_mfma_f32_16x16x32_bf16 v[136:139], a[12:15], a[64:67], v[136:139]
  buffer_load_dwordx4 v255, s[36:39], s62 offen offset:3072  lds
  v_mfma_f32_16x16x32_bf16 v[140:143], a[12:15], a[100:103], v[140:143]
  ds_read_b64_tr_b16 a[42:43], v242 offset:25600
  s_waitcnt lgkmcnt(6)
  v_mfma_f32_16x16x32_bf16 v[16:19], a[16:19], a[68:71], v[16:19]
  ds_read_b64_tr_b16 a[44:45], v243 offset:17408
  s_add_u32 m0, s52, 131072
  v_mfma_f32_16x16x32_bf16 v[20:23], a[16:19], a[104:107], v[20:23]
  ds_read_b64_tr_b16 a[46:47], v243 offset:25600
  s_add_u32 s62, s77, 3200
  v_mfma_f32_16x16x32_bf16 v[24:27], a[20:23], a[68:71], v[24:27]
  ds_read_b64_tr_b16 a[0:1], v240 offset:18432
  v_mfma_f32_16x16x32_bf16 v[28:31], a[20:23], a[104:107], v[28:31]
  ds_read_b64_tr_b16 a[2:3], v240 offset:26624
  v_mfma_f32_16x16x32_bf16 v[32:35], a[24:27], a[68:71], v[32:35]
  ds_read_b64_tr_b16 a[4:5], v241 offset:18432
  v_mfma_f32_16x16x32_bf16 v[36:39], a[24:27], a[104:107], v[36:39]
  ds_read_b64_tr_b16 a[6:7], v241 offset:26624
  ds_read_b64_tr_b16 a[8:9], v242 offset:18432
  v_mfma_f32_16x16x32_bf16 v[40:43], a[28:31], a[68:71], v[40:43]
  buffer_load_dwordx4 v255, s[36:39], s62 offen  lds
  v_mfma_f32_16x16x32_bf16 v[44:47], a[28:31], a[104:107], v[44:47]
  ds_read_b64_tr_b16 a[10:11], v242 offset:26624
  s_waitcnt lgkmcnt(6)
  v_mfma_f32_16x16x32_bf16 v[48:51], a[32:35], a[68:71], v[48:51]
  ds_read_b64_tr_b16 a[12:13], v243 offset:18432
  s_waitcnt vmcnt(26)
  v_subrev_u32 v252, s78, v252
  v_mfma_f32_16x16x32_bf16 v[52:55], a[32:35], a[104:107], v[52:55]
  ds_read_b64_tr_b16 a[14:15], v243 offset:26624
  v_add_u32 v252, -2, v252
  v_mfma_f32_16x16x32_bf16 v[56:59], a[36:39], a[68:71], v[56:59]
  ds_read_b64_tr_b16 a[16:17], v240 offset:19456
  s_add_u32 s62, s56, 223488
  v_mfma_f32_16x16x32_bf16 v[60:63], a[36:39], a[104:107], v[60:63]
  ds_read_b64_tr_b16 a[18:19], v240 offset:27648
  v_cmp_ne_u32 vcc, 0, v252
  v_mfma_f32_16x16x32_bf16 v[64:67], a[40:43], a[68:71], v[64:67]
  ds_read_b64_tr_b16 a[20:21], v241 offset:19456
  s_nop 3
  s_cbranch_vccnz K1_slowK
K1_backK:
  v_mfma_f32_16x16x32_bf16 v[68:71], a[40:43], a[104:107], v[68:71]
  ds_read_b64_tr_b16 a[22:23], v241 offset:27648
  ds_read_b64_tr_b16 a[24:25], v242 offset:19456
  v_mfma_f32_16x16x32_bf16 v[72:75], a[44:47], a[68:71], v[72:75]
  buffer_load_dwordx4 v255, s[36:39], s62 offen offset:1024  lds
  v_mfma_f32_16x16x32_bf16 v[76:79], a[44:47], a[104:107], v[76:79]
  ds_read_b64_tr_b16 a[26:27], v242 offset:27648
  s_waitcnt lgkmcnt(6)
  v_mfma_f32_16x16x32_bf16 v[80:83], a[0:3], a[68:71], v[80:83]
  ds_read_b64_tr_b16 a[28:29], v243 offset:19456
  buffer_load_dwordx4 v[180:183], v3, s[80:83], s3 offen offset:1024
  v_mfma_f32_16x16x32_bf16 v[84:87], a[0:3], a[104:107], v[84:87]
  ds_read_b64_tr_b16 a[30:31], v243 offset:27648
  s_add_u32 s62, s56, 259328
  v_mfma_f32_16x16x32_bf16 v[88:91], a[4:7], a[68:71], v[88:91]
  ds_read_b64_tr_b16 a[32:33], v8 offset:32768
  v_mfma_f32_16x16x32_bf16 v[92:95], a[4:7], a[104:107], v[92:95]
  ds_read_b64_tr_b16 a[34:35], v8 offset:36864
  v_mfma_f32_16x16x32_bf16 v[96:99], a[8:11], a[68:71], v[96:99]
  ds_read_b64_tr_b16 a[36:37], v9 offset:32768
  v_mfma_f32_16x16x32_bf16 v[100:103], a[8:11], a[104:107], v[100:103]
  ds_read_b64_tr_b16 a[38:39], v9 offset:36864
  ds_read_b64_tr_b16 a[40:41], v8 offset:40960
  v_mfma_f32_16x16x32_bf16 v[104:107], a[12:15], a[68:71], v[104:107]
  buffer_load_dwordx4 v255, s[36:39], s62 offen offset:2048  lds
  v_mfma_f32_16x16x32_bf16 v[108:111], a[12:15], a[104:107], v[108:111]
  ds_read_b64_tr_b16 a[42:43], v8 offset:45056
  s_waitcnt lgkmcnt(6)
  v_mfma_f32_16x16x32_bf16 v[112:115], a[16:19], a[68:71], v[112:115]
  ds_read_b64_tr_b16 a[44:45], v9 offset:40960
  s_add_u32 s62, s76, 256
  v_mfma_f32_16x16x32_bf16 v[116:119], a[16:19], a[104:107], v[116:119]
  ds_read_b64_tr_b16 a[46:47], v9 offset:45056
  ds_read_b64_tr_b16 a[0:1], v240 offset:33792
  v_mfma_f32_16x16x32_bf16 v[120:123], a[20:23], a[68:71], v[120:123]
  buffer_load_dwordx4 v[184:187], v3, s[80:83], s3 offen offset:2048
  v_mfma_f32_16x16x32_bf16 v[124:127], a[20:23], a[104:107], v[124:127]
  ds_read_b64_tr_b16 a[2:3], v240 offset:41984
  ds_read_b64_tr_b16 a[4:5], v241 offset:33792
  v_mfma_f32_16x16x32_bf16 v[128:131], a[24:27], a[68:71], v[128:131]
  buffer_load_dwordx4 a[48:51], v3, s[44:47], s97 offen offset:0 sc1
  v_mfma_f32_16x16x32_bf16 v[132:135], a[24:27], a[104:107], v[132:135]
  ds_read_b64_tr_b16 a[6:7], v241 offset:41984
  ds_read_b64_tr_b16 a[8:9], v242 offset:33792
  v_mfma_f32_16x16x32_bf16 v[136:139], a[28:31], a[68:71], v[136:139]
  buffer_load_dwordx4 v255, s[36:39], s62 offen offset:3072  lds
  v_mfma_f32_16x16x32_bf16 v[140:143], a[28:31], a[104:107], v[140:143]
  ds_read_b64_tr_b16 a[10:11], v242 offset:41984
  s_waitcnt lgkmcnt(6)
  v_mfma_f32_16x16x32_bf16 v[144:147], a[32:35], a[64:67], v[144:147]
  ds_read_b64_tr_b16 a[12:13], v243 offset:33792
  s_add_u32 m0, s52, 0
  v_mfma_f32_16x16x32_bf16 v[148:151], a[32:35], a[100:103], v[148:151]
  ds_read_b64_tr_b16 a[14:15], v243 offset:41984
  s_add_u32 s62, s76, 40192
  v_mfma_f32_16x16x32_bf16 v[152:155], a[36:39], a[64:67], v[152:155]
  ds_read_b64_tr_b16 a[16:17], v240 offset:34816
  v_mfma_f32_16x16x32_bf16 v[156:159], a[36:39], a[100:103], v[156:159]
  ds_read_b64_tr_b16 a[18:19], v240 offset:43008
  v_mfma_f32_16x16x32_bf16 v[144:147], a[40:43], a[68:71], v[144:147]
  ds_read_b64_tr_b16 a[20:21], v241 offset:34816
  v_mfma_f32_16x16x32_bf16 v[148:151], a[40:43], a[104:107], v[148:151]
  ds_read_b64_tr_b16 a[22:23], v241 offset:43008
  ds_read_b64_tr_b16 a[24:25], v242 offset:34816
  v_mfma_f32_16x16x32_bf16 v[152:155], a[44:47], a[68:71], v[152:155]
  buffer_load_dwordx4 v255, s[36:39], s62 offen  lds
  v_mfma_f32_16x16x32_bf16 v[156:159], a[44:47], a[104:107], v[156:159]
  ds_read_b64_tr_b16 a[26:27], v242 offset:43008
  s_waitcnt lgkmcnt(6)
  v_mfma_f32_16x16x32_bf16 v[16:19], a[0:3], a[72:75], v[16:19]
  ds_read_b64_tr_b16 a[28:29], v243 offset:34816
  ds_read_b64_tr_b16 a[30:31], v243 offset:43008
  v_mfma_f32_16x16x32_bf16 v[20:23], a[0:3], a[108:111], v[20:23]
  ds_read_b64_tr_b16 a[32:33], v240 offset:35840
  buffer_load_dword v4, off, s[44:47], s91 sc1
  v_mfma_f32_16x16x32_bf16 v[24:27], a[4:7], a[72:75], v[24:27]
  buffer_load_dwordx4 v[188:191], v3, s[80:83], s3 offen offset:3072
  v_mfma_f32_16x16x32_bf16 v[28:31], a[4:7], a[108:111], v[28:31]
  ds_read_b64_tr_b16 a[34:35], v240 offset:44032
  v_mfma_f32_16x16x32_bf16 v[32:35], a[8:11], a[72:75], v[32:35]
  ds_read_b64_tr_b16 a[36:37], v241 offset:35840
  v_mfma_f32_16x16x32_bf16 v[36:39], a[8:11], a[108:111], v[36:39]
  ds_read_b64_tr_b16 a[38:39], v241 offset:44032
  s_waitcnt vmcnt(31)
  s_barrier
  v_mfma_f32_16x16x32_bf16 v[40:43], a[12:15], a[72:75], v[40:43]
  ds_read_b64_tr_b16 a[40:41], v242 offset:35840
  s_add_u32 s62, s57, 2304
  v_mfma_f32_16x16x32_bf16 v[44:47], a[12:15], a[108:111], v[44:47]
  ds_read_b64_tr_b16 a[42:43], v242 offset:44032
  s_waitcnt lgkmcnt(6)
  v_mfma_f32_16x16x32_bf16 v[16:19], a[16:19], a[76:79], v[16:19]
  ds_read_b64_tr_b16 a[44:45], v243 offset:35840
  v_mfma_f32_16x16x32_bf16 v[20:23], a[16:19], a[112:115], v[20:23]
  ds_read_b64_tr_b16 a[46:47], v243 offset:44032
  ds_read_b64_tr_b16 a[0:1], v244 offset:0
  v_mfma_f32_16x16x32_bf16 v[24:27], a[20:23], a[76:79], v[24:27]
  buffer_load_dwordx4 v255, s[36:39], s62 offen offset:1024  lds
  v_mfma_f32_16x16x32_bf16 v[28:31], a[20:23], a[112:115], v[28:31]
  ds_read_b64_tr_b16 a[2:3], v244 offset:8192
  s_add_u32 s62, s76, 75008
  v_mfma_f32_16x16x32_bf16 v[32:35], a[24:27], a[76:79], v[32:35]
  ds_read_b64_tr_b16 a[4:5], v245 offset:0
  v_mfma_f32_16x16x32_bf16 v[36:39], a[24:27], a[112:115], v[36:39]
  ds_read_b64_tr_b16 a[6:7], v245 offset:8192
  ds_read_b64_tr_b16 a[8:9], v246 offset:0
  v_mfma_f32_16x16x32_bf16 v[40:43], a[28:31], a[76:79], v[40:43]
  buffer_load_dwordx4 v255, s[36:39], s62 offen offset:2048  lds
  v_mfma_f32_16x16x32_bf16 v[44:47], a[28:31], a[112:115], v[44:47]
  ds_read_b64_tr_b16 a[10:11], v246 offset:8192
  s_waitcnt lgkmcnt(6)
  v_mfma_f32_16x16x32_bf16 v[16:19], a[32:35], a[124:127], v[16:19]
  ds_read_b64_tr_b16 a[12:13], v247 offset:0
  s_add_u32 s62, s76, 110848
  v_mfma_f32_16x16x32_bf16 v[20:23], a[32:35], a[160:163], v[20:23]
  ds_read_b64_tr_b16 a[14:15], v247 offset:8192
  ds_read_b64_tr_b16 a[16:17], v244 offset:1024
  v_mfma_f32_16x16x32_bf16 v[24:27], a[36:39], a[124:127], v[24:27]
  buffer_load_dwordx4 a[52:55], v3, s[44:47], s97 offen offset:1024 sc1
  v_mfma_f32_16x16x32_bf16 v[28:31], a[36:39], a[160:163], v[28:31]
  ds_read_b64_tr_b16 a[18:19], v244 offset:9216
  v_mfma_f32_16x16x32_bf16 v[32:35], a[40:43], a[124:127], v[32:35]
  ds_read_b64_tr_b16 a[20:21], v245 offset:1024
  v_mfma_f32_16x16x32_bf16 v[36:39], a[40:43], a[160:163], v[36:39]
  ds_read_b64_tr_b16 a[22:23], v245 offset:9216
  ds_read_b64_tr_b16 a[24:25], v246 offset:1024
  v_mfma_f32_16x16x32_bf16 v[40:43], a[44:47], a[124:127], v[40:43]
  buffer_load_dwordx4 v255, s[36:39], s62 offen offset:3072  lds
  v_mfma_f32_16x16x32_bf16 v[44:47], a[44:47], a[160:163], v[44:47]
  ds_read_b64_tr_b16 a[26:27], v246 offset:9216
  s_waitcnt lgkmcnt(6)
  v_mfma_f32_16x16x32_bf16 v[16:19], a[0:3], a[128:131], v[16:19]
  ds_read_b64_tr_b16 a[28:29], v247 offset:1024
  s_add_u32 m0, s52, 16384
  v_mfma_f32_16x16x32_bf16 v[20:23], a[0:3], a[164:167], v[20:23]
  ds_read_b64_tr_b16 a[30:31], v247 offset:9216
  s_add_u32 s62, s76, 150784
  v_mfma_f32_16x16x32_bf16 v[24:27], a[4:7], a[128:131], v[24:27]
  ds_read_b64_tr_b16 a[32:33], v244 offset:2048
  v_mfma_f32_16x16x32_bf16 v[28:31], a[4:7], a[164:167], v[28:31]
  ds_read_b64_tr_b16 a[34:35], v244 offset:10240
  v_mfma_f32_16x16x32_bf16 v[32:35], a[8:11], a[128:131], v[32:35]
  ds_read_b64_tr_b16 a[36:37], v245 offset:2048
  v_mfma_f32_16x16x32_bf16 v[36:39], a[8:11], a[164:167], v[36:39]
  ds_read_b64_tr_b16 a[38:39], v245 offset:10240
  ds_read_b64_tr_b16 a[40:41], v246 offset:2048
  v_mfma_f32_16x16x32_bf16 v[40:43], a[12:15], a[128:131], v[40:43]
  buffer_load_dwordx4 v255, s[36:39], s62 offen  lds
  v_mfma_f32_16x16x32_bf16 v[44:47], a[12:15], a[164:167], v[44:47]
  ds_read_b64_tr_b16 a[42:43], v246 offset:10240
  s_waitcnt lgkmcnt(6)
  v_mfma_f32_16x16x32_bf16 v[16:19], a[16:19], a[80:83], v[16:19]
  ds_read_b64_tr_b16 a[44:45], v247 offset:2048
  s_add_u32 s62, s76, 186624
  v_mfma_f32_16x16x32_bf16 v[20:23], a[16:19], a[116:119], v[20:23]
  ds_read_b64_tr_b16 a[46:47], v247 offset:10240
  v_mfma_f32_16x16x32_bf16 v[24:27], a[20:23], a[80:83], v[24:27]
  ds_read_b64_tr_b16 a[0:1], v244 offset:3072
  v_mfma_f32_16x16x32_bf16 v[28:31], a[20:23], a[116:119], v[28:31]
  ds_read_b64_tr_b16 a[2:3], v244 offset:11264
  ds_read_b64_tr_b16 a[4:5], v245 offset:3072
  v_mfma_f32_16x16x32_bf16 v[32:35], a[24:27], a[80:83], v[32:35]
  buffer_load_dwordx4 a[56:59], v3, s[44:47], s97 offen offset:2048 sc1
  v_mfma_f32_16x16x32_bf16 v[36:39], a[24:27], a[116:119], v[36:39]
  ds_read_b64_tr_b16 a[6:7], v245 offset:11264
  ds_read_b64_tr_b16 a[8:9], v246 offset:3072
  v_mfma_f32_16x16x32_bf16 v[40:43], a[28:31], a[80:83], v[40:43]
  buffer_load_dwordx4 v255, s[36:39], s62 offen offset:1024  lds
  v_mfma_f32_16x16x32_bf16 v[44:47], a[28:31], a[116:119], v[44:47]
  ds_read_b64_tr_b16 a[10:11], v246 offset:11264
  s_waitcnt lgkmcnt(6)
  v_mfma_f32_16x16x32_bf16 v[16:19], a[32:35], a[132:135], v[16:19]
  ds_read_b64_tr_b16 a[12:13], v247 offset:3072
  s_add_u32 s62, s76, 222464
  v_mfma_f32_16x16x32_bf16 v[20:23], a[32:35], a[168:171], v[20:23]
  ds_read_b64_tr_b16 a[14:15], v247 offset:11264
  v_mfma_f32_16x16x32_bf16 v[24:27], a[36:39], a[132:135], v[24:27]
  ds_read_b64_tr_b16 a[16:17], v244 offset:16384
  v_mfma_f32_16x16x32_bf16 v[28:31], a[36:39], a[168:171], v[28:31]
  ds_read_b64_tr_b16 a[18:19], v244 offset:24576
  v_mfma_f32_16x16x32_bf16 v[32:35], a[40:43], a[132:135], v[32:35]
  ds_read_b64_tr_b16 a[20:21], v245 offset:16384
  v_mfma_f32_16x16x32_bf16 v[36:39], a[40:43], a[168:171], v[36:39]
  ds_read_b64_tr_b16 a[22:23], v245 offset:24576
  ds_read_b64_tr_b16 a[24:25], v246 offset:16384
  v_mfma_f32_16x16x32_bf16 v[40:43], a[44:47], a[132:135], v[40:43]
  buffer_load_dwordx4 v255, s[36:39], s62 offen offset:2048  lds
  v_mfma_f32_16x16x32_bf16 v[44:47], a[44:47], a[168:171], v[44:47]
  ds_read_b64_tr_b16 a[26:27], v246 offset:24576
  s_waitcnt lgkmcnt(6)
  v_mfma_f32_16x16x32_bf16 v[16:19], a[0:3], a[136:139], v[16:19]
  ds_read_b64_tr_b16 a[28:29], v247 offset:16384
  s_add_u32 s62, s76, 258304
  v_mfma_f32_16x16x32_bf16 v[20:23], a[0:3], a[172:175], v[20:23]
  ds_read_b64_tr_b16 a[30:31], v247 offset:24576
  v_mfma_f32_16x16x32_bf16 v[24:27], a[4:7], a[136:139], v[24:27]
  ds_read_b64_tr_b16 a[32:33], v244 offset:17408
  v_mfma_f32_16x16x32_bf16 v[28:31], a[4:7], a[172:175], v[28:31]
  ds_read_b64_tr_b16 a[34:35], v244 offset:25600
  v_mfma_f32_16x16x32_bf16 v[32:35], a[8:11], a[136:139], v[32:35]
  ds_read_b64_tr_b16 a[36:37], v245 offset:17408
  v_mfma_f32_16x16x32_bf16 v[36:39], a[8:11], a[172:175], v[36:39]
  ds_read_b64_tr_b16 a[38:39], v245 offset:25600
  ds_read_b64_tr_b16 a[40:41], v246 offset:17408
  v_mfma_f32_16x16x32_bf16 v[40:43], a[12:15], a[136:139], v[40:43]
  buffer_load_dwordx4 v255, s[36:39], s62 offen offset:3072  lds
  v_mfma_f32_16x16x32_bf16 v[44:47], a[12:15], a[172:175], v[44:47]
  ds_read_b64_tr_b16 a[42:43], v246 offset:25600
  s_waitcnt lgkmcnt(6)
  s_waitcnt vmcnt(37)
  v_mfma_f32_16x16x32_bf16 v[16:19], a[16:19], a[140:143], v[16:19]
  ds_read_b64_tr_b16 a[44:45], v247 offset:17408
  s_add_u32 m0, s52, 32768
  v_mfma_f32_16x16x32_bf16 v[20:23], a[16:19], a[176:179], v[20:23]
  ds_read_b64_tr_b16 a[46:47], v247 offset:25600
  s_add_u32 s62, s77, 3328
  v_mfma_f32_16x16x32_bf16 v[24:27], a[20:23], a[140:143], v[24:27]
  ds_read_b64_tr_b16 a[0:1], v244 offset:18432
  v_mfma_f32_16x16x32_bf16 v[28:31], a[20:23], a[176:179], v[28:31]
  ds_read_b64_tr_b16 a[2:3], v244 offset:26624
  ds_read_b64_tr_b16 a[4:5], v245 offset:18432
  v_mfma_f32_16x16x32_bf16 v[32:35], a[24:27], a[140:143], v[32:35]
  buffer_load_dwordx4 a[60:63], v3, s[44:47], s97 offen offset:3072 sc1
  v_mfma_f32_16x16x32_bf16 v[36:39], a[24:27], a[176:179], v[36:39]
  ds_read_b64_tr_b16 a[6:7], v245 offset:26624
  ds_read_b64_tr_b16 a[8:9], v246 offset:18432
  v_mfma_f32_16x16x32_bf16 v[40:43], a[28:31], a[140:143], v[40:43]
  buffer_load_dwordx4 v255, s[36:39], s62 offen  lds
  v_mfma_f32_16x16x32_bf16 v[44:47], a[28:31], a[176:179], v[44:47]
  ds_read_b64_tr_b16 a[10:11], v246 offset:26624
  s_waitcnt lgkmcnt(6)
  s_waitcnt vmcnt(28)
  v_mfma_f32_16x16x32_bf16 v[16:19], a[32:35], a[144:147], v[16:19]
  ds_read_b64_tr_b16 a[12:13], v247 offset:18432
  v_mfma_f32_16x16x32_bf16 v[20:23], a[32:35], a[180:183], v[20:23]
  ds_read_b64_tr_b16 a[14:15], v247 offset:26624
  v_mfma_f32_16x16x32_bf16 v[24:27], a[36:39], a[144:147], v[24:27]
  ds_read_b64_tr_b16 a[16:17], v244 offset:19456
  v_mfma_f32_16x16x32_bf16 v[28:31], a[36:39], a[180:183], v[28:31]
  ds_read_b64_tr_b16 a[18:19], v244 offset:27648
  v_mfma_f32_16x16x32_bf16 v[32:35], a[40:43], a[144:147], v[32:35]
  ds_read_b64_tr_b16 a[20:21], v245 offset:19456
  v_mfma_f32_16x16x32_bf16 v[36:39], a[40:43], a[180:183], v[36:39]
  ds_read_b64_tr_b16 a[22:23], v245 offset:27648
  s_barrier
  v_mfma_f32_16x16x32_bf16 v[40:43], a[44:47], a[144:147], v[40:43]
  ds_read_b64_tr_b16 a[24:25], v246 offset:19456
  s_add_u32 s62, s56, 223616
  v_mfma_f32_16x16x32_bf16 v[44:47], a[44:47], a[180:183], v[44:47]
  ds_read_b64_tr_b16 a[26:27], v246 offset:27648
  s_waitcnt lgkmcnt(6)
  v_mfma_f32_16x16x32_bf16 v[48:51], a[0:3], a[72:75], v[48:51]
  ds_read_b64_tr_b16 a[28:29], v247 offset:19456
  s_waitcnt vmcnt(12)
  v_readfirstlane_b32 s69, v4
  v_mfma_f32_16x16x32_bf16 v[52:55], a[0:3], a[108:111], v[52:55]
  ds_read_b64_tr_b16 a[30:31], v247 offset:27648
  s_add_u32 s79, s78, 3
  v_mfma_f32_16x16x32_bf16 v[56:59], a[4:7], a[72:75], v[56:59]
  ds_read_b64_tr_b16 a[32:33], v244 offset:32768
  buffer_load_dwordx4 v255, s[36:39], s62 offen offset:1024  lds
  s_sub_u32 s69, s69, s79
  s_cmp_gt_u32 s69, 1
  s_cbranch_scc1 K1_slow2
K1_back2:
  v_mfma_f32_16x16x32_bf16 v[60:63], a[4:7], a[108:111], v[60:63]
  ds_read_b64_tr_b16 a[34:35], v244 offset:40960
  s_add_u32 s69, s89, 12288
  v_mfma_f32_16x16x32_bf16 v[64:67], a[8:11], a[72:75], v[64:67]
  ds_read_b64_tr_b16 a[36:37], v245 offset:32768
  s_add_u32 s62, s56, 259456
  v_mfma_f32_16x16x32_bf16 v[68:71], a[8:11], a[108:111], v[68:71]
  ds_read_b64_tr_b16 a[38:39], v245 offset:40960
  ds_read_b64_tr_b16 a[40:41], v246 offset:32768
  v_mfma_f32_16x16x32_bf16 v[72:75], a[12:15], a[72:75], v[72:75]
  ds_read_b64_tr_b16 a[42:43], v246 offset:40960
  buffer_load_dwordx4 v255, s[36:39], s62 offen offset:2048  lds
  v_mfma_f32_16x16x32_bf16 v[76:79], a[12:15], a[108:111], v[76:79]
  buffer_load_dwordx4 a[148:151], v3, s[44:47], s69 offen offset:0 sc1
  s_waitcnt lgkmcnt(6)
  v_mfma_f32_16x16x32_bf16 v[48:51], a[16:19], a[76:79], v[48:51]
  ds_read_b64_tr_b16 a[44:45], v247 offset:32768
  s_add_u32 s62, s76, 384
  v_mfma_f32_16x16x32_bf16 v[52:55], a[16:19], a[112:115], v[52:55]
  ds_read_b64_tr_b16 a[46:47], v247 offset:40960
  ds_read_b64_tr_b16 a[0:1], v244 offset:33792
  v_mfma_f32_16x16x32_bf16 v[56:59], a[20:23], a[76:79], v[56:59]
  ds_read_b64_tr_b16 a[2:3], v244 offset:41984
  buffer_load_dwordx4 a[184:187], v3, s[44:47], s69 offen offset:1024 sc1
  v_mfma_f32_16x16x32_bf16 v[60:63], a[20:23], a[112:115], v[60:63]
  ds_read_b64_tr_b16 a[4:5], v245 offset:33792
  buffer_load_dwordx4 a[152:155], v3, s[44:47], s69 offen offset:2048 sc1
  v_mfma_f32_16x16x32_bf16 v[64:67], a[24:27], a[76:79], v[64:67]
  buffer_load_dwordx4 a[188:191], v3, s[44:47], s69 offen offset:3072 sc1
  v_mfma_f32_16x16x32_bf16 v[68:71], a[24:27], a[112:115], v[68:71]
  ds_read_b64_tr_b16 a[6:7], v245 offset:41984
  ds_read_b64_tr_b16 a[8:9], v246 offset:33792
  v_mfma_f32_16x16x32_bf16 v[72:75], a[28:31], a[76:79], v[72:75]
  buffer_load_dwordx4 v255, s[36:39], s62 offen offset:3072  lds
  v_mfma_f32_16x16x32_bf16 v[76:79], a[28:31], a[112:115], v[76:79]
  ds_read_b64_tr_b16 a[10:11], v246 offset:41984
  s_waitcnt lgkmcnt(6)
  v_mfma_f32_16x16x32_bf16 v[48:51], a[32:35], a[124:127], v[48:51]
  ds_read_b64_tr_b16 a[12:13], v247 offset:33792
  s_add_u32 m0, s52, 49152
  v_mfma_f32_16x16x32_bf16 v[52:55], a[32:35], a[160:163], v[52:55]
  ds_read_b64_tr_b16 a[14:15], v247 offset:41984
  s_add_u32 s69, s89, 16384
  v_mfma_f32_16x16x32_bf16 v[56:59], a[36:39], a[124:127], v[56:59]
  ds_read_b64_tr_b16 a[16:17], v244 offset:34816
  s_add_u32 s62, s76, 40320
  v_mfma_f32_16x16x32_bf16 v[60:63], a[36:39], a[160:163], v[60:63]
  ds_read_b64_tr_b16 a[18:19], v244 offset:43008
  ds_read_b64_tr_b16 a[20:21], v245 offset:34816
  v_mfma_f32_16x16x32_bf16 v[64:67], a[40:43], a[124:127], v[64:67]
  buffer_load_dwordx4 a[84:87], v3, s[44:47], s3 offen offset:0 sc1
  v_mfma_f32_16x16x32_bf16 v[68:71], a[40:43], a[160:163], v[68:71]
  ds_read_b64_tr_b16 a[22:23], v245 offset:43008
  ds_read_b64_tr_b16 a[24:25], v246 offset:34816
  v_mfma_f32_16x16x32_bf16 v[72:75], a[44:47], a[124:127], v[72:75]
  ds_read_b64_tr_b16 a[26:27], v246 offset:43008
  buffer_load_dwordx4 v255, s[36:39], s62 offen  lds
  v_mfma_f32_16x16x32_bf16 v[76:79], a[44:47], a[160:163], v[76:79]
  buffer_load_dwordx4 a[156:159], v3, s[44:47], s69 offen offset:0 sc1
  s_waitcnt lgkmcnt(6)
  v_mfma_f32_16x16x32_bf16 v[48:51], a[0:3], a[128:131], v[48:51]
  ds_read_b64_tr_b16 a[28:29], v247 offset:34816
  s_add_u32 s62, s57, 2432
  v_mfma_f32_16x16x32_bf16 v[52:55], a[0:3], a[164:167], v[52:55]
  ds_read_b64_tr_b16 a[30:31], v247 offset:43008
  ds_read_b64_tr_b16 a[32:33], v244 offset:35840
  v_mfma_f32_16x16x32_bf16 v[56:59], a[4:7], a[128:131], v[56:59]
  buffer_load_dwordx4 a[192:195], v3, s[44:47], s69 offen offset:1024 sc1
  v_mfma_f32_16x16x32_bf16 v[60:63], a[4:7], a[164:167], v[60:63]
  ds_read_b64_tr_b16 a[34:35], v244 offset:44032
  v_mfma_f32_16x16x32_bf16 v[64:67], a[8:11], a[128:131], v[64:67]
  ds_read_b64_tr_b16 a[36:37], v245 offset:35840
  v_mfma_f32_16x16x32_bf16 v[68:71], a[8:11], a[164:167], v[68:71]
  ds_read_b64_tr_b16 a[38:39], v245 offset:44032
  ds_read_b64_tr_b16 a[40:41], v246 offset:35840
  v_mfma_f32_16x16x32_bf16 v[72:75], a[12:15], a[128:131], v[72:75]
  buffer_load_dwordx4 v255, s[36:39], s62 offen offset:1024  lds
  v_mfma_f32_16x16x32_bf16 v[76:79], a[12:15], a[164:167], v[76:79]
  ds_read_b64_tr_b16 a[42:43], v246 offset:44032
  s_waitcnt lgkmcnt(6)
  v_mfma_f32_16x16x32_bf16 v[48:51], a[16:19], a[80:83], v[48:51]
  ds_read_b64_tr_b16 a[44:45], v247 offset:35840
  s_add_u32 s62, s76, 75136
  v_mfma_f32_16x16x32_bf16 v[52:55], a[16:19], a[116:119], v[52:55]
  ds_read_b64_tr_b16 a[46:47], v247 offset:44032
  v_mfma_f32_16x16x32_bf16 v[56:59], a[20:23], a[80:83], v[56:59]
  ds_read_b64_tr_b16 a[0:1], v248 offset:0
  s_waitcnt vmcnt(23)
  v_mfma_f32_16x16x32_bf16 v[60:63], a[20:23], a[116:119], v[60:63]
  ds_read_b64_tr_b16 a[2:3], v248 offset:8192
  v_readfirstlane_b32 s92, v164
  v_mfma_f32_16x16x32_bf16 v[64:67], a[24:27], a[80:83], v[64:67]
  ds_read_b64_tr_b16 a[4:5], v249 offset:0
  v_mov_b32_dpp v252, v160 wave_shl:1 row_mask:0xf bank_mask:0xf
  v_mfma_f32_16x16x32_bf16 v[68:71], a[24:27], a[116:119], v[68:71]
  ds_read_b64_tr_b16 a[6:7], v249 offset:8192
  ds_read_b64_tr_b16 a[8:9], v250 offset:0
  v_mfma_f32_16x16x32_bf16 v[72:75], a[28:31], a[80:83], v[72:75]
  buffer_load_dwordx4 v255, s[36:39], s62 offen offset:2048  lds
  v_mfma_f32_16x16x32_bf16 v[76:79], a[28:31], a[116:119], v[76:79]
  ds_read_b64_tr_b16 a[10:11], v250 offset:8192
  s_waitcnt lgkmcnt(6)
  v_mfma_f32_16x16x32_bf16 v[48:51], a[32:35], a[132:135], v[48:51]
  ds_read_b64_tr_b16 a[12:13], v251 offset:0
  s_add_u32 s62, s76, 110976
  v_mfma_f32_16x16x32_bf16 v[52:55], a[32:35], a[168:171], v[52:55]
  ds_read_b64_tr_b16 a[14:15], v251 offset:8192
  v_alignbyte_b32 v224, v161, v160, 2
  v_mfma_f32_16x16x32_bf16 v[56:59], a[36:39], a[132:135], v[56:59]
  ds_read_b64_tr_b16 a[16:17], v248 offset:1024
  v_alignbyte_b32 v225, v162, v161, 2
  v_mfma_f32_16x16x32_bf16 v[60:63], a[36:39], a[168:171], v[60:63]
  ds_read_b64_tr_b16 a[18:19], v248 offset:9216
  v_alignbyte_b32 v226, v163, v162, 2
  v_mfma_f32_16x16x32_bf16 v[64:67], a[40:43], a[132:135], v[64:67]
  ds_read_b64_tr_b16 a[20:21], v249 offset:1024
  buffer_load_dwordx4 a[88:91], v3, s[44:47], s3 offen offset:1024 sc1
  v_mfma_f32_16x16x32_bf16 v[68:71], a[40:43], a[168:171], v[68:71]
  ds_read_b64_tr_b16 a[22:23], v249 offset:9216
  ds_read_b64_tr_b16 a[24:25], v250 offset:1024
  v_mfma_f32_16x16x32_bf16 v[72:75], a[44:47], a[132:135], v[72:75]
  buffer_load_dwordx4 v255, s[36:39], s62 offen offset:3072  lds
  v_mfma_f32_16x16x32_bf16 v[76:79], a[44:47], a[168:171], v[76:79]
  ds_read_b64_tr_b16 a[26:27], v250 offset:9216
  s_waitcnt lgkmcnt(6)
  v_mfma_f32_16x16x32_bf16 v[48:51], a[0:3], a[136:139], v[48:51]
  ds_read_b64_tr_b16 a[28:29], v251 offset:1024
  s_add_u32 m0, s52, 65536
  v_mfma_f32_16x16x32_bf16 v[52:55], a[0:3], a[172:175], v[52:55]
  ds_read_b64_tr_b16 a[30:31], v251 offset:9216
  s_add_u32 s62, s76, 150912
  v_mfma_f32_16x16x32_bf16 v[56:59], a[4:7], a[136:139], v[56:59]
  ds_read_b64_tr_b16 a[32:33], v248 offset:2048
  v_writelane_b32 v252, s92, 63
  v_mfma_f32_16x16x32_bf16 v[60:63], a[4:7], a[172:175], v[60:63]
  ds_read_b64_tr_b16 a[34:35], v248 offset:10240
  v_alignbyte_b32 v227, v252, v163, 2
  v_mfma_f32_16x16x32_bf16 v[64:67], a[8:11], a[136:139], v[64:67]
  ds_read_b64_tr_b16 a[36:37], v249 offset:2048
  v_readfirstlane_b32 s23, v160
  v_mfma_f32_16x16x32_bf16 v[68:71], a[8:11], a[172:175], v[68:71]
  ds_read_b64_tr_b16 a[38:39], v249 offset:10240
  ds_read_b64_tr_b16 a[40:41], v250 offset:2048
  v_mfma_f32_16x16x32_bf16 v[72:75], a[12:15], a[136:139], v[72:75]
  buffer_load_dwordx4 v255, s[36:39], s62 offen  lds
  v_mfma_f32_16x16x32_bf16 v[76:79], a[12:15], a[172:175], v[76:79]
  ds_read_b64_tr_b16 a[42:43], v250 offset:10240
  s_waitcnt lgkmcnt(6)
  v_mfma_f32_16x16x32_bf16 v[48:51], a[16:19], a[140:143], v[48:51]
  ds_read_b64_tr_b16 a[44:45], v251 offset:2048
  v_mov_b32 v253, 0
  v_mfma_f32_16x16x32_bf16 v[52:55], a[16:19], a[176:179], v[52:55]
  ds_read_b64_tr_b16 a[46:47], v251 offset:10240
  s_lshl_b32 s23, s23, 16
  v_mfma_f32_16x16x32_bf16 v[56:59], a[20:23], a[140:143], v[56:59]
  ds_read_b64_tr_b16 a[0:1], v248 offset:3072
  v_writelane_b32 v253, s23, 1
  v_mfma_f32_16x16x32_bf16 v[60:63], a[20:23], a[176:179], v[60:63]
  ds_read_b64_tr_b16 a[2:3], v248 offset:11264
  v_accvgpr_write_b32 a251, v253
  v_mfma_f32_16x16x32_bf16 v[64:67], a[24:27], a[140:143], v[64:67]
  ds_read_b64_tr_b16 a[4:5], v249 offset:3072
  v_readfirstlane_b32 s93, v168
  v_mfma_f32_16x16x32_bf16 v[68:71], a[24:27], a[176:179], v[68:71]
  ds_read_b64_tr_b16 a[6:7], v249 offset:11264
  s_barrier
  v_mfma_f32_16x16x32_bf16 v[72:75], a[28:31], a[140:143], v[72:75]
  ds_read_b64_tr_b16 a[8:9], v250 offset:3072
  s_add_u32 s62, s76, 186752
  v_mfma_f32_16x16x32_bf16 v[76:79], a[28:31], a[176:179], v[76:79]
  ds_read_b64_tr_b16 a[10:11], v250 offset:11264
  s_waitcnt lgkmcnt(6)
  v_mfma_f32_16x16x32_bf16 v[48:51], a[32:35], a[144:147], v[48:51]
  ds_read_b64_tr_b16 a[12:13], v251 offset:3072
  v_mov_b32_dpp v253, v164 wave_shl:1 row_mask:0xf bank_mask:0xf
  v_mfma_f32_16x16x32_bf16 v[52:55], a[32:35], a[180:183], v[52:55]
  ds_read_b64_tr_b16 a[14:15], v251 offset:11264
  ds_read_b64_tr_b16 a[16:17], v248 offset:16384
  v_mfma_f32_16x16x32_bf16 v[56:59], a[36:39], a[144:147], v[56:59]
  buffer_load_dwordx4 v255, s[36:39], s62 offen offset:1024  lds
  v_mfma_f32_16x16x32_bf16 v[60:63], a[36:39], a[180:183], v[60:63]
  ds_read_b64_tr_b16 a[18:19], v248 offset:24576
  s_add_u32 s62, s76, 222592
  v_mfma_f32_16x16x32_bf16 v[64:67], a[40:43], a[144:147], v[64:67]
  ds_read_b64_tr_b16 a[20:21], v249 offset:16384
  buffer_load_dwordx4 a[92:95], v3, s[44:47], s3 offen offset:2048 sc1
  v_mfma_f32_16x16x32_bf16 v[68:71], a[40:43], a[180:183], v[68:71]
  ds_read_b64_tr_b16 a[22:23], v249 offset:24576
  ds_read_b64_tr_b16 a[24:25], v250 offset:16384
  v_mfma_f32_16x16x32_bf16 v[72:75], a[44:47], a[144:147], v[72:75]
  buffer_load_dwordx4 v255, s[36:39], s62 offen offset:2048  lds
  v_mfma_f32_16x16x32_bf16 v[76:79], a[44:47], a[180:183], v[76:79]
  ds_read_b64_tr_b16 a[26:27], v250 offset:24576
  s_waitcnt lgkmcnt(6)
  s_waitcnt vmcnt(15)
  v_mfma_f32_16x16x32_bf16 v[16:19], a[0:3], a[148:151], v[16:19]
  ds_read_b64_tr_b16 a[28:29], v251 offset:16384
  s_add_u32 s62, s76, 258432
  v_mfma_f32_16x16x32_bf16 v[20:23], a[0:3], a[184:187], v[20:23]
  ds_read_b64_tr_b16 a[30:31], v251 offset:24576
  v_alignbyte_b32 v228, v165, v164, 2
  v_mfma_f32_16x16x32_bf16 v[24:27], a[4:7], a[148:151], v[24:27]
  ds_read_b64_tr_b16 a[32:33], v248 offset:17408
  v_alignbyte_b32 v229, v166, v165, 2
  v_mfma_f32_16x16x32_bf16 v[28:31], a[4:7], a[184:187], v[28:31]
  ds_read_b64_tr_b16 a[34:35], v248 offset:25600
  v_alignbyte_b32 v230, v167, v166, 2
  v_mfma_f32_16x16x32_bf16 v[32:35], a[8:11], a[148:151], v[32:35]
  ds_read_b64_tr_b16 a[36:37], v249 offset:17408
  v_writelane_b32 v253, s93, 63
  v_mfma_f32_16x16x32_bf16 v[36:39], a[8:11], a[184:187], v[36:39]
  ds_read_b64_tr_b16 a[38:39], v249 offset:25600
  ds_read_b64_tr_b16 a[40:41], v250 offset:17408
  v_mfma_f32_16x16x32_bf16 v[40:43], a[12:15], a[148:151], v[40:43]
  buffer_load_dwordx4 v255, s[36:39], s62 offen offset:3072  lds
  v_mfma_f32_16x16x32_bf16 v[44:47], a[12:15], a[184:187], v[44:47]
  ds_read_b64_tr_b16 a[42:43], v250 offset:25600
  s_waitcnt lgkmcnt(6)
  s_waitcnt vmcnt(14)
  v_mfma_f32_16x16x32_bf16 v[16:19], a[16:19], a[152:155], v[16:19]
  ds_read_b64_tr_b16 a[44:45], v251 offset:17408
  s_add_u32 m0, s52, 81920
  v_mfma_f32_16x16x32_bf16 v[20:23], a[16:19], a[188:191], v[20:23]
  ds_read_b64_tr_b16 a[46:47], v251 offset:25600
  s_add_u32 s62, s77, 3456
  v_mfma_f32_16x16x32_bf16 v[24:27], a[20:23], a[152:155], v[24:27]
  ds_read_b64_tr_b16 a[0:1], v248 offset:18432
  v_alignbyte_b32 v231, v253, v167, 2
  v_mfma_f32_16x16x32_bf16 v[28:31], a[20:23], a[188:191], v[28:31]
  ds_read_b64_tr_b16 a[2:3], v248 offset:26624
  v_readfirstlane_b32 s92, v172
  v_mfma_f32_16x16x32_bf16 v[32:35], a[24:27], a[152:155], v[32:35]
  ds_read_b64_tr_b16 a[4:5], v249 offset:18432
  v_mov_b32_dpp v252, v168 wave_shl:1 row_mask:0xf bank_mask:0xf
  v_mfma_f32_16x16x32_bf16 v[36:39], a[24:27], a[188:191], v[36:39]
  ds_read_b64_tr_b16 a[6:7], v249 offset:26624
  ds_read_b64_tr_b16 a[8:9], v250 offset:18432
  v_mfma_f32_16x16x32_bf16 v[40:43], a[28:31], a[152:155], v[40:43]
  buffer_load_dwordx4 v255, s[36:39], s62 offen  lds
  v_mfma_f32_16x16x32_bf16 v[44:47], a[28:31], a[188:191], v[44:47]
  ds_read_b64_tr_b16 a[10:11], v250 offset:26624
  s_waitcnt lgkmcnt(6)
  s_waitcnt vmcnt(10)
  v_mfma_f32_16x16x32_bf16 v[16:19], a[32:35], a[156:159], v[16:19]
  ds_read_b64_tr_b16 a[12:13], v251 offset:18432
  s_add_u32 s62, s61, 223232
  v_mfma_f32_16x16x32_bf16 v[20:23], a[32:35], a[192:195], v[20:23]
  ds_read_b64_tr_b16 a[14:15], v251 offset:26624
  v_alignbyte_b32 v232, v169, v168, 2
  v_mfma_f32_16x16x32_bf16 v[24:27], a[36:39], a[156:159], v[24:27]
  ds_read_b64_tr_b16 a[16:17], v248 offset:19456
  v_alignbyte_b32 v233, v170, v169, 2
  v_mfma_f32_16x16x32_bf16 v[28:31], a[36:39], a[192:195], v[28:31]
  ds_read_b64_tr_b16 a[18:19], v248 offset:27648
  v_alignbyte_b32 v234, v171, v170, 2
  v_mfma_f32_16x16x32_bf16 v[32:35], a[40:43], a[156:159], v[32:35]
  ds_read_b64_tr_b16 a[20:21], v249 offset:19456
  buffer_load_dwordx4 a[96:99], v3, s[44:47], s3 offen offset:3072 sc1
  v_mfma_f32_16x16x32_bf16 v[36:39], a[40:43], a[192:195], v[36:39]
  ds_read_b64_tr_b16 a[22:23], v249 offset:27648
  ds_read_b64_tr_b16 a[24:25], v250 offset:19456
  v_mfma_f32_16x16x32_bf16 v[40:43], a[44:47], a[156:159], v[40:43]
  buffer_load_dwordx4 v6, s[36:39], s62 offen offset:1024  lds
  v_mfma_f32_16x16x32_bf16 v[44:47], a[44:47], a[192:195], v[44:47]
  ds_read_b64_tr_b16 a[26:27], v250 offset:27648
  s_waitcnt lgkmcnt(6)
  v_mfma_f32_16x16x32_bf16 v[48:51], a[0:3], a[148:151], v[48:51]
  ds_read_b64_tr_b16 a[28:29], v251 offset:19456
  s_add_u32 s62, s60, 1024
  v_mfma_f32_16x16x32_bf16 v[52:55], a[0:3], a[184:187], v[52:55]
  ds_read_b64_tr_b16 a[30:31], v251 offset:27648
  v_cvt_pk_bf16_f32 v192, v16, v17
  v_mfma_f32_16x16x32_bf16 v[56:59], a[4:7], a[148:151], v[56:59]
  ds_read_b64_tr_b16 a[32:33], v248 offset:32768
  v_cvt_pk_bf16_f32 v193, v18, v19
  v_mfma_f32_16x16x32_bf16 v[60:63], a[4:7], a[184:187], v[60:63]
  ds_read_b64_tr_b16 a[34:35], v248 offset:40960
  v_cvt_pk_bf16_f32 v194, v20, v21
  v_mfma_f32_16x16x32_bf16 v[64:67], a[8:11], a[148:151], v[64:67]
  ds_read_b64_tr_b16 a[36:37], v249 offset:32768
  v_cvt_pk_bf16_f32 v195, v22, v23
  v_mfma_f32_16x16x32_bf16 v[68:71], a[8:11], a[184:187], v[68:71]
  ds_read_b64_tr_b16 a[38:39], v249 offset:40960
  ds_read_b64_tr_b16 a[40:41], v250 offset:32768
  v_mfma_f32_16x16x32_bf16 v[72:75], a[12:15], a[148:151], v[72:75]
  buffer_load_dwordx4 v6, s[36:39], s62 offen offset:2048  lds
  v_mfma_f32_16x16x32_bf16 v[76:79], a[12:15], a[184:187], v[76:79]
  ds_read_b64_tr_b16 a[42:43], v250 offset:40960
  s_waitcnt lgkmcnt(6)
  v_mfma_f32_16x16x32_bf16 v[48:51], a[16:19], a[152:155], v[48:51]
  ds_read_b64_tr_b16 a[44:45], v251 offset:32768
  s_add_u32 s70, s58, 0
  v_mfma_f32_16x16x32_bf16 v[52:55], a[16:19], a[188:191], v[52:55]
  ds_read_b64_tr_b16 a[46:47], v251 offset:40960
  s_add_u32 s62, s60, 73728
  v_mfma_f32_16x16x32_bf16 v[56:59], a[20:23], a[152:155], v[56:59]
  ds_read_b64_tr_b16 a[0:1], v248 offset:33792
  v_writelane_b32 v252, s92, 63
  v_mfma_f32_16x16x32_bf16 v[60:63], a[20:23], a[188:191], v[60:63]
  ds_read_b64_tr_b16 a[2:3], v248 offset:41984
  v_alignbyte_b32 v235, v252, v171, 2
  v_mfma_f32_16x16x32_bf16 v[64:67], a[24:27], a[152:155], v[64:67]
  ds_read_b64_tr_b16 a[4:5], v249 offset:33792
  v_mov_b32_dpp v253, v172 wave_shl:1 row_mask:0xf bank_mask:0xf
  v_mfma_f32_16x16x32_bf16 v[68:71], a[24:27], a[188:191], v[68:71]
  ds_read_b64_tr_b16 a[6:7], v249 offset:41984
  ds_read_b64_tr_b16 a[8:9], v250 offset:33792
  v_mfma_f32_16x16x32_bf16 v[72:75], a[28:31], a[152:155], v[72:75]
  buffer_load_dwordx4 v6, s[36:39], s62 offen offset:3072  lds
  v_mfma_f32_16x16x32_bf16 v[76:79], a[28:31], a[188:191], v[76:79]
  ds_read_b64_tr_b16 a[10:11], v250 offset:41984
  s_waitcnt lgkmcnt(6)
  v_mfma_f32_16x16x32_bf16 v[48:51], a[32:35], a[156:159], v[48:51]
  ds_read_b64_tr_b16 a[12:13], v251 offset:33792
  v_permlane16_swap_b32 v192, v194
  v_permlane16_swap_b32 v193, v195
  buffer_store_dwordx4 v[192:195], v7, s[44:47], s70 offen sc1
  v_mfma_f32_16x16x32_bf16 v[52:55], a[32:35], a[192:195], v[52:55]
  ds_read_b64_tr_b16 a[14:15], v251 offset:41984
  s_add_u32 m0, s52, 98304
  v_mfma_f32_16x16x32_bf16 v[56:59], a[36:39], a[156:159], v[56:59]
  ds_read_b64_tr_b16 a[16:17], v248 offset:34816
  s_add_u32 s62, s60, 150528
  v_mfma_f32_16x16x32_bf16 v[60:63], a[36:39], a[192:195], v[60:63]
  ds_read_b64_tr_b16 a[18:19], v248 offset:43008
  v_cvt_pk_bf16_f32 v196, v24, v25
  v_mfma_f32_16x16x32_bf16 v[64:67], a[40:43], a[156:159], v[64:67]
  ds_read_b64_tr_b16 a[20:21], v249 offset:34816
  v_cvt_pk_bf16_f32 v197, v26, v27
  v_mfma_f32_16x16x32_bf16 v[68:71], a[40:43], a[192:195], v[68:71]
  ds_read_b64_tr_b16 a[22:23], v249 offset:43008
  ds_read_b64_tr_b16 a[24:25], v250 offset:34816
  v_mfma_f32_16x16x32_bf16 v[72:75], a[44:47], a[156:159], v[72:75]
  buffer_load_dwordx4 v6, s[36:39], s62 offen  lds
  v_mfma_f32_16x16x32_bf16 v[76:79], a[44:47], a[192:195], v[76:79]
  ds_read_b64_tr_b16 a[26:27], v250 offset:43008
  s_waitcnt lgkmcnt(6)
  v_mfma_f32_16x16x32_bf16 v[80:83], a[0:3], a[72:75], v[80:83]
  ds_read_b64_tr_b16 a[28:29], v251 offset:34816
  v_cvt_pk_bf16_f32 v198, v28, v29
  v_mfma_f32_16x16x32_bf16 v[84:87], a[0:3], a[108:111], v[84:87]
  ds_read_b64_tr_b16 a[30:31], v251 offset:43008
  v_cvt_pk_bf16_f32 v199, v30, v31
  v_mfma_f32_16x16x32_bf16 v[88:91], a[4:7], a[72:75], v[88:91]
  ds_read_b64_tr_b16 a[32:33], v248 offset:35840
  s_add_u32 s71, s58, 4096
  v_mfma_f32_16x16x32_bf16 v[92:95], a[4:7], a[108:111], v[92:95]
  ds_read_b64_tr_b16 a[34:35], v248 offset:44032
  v_alignbyte_b32 v236, v173, v172, 2
  v_mfma_f32_16x16x32_bf16 v[96:99], a[8:11], a[72:75], v[96:99]
  ds_read_b64_tr_b16 a[36:37], v249 offset:35840
  v_alignbyte_b32 v237, v174, v173, 2
  v_mfma_f32_16x16x32_bf16 v[100:103], a[8:11], a[108:111], v[100:103]
  ds_read_b64_tr_b16 a[38:39], v249 offset:44032
  s_barrier
  v_mfma_f32_16x16x32_bf16 v[104:107], a[12:15], a[72:75], v[104:107]
  ds_read_b64_tr_b16 a[40:41], v250 offset:35840
  s_add_u32 s62, s60, 223232
  v_mfma_f32_16x16x32_bf16 v[108:111], a[12:15], a[108:111], v[108:111]
  ds_read_b64_tr_b16 a[42:43], v250 offset:44032
  s_waitcnt lgkmcnt(6)
  v_mfma_f32_16x16x32_bf16 v[80:83], a[16:19], a[76:79], v[80:83]
  ds_read_b64_tr_b16 a[44:45], v251 offset:35840
  v_alignbyte_b32 v238, v175, v174, 2
  v_mfma_f32_16x16x32_bf16 v[84:87], a[16:19], a[112:115], v[84:87]
  ds_read_b64_tr_b16 a[46:47], v251 offset:44032
  ds_read_b64_tr_b16 a[0:1], v240 offset:0
  v_mfma_f32_16x16x32_bf16 v[88:91], a[20:23], a[76:79], v[88:91]
  ds_read_b64_tr_b16 a[2:3], v240 offset:8192
  buffer_load_dwordx4 v6, s[36:39], s62 offen offset:1024  lds
  v_mfma_f32_16x16x32_bf16 v[92:95], a[20:23], a[112:115], v[92:95]
  v_permlane16_swap_b32 v196, v198
  v_mfma_f32_16x16x32_bf16 v[96:99], a[24:27], a[76:79], v[96:99]
  ds_read_b64_tr_b16 a[4:5], v241 offset:0
  s_add_u32 s62, s59, 1024
  v_permlane16_swap_b32 v197, v199
  buffer_store_dwordx4 v[196:199], v7, s[44:47], s71 offen sc1
  v_mfma_f32_16x16x32_bf16 v[100:103], a[24:27], a[112:115], v[100:103]
  ds_read_b64_tr_b16 a[6:7], v241 offset:8192
  ds_read_b64_tr_b16 a[8:9], v242 offset:0
  v_mfma_f32_16x16x32_bf16 v[104:107], a[28:31], a[76:79], v[104:107]
  buffer_load_dwordx4 v6, s[36:39], s62 offen offset:2048  lds
  v_mfma_f32_16x16x32_bf16 v[108:111], a[28:31], a[112:115], v[108:111]
  ds_read_b64_tr_b16 a[10:11], v242 offset:8192
  s_waitcnt lgkmcnt(6)
  v_mfma_f32_16x16x32_bf16 v[80:83], a[32:35], a[124:127], v[80:83]
  ds_read_b64_tr_b16 a[12:13], v243 offset:0
  v_cvt_pk_bf16_f32 v200, v32, v33
  v_mfma_f32_16x16x32_bf16 v[84:87], a[32:35], a[160:163], v[84:87]
  ds_read_b64_tr_b16 a[14:15], v243 offset:8192
  v_cvt_pk_bf16_f32 v201, v34, v35
  v_mfma_f32_16x16x32_bf16 v[88:91], a[36:39], a[124:127], v[88:91]
  ds_read_b64_tr_b16 a[16:17], v240 offset:1024
  v_cvt_pk_bf16_f32 v202, v36, v37
  v_mfma_f32_16x16x32_bf16 v[92:95], a[36:39], a[160:163], v[92:95]
  ds_read_b64_tr_b16 a[18:19], v240 offset:9216
  v_cvt_pk_bf16_f32 v203, v38, v39
  v_mfma_f32_16x16x32_bf16 v[96:99], a[40:43], a[124:127], v[96:99]
  ds_read_b64_tr_b16 a[20:21], v241 offset:1024
  s_add_u32 s72, s58, 8192
  v_mfma_f32_16x16x32_bf16 v[100:103], a[40:43], a[160:163], v[100:103]
  ds_read_b64_tr_b16 a[22:23], v241 offset:9216
  v_alignbyte_b32 v239, v253, v175, 2
  v_mfma_f32_16x16x32_bf16 v[104:107], a[44:47], a[124:127], v[104:107]
  ds_read_b64_tr_b16 a[24:25], v242 offset:1024
  v_readfirstlane_b32 s92, v180
  v_mfma_f32_16x16x32_bf16 v[108:111], a[44:47], a[160:163], v[108:111]
  ds_read_b64_tr_b16 a[26:27], v242 offset:9216
  s_waitcnt lgkmcnt(6)
  v_mfma_f32_16x16x32_bf16 v[80:83], a[0:3], a[128:131], v[80:83]
  ds_read_b64_tr_b16 a[28:29], v243 offset:1024
  v_mov_b32_dpp v252, v176 wave_shl:1 row_mask:0xf bank_mask:0xf
  v_mfma_f32_16x16x32_bf16 v[84:87], a[0:3], a[164:167], v[84:87]
  ds_read_b64_tr_b16 a[30:31], v243 offset:9216
  v_alignbyte_b32 v208, v177, v176, 2
  v_mfma_f32_16x16x32_bf16 v[88:91], a[4:7], a[128:131], v[88:91]
  ds_read_b64_tr_b16 a[32:33], v240 offset:2048
  v_alignbyte_b32 v209, v178, v177, 2
  v_mfma_f32_16x16x32_bf16 v[92:95], a[4:7], a[164:167], v[92:95]
  ds_read_b64_tr_b16 a[34:35], v240 offset:10240
  v_alignbyte_b32 v210, v179, v178, 2
  v_mfma_f32_16x16x32_bf16 v[96:99], a[8:11], a[128:131], v[96:99]
  ds_read_b64_tr_b16 a[36:37], v241 offset:2048
  v_writelane_b32 v252, s92, 63
  v_mfma_f32_16x16x32_bf16 v[100:103], a[8:11], a[164:167], v[100:103]
  ds_read_b64_tr_b16 a[38:39], v241 offset:10240
  v_alignbyte_b32 v211, v252, v179, 2
  v_mfma_f32_16x16x32_bf16 v[104:107], a[12:15], a[128:131], v[104:107]
  ds_read_b64_tr_b16 a[40:41], v242 offset:2048
  v_readfirstlane_b32 s23, v176
  v_mfma_f32_16x16x32_bf16 v[108:111], a[12:15], a[164:167], v[108:111]
  ds_read_b64_tr_b16 a[42:43], v242 offset:10240
  s_waitcnt lgkmcnt(6)
  v_mfma_f32_16x16x32_bf16 v[80:83], a[16:19], a[80:83], v[80:83]
  ds_read_b64_tr_b16 a[44:45], v243 offset:2048
  v_permlane16_swap_b32 v200, v202
  v_permlane16_swap_b32 v201, v203
  buffer_store_dwordx4 v[200:203], v7, s[44:47], s72 offen sc1
  v_mfma_f32_16x16x32_bf16 v[84:87], a[16:19], a[116:119], v[84:87]
  ds_read_b64_tr_b16 a[46:47], v243 offset:10240
  v_cvt_pk_bf16_f32 v204, v40, v41
  v_mfma_f32_16x16x32_bf16 v[88:91], a[20:23], a[80:83], v[88:91]
  ds_read_b64_tr_b16 a[0:1], v240 offset:3072
  v_cvt_pk_bf16_f32 v205, v42, v43
  v_mfma_f32_16x16x32_bf16 v[92:95], a[20:23], a[116:119], v[92:95]
  ds_read_b64_tr_b16 a[2:3], v240 offset:11264
  v_cvt_pk_bf16_f32 v206, v44, v45
  v_mfma_f32_16x16x32_bf16 v[96:99], a[24:27], a[80:83], v[96:99]
  ds_read_b64_tr_b16 a[4:5], v241 offset:3072
  v_cvt_pk_bf16_f32 v207, v46, v47
  v_mfma_f32_16x16x32_bf16 v[100:103], a[24:27], a[116:119], v[100:103]
  ds_read_b64_tr_b16 a[6:7], v241 offset:11264
  s_add_u32 s73, s58, 12288
  v_mfma_f32_16x16x32_bf16 v[104:107], a[28:31], a[80:83], v[104:107]
  ds_read_b64_tr_b16 a[8:9], v242 offset:3072
  v_mov_b32 v253, 0
  v_mfma_f32_16x16x32_bf16 v[108:111], a[28:31], a[116:119], v[108:111]
  ds_read_b64_tr_b16 a[10:11], v242 offset:11264
  s_waitcnt lgkmcnt(6)
  v_mfma_f32_16x16x32_bf16 v[80:83], a[32:35], a[132:135], v[80:83]
  ds_read_b64_tr_b16 a[12:13], v243 offset:3072
  s_lshl_b32 s23, s23, 16
  v_mfma_f32_16x16x32_bf16 v[84:87], a[32:35], a[168:171], v[84:87]
  ds_read_b64_tr_b16 a[14:15], v243 offset:11264
  v_writelane_b32 v253, s23, 1
  v_mfma_f32_16x16x32_bf16 v[88:91], a[36:39], a[132:135], v[88:91]
  ds_read_b64_tr_b16 a[16:17], v240 offset:16384
  v_accvgpr_write_b32 a255, v253
  v_mfma_f32_16x16x32_bf16 v[92:95], a[36:39], a[168:171], v[92:95]
  ds_read_b64_tr_b16 a[18:19], v240 offset:24576
  v_readfirstlane_b32 s93, v184
  v_mfma_f32_16x16x32_bf16 v[96:99], a[40:43], a[132:135], v[96:99]
  ds_read_b64_tr_b16 a[20:21], v241 offset:16384
  v_mov_b32_dpp v253, v180 wave_shl:1 row_mask:0xf bank_mask:0xf
  v_mfma_f32_16x16x32_bf16 v[100:103], a[40:43], a[168:171], v[100:103]
  ds_read_b64_tr_b16 a[22:23], v241 offset:24576
  v_alignbyte_b32 v212, v181, v180, 2
  v_mfma_f32_16x16x32_bf16 v[104:107], a[44:47], a[132:135], v[104:107]
  ds_read_b64_tr_b16 a[24:25], v242 offset:16384
  v_alignbyte_b32 v213, v182, v181, 2
  v_mfma_f32_16x16x32_bf16 v[108:111], a[44:47], a[168:171], v[108:111]
  ds_read_b64_tr_b16 a[26:27], v242 offset:24576
  s_waitcnt lgkmcnt(6)
  v_mfma_f32_16x16x32_bf16 v[80:83], a[0:3], a[136:139], v[80:83]
  ds_read_b64_tr_b16 a[28:29], v243 offset:16384
  v_alignbyte_b32 v214, v183, v182, 2
  v_mfma_f32_16x16x32_bf16 v[84:87], a[0:3], a[172:175], v[84:87]
  ds_read_b64_tr_b16 a[30:31], v243 offset:24576
  v_writelane_b32 v253, s93, 63
  v_mfma_f32_16x16x32_bf16 v[88:91], a[4:7], a[136:139], v[88:91]
  ds_read_b64_tr_b16 a[32:33], v240 offset:17408
  v_alignbyte_b32 v215, v253, v183, 2
  v_mfma_f32_16x16x32_bf16 v[92:95], a[4:7], a[172:175], v[92:95]
  ds_read_b64_tr_b16 a[34:35], v240 offset:25600
  v_readfirstlane_b32 s92, v188
  v_mfma_f32_16x16x32_bf16 v[96:99], a[8:11], a[136:139], v[96:99]
  ds_read_b64_tr_b16 a[36:37], v241 offset:17408
  v_permlane16_swap_b32 v204, v206
  v_permlane16_swap_b32 v205, v207
  buffer_store_dwordx4 v[204:207], v7, s[44:47], s73 offen sc1
  v_mfma_f32_16x16x32_bf16 v[100:103], a[8:11], a[172:175], v[100:103]
  ds_read_b64_tr_b16 a[38:39], v241 offset:25600
  v_cvt_pk_bf16_f32 v192, v48, v49
  v_mfma_f32_16x16x32_bf16 v[104:107], a[12:15], a[136:139], v[104:107]
  ds_read_b64_tr_b16 a[40:41], v242 offset:17408
  v_cvt_pk_bf16_f32 v193, v50, v51
  v_mfma_f32_16x16x32_bf16 v[108:111], a[12:15], a[172:175], v[108:111]
  ds_read_b64_tr_b16 a[42:43], v242 offset:25600
  s_waitcnt lgkmcnt(6)
  v_mfma_f32_16x16x32_bf16 v[80:83], a[16:19], a[140:143], v[80:83]
  ds_read_b64_tr_b16 a[44:45], v243 offset:17408
  v_cvt_pk_bf16_f32 v194, v52, v53
  v_mfma_f32_16x16x32_bf16 v[84:87], a[16:19], a[176:179], v[84:87]
  ds_read_b64_tr_b16 a[46:47], v243 offset:25600
  v_cvt_pk_bf16_f32 v195, v54, v55
  v_mfma_f32_16x16x32_bf16 v[88:91], a[20:23], a[140:143], v[88:91]
  ds_read_b64_tr_b16 a[0:1], v240 offset:18432
  s_add_u32 s74, s58, 16384
  v_mfma_f32_16x16x32_bf16 v[92:95], a[20:23], a[176:179], v[92:95]
  ds_read_b64_tr_b16 a[2:3], v240 offset:26624
  v_mov_b32_dpp v252, v184 wave_shl:1 row_mask:0xf bank_mask:0xf
  v_mfma_f32_16x16x32_bf16 v[96:99], a[24:27], a[140:143], v[96:99]
  ds_read_b64_tr_b16 a[4:5], v241 offset:18432
  v_alignbyte_b32 v216, v185, v184, 2
  v_mfma_f32_16x16x32_bf16 v[100:103], a[24:27], a[176:179], v[100:103]
  ds_read_b64_tr_b16 a[6:7], v241 offset:26624
  v_alignbyte_b32 v217, v186, v185, 2
  v_mfma_f32_16x16x32_bf16 v[104:107], a[28:31], a[140:143], v[104:107]
  ds_read_b64_tr_b16 a[8:9], v242 offset:18432
  v_alignbyte_b32 v218, v187, v186, 2
  v_mfma_f32_16x16x32_bf16 v[108:111], a[28:31], a[176:179], v[108:111]
  ds_read_b64_tr_b16 a[10:11], v242 offset:26624
  s_waitcnt lgkmcnt(6)
  v_mfma_f32_16x16x32_bf16 v[80:83], a[32:35], a[144:147], v[80:83]
  ds_read_b64_tr_b16 a[12:13], v243 offset:18432
  v_writelane_b32 v252, s92, 63
  v_mfma_f32_16x16x32_bf16 v[84:87], a[32:35], a[180:183], v[84:87]
  ds_read_b64_tr_b16 a[14:15], v243 offset:26624
  v_alignbyte_b32 v219, v252, v187, 2
  v_mfma_f32_16x16x32_bf16 v[88:91], a[36:39], a[144:147], v[88:91]
  ds_read_b64_tr_b16 a[16:17], v240 offset:19456
  v_mov_b32_dpp v253, v188 wave_shl:1 row_mask:0xf bank_mask:0xf
  v_mfma_f32_16x16x32_bf16 v[92:95], a[36:39], a[180:183], v[92:95]
  ds_read_b64_tr_b16 a[18:19], v240 offset:27648
  v_alignbyte_b32 v220, v189, v188, 2
  v_mfma_f32_16x16x32_bf16 v[96:99], a[40:43], a[144:147], v[96:99]
  ds_read_b64_tr_b16 a[20:21], v241 offset:19456
  v_alignbyte_b32 v221, v190, v189, 2
  v_mfma_f32_16x16x32_bf16 v[100:103], a[40:43], a[180:183], v[100:103]
  ds_read_b64_tr_b16 a[22:23], v241 offset:27648
  s_waitcnt vmcnt(17)
  s_barrier
  v_mfma_f32_16x16x32_bf16 v[104:107], a[44:47], a[144:147], v[104:107]
  ds_read_b64_tr_b16 a[24:25], v242 offset:19456
  v_alignbyte_b32 v222, v191, v190, 2
  v_mfma_f32_16x16x32_bf16 v[108:111], a[44:47], a[180:183], v[108:111]
  ds_read_b64_tr_b16 a[26:27], v242 offset:27648
  s_waitcnt lgkmcnt(6)
  v_mfma_f32_16x16x32_bf16 v[80:83], a[0:3], a[148:151], v[80:83]
  ds_read_b64_tr_b16 a[28:29], v243 offset:19456
  v_permlane16_swap_b32 v192, v194
  v_permlane16_swap_b32 v193, v195
  buffer_store_dwordx4 v[192:195], v7, s[44:47], s74 offen sc1
  v_mfma_f32_16x16x32_bf16 v[84:87], a[0:3], a[184:187], v[84:87]
  ds_read_b64_tr_b16 a[30:31], v243 offset:27648
  v_cvt_pk_bf16_f32 v196, v56, v57
  v_mfma_f32_16x16x32_bf16 v[88:91], a[4:7], a[148:151], v[88:91]
  ds_read_b64_tr_b16 a[32:33], v240 offset:32768
  v_cvt_pk_bf16_f32 v197, v58, v59
  v_mfma_f32_16x16x32_bf16 v[92:95], a[4:7], a[184:187], v[92:95]
  ds_read_b64_tr_b16 a[34:35], v240 offset:40960
  v_cvt_pk_bf16_f32 v198, v60, v61
  v_mfma_f32_16x16x32_bf16 v[96:99], a[8:11], a[148:151], v[96:99]
  ds_read_b64_tr_b16 a[36:37], v241 offset:32768
  v_cvt_pk_bf16_f32 v199, v62, v63
  v_mfma_f32_16x16x32_bf16 v[100:103], a[8:11], a[184:187], v[100:103]
  ds_read_b64_tr_b16 a[38:39], v241 offset:40960
  s_add_u32 s75, s58, 20480
  v_mfma_f32_16x16x32_bf16 v[104:107], a[12:15], a[148:151], v[104:107]
  ds_read_b64_tr_b16 a[40:41], v242 offset:32768
  v_alignbyte_b32 v223, v253, v191, 2
  v_mfma_f32_16x16x32_bf16 v[108:111], a[12:15], a[184:187], v[108:111]
  ds_read_b64_tr_b16 a[42:43], v242 offset:40960
  s_waitcnt lgkmcnt(6)
  v_mfma_f32_16x16x32_bf16 v[80:83], a[16:19], a[152:155], v[80:83]
  ds_read_b64_tr_b16 a[44:45], v243 offset:32768
  v_accvgpr_read_b32 v254, a243
  v_mfma_f32_16x16x32_bf16 v[84:87], a[16:19], a[188:191], v[84:87]
  ds_read_b64_tr_b16 a[46:47], v243 offset:40960
  v_add_u32 v255, s19, v254
  v_mfma_f32_16x16x32_bf16 v[88:91], a[20:23], a[152:155], v[88:91]
  ds_read_b64_tr_b16 a[0:1], v240 offset:33792
  s_add_u32 s20, s15, 0
  v_mfma_f32_16x16x32_bf16 v[92:95], a[20:23], a[188:191], v[92:95]
  ds_read_b64_tr_b16 a[2:3], v240 offset:41984
  s_and_b32 s62, s20, 1
  v_mfma_f32_16x16x32_bf16 v[96:99], a[24:27], a[152:155], v[96:99]
  ds_read_b64_tr_b16 a[4:5], v241 offset:33792
  s_lshr_b32 s20, s20, 1
  v_mfma_f32_16x16x32_bf16 v[100:103], a[24:27], a[188:191], v[100:103]
  ds_read_b64_tr_b16 a[6:7], v241 offset:41984
  s_mul_i32 s20, s20, 313600
  v_mfma_f32_16x16x32_bf16 v[104:107], a[28:31], a[152:155], v[104:107]
  ds_read_b64_tr_b16 a[8:9], v242 offset:33792
  s_lshl_b32 s76, s11, 1
  v_mfma_f32_16x16x32_bf16 v[108:111], a[28:31], a[188:191], v[108:111]
  ds_read_b64_tr_b16 a[10:11], v242 offset:41984
  s_waitcnt lgkmcnt(6)
  v_mfma_f32_16x16x32_bf16 v[80:83], a[32:35], a[156:159], v[80:83]
  ds_read_b64_tr_b16 a[12:13], v243 offset:33792
  s_add_u32 s76, s76, s62
  v_mfma_f32_16x16x32_bf16 v[84:87], a[32:35], a[192:195], v[84:87]
  ds_read_b64_tr_b16 a[14:15], v243 offset:41984
  s_lshl_b32 s76, s76, 10
  v_mfma_f32_16x16x32_bf16 v[88:91], a[36:39], a[156:159], v[88:91]
  ds_read_b64_tr_b16 a[16:17], v240 offset:34816
  s_add_u32 s76, s76, s20
  v_mfma_f32_16x16x32_bf16 v[92:95], a[36:39], a[192:195], v[92:95]
  ds_read_b64_tr_b16 a[18:19], v240 offset:43008
  s_add_u32 s76, s76, 6438912
  v_mfma_f32_16x16x32_bf16 v[96:99], a[40:43], a[156:159], v[96:99]
  ds_read_b64_tr_b16 a[20:21], v241 offset:34816
  v_permlane16_swap_b32 v196, v198
  v_permlane16_swap_b32 v197, v199
  buffer_store_dwordx4 v[196:199], v7, s[44:47], s75 offen sc1
  v_mfma_f32_16x16x32_bf16 v[100:103], a[40:43], a[192:195], v[100:103]
  ds_read_b64_tr_b16 a[22:23], v241 offset:43008
  v_cvt_pk_bf16_f32 v200, v64, v65
  v_mfma_f32_16x16x32_bf16 v[104:107], a[44:47], a[156:159], v[104:107]
  ds_read_b64_tr_b16 a[24:25], v242 offset:34816
  v_cvt_pk_bf16_f32 v201, v66, v67
  v_mfma_f32_16x16x32_bf16 v[108:111], a[44:47], a[192:195], v[108:111]
  ds_read_b64_tr_b16 a[26:27], v242 offset:43008
  s_waitcnt lgkmcnt(6)
  v_mfma_f32_16x16x32_bf16 v[112:115], a[0:3], a[72:75], v[112:115]
  ds_read_b64_tr_b16 a[28:29], v243 offset:34816
  v_cvt_pk_bf16_f32 v202, v68, v69
  v_mfma_f32_16x16x32_bf16 v[116:119], a[0:3], a[108:111], v[116:119]
  ds_read_b64_tr_b16 a[30:31], v243 offset:43008
  v_cvt_pk_bf16_f32 v203, v70, v71
  v_mfma_f32_16x16x32_bf16 v[120:123], a[4:7], a[72:75], v[120:123]
  ds_read_b64_tr_b16 a[32:33], v240 offset:35840
  s_add_u32 s70, s58, 24576
  v_mfma_f32_16x16x32_bf16 v[124:127], a[4:7], a[108:111], v[124:127]
  ds_read_b64_tr_b16 a[34:35], v240 offset:44032
  s_mul_i32 s62, s62, 20070400
  v_mfma_f32_16x16x32_bf16 v[128:131], a[8:11], a[72:75], v[128:131]
  ds_read_b64_tr_b16 a[36:37], v241 offset:35840
  s_add_u32 s20, s20, s62
  v_mfma_f32_16x16x32_bf16 v[132:135], a[8:11], a[108:111], v[132:135]
  ds_read_b64_tr_b16 a[38:39], v241 offset:44032
  s_lshl_b32 s62, s11, 8
  v_mfma_f32_16x16x32_bf16 v[136:139], a[12:15], a[72:75], v[136:139]
  ds_read_b64_tr_b16 a[40:41], v242 offset:35840
  s_add_u32 s20, s20, s62
  v_mfma_f32_16x16x32_bf16 v[140:143], a[12:15], a[108:111], v[140:143]
  ds_read_b64_tr_b16 a[42:43], v242 offset:44032
  s_waitcnt lgkmcnt(6)
  v_mfma_f32_16x16x32_bf16 v[112:115], a[16:19], a[76:79], v[112:115]
  ds_read_b64_tr_b16 a[44:45], v243 offset:35840
  s_add_u32 s88, s20, 6586624
  v_mfma_f32_16x16x32_bf16 v[116:119], a[16:19], a[112:115], v[116:119]
  ds_read_b64_tr_b16 a[46:47], v243 offset:44032
  s_add_u32 s20, s15, 1
  v_mfma_f32_16x16x32_bf16 v[120:123], a[20:23], a[76:79], v[120:123]
  ds_read_b64_tr_b16 a[0:1], v244 offset:0
  s_and_b32 s62, s20, 1
  v_mfma_f32_16x16x32_bf16 v[124:127], a[20:23], a[112:115], v[124:127]
  ds_read_b64_tr_b16 a[2:3], v244 offset:8192
  s_lshr_b32 s20, s20, 1
  v_mfma_f32_16x16x32_bf16 v[128:131], a[24:27], a[76:79], v[128:131]
  ds_read_b64_tr_b16 a[4:5], v245 offset:0
  s_mul_i32 s20, s20, 313600
  v_mfma_f32_16x16x32_bf16 v[132:135], a[24:27], a[112:115], v[132:135]
  ds_read_b64_tr_b16 a[6:7], v245 offset:8192
  s_lshl_b32 s77, s11, 1
  v_mfma_f32_16x16x32_bf16 v[136:139], a[28:31], a[76:79], v[136:139]
  ds_read_b64_tr_b16 a[8:9], v246 offset:0
  s_add_u32 s77, s77, s62
  v_mfma_f32_16x16x32_bf16 v[140:143], a[28:31], a[112:115], v[140:143]
  ds_read_b64_tr_b16 a[10:11], v246 offset:8192
  s_waitcnt lgkmcnt(6)
  v_mfma_f32_16x16x32_bf16 v[112:115], a[32:35], a[124:127], v[112:115]
  ds_read_b64_tr_b16 a[12:13], v247 offset:0
  v_permlane16_swap_b32 v200, v202
  v_permlane16_swap_b32 v201, v203
  buffer_store_dwordx4 v[200:203], v7, s[44:47], s70 offen sc1
  v_mfma_f32_16x16x32_bf16 v[116:119], a[32:35], a[160:163], v[116:119]
  ds_read_b64_tr_b16 a[14:15], v247 offset:8192
  v_cvt_pk_bf16_f32 v204, v72, v73
  v_mfma_f32_16x16x32_bf16 v[120:123], a[36:39], a[124:127], v[120:123]
  ds_read_b64_tr_b16 a[16:17], v244 offset:1024
  v_cvt_pk_bf16_f32 v205, v74, v75
  v_mfma_f32_16x16x32_bf16 v[124:127], a[36:39], a[160:163], v[124:127]
  ds_read_b64_tr_b16 a[18:19], v244 offset:9216
  v_cvt_pk_bf16_f32 v206, v76, v77
  v_mfma_f32_16x16x32_bf16 v[128:131], a[40:43], a[124:127], v[128:131]
  ds_read_b64_tr_b16 a[20:21], v245 offset:1024
  v_cvt_pk_bf16_f32 v207, v78, v79
  v_mfma_f32_16x16x32_bf16 v[132:135], a[40:43], a[160:163], v[132:135]
  ds_read_b64_tr_b16 a[22:23], v245 offset:9216
  s_add_u32 s71, s58, 28672
  v_mfma_f32_16x16x32_bf16 v[136:139], a[44:47], a[124:127], v[136:139]
  ds_read_b64_tr_b16 a[24:25], v246 offset:1024
  s_lshl_b32 s77, s77, 10
  v_mfma_f32_16x16x32_bf16 v[140:143], a[44:47], a[160:163], v[140:143]
  ds_read_b64_tr_b16 a[26:27], v246 offset:9216
  s_waitcnt lgkmcnt(6)
  v_mfma_f32_16x16x32_bf16 v[112:115], a[0:3], a[128:131], v[112:115]
  ds_read_b64_tr_b16 a[28:29], v247 offset:1024
  s_add_u32 s77, s77, s20
  v_mfma_f32_16x16x32_bf16 v[116:119], a[0:3], a[164:167], v[116:119]
  ds_read_b64_tr_b16 a[30:31], v247 offset:9216
  s_add_u32 s77, s77, 6438912
  v_mfma_f32_16x16x32_bf16 v[120:123], a[4:7], a[128:131], v[120:123]
  ds_read_b64_tr_b16 a[32:33], v244 offset:2048
  s_mul_i32 s62, s62, 20070400
  v_mfma_f32_16x16x32_bf16 v[124:127], a[4:7], a[164:167], v[124:127]
  ds_read_b64_tr_b16 a[34:35], v244 offset:10240
  s_add_u32 s20, s20, s62
  v_mfma_f32_16x16x32_bf16 v[128:131], a[8:11], a[128:131], v[128:131]
  ds_read_b64_tr_b16 a[36:37], v245 offset:2048
  s_lshl_b32 s62, s11, 8
  v_mfma_f32_16x16x32_bf16 v[132:135], a[8:11], a[164:167], v[132:135]
  ds_read_b64_tr_b16 a[38:39], v245 offset:10240
  s_add_u32 s20, s20, s62
  v_mfma_f32_16x16x32_bf16 v[136:139], a[12:15], a[128:131], v[136:139]
  ds_read_b64_tr_b16 a[40:41], v246 offset:2048
  s_add_u32 s89, s20, 6586624
  v_mfma_f32_16x16x32_bf16 v[140:143], a[12:15], a[164:167], v[140:143]
  ds_read_b64_tr_b16 a[42:43], v246 offset:10240
  s_waitcnt lgkmcnt(6)
  v_mfma_f32_16x16x32_bf16 v[112:115], a[16:19], a[80:83], v[112:115]
  ds_read_b64_tr_b16 a[44:45], v247 offset:2048
  s_add_u32 s20, s15, 2
  v_mfma_f32_16x16x32_bf16 v[116:119], a[16:19], a[116:119], v[116:119]
  ds_read_b64_tr_b16 a[46:47], v247 offset:10240
  s_waitcnt vmcnt(13)
  v_mfma_f32_16x16x32_bf16 v[120:123], a[20:23], a[80:83], v[120:123]
  ds_read_b64_tr_b16 a[0:1], v244 offset:3072
  s_and_b32 s62, s20, 1
  v_mfma_f32_16x16x32_bf16 v[124:127], a[20:23], a[116:119], v[124:127]
  ds_read_b64_tr_b16 a[2:3], v244 offset:11264
  s_lshr_b32 s20, s20, 1
  v_mfma_f32_16x16x32_bf16 v[128:131], a[24:27], a[80:83], v[128:131]
  ds_read_b64_tr_b16 a[4:5], v245 offset:3072
  v_permlane16_swap_b32 v204, v206
  v_permlane16_swap_b32 v205, v207
  buffer_store_dwordx4 v[204:207], v7, s[44:47], s71 offen sc1
  v_mfma_f32_16x16x32_bf16 v[132:135], a[24:27], a[116:119], v[132:135]
  ds_read_b64_tr_b16 a[6:7], v245 offset:11264
  s_waitcnt vmcnt(11)
  s_barrier
  v_mfma_f32_16x16x32_bf16 v[136:139], a[28:31], a[80:83], v[136:139]
  ds_read_b64_tr_b16 a[8:9], v246 offset:3072
  ds_write_b128 v254, a[244:247]
  v_mfma_f32_16x16x32_bf16 v[140:143], a[28:31], a[116:119], v[140:143]
  ds_read_b64_tr_b16 a[10:11], v246 offset:11264
  s_waitcnt lgkmcnt(7)
  v_mfma_f32_16x16x32_bf16 v[112:115], a[32:35], a[132:135], v[112:115]
  ds_read_b64_tr_b16 a[12:13], v247 offset:3072
  v_cvt_pk_bf16_f32 v192, v80, v81
  v_mfma_f32_16x16x32_bf16 v[116:119], a[32:35], a[168:171], v[116:119]
  ds_read_b64_tr_b16 a[14:15], v247 offset:11264
  v_cvt_pk_bf16_f32 v193, v82, v83
  v_mfma_f32_16x16x32_bf16 v[120:123], a[36:39], a[132:135], v[120:123]
  ds_read_b64_tr_b16 a[16:17], v244 offset:16384
  v_cvt_pk_bf16_f32 v194, v84, v85
  v_mfma_f32_16x16x32_bf16 v[124:127], a[36:39], a[168:171], v[124:127]
  ds_read_b64_tr_b16 a[18:19], v244 offset:24576
  v_cvt_pk_bf16_f32 v195, v86, v87
  v_mfma_f32_16x16x32_bf16 v[128:131], a[40:43], a[132:135], v[128:131]
  ds_read_b64_tr_b16 a[20:21], v245 offset:16384
  ds_write_b128 v254, a[248:251] offset:4160
  v_mfma_f32_16x16x32_bf16 v[132:135], a[40:43], a[168:171], v[132:135]
  ds_read_b64_tr_b16 a[22:23], v245 offset:24576
  s_add_u32 s72, s58, 32768
  v_mfma_f32_16x16x32_bf16 v[136:139], a[44:47], a[132:135], v[136:139]
  ds_read_b64_tr_b16 a[24:25], v246 offset:16384
  s_mul_i32 s20, s20, 313600
  v_mfma_f32_16x16x32_bf16 v[140:143], a[44:47], a[168:171], v[140:143]
  ds_read_b64_tr_b16 a[26:27], v246 offset:24576
  s_waitcnt lgkmcnt(7)
  v_mfma_f32_16x16x32_bf16 v[112:115], a[0:3], a[136:139], v[112:115]
  ds_read_b64_tr_b16 a[28:29], v247 offset:16384
  s_lshl_b32 s96, s11, 1
  v_mfma_f32_16x16x32_bf16 v[116:119], a[0:3], a[172:175], v[116:119]
  ds_read_b64_tr_b16 a[30:31], v247 offset:24576
  s_add_u32 s96, s96, s62
  v_mfma_f32_16x16x32_bf16 v[120:123], a[4:7], a[136:139], v[120:123]
  ds_read_b64_tr_b16 a[32:33], v244 offset:17408
  ds_write_b128 v254, a[244:247] offset:12416
  v_mfma_f32_16x16x32_bf16 v[124:127], a[4:7], a[172:175], v[124:127]
  ds_read_b64_tr_b16 a[34:35], v244 offset:25600
  s_lshl_b32 s96, s96, 10
  v_mfma_f32_16x16x32_bf16 v[128:131], a[8:11], a[136:139], v[128:131]
  ds_read_b64_tr_b16 a[36:37], v245 offset:17408
  s_add_u32 s96, s96, s20
  v_mfma_f32_16x16x32_bf16 v[132:135], a[8:11], a[172:175], v[132:135]
  ds_read_b64_tr_b16 a[38:39], v245 offset:25600
  s_add_u32 s96, s96, 6438912
  v_mfma_f32_16x16x32_bf16 v[136:139], a[12:15], a[136:139], v[136:139]
  ds_read_b64_tr_b16 a[40:41], v246 offset:17408
  s_mul_i32 s62, s62, 20070400
  v_mfma_f32_16x16x32_bf16 v[140:143], a[12:15], a[172:175], v[140:143]
  ds_read_b64_tr_b16 a[42:43], v246 offset:25600
  s_waitcnt lgkmcnt(7)
  v_mfma_f32_16x16x32_bf16 v[112:115], a[16:19], a[140:143], v[112:115]
  ds_read_b64_tr_b16 a[44:45], v247 offset:17408
  v_permlane16_swap_b32 v192, v194
  v_permlane16_swap_b32 v193, v195
  buffer_store_dwordx4 v[192:195], v7, s[44:47], s72 offen sc1
  v_mfma_f32_16x16x32_bf16 v[116:119], a[16:19], a[176:179], v[116:119]
  ds_read_b64_tr_b16 a[46:47], v247 offset:25600
  ds_write_b128 v254, v[224:227] offset:4192
  v_mfma_f32_16x16x32_bf16 v[120:123], a[20:23], a[140:143], v[120:123]
  ds_read_b64_tr_b16 a[0:1], v244 offset:18432
  v_cvt_pk_bf16_f32 v196, v88, v89
  v_mfma_f32_16x16x32_bf16 v[124:127], a[20:23], a[176:179], v[124:127]
  ds_read_b64_tr_b16 a[2:3], v244 offset:26624
  v_cvt_pk_bf16_f32 v197, v90, v91
  v_mfma_f32_16x16x32_bf16 v[128:131], a[24:27], a[140:143], v[128:131]
  ds_read_b64_tr_b16 a[4:5], v245 offset:18432
  v_cvt_pk_bf16_f32 v198, v92, v93
  v_mfma_f32_16x16x32_bf16 v[132:135], a[24:27], a[176:179], v[132:135]
  ds_read_b64_tr_b16 a[6:7], v245 offset:26624
  v_cvt_pk_bf16_f32 v199, v94, v95
  v_mfma_f32_16x16x32_bf16 v[136:139], a[28:31], a[140:143], v[136:139]
  ds_read_b64_tr_b16 a[8:9], v246 offset:18432
  ds_write_b128 v254, v[160:163] offset:32
  v_mfma_f32_16x16x32_bf16 v[140:143], a[28:31], a[176:179], v[140:143]
  ds_read_b64_tr_b16 a[10:11], v246 offset:26624
  s_waitcnt lgkmcnt(8)
  v_mfma_f32_16x16x32_bf16 v[112:115], a[32:35], a[144:147], v[112:115]
  ds_read_b64_tr_b16 a[12:13], v247 offset:18432
  s_add_u32 s73, s58, 36864
  v_mfma_f32_16x16x32_bf16 v[116:119], a[32:35], a[180:183], v[116:119]
  ds_read_b64_tr_b16 a[14:15], v247 offset:26624
  s_add_u32 s20, s20, s62
  v_mfma_f32_16x16x32_bf16 v[120:123], a[36:39], a[144:147], v[120:123]
  ds_read_b64_tr_b16 a[16:17], v244 offset:19456
  s_lshl_b32 s62, s11, 8
  v_mfma_f32_16x16x32_bf16 v[124:127], a[36:39], a[180:183], v[124:127]
  ds_read_b64_tr_b16 a[18:19], v244 offset:27648
  s_add_u32 s20, s20, s62
  v_mfma_f32_16x16x32_bf16 v[128:131], a[40:43], a[144:147], v[128:131]
  ds_read_b64_tr_b16 a[20:21], v245 offset:19456
  ds_write_b128 v254, a[48:51] offset:8320
  v_mfma_f32_16x16x32_bf16 v[132:135], a[40:43], a[180:183], v[132:135]
  ds_read_b64_tr_b16 a[22:23], v245 offset:27648
  s_add_u32 s91, s20, 6586624
  v_mfma_f32_16x16x32_bf16 v[136:139], a[44:47], a[144:147], v[136:139]
  ds_read_b64_tr_b16 a[24:25], v246 offset:19456
  s_movk_i32 s57, 0x5555
  v_mfma_f32_16x16x32_bf16 v[140:143], a[44:47], a[180:183], v[140:143]
  ds_read_b64_tr_b16 a[26:27], v246 offset:27648
  s_waitcnt lgkmcnt(7)
  v_mfma_f32_16x16x32_bf16 v[112:115], a[0:3], a[148:151], v[112:115]
  ds_read_b64_tr_b16 a[28:29], v247 offset:19456
  s_mov_b32 s56, 0
  v_mfma_f32_16x16x32_bf16 v[116:119], a[0:3], a[184:187], v[116:119]
  ds_read_b64_tr_b16 a[30:31], v247 offset:27648
  s_mov_b32 s61, 0
  v_mfma_f32_16x16x32_bf16 v[120:123], a[4:7], a[148:151], v[120:123]
  ds_read_b64_tr_b16 a[32:33], v244 offset:32768
  ds_write_b128 v254, v[228:231] offset:5216
  v_mfma_f32_16x16x32_bf16 v[124:127], a[4:7], a[184:187], v[124:127]
  ds_read_b64_tr_b16 a[34:35], v244 offset:40960
  s_mov_b32 s54, 0x00003f80
  v_mfma_f32_16x16x32_bf16 v[128:131], a[8:11], a[148:151], v[128:131]
  ds_read_b64_tr_b16 a[36:37], v245 offset:32768
  v_permlane16_swap_b32 v196, v198
  v_permlane16_swap_b32 v197, v199
  buffer_store_dwordx4 v[196:199], v7, s[44:47], s73 offen sc1
  v_mfma_f32_16x16x32_bf16 v[132:135], a[8:11], a[184:187], v[132:135]
  ds_read_b64_tr_b16 a[38:39], v245 offset:40960
  v_cvt_pk_bf16_f32 v200, v96, v97
  v_mfma_f32_16x16x32_bf16 v[136:139], a[12:15], a[148:151], v[136:139]
  ds_read_b64_tr_b16 a[40:41], v246 offset:32768
  v_cvt_pk_bf16_f32 v201, v98, v99
  v_mfma_f32_16x16x32_bf16 v[140:143], a[12:15], a[184:187], v[140:143]
  ds_read_b64_tr_b16 a[42:43], v246 offset:40960
  s_waitcnt lgkmcnt(7)
  v_mfma_f32_16x16x32_bf16 v[112:115], a[16:19], a[152:155], v[112:115]
  ds_read_b64_tr_b16 a[44:45], v247 offset:32768
  ds_write_b128 v254, v[164:167] offset:1056
  v_mfma_f32_16x16x32_bf16 v[116:119], a[16:19], a[188:191], v[116:119]
  ds_read_b64_tr_b16 a[46:47], v247 offset:40960
  v_cvt_pk_bf16_f32 v202, v100, v101
  v_mfma_f32_16x16x32_bf16 v[120:123], a[20:23], a[152:155], v[120:123]
  ds_read_b64_tr_b16 a[0:1], v10 offset:33792
  v_cvt_pk_bf16_f32 v203, v102, v103
  v_mfma_f32_16x16x32_bf16 v[124:127], a[20:23], a[188:191], v[124:127]
  ds_read_b64_tr_b16 a[2:3], v10 offset:37888
  s_add_u32 s74, s58, 40960
  v_mfma_f32_16x16x32_bf16 v[128:131], a[24:27], a[152:155], v[128:131]
  ds_read_b64_tr_b16 a[4:5], v11 offset:33792
  s_mov_b32 s55, 0x3f800000
  v_mfma_f32_16x16x32_bf16 v[132:135], a[24:27], a[188:191], v[132:135]
  ds_read_b64_tr_b16 a[6:7], v11 offset:37888
  s_mov_b32 s36, s8
  v_mfma_f32_16x16x32_bf16 v[136:139], a[28:31], a[152:155], v[136:139]
  ds_read_b64_tr_b16 a[8:9], v10 offset:41984
  ds_write_b128 v254, a[52:55] offset:9344
  v_mfma_f32_16x16x32_bf16 v[140:143], a[28:31], a[188:191], v[140:143]
  ds_read_b64_tr_b16 a[10:11], v10 offset:46080
  s_waitcnt lgkmcnt(7)
  v_mfma_f32_16x16x32_bf16 v[112:115], a[32:35], a[156:159], v[112:115]
  ds_read_b64_tr_b16 a[12:13], v11 offset:41984
  s_mov_b32 s37, s9
  v_mfma_f32_16x16x32_bf16 v[116:119], a[32:35], a[192:195], v[116:119]
  ds_read_b64_tr_b16 a[14:15], v11 offset:46080
  s_mov_b32 s38, 1152
  v_mfma_f32_16x16x32_bf16 v[120:123], a[36:39], a[156:159], v[120:123]
  ds_read_b64_tr_b16 a[16:17], v10 offset:34816
  s_mov_b32 s32, s98
  v_mfma_f32_16x16x32_bf16 v[124:127], a[36:39], a[192:195], v[124:127]
  ds_read_b64_tr_b16 a[18:19], v10 offset:38912
  s_mov_b32 s33, s99
  v_mfma_f32_16x16x32_bf16 v[128:131], a[40:43], a[156:159], v[128:131]
  ds_read_b64_tr_b16 a[20:21], v11 offset:34816
  ds_write_b128 v254, v[232:235] offset:6240
  v_mfma_f32_16x16x32_bf16 v[132:135], a[40:43], a[192:195], v[132:135]
  ds_read_b64_tr_b16 a[22:23], v11 offset:38912
  s_mov_b32 s34, 2359296
  v_mfma_f32_16x16x32_bf16 v[136:139], a[44:47], a[156:159], v[136:139]
  ds_read_b64_tr_b16 a[24:25], v10 offset:43008
  s_lshl_b32 s66, s15, 9
  v_mfma_f32_16x16x32_bf16 v[140:143], a[44:47], a[192:195], v[140:143]
  ds_read_b64_tr_b16 a[26:27], v10 offset:47104
  s_waitcnt lgkmcnt(7)
  v_mfma_f32_16x16x32_bf16 v[144:147], a[0:3], a[72:75], v[144:147]
  ds_read_b64_tr_b16 a[28:29], v11 offset:43008
  v_permlane16_swap_b32 v200, v202
  v_permlane16_swap_b32 v201, v203
  buffer_store_dwordx4 v[200:203], v7, s[44:47], s74 offen sc1
  v_mfma_f32_16x16x32_bf16 v[148:151], a[0:3], a[108:111], v[148:151]
  ds_read_b64_tr_b16 a[30:31], v11 offset:47104
  v_cvt_pk_bf16_f32 v204, v104, v105
  v_mfma_f32_16x16x32_bf16 v[152:155], a[4:7], a[72:75], v[152:155]
  ds_read_b64_tr_b16 a[32:33], v10 offset:35840
  v_cvt_pk_bf16_f32 v205, v106, v107
  v_mfma_f32_16x16x32_bf16 v[156:159], a[4:7], a[108:111], v[156:159]
  ds_read_b64_tr_b16 a[34:35], v10 offset:39936
  v_cvt_pk_bf16_f32 v206, v108, v109
  v_mfma_f32_16x16x32_bf16 v[144:147], a[8:11], a[76:79], v[144:147]
  ds_read_b64_tr_b16 a[36:37], v11 offset:35840
  v_cvt_pk_bf16_f32 v207, v110, v111
  v_mfma_f32_16x16x32_bf16 v[148:151], a[8:11], a[112:115], v[148:151]
  ds_read_b64_tr_b16 a[38:39], v11 offset:39936
  s_waitcnt vmcnt(9)
  s_barrier
  v_mfma_f32_16x16x32_bf16 v[152:155], a[12:15], a[76:79], v[152:155]
  ds_read_b64_tr_b16 a[40:41], v10 offset:44032
  s_add_u32 s75, s58, 45056
  v_mfma_f32_16x16x32_bf16 v[156:159], a[12:15], a[112:115], v[156:159]
  ds_read_b64_tr_b16 a[42:43], v10 offset:48128
  ds_write_b128 v254, v[168:171] offset:2080
  s_waitcnt lgkmcnt(7)
  v_mfma_f32_16x16x32_bf16 v[144:147], a[16:19], a[124:127], v[144:147]
  ds_read_b64_tr_b16 a[44:45], v11 offset:44032
  ds_write_b128 v254, a[56:59] offset:10368
  v_mfma_f32_16x16x32_bf16 v[148:151], a[16:19], a[160:163], v[148:151]
  ds_read_b64_tr_b16 a[46:47], v11 offset:48128
  s_add_u32 s66, s66, 2359296
  v_mfma_f32_16x16x32_bf16 v[152:155], a[20:23], a[124:127], v[152:155]
  ds_read_b64_tr_b16 a[0:1], v12 offset:0
  s_lshr_b32 s67, s97, 11
  v_mfma_f32_16x16x32_bf16 v[156:159], a[20:23], a[160:163], v[156:159]
  ds_read_b64_tr_b16 a[2:3], v12 offset:4096
  ds_read_b64_tr_b16 a[4:5], v13 offset:0
  v_mfma_f32_16x16x32_bf16 v[144:147], a[24:27], a[128:131], v[144:147]
  ds_read_b64_tr_b16 a[6:7], v13 offset:4096
  v_permlane16_swap_b32 v204, v206
  v_mfma_f32_16x16x32_bf16 v[148:151], a[24:27], a[164:167], v[148:151]
  ds_read_b64_tr_b16 a[8:9], v12 offset:8192
  v_permlane16_swap_b32 v205, v207
  v_mfma_f32_16x16x32_bf16 v[152:155], a[28:31], a[128:131], v[152:155]
  buffer_store_dwordx4 v[204:207], v7, s[44:47], s75 offen sc1
  v_mfma_f32_16x16x32_bf16 v[156:159], a[28:31], a[164:167], v[156:159]
  ds_read_b64_tr_b16 a[10:11], v12 offset:12288
  s_waitcnt lgkmcnt(6)
  v_mfma_f32_16x16x32_bf16 v[144:147], a[32:35], a[132:135], v[144:147]
  ds_read_b64_tr_b16 a[12:13], v13 offset:8192
  ds_write_b128 v254, v[236:239] offset:7264
  v_mfma_f32_16x16x32_bf16 v[148:151], a[32:35], a[168:171], v[148:151]
  ds_read_b64_tr_b16 a[14:15], v13 offset:12288
  v_mfma_f32_16x16x32_bf16 v[152:155], a[36:39], a[132:135], v[152:155]
  ds_read_b64_tr_b16 a[16:17], v12 offset:1024
  v_mfma_f32_16x16x32_bf16 v[156:159], a[36:39], a[168:171], v[156:159]
  ds_read_b64_tr_b16 a[18:19], v12 offset:5120
  v_mfma_f32_16x16x32_bf16 v[144:147], a[40:43], a[136:139], v[144:147]
  ds_read_b64_tr_b16 a[20:21], v13 offset:1024
  v_cvt_pk_bf16_f32 v192, v112, v113
  v_mfma_f32_16x16x32_bf16 v[148:151], a[40:43], a[172:175], v[148:151]
  ds_read_b64_tr_b16 a[22:23], v13 offset:5120
  v_cvt_pk_bf16_f32 v193, v114, v115
  v_mfma_f32_16x16x32_bf16 v[152:155], a[44:47], a[136:139], v[152:155]
  ds_read_b64_tr_b16 a[24:25], v12 offset:9216
  v_cvt_pk_bf16_f32 v194, v116, v117
  v_mfma_f32_16x16x32_bf16 v[156:159], a[44:47], a[172:175], v[156:159]
  ds_read_b64_tr_b16 a[26:27], v12 offset:13312
  s_waitcnt lgkmcnt(6)
  v_mfma_f32_16x16x32_bf16 v[144:147], a[0:3], a[140:143], v[144:147]
  ds_read_b64_tr_b16 a[28:29], v13 offset:9216
  v_cvt_pk_bf16_f32 v195, v118, v119
  v_mfma_f32_16x16x32_bf16 v[148:151], a[0:3], a[176:179], v[148:151]
  ds_read_b64_tr_b16 a[30:31], v13 offset:13312
  ds_write_b128 v254, v[172:175] offset:3104
  v_mfma_f32_16x16x32_bf16 v[152:155], a[4:7], a[140:143], v[152:155]
  ds_read_b64_tr_b16 a[32:33], v12 offset:2048
  s_add_u32 s70, s58, 49152
  v_mfma_f32_16x16x32_bf16 v[156:159], a[4:7], a[176:179], v[156:159]
  ds_read_b64_tr_b16 a[34:35], v12 offset:6144
  ds_write_b128 v254, a[60:63] offset:11392
  v_mfma_f32_16x16x32_bf16 v[144:147], a[8:11], a[144:147], v[144:147]
  ds_read_b64_tr_b16 a[36:37], v13 offset:2048
  ds_read_b64_tr_b16 a[38:39], v13 offset:6144
  v_mfma_f32_16x16x32_bf16 v[148:151], a[8:11], a[180:183], v[148:151]
  ds_read_b64_tr_b16 a[40:41], v12 offset:10240
  v_permlane16_swap_b32 v192, v194
  v_mfma_f32_16x16x32_bf16 v[152:155], a[12:15], a[144:147], v[152:155]
  v_permlane16_swap_b32 v193, v195
  v_mfma_f32_16x16x32_bf16 v[156:159], a[12:15], a[180:183], v[156:159]
  ds_read_b64_tr_b16 a[42:43], v12 offset:14336
  s_waitcnt lgkmcnt(8)
  v_mfma_f32_16x16x32_bf16 v[144:147], a[16:19], a[148:151], v[144:147]
  ds_read_b64_tr_b16 a[44:45], v13 offset:10240
  ds_read_b64_tr_b16 a[46:47], v13 offset:14336
  v_mfma_f32_16x16x32_bf16 v[148:151], a[16:19], a[184:187], v[148:151]
  buffer_store_dwordx4 v[192:195], v7, s[44:47], s70 offen sc1
  v_mfma_f32_16x16x32_bf16 v[152:155], a[20:23], a[148:151], v[152:155]
  v_mfma_f32_16x16x32_bf16 v[156:159], a[20:23], a[184:187], v[156:159]
  v_mfma_f32_16x16x32_bf16 v[144:147], a[24:27], a[152:155], v[144:147]
  v_mfma_f32_16x16x32_bf16 v[148:151], a[24:27], a[188:191], v[148:151]
  v_mfma_f32_16x16x32_bf16 v[152:155], a[28:31], a[152:155], v[152:155]
  v_cvt_pk_bf16_f32 v196, v120, v121
  v_cvt_pk_bf16_f32 v197, v122, v123
  v_cvt_pk_bf16_f32 v198, v124, v125
  v_mfma_f32_16x16x32_bf16 v[156:159], a[28:31], a[188:191], v[156:159]
  v_cvt_pk_bf16_f32 v199, v126, v127
  s_add_u32 s71, s58, 53248
  s_waitcnt lgkmcnt(0)
  v_mfma_f32_16x16x32_bf16 v[144:147], a[32:35], a[80:83], v[144:147]
  v_mfma_f32_16x16x32_bf16 v[148:151], a[32:35], a[116:119], v[148:151]
  v_mfma_f32_16x16x32_bf16 v[152:155], a[36:39], a[80:83], v[152:155]
  v_mfma_f32_16x16x32_bf16 v[156:159], a[36:39], a[116:119], v[156:159]
  v_mfma_f32_16x16x32_bf16 v[144:147], a[40:43], a[156:159], v[144:147]
  v_mfma_f32_16x16x32_bf16 v[148:151], a[40:43], a[192:195], v[148:151]
  v_mfma_f32_16x16x32_bf16 v[152:155], a[44:47], a[156:159], v[152:155]
  v_mfma_f32_16x16x32_bf16 v[156:159], a[44:47], a[192:195], v[156:159]
  v_permlane16_swap_b32 v196, v198
  v_permlane16_swap_b32 v197, v199
  buffer_store_dwordx4 v[196:199], v7, s[44:47], s71 offen sc1
  v_cvt_pk_bf16_f32 v200, v128, v129
  v_cvt_pk_bf16_f32 v201, v130, v131
  v_cvt_pk_bf16_f32 v202, v132, v133
  v_cvt_pk_bf16_f32 v203, v134, v135
  s_add_u32 s72, s58, 57344
  v_permlane16_swap_b32 v200, v202
  v_permlane16_swap_b32 v201, v203
  buffer_store_dwordx4 v[200:203], v7, s[44:47], s72 offen sc1
  v_cvt_pk_bf16_f32 v204, v136, v137
  v_cvt_pk_bf16_f32 v205, v138, v139
  v_cvt_pk_bf16_f32 v206, v140, v141
  v_cvt_pk_bf16_f32 v207, v142, v143
  s_add_u32 s73, s58, 61440
  v_permlane16_swap_b32 v204, v206
  v_permlane16_swap_b32 v205, v207
  buffer_store_dwordx4 v[204:207], v7, s[44:47], s73 offen sc1
  v_cvt_pk_bf16_f32 v192, v144, v145
  v_cvt_pk_bf16_f32 v193, v146, v147
  v_cvt_pk_bf16_f32 v194, v148, v149
  v_cvt_pk_bf16_f32 v195, v150, v151
  s_add_u32 s74, s53, 0
  v_permlane16_swap_b32 v192, v194
  v_permlane16_swap_b32 v193, v195
  buffer_store_dwordx4 v[192:195], v7, s[44:47], s74 offen sc1
  v_cvt_pk_bf16_f32 v196, v152, v153
  v_cvt_pk_bf16_f32 v197, v154, v155
  v_cvt_pk_bf16_f32 v198, v156, v157
  v_cvt_pk_bf16_f32 v199, v158, v159
  s_add_u32 s75, s53, 4096
  v_permlane16_swap_b32 v196, v198
  v_permlane16_swap_b32 v197, v199
  buffer_store_dwordx4 v[196:199], v7, s[44:47], s75 offen sc1
  s_nop 0
  v_add_u32 v5, 1, v5
  s_cmp_lt_u32 s16, 27
  s_cbranch_scc1 KF_start
  s_waitcnt vmcnt(0)
  s_barrier
  buffer_store_dword v5, v1, s[44:47], s90 offen sc1
  s_branch K1_fin
KF_start:
  v_accvgpr_read_b32 v15, a241
  v_lshrrev_b32 v13, 4, v2
  s_mov_b32 s20, 5017600
  v_mul_lo_u32 v13, v13, s20
  v_and_b32 v14, 15, v2
  v_lshl_add_u32 v13, v14, 4, v13
  v_lshlrev_b32 v12, 3, v2
  s_waitcnt lgkmcnt(0)
  v_accvgpr_read_b32 v224, a236
  v_accvgpr_read_b32 v232, a237
  v_accvgpr_read_b32 v234, a238
  v_accvgpr_read_b32 v236, a239
  v_accvgpr_read_b32 v237, a240
  v_accvgpr_read_b32 v238, a242
  v_add_u32 v228, s19, v224
  v_add_u32 v233, s19, v232
  v_add_u32 v235, s19, v234
  v_add_u32 v225, 1024, v224
  v_add_u32 v226, 2048, v224
  v_add_u32 v227, 3072, v224
  v_add_u32 v229, 1024, v228
  v_add_u32 v230, 2048, v228
  v_add_u32 v231, 3072, v228
  buffer_load_dword v252, v15, s[44:47], 0 offen sc1
  s_cmp_eq_u32 s12, 1
  s_cbranch_scc1 KF_conv1
  s_cmp_eq_u32 s12, 2
  s_cbranch_scc1 KF_conv2
  ds_read2_b32 a[112:113], v224 offset0:0 offset1:1
  ds_read2_b32 a[114:115], v224 offset0:2 offset1:3
  ds_read_b128 a[172:175], v232 offset:0
  ds_read_b128 a[168:171], v232 offset:512
  ds_read2_b32 a[116:117], v224 offset0:128 offset1:129
  ds_read2_b32 a[118:119], v224 offset0:130 offset1:131
  ds_read_b128 a[164:167], v232 offset:1024
  ds_read2_b32 a[120:121], v225 offset0:0 offset1:1
  ds_read2_b32 a[122:123], v225 offset0:2 offset1:3
  ds_read_b128 a[160:163], v232 offset:1536
  ds_read2_b32 a[124:125], v225 offset0:128 offset1:129
  ds_read2_b32 a[126:127], v225 offset0:130 offset1:131
  ds_read_b128 a[156:159], v232 offset:2048
  ds_read2_b32 a[128:129], v226 offset0:0 offset1:1
  ds_read2_b32 a[130:131], v226 offset0:2 offset1:3
  ds_read_b128 a[152:155], v232 offset:2560
  ds_read2_b32 a[132:133], v226 offset0:128 offset1:129
  ds_read2_b32 a[134:135], v226 offset0:130 offset1:131
  ds_read_b128 a[148:151], v232 offset:3072
  ds_read2_b32 a[136:137], v227 offset0:0 offset1:1
  ds_read2_b32 a[138:139], v227 offset0:2 offset1:3
  ds_read_b128 a[144:147], v232 offset:3584
  ds_read2_b32 a[140:141], v227 offset0:128 offset1:129
  ds_read2_b32 a[142:143], v227 offset0:130 offset1:131
  s_waitcnt lgkmcnt(15)
  v_mfma_f32_16x16x32_bf16 v[164:167], a[112:115], a[172:175], 0
  ds_read2_b32 a[176:177], v224 offset0:16 offset1:17
  ds_read2_b32 a[178:179], v224 offset0:18 offset1:19
  v_mfma_f32_16x16x32_bf16 v[160:163], a[112:115], a[168:171], 0
  ds_read_b128 a[236:239], v232 offset:64
  ds_read_b128 a[232:235], v232 offset:576
  ds_write_b128 v255, a[244:247]
  v_mfma_f32_16x16x32_bf16 v[164:167], a[116:119], a[168:171], v[164:167]
  ds_read2_b32 a[180:181], v224 offset0:144 offset1:145
  ds_read2_b32 a[182:183], v224 offset0:146 offset1:147
  s_waitcnt lgkmcnt(15)
  v_mfma_f32_16x16x32_bf16 v[160:163], a[116:119], a[164:167], v[160:163]
  ds_read_b128 a[228:231], v232 offset:1088
  ds_read2_b32 a[184:185], v225 offset0:16 offset1:17
  v_mfma_f32_16x16x32_bf16 v[164:167], a[120:123], a[164:167], v[164:167]
  ds_read2_b32 a[186:187], v225 offset0:18 offset1:19
  ds_read_b128 a[224:227], v232 offset:1600
  ds_write_b128 v255, a[252:255] offset:4160
  v_mfma_f32_16x16x32_bf16 v[160:163], a[120:123], a[160:163], v[160:163]
  ds_read2_b32 a[188:189], v225 offset0:144 offset1:145
  ds_read2_b32 a[190:191], v225 offset0:146 offset1:147
  v_mfma_f32_16x16x32_bf16 v[164:167], a[124:127], a[160:163], v[164:167]
  ds_read_b128 a[220:223], v232 offset:2112
  ds_read2_b32 a[192:193], v226 offset0:16 offset1:17
  v_mfma_f32_16x16x32_bf16 v[160:163], a[124:127], a[156:159], v[160:163]
  ds_read2_b32 a[194:195], v226 offset0:18 offset1:19
  ds_read_b128 a[216:219], v232 offset:2624
  ds_write_b128 v255, a[244:247] offset:12416
  v_mfma_f32_16x16x32_bf16 v[164:167], a[128:131], a[156:159], v[164:167]
  ds_read2_b32 a[196:197], v226 offset0:144 offset1:145
  ds_read2_b32 a[198:199], v226 offset0:146 offset1:147
  s_waitcnt lgkmcnt(15)
  v_mfma_f32_16x16x32_bf16 v[160:163], a[128:131], a[152:155], v[160:163]
  ds_read_b128 a[212:215], v232 offset:3136
  v_mfma_f32_16x16x32_bf16 v[164:167], a[132:135], a[152:155], v[164:167]
  ds_read2_b32 a[200:201], v227 offset0:16 offset1:17
  ds_write_b128 v255, v[208:211] offset:4192
  v_mfma_f32_16x16x32_bf16 v[160:163], a[132:135], a[148:151], v[160:163]
  ds_read2_b32 a[202:203], v227 offset0:18 offset1:19
  v_mfma_f32_16x16x32_bf16 v[164:167], a[136:139], a[148:151], v[164:167]
  ds_read_b128 a[208:211], v232 offset:3648
  v_mfma_f32_16x16x32_bf16 v[160:163], a[136:139], a[144:147], v[160:163]
  ds_read2_b32 a[204:205], v227 offset0:144 offset1:145
  ds_write_b128 v255, v[176:179] offset:32
  v_mfma_f32_16x16x32_bf16 v[164:167], a[140:143], a[144:147], v[164:167]
  ds_read2_b32 a[206:207], v227 offset0:146 offset1:147
  s_waitcnt lgkmcnt(15)
  v_mfma_f32_16x16x32_bf16 v[164:167], a[176:179], a[236:239], v[164:167]
  ds_read2_b32 a[112:113], v224 offset0:32 offset1:33
  ds_read2_b32 a[114:115], v224 offset0:34 offset1:35
  v_mfma_f32_16x16x32_bf16 v[160:163], a[176:179], a[232:235], v[160:163]
  ds_read_b128 a[172:175], v232 offset:128
  ds_read_b128 a[168:171], v232 offset:640
  ds_write_b128 v255, a[84:87] offset:8320
  v_mfma_f32_16x16x32_bf16 v[164:167], a[180:183], a[232:235], v[164:167]
  ds_read2_b32 a[116:117], v224 offset0:160 offset1:161
  ds_read2_b32 a[118:119], v224 offset0:162 offset1:163
  v_mfma_f32_16x16x32_bf16 v[160:163], a[180:183], a[228:231], v[160:163]
  ds_read_b128 a[164:167], v232 offset:1152
  ds_read2_b32 a[120:121], v225 offset0:32 offset1:33
  v_mfma_f32_16x16x32_bf16 v[164:167], a[184:187], a[228:231], v[164:167]
  ds_read2_b32 a[122:123], v225 offset0:34 offset1:35
  ds_read_b128 a[160:163], v232 offset:1664
  ds_write_b128 v255, v[212:215] offset:5216
  v_mfma_f32_16x16x32_bf16 v[160:163], a[184:187], a[224:227], v[160:163]
  ds_read2_b32 a[124:125], v225 offset0:160 offset1:161
  ds_read2_b32 a[126:127], v225 offset0:162 offset1:163
  s_waitcnt lgkmcnt(15)
  v_mfma_f32_16x16x32_bf16 v[164:167], a[188:191], a[224:227], v[164:167]
  ds_read_b128 a[156:159], v232 offset:2176
  ds_read2_b32 a[128:129], v226 offset0:32 offset1:33
  v_mfma_f32_16x16x32_bf16 v[160:163], a[188:191], a[220:223], v[160:163]
  ds_read2_b32 a[130:131], v226 offset0:34 offset1:35
  ds_read_b128 a[152:155], v232 offset:2688
  ds_write_b128 v255, v[180:183] offset:1056
  v_mfma_f32_16x16x32_bf16 v[164:167], a[192:195], a[220:223], v[164:167]
  ds_read2_b32 a[132:133], v226 offset0:160 offset1:161
  ds_read2_b32 a[134:135], v226 offset0:162 offset1:163
  v_mfma_f32_16x16x32_bf16 v[160:163], a[192:195], a[216:219], v[160:163]
  ds_read_b128 a[148:151], v232 offset:3200
  v_mfma_f32_16x16x32_bf16 v[164:167], a[196:199], a[216:219], v[164:167]
  ds_read2_b32 a[136:137], v227 offset0:32 offset1:33
  ds_write_b128 v255, a[88:91] offset:9344
  v_mfma_f32_16x16x32_bf16 v[160:163], a[196:199], a[212:215], v[160:163]
  ds_read2_b32 a[138:139], v227 offset0:34 offset1:35
  s_waitcnt lgkmcnt(15)
  v_mfma_f32_16x16x32_bf16 v[164:167], a[200:203], a[212:215], v[164:167]
  ds_read_b128 a[144:147], v232 offset:3712
  v_mfma_f32_16x16x32_bf16 v[160:163], a[200:203], a[208:211], v[160:163]
  ds_read2_b32 a[140:141], v227 offset0:160 offset1:161
  ds_write_b128 v255, v[216:219] offset:6240
  v_mfma_f32_16x16x32_bf16 v[164:167], a[204:207], a[208:211], v[164:167]
  ds_read2_b32 a[142:143], v227 offset0:162 offset1:163
  v_mfma_f32_16x16x32_bf16 v[164:167], a[112:115], a[172:175], v[164:167]
  ds_read2_b32 a[176:177], v224 offset0:48 offset1:49
  ds_read2_b32 a[178:179], v224 offset0:50 offset1:51
  v_mfma_f32_16x16x32_bf16 v[160:163], a[112:115], a[168:171], v[160:163]
  ds_read_b128 a[236:239], v232 offset:192
  ds_read_b128 a[232:235], v232 offset:704
  ds_write_b128 v255, v[184:187] offset:2080
  v_mfma_f32_16x16x32_bf16 v[164:167], a[116:119], a[168:171], v[164:167]
  ds_read2_b32 a[180:181], v224 offset0:176 offset1:177
  ds_read2_b32 a[182:183], v224 offset0:178 offset1:179
  s_waitcnt lgkmcnt(15)
  v_mfma_f32_16x16x32_bf16 v[160:163], a[116:119], a[164:167], v[160:163]
  ds_read_b128 a[228:231], v232 offset:1216
  ds_read2_b32 a[184:185], v225 offset0:48 offset1:49
  v_mfma_f32_16x16x32_bf16 v[164:167], a[120:123], a[164:167], v[164:167]
  ds_read2_b32 a[186:187], v225 offset0:50 offset1:51
  ds_read_b128 a[224:227], v232 offset:1728
  ds_write_b128 v255, a[92:95] offset:10368
  v_mfma_f32_16x16x32_bf16 v[160:163], a[120:123], a[160:163], v[160:163]
  ds_read2_b32 a[188:189], v225 offset0:176 offset1:177
  ds_read2_b32 a[190:191], v225 offset0:178 offset1:179
  v_mfma_f32_16x16x32_bf16 v[164:167], a[124:127], a[160:163], v[164:167]
  ds_read_b128 a[220:223], v232 offset:2240
  ds_read2_b32 a[192:193], v226 offset0:48 offset1:49
  v_mfma_f32_16x16x32_bf16 v[160:163], a[124:127], a[156:159], v[160:163]
  ds_read2_b32 a[194:195], v226 offset0:50 offset1:51
  ds_read_b128 a[216:219], v232 offset:2752
  ds_write_b128 v255, v[220:223] offset:7264
  v_mfma_f32_16x16x32_bf16 v[164:167], a[128:131], a[156:159], v[164:167]
  ds_read2_b32 a[196:197], v226 offset0:176 offset1:177
  ds_read2_b32 a[198:199], v226 offset0:178 offset1:179
  s_waitcnt lgkmcnt(15)
  v_mfma_f32_16x16x32_bf16 v[160:163], a[128:131], a[152:155], v[160:163]
  ds_read_b128 a[212:215], v232 offset:3264
  v_mfma_f32_16x16x32_bf16 v[164:167], a[132:135], a[152:155], v[164:167]
  ds_read2_b32 a[200:201], v227 offset0:48 offset1:49
  ds_write_b128 v255, v[188:191] offset:3104
  v_mfma_f32_16x16x32_bf16 v[160:163], a[132:135], a[148:151], v[160:163]
  ds_read2_b32 a[202:203], v227 offset0:50 offset1:51
  v_mfma_f32_16x16x32_bf16 v[164:167], a[136:139], a[148:151], v[164:167]
  ds_read_b128 a[208:211], v232 offset:3776
  v_mfma_f32_16x16x32_bf16 v[160:163], a[136:139], a[144:147], v[160:163]
  ds_read2_b32 a[204:205], v227 offset0:176 offset1:177
  ds_write_b128 v255, a[96:99] offset:11392
  v_mfma_f32_16x16x32_bf16 v[164:167], a[140:143], a[144:147], v[164:167]
  ds_read2_b32 a[206:207], v227 offset0:178 offset1:179
  s_waitcnt vmcnt(0)
  s_barrier
  buffer_store_dword v5, v1, s[44:47], s90 offen sc1
KF_chk0:
  v_subrev_u32 v253, s78, v252
  v_add_u32 v253, -1, v253
  v_cmp_lt_u32 vcc, 3, v253
  s_nop 4
  s_cbranch_vccz KF_go0
  s_add_u32 s63, s63, 1
  s_cmp_ge_u32 s63, 0x40000
  s_cbranch_scc1 KF_go0
  s_nop 0
  buffer_load_dword v252, v15, s[44:47], 0 offen sc1
  s_waitcnt vmcnt(0)
  s_branch KF_chk0
KF_go0:
  v_subrev_u32 v253, s78, v252
  v_cmp_eq_u32 vcc, 4, v253
  s_nop 1
  s_lshr_b32 s20, vcc_lo, 16
  s_and_b32 s20, s20, vcc_lo
  s_lshr_b32 s23, s20, 1
  s_and_b32 s20, s20, s23
  s_and_b32 s20, s20, s57
  s_andn2_b32 s57, s57, s20
  s_or_b32 s56, s56, s20
  s_waitcnt lgkmcnt(15)
  v_mfma_f32_16x16x32_bf16 v[164:167], a[176:179], a[236:239], v[164:167]
  ds_read2_b32 a[112:113], v224 offset0:64 offset1:65
  ds_read2_b32 a[114:115], v224 offset0:66 offset1:67
  buffer_load_dwordx4 v[144:147], v13, s[44:47], s88 offen sc1
  v_mfma_f32_16x16x32_bf16 v[160:163], a[176:179], a[232:235], v[160:163]
  ds_read_b128 a[172:175], v232 offset:256
  ds_read_b128 a[168:171], v232 offset:768
  buffer_load_dwordx4 v[148:151], v13, s[44:47], s89 offen sc1
  v_mfma_f32_16x16x32_bf16 v[164:167], a[180:183], a[232:235], v[164:167]
  ds_read2_b32 a[116:117], v224 offset0:192 offset1:193
  ds_read2_b32 a[118:119], v224 offset0:194 offset1:195
  buffer_load_dwordx2 v[240:241], v12, s[44:47], s66 offen offset:0 sc1
  v_mfma_f32_16x16x32_bf16 v[160:163], a[180:183], a[228:231], v[160:163]
  ds_read_b128 a[164:167], v232 offset:1280
  ds_read2_b32 a[120:121], v225 offset0:64 offset1:65
  buffer_load_dwordx2 v[242:243], v12, s[44:47], s66 offen offset:512 sc1
  v_mfma_f32_16x16x32_bf16 v[164:167], a[184:187], a[228:231], v[164:167]
  ds_read2_b32 a[122:123], v225 offset0:66 offset1:67
  ds_read_b128 a[160:163], v232 offset:1792
  buffer_load_ushort v8, off, s[36:39], s67 offset:0
  v_mfma_f32_16x16x32_bf16 v[160:163], a[184:187], a[224:227], v[160:163]
  ds_read2_b32 a[124:125], v225 offset0:192 offset1:193
  ds_read2_b32 a[126:127], v225 offset0:194 offset1:195
  buffer_load_ushort v10, off, s[36:39], s67 offset:2
  s_waitcnt lgkmcnt(15)
  v_mfma_f32_16x16x32_bf16 v[164:167], a[188:191], a[224:227], v[164:167]
  ds_read_b128 a[156:159], v232 offset:2304
  ds_read2_b32 a[128:129], v226 offset0:64 offset1:65
  s_ff1_i32_b32 s20, s56
  s_bitset0_b32 s56, s20
  s_cmp_lt_i32 s20, 0
  s_mul_i32 s20, s20, 2508800
  s_cselect_b32 s20, 0x40000000, s20
  s_cselect_b32 s62, 0, 1
  s_or_b32 s61, s61, s62
  s_add_u32 s23, s20, s76
  buffer_load_dwordx4 v[16:19], v3, s[44:47], s23 offen sc1
  v_mfma_f32_16x16x32_bf16 v[160:163], a[188:191], a[220:223], v[160:163]
  ds_read2_b32 a[130:131], v226 offset0:66 offset1:67
  ds_read_b128 a[152:155], v232 offset:2816
  s_add_u32 s23, s20, s77
  buffer_load_dwordx4 v[20:23], v3, s[44:47], s23 offen sc1
  v_mfma_f32_16x16x32_bf16 v[164:167], a[192:195], a[220:223], v[164:167]
  ds_read2_b32 a[132:133], v226 offset0:192 offset1:193
  ds_read2_b32 a[134:135], v226 offset0:194 offset1:195
  s_ff1_i32_b32 s20, s56
  s_bitset0_b32 s56, s20
  s_cmp_lt_i32 s20, 0
  s_mul_i32 s20, s20, 2508800
  s_cselect_b32 s20, 0x40000000, s20
  s_cselect_b32 s62, 0, 2
  s_or_b32 s61, s61, s62
  s_add_u32 s23, s20, s76
  buffer_load_dwordx4 v[32:35], v3, s[44:47], s23 offen sc1
  v_mfma_f32_16x16x32_bf16 v[160:163], a[192:195], a[216:219], v[160:163]
  ds_read_b128 a[148:151], v232 offset:3328
  s_add_u32 s23, s20, s77
  buffer_load_dwordx4 v[36:39], v3, s[44:47], s23 offen sc1
  v_mfma_f32_16x16x32_bf16 v[164:167], a[196:199], a[216:219], v[164:167]
  ds_read2_b32 a[136:137], v227 offset0:64 offset1:65
  s_ff1_i32_b32 s20, s56
  s_bitset0_b32 s56, s20
  s_cmp_lt_i32 s20, 0
  s_mul_i32 s20, s20, 2508800
  s_cselect_b32 s20, 0x40000000, s20
  s_cselect_b32 s62, 0, 4
  s_or_b32 s61, s61, s62
  s_add_u32 s23, s20, s76
  buffer_load_dwordx4 v[48:51], v3, s[44:47], s23 offen sc1
  v_mfma_f32_16x16x32_bf16 v[160:163], a[196:199], a[212:215], v[160:163]
  ds_read2_b32 a[138:139], v227 offset0:66 offset1:67
  s_add_u32 s23, s20, s77
  buffer_load_dwordx4 v[52:55], v3, s[44:47], s23 offen sc1
  s_waitcnt lgkmcnt(15)
  v_mfma_f32_16x16x32_bf16 v[164:167], a[200:203], a[212:215], v[164:167]
  ds_read_b128 a[144:147], v232 offset:3840
  s_ff1_i32_b32 s20, s56
  s_bitset0_b32 s56, s20
  s_cmp_lt_i32 s20, 0
  s_mul_i32 s20, s20, 2508800
  s_cselect_b32 s20, 0x40000000, s20
  s_cselect_b32 s62, 0, 8
  s_or_b32 s61, s61, s62
  s_add_u32 s23, s20, s76
  buffer_load_dwordx4 v[64:67], v3, s[44:47], s23 offen sc1
  v_mfma_f32_16x16x32_bf16 v[160:163], a[200:203], a[208:211], v[160:163]
  ds_read2_b32 a[140:141], v227 offset0:192 offset1:193
  s_add_u32 s23, s20, s77
  buffer_load_dwordx4 v[68:71], v3, s[44:47], s23 offen sc1
  v_mfma_f32_16x16x32_bf16 v[164:167], a[204:207], a[208:211], v[164:167]
  ds_read2_b32 a[142:143], v227 offset0:194 offset1:195
  s_ff1_i32_b32 s20, s56
  s_bitset0_b32 s56, s20
  s_cmp_lt_i32 s20, 0
  s_mul_i32 s20, s20, 2508800
  s_cselect_b32 s20, 0x40000000, s20
  s_cselect_b32 s62, 0, 16
  s_or_b32 s61, s61, s62
  s_add_u32 s23, s20, s76
  buffer_load_dwordx4 v[80:83], v3, s[44:47], s23 offen sc1
  v_mfma_f32_16x16x32_bf16 v[164:167], a[112:115], a[172:175], v[164:167]
  ds_read2_b32 a[176:177], v224 offset0:80 offset1:81
  ds_read2_b32 a[178:179], v224 offset0:82 offset1:83
  s_add_u32 s23, s20, s77
  buffer_load_dwordx4 v[84:87], v3, s[44:47], s23 offen sc1
  v_mfma_f32_16x16x32_bf16 v[160:163], a[112:115], a[168:171], v[160:163]
  ds_read_b128 a[236:239], v232 offset:320
  ds_read_b128 a[232:235], v232 offset:832
  v_mfma_f32_16x16x32_bf16 v[164:167], a[116:119], a[168:171], v[164:167]
  ds_read2_b32 a[180:181], v224 offset0:208 offset1:209
  ds_read2_b32 a[182:183], v224 offset0:210 offset1:211
  s_waitcnt lgkmcnt(15)
  v_mfma_f32_16x16x32_bf16 v[160:163], a[116:119], a[164:167], v[160:163]
  ds_read_b128 a[228:231], v232 offset:1344
  ds_read2_b32 a[184:185], v225 offset0:80 offset1:81
  v_mfma_f32_16x16x32_bf16 v[164:167], a[120:123], a[164:167], v[164:167]
  ds_read2_b32 a[186:187], v225 offset0:82 offset1:83
  ds_read_b128 a[224:227], v232 offset:1856
  v_mfma_f32_16x16x32_bf16 v[160:163], a[120:123], a[160:163], v[160:163]
  ds_read2_b32 a[188:189], v225 offset0:208 offset1:209
  ds_read2_b32 a[190:191], v225 offset0:210 offset1:211
  v_mfma_f32_16x16x32_bf16 v[164:167], a[124:127], a[160:163], v[164:167]
  ds_read_b128 a[220:223], v232 offset:2368
  ds_read2_b32 a[192:193], v226 offset0:80 offset1:81
  v_mfma_f32_16x16x32_bf16 v[160:163], a[124:127], a[156:159], v[160:163]
  ds_read2_b32 a[194:195], v226 offset0:82 offset1:83
  ds_read_b128 a[216:219], v232 offset:2880
  v_mfma_f32_16x16x32_bf16 v[164:167], a[128:131], a[156:159], v[164:167]
  ds_read2_b32 a[196:197], v226 offset0:208 offset1:209
  ds_read2_b32 a[198:199], v226 offset0:210 offset1:211
  s_waitcnt lgkmcnt(15)
  v_mfma_f32_16x16x32_bf16 v[160:163], a[128:131], a[152:155], v[160:163]
  ds_read_b128 a[212:215], v232 offset:3392
  v_mfma_f32_16x16x32_bf16 v[164:167], a[132:135], a[152:155], v[164:167]
  ds_read2_b32 a[200:201], v227 offset0:80 offset1:81
  v_mfma_f32_16x16x32_bf16 v[160:163], a[132:135], a[148:151], v[160:163]
  ds_read2_b32 a[202:203], v227 offset0:82 offset1:83
  v_mfma_f32_16x16x32_bf16 v[164:167], a[136:139], a[148:151], v[164:167]
  ds_read_b128 a[208:211], v232 offset:3904
  v_mfma_f32_16x16x32_bf16 v[160:163], a[136:139], a[144:147], v[160:163]
  ds_read2_b32 a[204:205], v227 offset0:208 offset1:209
  v_mfma_f32_16x16x32_bf16 v[164:167], a[140:143], a[144:147], v[164:167]
  ds_read2_b32 a[206:207], v227 offset0:210 offset1:211
  s_waitcnt lgkmcnt(15)
  v_mfma_f32_16x16x32_bf16 v[164:167], a[176:179], a[236:239], v[164:167]
  ds_read2_b32 a[112:113], v224 offset0:96 offset1:97
  ds_read2_b32 a[114:115], v224 offset0:98 offset1:99
  v_mfma_f32_16x16x32_bf16 v[160:163], a[176:179], a[232:235], v[160:163]
  ds_read_b128 a[172:175], v232 offset:384
  ds_read_b128 a[168:171], v232 offset:896
  v_mfma_f32_16x16x32_bf16 v[164:167], a[180:183], a[232:235], v[164:167]
  ds_read2_b32 a[116:117], v224 offset0:224 offset1:225
  ds_read2_b32 a[118:119], v224 offset0:226 offset1:227
  s_waitcnt lgkmcnt(15)
  v_mfma_f32_16x16x32_bf16 v[160:163], a[180:183], a[228:231], v[160:163]
  ds_read_b128 a[164:167], v232 offset:1408
  ds_read2_b32 a[120:121], v225 offset0:96 offset1:97
  v_mfma_f32_16x16x32_bf16 v[164:167], a[184:187], a[228:231], v[164:167]
  ds_read2_b32 a[122:123], v225 offset0:98 offset1:99
  ds_read_b128 a[160:163], v232 offset:1920
  v_mfma_f32_16x16x32_bf16 v[160:163], a[184:187], a[224:227], v[160:163]
  ds_read2_b32 a[124:125], v225 offset0:224 offset1:225
  ds_read2_b32 a[126:127], v225 offset0:226 offset1:227
  v_mfma_f32_16x16x32_bf16 v[164:167], a[188:191], a[224:227], v[164:167]
  ds_read_b128 a[156:159], v232 offset:2432
  ds_read2_b32 a[128:129], v226 offset0:96 offset1:97
  v_mfma_f32_16x16x32_bf16 v[160:163], a[188:191], a[220:223], v[160:163]
  ds_read2_b32 a[130:131], v226 offset0:98 offset1:99
  ds_read_b128 a[152:155], v232 offset:2944
  v_mfma_f32_16x16x32_bf16 v[164:167], a[192:195], a[220:223], v[164:167]
  ds_read2_b32 a[132:133], v226 offset0:224 offset1:225
  ds_read2_b32 a[134:135], v226 offset0:226 offset1:227
  s_waitcnt lgkmcnt(15)
  v_mfma_f32_16x16x32_bf16 v[160:163], a[192:195], a[216:219], v[160:163]
  ds_read_b128 a[148:151], v232 offset:3456
  v_mfma_f32_16x16x32_bf16 v[164:167], a[196:199], a[216:219], v[164:167]
  ds_read2_b32 a[136:137], v227 offset0:96 offset1:97
  v_mfma_f32_16x16x32_bf16 v[160:163], a[196:199], a[212:215], v[160:163]
  ds_read2_b32 a[138:139], v227 offset0:98 offset1:99
  v_mfma_f32_16x16x32_bf16 v[164:167], a[200:203], a[212:215], v[164:167]
  ds_read_b128 a[144:147], v232 offset:3968
  v_mfma_f32_16x16x32_bf16 v[160:163], a[200:203], a[208:211], v[160:163]
  ds_read2_b32 a[140:141], v227 offset0:224 offset1:225
  v_mfma_f32_16x16x32_bf16 v[164:167], a[204:207], a[208:211], v[164:167]
  ds_read2_b32 a[142:143], v227 offset0:226 offset1:227
  s_waitcnt lgkmcnt(15)
  v_mfma_f32_16x16x32_bf16 v[164:167], a[112:115], a[172:175], v[164:167]
  ds_read2_b32 a[176:177], v224 offset0:112 offset1:113
  ds_read2_b32 a[178:179], v224 offset0:114 offset1:115
  v_mfma_f32_16x16x32_bf16 v[160:163], a[112:115], a[168:171], v[160:163]
  ds_read_b128 a[236:239], v232 offset:448
  ds_read_b128 a[232:235], v232 offset:960
  v_mfma_f32_16x16x32_bf16 v[164:167], a[116:119], a[168:171], v[164:167]
  ds_read2_b32 a[180:181], v224 offset0:240 offset1:241
  ds_read2_b32 a[182:183], v224 offset0:242 offset1:243
  s_waitcnt lgkmcnt(15)
  v_mfma_f32_16x16x32_bf16 v[160:163], a[116:119], a[164:167], v[160:163]
  ds_read_b128 a[228:231], v232 offset:1472
  ds_read2_b32 a[184:185], v225 offset0:112 offset1:113
  v_mfma_f32_16x16x32_bf16 v[164:167], a[120:123], a[164:167], v[164:167]
  ds_read2_b32 a[186:187], v225 offset0:114 offset1:115
  ds_read_b128 a[224:227], v232 offset:1984
  v_mfma_f32_16x16x32_bf16 v[160:163], a[120:123], a[160:163], v[160:163]
  ds_read2_b32 a[188:189], v225 offset0:240 offset1:241
  ds_read2_b32 a[190:191], v225 offset0:242 offset1:243
  v_mfma_f32_16x16x32_bf16 v[164:167], a[124:127], a[160:163], v[164:167]
  ds_read_b128 a[220:223], v232 offset:2496
  ds_read2_b32 a[192:193], v226 offset0:112 offset1:113
  v_mfma_f32_16x16x32_bf16 v[160:163], a[124:127], a[156:159], v[160:163]
  ds_read2_b32 a[194:195], v226 offset0:114 offset1:115
  ds_read_b128 a[216:219], v232 offset:3008
  v_mfma_f32_16x16x32_bf16 v[164:167], a[128:131], a[156:159], v[164:167]
  ds_read2_b32 a[196:197], v226 offset0:240 offset1:241
  ds_read2_b32 a[198:199], v226 offset0:242 offset1:243
  s_waitcnt lgkmcnt(15)
  v_mfma_f32_16x16x32_bf16 v[160:163], a[128:131], a[152:155], v[160:163]
  ds_read_b128 a[212:215], v232 offset:3520
  v_mfma_f32_16x16x32_bf16 v[164:167], a[132:135], a[152:155], v[164:167]
  ds_read2_b32 a[200:201], v227 offset0:112 offset1:113
  v_mfma_f32_16x16x32_bf16 v[160:163], a[132:135], a[148:151], v[160:163]
  ds_read2_b32 a[202:203], v227 offset0:114 offset1:115
  v_mfma_f32_16x16x32_bf16 v[164:167], a[136:139], a[148:151], v[164:167]
  ds_read_b128 a[208:211], v232 offset:4032
  v_mfma_f32_16x16x32_bf16 v[160:163], a[136:139], a[144:147], v[160:163]
  ds_read2_b32 a[204:205], v227 offset0:240 offset1:241
  v_mfma_f32_16x16x32_bf16 v[164:167], a[140:143], a[144:147], v[164:167]
  ds_read2_b32 a[206:207], v227 offset0:242 offset1:243
  s_waitcnt lgkmcnt(15)
  v_mfma_f32_16x16x32_bf16 v[164:167], a[176:179], a[236:239], v[164:167]
  ds_read2_b32 a[112:113], v228 offset0:0 offset1:1
  ds_read2_b32 a[114:115], v228 offset0:2 offset1:3
  v_mfma_f32_16x16x32_bf16 v[160:163], a[176:179], a[232:235], v[160:163]
  ds_read_b128 a[172:175], v233 offset:0
  ds_read_b128 a[168:171], v233 offset:512
  v_mfma_f32_16x16x32_bf16 v[164:167], a[180:183], a[232:235], v[164:167]
  ds_read2_b32 a[116:117], v228 offset0:128 offset1:129
  ds_read2_b32 a[118:119], v228 offset0:130 offset1:131
  s_waitcnt lgkmcnt(15)
  v_mfma_f32_16x16x32_bf16 v[160:163], a[180:183], a[228:231], v[160:163]
  ds_read_b128 a[164:167], v233 offset:1024
  ds_read2_b32 a[120:121], v229 offset0:0 offset1:1
  v_mfma_f32_16x16x32_bf16 v[164:167], a[184:187], a[228:231], v[164:167]
  ds_read2_b32 a[122:123], v229 offset0:2 offset1:3
  ds_read_b128 a[160:163], v233 offset:1536
  v_mfma_f32_16x16x32_bf16 v[160:163], a[184:187], a[224:227], v[160:163]
  ds_read2_b32 a[124:125], v229 offset0:128 offset1:129
  ds_read2_b32 a[126:127], v229 offset0:130 offset1:131
  v_mfma_f32_16x16x32_bf16 v[164:167], a[188:191], a[224:227], v[164:167]
  ds_read_b128 a[156:159], v233 offset:2048
  ds_read2_b32 a[128:129], v230 offset0:0 offset1:1
  v_mfma_f32_16x16x32_bf16 v[160:163], a[188:191], a[220:223], v[160:163]
  ds_read2_b32 a[130:131], v230 offset0:2 offset1:3
  ds_read_b128 a[152:155], v233 offset:2560
  v_mfma_f32_16x16x32_bf16 v[164:167], a[192:195], a[220:223], v[164:167]
  ds_read2_b32 a[132:133], v230 offset0:128 offset1:129
  ds_read2_b32 a[134:135], v230 offset0:130 offset1:131
  s_waitcnt lgkmcnt(15)
  v_mfma_f32_16x16x32_bf16 v[160:163], a[192:195], a[216:219], v[160:163]
  ds_read_b128 a[148:151], v233 offset:3072
  v_mfma_f32_16x16x32_bf16 v[164:167], a[196:199], a[216:219], v[164:167]
  ds_read2_b32 a[136:137], v231 offset0:0 offset1:1
  v_mfma_f32_16x16x32_bf16 v[160:163], a[196:199], a[212:215], v[160:163]
  ds_read2_b32 a[138:139], v231 offset0:2 offset1:3
  v_mfma_f32_16x16x32_bf16 v[164:167], a[200:203], a[212:215], v[164:167]
  ds_read_b128 a[144:147], v233 offset:3584
  v_mfma_f32_16x16x32_bf16 v[160:163], a[200:203], a[208:211], v[160:163]
  ds_read2_b32 a[140:141], v231 offset0:128 offset1:129
  v_mfma_f32_16x16x32_bf16 v[164:167], a[204:207], a[208:211], v[164:167]
  ds_read2_b32 a[142:143], v231 offset0:130 offset1:131
  buffer_load_dword v252, v15, s[44:47], 0 offen sc1
  s_waitcnt lgkmcnt(15)
  v_mfma_f32_16x16x32_bf16 v[180:183], a[112:115], a[172:175], 0
  ds_read2_b32 a[176:177], v228 offset0:16 offset1:17
  ds_read2_b32 a[178:179], v228 offset0:18 offset1:19
  v_mfma_f32_16x16x32_bf16 v[176:179], a[112:115], a[168:171], 0
  ds_read_b128 a[236:239], v233 offset:64
  ds_read_b128 a[232:235], v233 offset:576
  v_mfma_f32_16x16x32_bf16 v[180:183], a[116:119], a[168:171], v[180:183]
  ds_read2_b32 a[180:181], v228 offset0:144 offset1:145
  ds_read2_b32 a[182:183], v228 offset0:146 offset1:147
  s_waitcnt lgkmcnt(15)
  v_mfma_f32_16x16x32_bf16 v[176:179], a[116:119], a[164:167], v[176:179]
  ds_read_b128 a[228:231], v233 offset:1088
  ds_read2_b32 a[184:185], v229 offset0:16 offset1:17
  v_mfma_f32_16x16x32_bf16 v[180:183], a[120:123], a[164:167], v[180:183]
  ds_read2_b32 a[186:187], v229 offset0:18 offset1:19
  ds_read_b128 a[224:227], v233 offset:1600
  v_mfma_f32_16x16x32_bf16 v[176:179], a[120:123], a[160:163], v[176:179]
  ds_read2_b32 a[188:189], v229 offset0:144 offset1:145
  ds_read2_b32 a[190:191], v229 offset0:146 offset1:147
  v_mfma_f32_16x16x32_bf16 v[180:183], a[124:127], a[160:163], v[180:183]
  ds_read_b128 a[220:223], v233 offset:2112
  ds_read2_b32 a[192:193], v230 offset0:16 offset1:17
  v_mfma_f32_16x16x32_bf16 v[176:179], a[124:127], a[156:159], v[176:179]
  ds_read2_b32 a[194:195], v230 offset0:18 offset1:19
  ds_read_b128 a[216:219], v233 offset:2624
  v_mfma_f32_16x16x32_bf16 v[180:183], a[128:131], a[156:159], v[180:183]
  ds_read2_b32 a[196:197], v230 offset0:144 offset1:145
  ds_read2_b32 a[198:199], v230 offset0:146 offset1:147
  s_waitcnt lgkmcnt(15)
  v_mfma_f32_16x16x32_bf16 v[176:179], a[128:131], a[152:155], v[176:179]
  ds_read_b128 a[212:215], v233 offset:3136
  v_mfma_f32_16x16x32_bf16 v[180:183], a[132:135], a[152:155], v[180:183]
  ds_read2_b32 a[200:201], v231 offset0:16 offset1:17
  v_mfma_f32_16x16x32_bf16 v[176:179], a[132:135], a[148:151], v[176:179]
  ds_read2_b32 a[202:203], v231 offset0:18 offset1:19
  v_mfma_f32_16x16x32_bf16 v[180:183], a[136:139], a[148:151], v[180:183]
  ds_read_b128 a[208:211], v233 offset:3648
  v_mfma_f32_16x16x32_bf16 v[176:179], a[136:139], a[144:147], v[176:179]
  ds_read2_b32 a[204:205], v231 offset0:144 offset1:145
  v_mfma_f32_16x16x32_bf16 v[180:183], a[140:143], a[144:147], v[180:183]
  ds_read2_b32 a[206:207], v231 offset0:146 offset1:147
  s_waitcnt lgkmcnt(15)
  v_mfma_f32_16x16x32_bf16 v[180:183], a[176:179], a[236:239], v[180:183]
  ds_read2_b32 a[112:113], v228 offset0:32 offset1:33
  ds_read2_b32 a[114:115], v228 offset0:34 offset1:35
  v_mfma_f32_16x16x32_bf16 v[176:179], a[176:179], a[232:235], v[176:179]
  ds_read_b128 a[172:175], v233 offset:128
  ds_read_b128 a[168:171], v233 offset:640
  v_mfma_f32_16x16x32_bf16 v[180:183], a[180:183], a[232:235], v[180:183]
  ds_read2_b32 a[116:117], v228 offset0:160 offset1:161
  ds_read2_b32 a[118:119], v228 offset0:162 offset1:163
  s_waitcnt lgkmcnt(15)
  v_mfma_f32_16x16x32_bf16 v[176:179], a[180:183], a[228:231], v[176:179]
  ds_read_b128 a[164:167], v233 offset:1152
  ds_read2_b32 a[120:121], v229 offset0:32 offset1:33
  v_mfma_f32_16x16x32_bf16 v[180:183], a[184:187], a[228:231], v[180:183]
  ds_read2_b32 a[122:123], v229 offset0:34 offset1:35
  ds_read_b128 a[160:163], v233 offset:1664
  v_mfma_f32_16x16x32_bf16 v[176:179], a[184:187], a[224:227], v[176:179]
  ds_read2_b32 a[124:125], v229 offset0:160 offset1:161
  ds_read2_b32 a[126:127], v229 offset0:162 offset1:163
  v_mfma_f32_16x16x32_bf16 v[180:183], a[188:191], a[224:227], v[180:183]
  ds_read_b128 a[156:159], v233 offset:2176
  ds_read2_b32 a[128:129], v230 offset0:32 offset1:33
  v_mfma_f32_16x16x32_bf16 v[176:179], a[188:191], a[220:223], v[176:179]
  ds_read2_b32 a[130:131], v230 offset0:34 offset1:35
  ds_read_b128 a[152:155], v233 offset:2688
  v_mfma_f32_16x16x32_bf16 v[180:183], a[192:195], a[220:223], v[180:183]
  ds_read2_b32 a[132:133], v230 offset0:160 offset1:161
  ds_read2_b32 a[134:135], v230 offset0:162 offset1:163
  s_waitcnt lgkmcnt(15)
  v_mfma_f32_16x16x32_bf16 v[176:179], a[192:195], a[216:219], v[176:179]
  ds_read_b128 a[148:151], v233 offset:3200
  v_mfma_f32_16x16x32_bf16 v[180:183], a[196:199], a[216:219], v[180:183]
  ds_read2_b32 a[136:137], v231 offset0:32 offset1:33
  v_mfma_f32_16x16x32_bf16 v[176:179], a[196:199], a[212:215], v[176:179]
  ds_read2_b32 a[138:139], v231 offset0:34 offset1:35
  v_mfma_f32_16x16x32_bf16 v[180:183], a[200:203], a[212:215], v[180:183]
  ds_read_b128 a[144:147], v233 offset:3712
  v_mfma_f32_16x16x32_bf16 v[176:179], a[200:203], a[208:211], v[176:179]
  ds_read2_b32 a[140:141], v231 offset0:160 offset1:161
  v_mfma_f32_16x16x32_bf16 v[180:183], a[204:207], a[208:211], v[180:183]
  ds_read2_b32 a[142:143], v231 offset0:162 offset1:163
  s_waitcnt lgkmcnt(15)
  v_mfma_f32_16x16x32_bf16 v[180:183], a[112:115], a[172:175], v[180:183]
  ds_read2_b32 a[176:177], v228 offset0:48 offset1:49
  ds_read2_b32 a[178:179], v228 offset0:50 offset1:51
  v_mfma_f32_16x16x32_bf16 v[176:179], a[112:115], a[168:171], v[176:179]
  ds_read_b128 a[236:239], v233 offset:192
  ds_read_b128 a[232:235], v233 offset:704
  v_mfma_f32_16x16x32_bf16 v[180:183], a[116:119], a[168:171], v[180:183]
  ds_read2_b32 a[180:181], v228 offset0:176 offset1:177
  ds_read2_b32 a[182:183], v228 offset0:178 offset1:179
  s_waitcnt lgkmcnt(15)
  v_mfma_f32_16x16x32_bf16 v[176:179], a[116:119], a[164:167], v[176:179]
  ds_read_b128 a[228:231], v233 offset:1216
  ds_read2_b32 a[184:185], v229 offset0:48 offset1:49
  v_mfma_f32_16x16x32_bf16 v[180:183], a[120:123], a[164:167], v[180:183]
  ds_read2_b32 a[186:187], v229 offset0:50 offset1:51
  ds_read_b128 a[224:227], v233 offset:1728
  v_mfma_f32_16x16x32_bf16 v[176:179], a[120:123], a[160:163], v[176:179]
  ds_read2_b32 a[188:189], v229 offset0:176 offset1:177
  ds_read2_b32 a[190:191], v229 offset0:178 offset1:179
  v_mfma_f32_16x16x32_bf16 v[180:183], a[124:127], a[160:163], v[180:183]
  ds_read_b128 a[220:223], v233 offset:2240
  ds_read2_b32 a[192:193], v230 offset0:48 offset1:49
  v_mfma_f32_16x16x32_bf16 v[176:179], a[124:127], a[156:159], v[176:179]
  ds_read2_b32 a[194:195], v230 offset0:50 offset1:51
  ds_read_b128 a[216:219], v233 offset:2752
  v_mfma_f32_16x16x32_bf16 v[180:183], a[128:131], a[156:159], v[180:183]
  ds_read2_b32 a[196:197], v230 offset0:176 offset1:177
  ds_read2_b32 a[198:199], v230 offset0:178 offset1:179
  s_waitcnt lgkmcnt(15)
  v_mfma_f32_16x16x32_bf16 v[176:179], a[128:131], a[152:155], v[176:179]
  ds_read_b128 a[212:215], v233 offset:3264
  v_mfma_f32_16x16x32_bf16 v[180:183], a[132:135], a[152:155], v[180:183]
  ds_read2_b32 a[200:201], v231 offset0:48 offset1:49
  v_mfma_f32_16x16x32_bf16 v[176:179], a[132:135], a[148:151], v[176:179]
  ds_read2_b32 a[202:203], v231 offset0:50 offset1:51
  v_mfma_f32_16x16x32_bf16 v[180:183], a[136:139], a[148:151], v[180:183]
  ds_read_b128 a[208:211], v233 offset:3776
  v_mfma_f32_16x16x32_bf16 v[176:179], a[136:139], a[144:147], v[176:179]
  ds_read2_b32 a[204:205], v231 offset0:176 offset1:177
  v_mfma_f32_16x16x32_bf16 v[180:183], a[140:143], a[144:147], v[180:183]
  ds_read2_b32 a[206:207], v231 offset0:178 offset1:179
  s_waitcnt lgkmcnt(15)
  v_mfma_f32_16x16x32_bf16 v[180:183], a[176:179], a[236:239], v[180:183]
  ds_read2_b32 a[112:113], v228 offset0:64 offset1:65
  ds_read2_b32 a[114:115], v228 offset0:66 offset1:67
  v_mfma_f32_16x16x32_bf16 v[176:179], a[176:179], a[232:235], v[176:179]
  ds_read_b128 a[172:175], v233 offset:256
  ds_read_b128 a[168:171], v233 offset:768
  v_mfma_f32_16x16x32_bf16 v[180:183], a[180:183], a[232:235], v[180:183]
  ds_read2_b32 a[116:117], v228 offset0:192 offset1:193
  ds_read2_b32 a[118:119], v228 offset0:194 offset1:195
  s_waitcnt lgkmcnt(15)
  v_mfma_f32_16x16x32_bf16 v[176:179], a[180:183], a[228:231], v[176:179]
  ds_read_b128 a[164:167], v233 offset:1280
  ds_read2_b32 a[120:121], v229 offset0:64 offset1:65
  v_mfma_f32_16x16x32_bf16 v[180:183], a[184:187], a[228:231], v[180:183]
  ds_read2_b32 a[122:123], v229 offset0:66 offset1:67
  ds_read_b128 a[160:163], v233 offset:1792
  v_mfma_f32_16x16x32_bf16 v[176:179], a[184:187], a[224:227], v[176:179]
  ds_read2_b32 a[124:125], v229 offset0:192 offset1:193
  ds_read2_b32 a[126:127], v229 offset0:194 offset1:195
  v_mfma_f32_16x16x32_bf16 v[180:183], a[188:191], a[224:227], v[180:183]
  ds_read_b128 a[156:159], v233 offset:2304
  ds_read2_b32 a[128:129], v230 offset0:64 offset1:65
  v_mfma_f32_16x16x32_bf16 v[176:179], a[188:191], a[220:223], v[176:179]
  ds_read2_b32 a[130:131], v230 offset0:66 offset1:67
  ds_read_b128 a[152:155], v233 offset:2816
  v_mfma_f32_16x16x32_bf16 v[180:183], a[192:195], a[220:223], v[180:183]
  ds_read2_b32 a[132:133], v230 offset0:192 offset1:193
  ds_read2_b32 a[134:135], v230 offset0:194 offset1:195
  s_waitcnt lgkmcnt(15)
  v_mfma_f32_16x16x32_bf16 v[176:179], a[192:195], a[216:219], v[176:179]
  ds_read_b128 a[148:151], v233 offset:3328
  v_mfma_f32_16x16x32_bf16 v[180:183], a[196:199], a[216:219], v[180:183]
  ds_read2_b32 a[136:137], v231 offset0:64 offset1:65
  v_mfma_f32_16x16x32_bf16 v[176:179], a[196:199], a[212:215], v[176:179]
  ds_read2_b32 a[138:139], v231 offset0:66 offset1:67
  v_mfma_f32_16x16x32_bf16 v[180:183], a[200:203], a[212:215], v[180:183]
  ds_read_b128 a[144:147], v233 offset:3840
  v_mfma_f32_16x16x32_bf16 v[176:179], a[200:203], a[208:211], v[176:179]
  ds_read2_b32 a[140:141], v231 offset0:192 offset1:193
  v_mfma_f32_16x16x32_bf16 v[180:183], a[204:207], a[208:211], v[180:183]
  ds_read2_b32 a[142:143], v231 offset0:194 offset1:195
  s_waitcnt vmcnt(0)
  v_subrev_u32 v253, s78, v252
  v_cmp_eq_u32 vcc, 4, v253
  s_nop 1
  s_lshr_b32 s20, vcc_lo, 16
  s_and_b32 s20, s20, vcc_lo
  s_lshr_b32 s23, s20, 1
  s_and_b32 s20, s20, s23
  s_and_b32 s20, s20, s57
  s_andn2_b32 s57, s57, s20
  s_or_b32 s56, s56, s20
  buffer_load_dword v252, v15, s[44:47], 0 offen sc1
  v_dot2_f32_bf16 v192, v16, s54, 0
  v_dot2_f32_bf16 v193, v16, s55, 0
  v_dot2_f32_bf16 v194, v17, s54, 0
  v_dot2_f32_bf16 v195, v17, s55, 0
  v_dot2_f32_bf16 v196, v18, s54, 0
  v_dot2_f32_bf16 v197, v18, s55, 0
  v_dot2_f32_bf16 v198, v19, s54, 0
  v_dot2_f32_bf16 v199, v19, s55, 0
  v_dot2_f32_bf16 v200, v20, s54, 0
  v_dot2_f32_bf16 v201, v20, s55, 0
  v_dot2_f32_bf16 v202, v21, s54, 0
  v_dot2_f32_bf16 v203, v21, s55, 0
  v_dot2_f32_bf16 v204, v22, s54, 0
  v_dot2_f32_bf16 v205, v22, s55, 0
  v_dot2_f32_bf16 v206, v23, s54, 0
  v_dot2_f32_bf16 v207, v23, s55, 0
  s_andn2_b32 s61, s61, 1
  s_waitcnt lgkmcnt(15)
  v_mfma_f32_16x16x32_bf16 v[180:183], a[112:115], a[172:175], v[180:183]
  ds_read2_b32 a[176:177], v228 offset0:80 offset1:81
  ds_read2_b32 a[178:179], v228 offset0:82 offset1:83
  s_ff1_i32_b32 s20, s56
  s_bitset0_b32 s56, s20
  s_cmp_lt_i32 s20, 0
  s_mul_i32 s20, s20, 2508800
  s_cselect_b32 s20, 0x40000000, s20
  s_cselect_b32 s62, 0, 32
  s_or_b32 s61, s61, s62
  s_add_u32 s23, s20, s76
  buffer_load_dwordx4 v[96:99], v3, s[44:47], s23 offen sc1
  v_mfma_f32_16x16x32_bf16 v[176:179], a[112:115], a[168:171], v[176:179]
  ds_read_b128 a[236:239], v233 offset:320
  ds_read_b128 a[232:235], v233 offset:832
  s_add_u32 s23, s20, s77
  buffer_load_dwordx4 v[100:103], v3, s[44:47], s23 offen sc1
  v_mfma_f32_16x16x32_bf16 v[180:183], a[116:119], a[168:171], v[180:183]
  ds_read2_b32 a[180:181], v228 offset0:208 offset1:209
  ds_read2_b32 a[182:183], v228 offset0:210 offset1:211
  s_ff1_i32_b32 s20, s56
  s_bitset0_b32 s56, s20
  s_cmp_lt_i32 s20, 0
  s_mul_i32 s20, s20, 2508800
  s_cselect_b32 s20, 0x40000000, s20
  s_cselect_b32 s62, 0, 64
  s_or_b32 s61, s61, s62
  s_add_u32 s23, s20, s76
  buffer_load_dwordx4 v[112:115], v3, s[44:47], s23 offen sc1
  s_waitcnt lgkmcnt(15)
  v_mfma_f32_16x16x32_bf16 v[176:179], a[116:119], a[164:167], v[176:179]
  ds_read_b128 a[228:231], v233 offset:1344
  ds_read2_b32 a[184:185], v229 offset0:80 offset1:81
  s_add_u32 s23, s20, s77
  buffer_load_dwordx4 v[116:119], v3, s[44:47], s23 offen sc1
  v_mfma_f32_16x16x32_bf16 v[180:183], a[120:123], a[164:167], v[180:183]
  ds_read2_b32 a[186:187], v229 offset0:82 offset1:83
  ds_read_b128 a[224:227], v233 offset:1856
  v_mfma_f32_16x16x32_bf16 v[176:179], a[120:123], a[160:163], v[176:179]
  ds_read2_b32 a[188:189], v229 offset0:208 offset1:209
  ds_read2_b32 a[190:191], v229 offset0:210 offset1:211
  v_mfma_f32_16x16x32_bf16 v[180:183], a[124:127], a[160:163], v[180:183]
  ds_read_b128 a[220:223], v233 offset:2368
  ds_read2_b32 a[192:193], v230 offset0:80 offset1:81
  v_mfma_f32_16x16x32_bf16 v[176:179], a[124:127], a[156:159], v[176:179]
  ds_read2_b32 a[194:195], v230 offset0:82 offset1:83
  ds_read_b128 a[216:219], v233 offset:2880
  v_mfma_f32_16x16x32_bf16 v[180:183], a[128:131], a[156:159], v[180:183]
  ds_read2_b32 a[196:197], v230 offset0:208 offset1:209
  ds_read2_b32 a[198:199], v230 offset0:210 offset1:211
  s_waitcnt lgkmcnt(15)
  v_mfma_f32_16x16x32_bf16 v[176:179], a[128:131], a[152:155], v[176:179]
  ds_read_b128 a[212:215], v233 offset:3392
  v_mfma_f32_16x16x32_bf16 v[180:183], a[132:135], a[152:155], v[180:183]
  ds_read2_b32 a[200:201], v231 offset0:80 offset1:81
  v_mfma_f32_16x16x32_bf16 v[176:179], a[132:135], a[148:151], v[176:179]
  ds_read2_b32 a[202:203], v231 offset0:82 offset1:83
  v_mfma_f32_16x16x32_bf16 v[180:183], a[136:139], a[148:151], v[180:183]
  ds_read_b128 a[208:211], v233 offset:3904
  v_mfma_f32_16x16x32_bf16 v[176:179], a[136:139], a[144:147], v[176:179]
  ds_read2_b32 a[204:205], v231 offset0:208 offset1:209
  v_mfma_f32_16x16x32_bf16 v[180:183], a[140:143], a[144:147], v[180:183]
  ds_read2_b32 a[206:207], v231 offset0:210 offset1:211
  v_dot2_f32_bf16 v192, v32, s54, v192
  v_dot2_f32_bf16 v193, v32, s55, v193
  v_dot2_f32_bf16 v194, v33, s54, v194
  v_dot2_f32_bf16 v195, v33, s55, v195
  v_dot2_f32_bf16 v196, v34, s54, v196
  v_dot2_f32_bf16 v197, v34, s55, v197
  v_dot2_f32_bf16 v198, v35, s54, v198
  v_dot2_f32_bf16 v199, v35, s55, v199
  v_dot2_f32_bf16 v200, v36, s54, v200
  v_dot2_f32_bf16 v201, v36, s55, v201
  v_dot2_f32_bf16 v202, v37, s54, v202
  v_dot2_f32_bf16 v203, v37, s55, v203
  v_dot2_f32_bf16 v204, v38, s54, v204
  v_dot2_f32_bf16 v205, v38, s55, v205
  v_dot2_f32_bf16 v206, v39, s54, v206
  v_dot2_f32_bf16 v207, v39, s55, v207
  v_dot2_f32_bf16 v192, v48, s54, v192
  v_dot2_f32_bf16 v193, v48, s55, v193
  v_dot2_f32_bf16 v194, v49, s54, v194
  v_dot2_f32_bf16 v195, v49, s55, v195
  v_dot2_f32_bf16 v196, v50, s54, v196
  v_dot2_f32_bf16 v197, v50, s55, v197
  v_dot2_f32_bf16 v198, v51, s54, v198
  v_dot2_f32_bf16 v199, v51, s55, v199
  v_dot2_f32_bf16 v200, v52, s54, v200
  v_dot2_f32_bf16 v201, v52, s55, v201
  v_dot2_f32_bf16 v202, v53, s54, v202
  v_dot2_f32_bf16 v203, v53, s55, v203
  v_dot2_f32_bf16 v204, v54, s54, v204
  v_dot2_f32_bf16 v205, v54, s55, v205
  v_dot2_f32_bf16 v206, v55, s54, v206
  v_dot2_f32_bf16 v207, v55, s55, v207
  s_andn2_b32 s61, s61, 6
  s_waitcnt lgkmcnt(15)
  v_mfma_f32_16x16x32_bf16 v[180:183], a[176:179], a[236:239], v[180:183]
  ds_read2_b32 a[112:113], v228 offset0:96 offset1:97
  ds_read2_b32 a[114:115], v228 offset0:98 offset1:99
  v_mfma_f32_16x16x32_bf16 v[176:179], a[176:179], a[232:235], v[176:179]
  ds_read_b128 a[172:175], v233 offset:384
  ds_read_b128 a[168:171], v233 offset:896
  v_mfma_f32_16x16x32_bf16 v[180:183], a[180:183], a[232:235], v[180:183]
  ds_read2_b32 a[116:117], v228 offset0:224 offset1:225
  ds_read2_b32 a[118:119], v228 offset0:226 offset1:227
  s_waitcnt lgkmcnt(15)
  v_mfma_f32_16x16x32_bf16 v[176:179], a[180:183], a[228:231], v[176:179]
  ds_read_b128 a[164:167], v233 offset:1408
  ds_read2_b32 a[120:121], v229 offset0:96 offset1:97
  v_mfma_f32_16x16x32_bf16 v[180:183], a[184:187], a[228:231], v[180:183]
  ds_read2_b32 a[122:123], v229 offset0:98 offset1:99
  ds_read_b128 a[160:163], v233 offset:1920
  v_mfma_f32_16x16x32_bf16 v[176:179], a[184:187], a[224:227], v[176:179]
  ds_read2_b32 a[124:125], v229 offset0:224 offset1:225
  ds_read2_b32 a[126:127], v229 offset0:226 offset1:227
  v_mfma_f32_16x16x32_bf16 v[180:183], a[188:191], a[224:227], v[180:183]
  ds_read_b128 a[156:159], v233 offset:2432
  ds_read2_b32 a[128:129], v230 offset0:96 offset1:97
  v_mfma_f32_16x16x32_bf16 v[176:179], a[188:191], a[220:223], v[176:179]
  ds_read2_b32 a[130:131], v230 offset0:98 offset1:99
  ds_read_b128 a[152:155], v233 offset:2944
  v_mfma_f32_16x16x32_bf16 v[180:183], a[192:195], a[220:223], v[180:183]
  ds_read2_b32 a[132:133], v230 offset0:224 offset1:225
  ds_read2_b32 a[134:135], v230 offset0:226 offset1:227
  s_waitcnt lgkmcnt(15)
  v_mfma_f32_16x16x32_bf16 v[176:179], a[192:195], a[216:219], v[176:179]
  ds_read_b128 a[148:151], v233 offset:3456
  v_mfma_f32_16x16x32_bf16 v[180:183], a[196:199], a[216:219], v[180:183]
  ds_read2_b32 a[136:137], v231 offset0:96 offset1:97
  v_mfma_f32_16x16x32_bf16 v[176:179], a[196:199], a[212:215], v[176:179]
  ds_read2_b32 a[138:139], v231 offset0:98 offset1:99
  v_mfma_f32_16x16x32_bf16 v[180:183], a[200:203], a[212:215], v[180:183]
  ds_read_b128 a[144:147], v233 offset:3968
  v_mfma_f32_16x16x32_bf16 v[176:179], a[200:203], a[208:211], v[176:179]
  ds_read2_b32 a[140:141], v231 offset0:224 offset1:225
  v_mfma_f32_16x16x32_bf16 v[180:183], a[204:207], a[208:211], v[180:183]
  ds_read2_b32 a[142:143], v231 offset0:226 offset1:227
  v_dot2_f32_bf16 v192, v64, s54, v192
  v_dot2_f32_bf16 v193, v64, s55, v193
  v_dot2_f32_bf16 v194, v65, s54, v194
  v_dot2_f32_bf16 v195, v65, s55, v195
  v_dot2_f32_bf16 v196, v66, s54, v196
  v_dot2_f32_bf16 v197, v66, s55, v197
  v_dot2_f32_bf16 v198, v67, s54, v198
  v_dot2_f32_bf16 v199, v67, s55, v199
  v_dot2_f32_bf16 v200, v68, s54, v200
  v_dot2_f32_bf16 v201, v68, s55, v201
  v_dot2_f32_bf16 v202, v69, s54, v202
  v_dot2_f32_bf16 v203, v69, s55, v203
  v_dot2_f32_bf16 v204, v70, s54, v204
  v_dot2_f32_bf16 v205, v70, s55, v205
  v_dot2_f32_bf16 v206, v71, s54, v206
  v_dot2_f32_bf16 v207, v71, s55, v207
  v_dot2_f32_bf16 v192, v80, s54, v192
  v_dot2_f32_bf16 v193, v80, s55, v193
  v_dot2_f32_bf16 v194, v81, s54, v194
  v_dot2_f32_bf16 v195, v81, s55, v195
  v_dot2_f32_bf16 v196, v82, s54, v196
  v_dot2_f32_bf16 v197, v82, s55, v197
  v_dot2_f32_bf16 v198, v83, s54, v198
  v_dot2_f32_bf16 v199, v83, s55, v199
  v_dot2_f32_bf16 v200, v84, s54, v200
  v_dot2_f32_bf16 v201, v84, s55, v201
  v_dot2_f32_bf16 v202, v85, s54, v202
  v_dot2_f32_bf16 v203, v85, s55, v203
  v_dot2_f32_bf16 v204, v86, s54, v204
  v_dot2_f32_bf16 v205, v86, s55, v205
  v_dot2_f32_bf16 v206, v87, s54, v206
  v_dot2_f32_bf16 v207, v87, s55, v207
  v_mul_f32 v244, v241, v241
  v_mul_f32 v241, v241, v244
  v_mul_f32 v244, 0xbfb8aa3b, v244
  v_lshlrev_b32 v24, 16, v144
  v_and_b32 v25, 0xffff0000, v144
  v_pk_add_f32 v[24:25], v[24:25], v[240:241] op_sel_hi:[1,0] neg_lo:[0,1] neg_hi:[0,1]
  v_pk_mul_f32 v[24:25], v[24:25], v[240:241] op_sel:[0,1] op_sel_hi:[1,1]
  v_lshlrev_b32 v26, 16, v145
  v_and_b32 v27, 0xffff0000, v145
  v_pk_add_f32 v[26:27], v[26:27], v[240:241] op_sel_hi:[1,0] neg_lo:[0,1] neg_hi:[0,1]
  v_pk_mul_f32 v[26:27], v[26:27], v[240:241] op_sel:[0,1] op_sel_hi:[1,1]
  v_lshlrev_b32 v28, 16, v146
  v_and_b32 v29, 0xffff0000, v146
  v_pk_add_f32 v[28:29], v[28:29], v[240:241] op_sel_hi:[1,0] neg_lo:[0,1] neg_hi:[0,1]
  v_pk_mul_f32 v[28:29], v[28:29], v[240:241] op_sel:[0,1] op_sel_hi:[1,1]
  v_lshlrev_b32 v30, 16, v147
  v_and_b32 v31, 0xffff0000, v147
  v_pk_add_f32 v[30:31], v[30:31], v[240:241] op_sel_hi:[1,0] neg_lo:[0,1] neg_hi:[0,1]
  v_pk_mul_f32 v[30:31], v[30:31], v[240:241] op_sel:[0,1] op_sel_hi:[1,1]
  v_mul_f32 v245, v243, v243
  v_mul_f32 v243, v243, v245
  v_mul_f32 v245, 0xbfb8aa3b, v245
  v_lshlrev_b32 v40, 16, v148
  v_and_b32 v41, 0xffff0000, v148
  v_pk_add_f32 v[40:41], v[40:41], v[242:243] op_sel_hi:[1,0] neg_lo:[0,1] neg_hi:[0,1]
  v_pk_mul_f32 v[40:41], v[40:41], v[242:243] op_sel:[0,1] op_sel_hi:[1,1]
  v_lshlrev_b32 v42, 16, v149
  v_and_b32 v43, 0xffff0000, v149
  v_pk_add_f32 v[42:43], v[42:43], v[242:243] op_sel_hi:[1,0] neg_lo:[0,1] neg_hi:[0,1]
  v_pk_mul_f32 v[42:43], v[42:43], v[242:243] op_sel:[0,1] op_sel_hi:[1,1]
  v_lshlrev_b32 v44, 16, v150
  v_and_b32 v45, 0xffff0000, v150
  v_pk_add_f32 v[44:45], v[44:45], v[242:243] op_sel_hi:[1,0] neg_lo:[0,1] neg_hi:[0,1]
  v_pk_mul_f32 v[44:45], v[44:45], v[242:243] op_sel:[0,1] op_sel_hi:[1,1]
  v_lshlrev_b32 v46, 16, v151
  v_and_b32 v47, 0xffff0000, v151
  v_pk_add_f32 v[46:47], v[46:47], v[242:243] op_sel_hi:[1,0] neg_lo:[0,1] neg_hi:[0,1]
  v_pk_mul_f32 v[46:47], v[46:47], v[242:243] op_sel:[0,1] op_sel_hi:[1,1]
  s_andn2_b32 s61, s61, 24
  s_waitcnt lgkmcnt(15)
  v_mfma_f32_16x16x32_bf16 v[180:183], a[112:115], a[172:175], v[180:183]
  ds_read2_b32 a[176:177], v228 offset0:112 offset1:113
  ds_read2_b32 a[178:179], v228 offset0:114 offset1:115
  v_mfma_f32_16x16x32_bf16 v[176:179], a[112:115], a[168:171], v[176:179]
  ds_read_b128 a[236:239], v233 offset:448
  ds_read_b128 a[232:235], v233 offset:960
  v_mfma_f32_16x16x32_bf16 v[180:183], a[116:119], a[168:171], v[180:183]
  ds_read2_b32 a[180:181], v228 offset0:240 offset1:241
  ds_read2_b32 a[182:183], v228 offset0:242 offset1:243
  s_waitcnt lgkmcnt(15)
  v_mfma_f32_16x16x32_bf16 v[176:179], a[116:119], a[164:167], v[176:179]
  ds_read_b128 a[228:231], v233 offset:1472
  ds_read2_b32 a[184:185], v229 offset0:112 offset1:113
  v_mfma_f32_16x16x32_bf16 v[180:183], a[120:123], a[164:167], v[180:183]
  ds_read2_b32 a[186:187], v229 offset0:114 offset1:115
  ds_read_b128 a[224:227], v233 offset:1984
  v_mfma_f32_16x16x32_bf16 v[176:179], a[120:123], a[160:163], v[176:179]
  ds_read2_b32 a[188:189], v229 offset0:240 offset1:241
  ds_read2_b32 a[190:191], v229 offset0:242 offset1:243
  v_mfma_f32_16x16x32_bf16 v[180:183], a[124:127], a[160:163], v[180:183]
  ds_read_b128 a[220:223], v233 offset:2496
  ds_read2_b32 a[192:193], v230 offset0:112 offset1:113
  v_mfma_f32_16x16x32_bf16 v[176:179], a[124:127], a[156:159], v[176:179]
  ds_read2_b32 a[194:195], v230 offset0:114 offset1:115
  ds_read_b128 a[216:219], v233 offset:3008
  v_mfma_f32_16x16x32_bf16 v[180:183], a[128:131], a[156:159], v[180:183]
  ds_read2_b32 a[196:197], v230 offset0:240 offset1:241
  ds_read2_b32 a[198:199], v230 offset0:242 offset1:243
  s_waitcnt lgkmcnt(15)
  v_mfma_f32_16x16x32_bf16 v[176:179], a[128:131], a[152:155], v[176:179]
  ds_read_b128 a[212:215], v233 offset:3520
  v_mfma_f32_16x16x32_bf16 v[180:183], a[132:135], a[152:155], v[180:183]
  ds_read2_b32 a[200:201], v231 offset0:112 offset1:113
  v_mfma_f32_16x16x32_bf16 v[176:179], a[132:135], a[148:151], v[176:179]
  ds_read2_b32 a[202:203], v231 offset0:114 offset1:115
  v_mfma_f32_16x16x32_bf16 v[180:183], a[136:139], a[148:151], v[180:183]
  ds_read_b128 a[208:211], v233 offset:4032
  v_mfma_f32_16x16x32_bf16 v[176:179], a[136:139], a[144:147], v[176:179]
  ds_read2_b32 a[204:205], v231 offset0:240 offset1:241
  v_mfma_f32_16x16x32_bf16 v[180:183], a[140:143], a[144:147], v[180:183]
  ds_read2_b32 a[206:207], v231 offset0:242 offset1:243
  s_waitcnt lgkmcnt(15)
  v_mfma_f32_16x16x32_bf16 v[180:183], a[176:179], a[236:239], v[180:183]
  v_mfma_f32_16x16x32_bf16 v[176:179], a[176:179], a[232:235], v[176:179]
  v_mfma_f32_16x16x32_bf16 v[180:183], a[180:183], a[232:235], v[180:183]
  s_waitcnt lgkmcnt(14)
  v_mfma_f32_16x16x32_bf16 v[176:179], a[180:183], a[228:231], v[176:179]
  v_mfma_f32_16x16x32_bf16 v[180:183], a[184:187], a[228:231], v[180:183]
  v_mfma_f32_16x16x32_bf16 v[176:179], a[184:187], a[224:227], v[176:179]
  s_waitcnt lgkmcnt(9)
  v_mfma_f32_16x16x32_bf16 v[180:183], a[188:191], a[224:227], v[180:183]
  v_mfma_f32_16x16x32_bf16 v[176:179], a[188:191], a[220:223], v[176:179]
  v_mfma_f32_16x16x32_bf16 v[180:183], a[192:195], a[220:223], v[180:183]
  s_waitcnt lgkmcnt(5)
  v_mfma_f32_16x16x32_bf16 v[176:179], a[192:195], a[216:219], v[176:179]
  v_mfma_f32_16x16x32_bf16 v[180:183], a[196:199], a[216:219], v[180:183]
  v_mfma_f32_16x16x32_bf16 v[176:179], a[196:199], a[212:215], v[176:179]
  s_waitcnt lgkmcnt(0)
  v_mfma_f32_16x16x32_bf16 v[180:183], a[200:203], a[212:215], v[180:183]
  v_mfma_f32_16x16x32_bf16 v[176:179], a[200:203], a[208:211], v[176:179]
  v_mfma_f32_16x16x32_bf16 v[180:183], a[204:207], a[208:211], v[180:183]
  s_waitcnt vmcnt(4)
  v_subrev_u32 v253, s78, v252
  v_cmp_eq_u32 vcc, 4, v253
  s_nop 1
  s_lshr_b32 s20, vcc_lo, 16
  s_and_b32 s20, s20, vcc_lo
  s_lshr_b32 s23, s20, 1
  s_and_b32 s20, s20, s23
  s_and_b32 s20, s20, s57
  s_andn2_b32 s57, s57, s20
  s_or_b32 s56, s56, s20
  buffer_load_dword v252, v15, s[44:47], 0 offen sc1
  s_ff1_i32_b32 s20, s56
  s_bitset0_b32 s56, s20
  s_cmp_lt_i32 s20, 0
  s_mul_i32 s20, s20, 2508800
  s_cselect_b32 s20, 0x40000000, s20
  s_cselect_b32 s62, 0, 128
  s_or_b32 s61, s61, s62
  s_add_u32 s23, s20, s76
  buffer_load_dwordx4 v[128:131], v3, s[44:47], s23 offen sc1
  s_add_u32 s23, s20, s77
  buffer_load_dwordx4 v[132:135], v3, s[44:47], s23 offen sc1
  ds_read_b64 v[208:209], v234 offset:512
  ds_read_b64 v[210:211], v234 offset:0
  ds_read_b64 v[212:213], v235 offset:512
  ds_read_b64 v[214:215], v235 offset:0
  v_lshlrev_b32 v8, 16, v8
  v_lshlrev_b32 v10, 16, v10
  s_waitcnt lgkmcnt(3)
  v_and_b32 v248, 0xffff0000, v209
  v_lshlrev_b32 v249, 16, v209
  v_and_b32 v250, 0xffff0000, v208
  v_lshlrev_b32 v251, 16, v208
  v_pk_fma_f32 v[160:161], v[248:249], v[8:9], v[160:161] op_sel_hi:[1,0,1]
  v_pk_fma_f32 v[162:163], v[250:251], v[8:9], v[162:163] op_sel_hi:[1,0,1]
  v_cvt_pk_bf16_f32 v208, v160, v161
  v_cvt_pk_bf16_f32 v209, v162, v163
  ds_write_b64 v236, v[208:209] offset:0
  s_waitcnt lgkmcnt(3)
  v_and_b32 v248, 0xffff0000, v211
  v_lshlrev_b32 v249, 16, v211
  v_and_b32 v250, 0xffff0000, v210
  v_lshlrev_b32 v251, 16, v210
  v_pk_fma_f32 v[164:165], v[248:249], v[8:9], v[164:165] op_sel_hi:[1,0,1]
  v_pk_fma_f32 v[166:167], v[250:251], v[8:9], v[166:167] op_sel_hi:[1,0,1]
  v_cvt_pk_bf16_f32 v210, v164, v165
  v_cvt_pk_bf16_f32 v211, v166, v167
  ds_write_b64 v236, v[210:211] offset:512
  s_waitcnt lgkmcnt(3)
  v_and_b32 v248, 0xffff0000, v213
  v_lshlrev_b32 v249, 16, v213
  v_and_b32 v250, 0xffff0000, v212
  v_lshlrev_b32 v251, 16, v212
  v_pk_fma_f32 v[176:177], v[248:249], v[10:11], v[176:177] op_sel_hi:[1,0,1]
  v_pk_fma_f32 v[178:179], v[250:251], v[10:11], v[178:179] op_sel_hi:[1,0,1]
  v_cvt_pk_bf16_f32 v212, v176, v177
  v_cvt_pk_bf16_f32 v213, v178, v179
  ds_write_b64 v236, v[212:213] offset:2112
  s_waitcnt lgkmcnt(3)
  v_and_b32 v248, 0xffff0000, v215
  v_lshlrev_b32 v249, 16, v215
  v_and_b32 v250, 0xffff0000, v214
  v_lshlrev_b32 v251, 16, v214
  v_pk_fma_f32 v[180:181], v[248:249], v[10:11], v[180:181] op_sel_hi:[1,0,1]
  v_pk_fma_f32 v[182:183], v[250:251], v[10:11], v[182:183] op_sel_hi:[1,0,1]
  v_cvt_pk_bf16_f32 v214, v180, v181
  v_cvt_pk_bf16_f32 v215, v182, v183
  ds_write_b64 v236, v[214:215] offset:2624
  s_waitcnt lgkmcnt(0)
  s_barrier
  ds_read_b64_tr_b16 v[216:217], v237 offset:0
  ds_read_b64_tr_b16 v[218:219], v237 offset:8448
  ds_read_b64_tr_b16 v[220:221], v237 offset:128
  ds_read_b64_tr_b16 v[222:223], v237 offset:8576
  s_waitcnt lgkmcnt(2)
  v_lshlrev_b32 v254, 16, v216
  v_and_b32 v255, 0xffff0000, v216
  v_pk_mul_f32 v[24:25], v[24:25], v[254:255]
  v_lshlrev_b32 v254, 16, v217
  v_and_b32 v255, 0xffff0000, v217
  v_pk_mul_f32 v[26:27], v[26:27], v[254:255]
  v_lshlrev_b32 v254, 16, v218
  v_and_b32 v255, 0xffff0000, v218
  v_pk_mul_f32 v[28:29], v[28:29], v[254:255]
  v_lshlrev_b32 v254, 16, v219
  v_and_b32 v255, 0xffff0000, v219
  v_pk_mul_f32 v[30:31], v[30:31], v[254:255]
  s_waitcnt lgkmcnt(0)
  v_lshlrev_b32 v254, 16, v220
  v_and_b32 v255, 0xffff0000, v220
  v_pk_mul_f32 v[40:41], v[40:41], v[254:255]
  v_lshlrev_b32 v254, 16, v221
  v_and_b32 v255, 0xffff0000, v221
  v_pk_mul_f32 v[42:43], v[42:43], v[254:255]
  v_lshlrev_b32 v254, 16, v222
  v_and_b32 v255, 0xffff0000, v222
  v_pk_mul_f32 v[44:45], v[44:45], v[254:255]
  v_lshlrev_b32 v254, 16, v223
  v_and_b32 v255, 0xffff0000, v223
  v_pk_mul_f32 v[46:47], v[46:47], v[254:255]
KF_loop2:
  s_waitcnt vmcnt(0)
  s_mov_b32 s59, s61
  s_mov_b32 s61, 0
  s_or_b32 s20, s56, s57
  s_cmp_eq_u32 s20, 0
  s_cbranch_scc1 KF_acc2
  s_add_u32 s63, s63, 1
  s_cmp_ge_u32 s63, 0x40000
  s_cbranch_scc1 KF_sum2
  v_subrev_u32 v253, s78, v252
  v_cmp_eq_u32 vcc, 4, v253
  s_nop 1
  s_lshr_b32 s20, vcc_lo, 16
  s_and_b32 s20, s20, vcc_lo
  s_lshr_b32 s23, s20, 1
  s_and_b32 s20, s20, s23
  s_and_b32 s20, s20, s57
  s_andn2_b32 s57, s57, s20
  s_or_b32 s56, s56, s20
  buffer_load_dword v252, v15, s[44:47], 0 offen sc1
  s_cmp_eq_u32 s56, 0
  s_cbranch_scc1 KF_acc2
  s_bitcmp1_b32 s59, 0
  s_cbranch_scc1 KF_p20
  s_ff1_i32_b32 s20, s56
  s_bitset0_b32 s56, s20
  s_cmp_lt_i32 s20, 0
  s_mul_i32 s20, s20, 2508800
  s_cselect_b32 s20, 0x40000000, s20
  s_cselect_b32 s62, 0, 1
  s_or_b32 s61, s61, s62
  s_add_u32 s23, s20, s76
  buffer_load_dwordx4 v[16:19], v3, s[44:47], s23 offen sc1
  s_add_u32 s23, s20, s77
  buffer_load_dwordx4 v[20:23], v3, s[44:47], s23 offen sc1
KF_p20:
  s_cmp_eq_u32 s56, 0
  s_cbranch_scc1 KF_acc2
  s_bitcmp1_b32 s59, 1
  s_cbranch_scc1 KF_p21
  s_ff1_i32_b32 s20, s56
  s_bitset0_b32 s56, s20
  s_cmp_lt_i32 s20, 0
  s_mul_i32 s20, s20, 2508800
  s_cselect_b32 s20, 0x40000000, s20
  s_cselect_b32 s62, 0, 2
  s_or_b32 s61, s61, s62
  s_add_u32 s23, s20, s76
  buffer_load_dwordx4 v[32:35], v3, s[44:47], s23 offen sc1
  s_add_u32 s23, s20, s77
  buffer_load_dwordx4 v[36:39], v3, s[44:47], s23 offen sc1
KF_p21:
  s_cmp_eq_u32 s56, 0
  s_cbranch_scc1 KF_acc2
  s_bitcmp1_b32 s59, 2
  s_cbranch_scc1 KF_p22
  s_ff1_i32_b32 s20, s56
  s_bitset0_b32 s56, s20
  s_cmp_lt_i32 s20, 0
  s_mul_i32 s20, s20, 2508800
  s_cselect_b32 s20, 0x40000000, s20
  s_cselect_b32 s62, 0, 4
  s_or_b32 s61, s61, s62
  s_add_u32 s23, s20, s76
  buffer_load_dwordx4 v[48:51], v3, s[44:47], s23 offen sc1
  s_add_u32 s23, s20, s77
  buffer_load_dwordx4 v[52:55], v3, s[44:47], s23 offen sc1
KF_p22:
  s_cmp_eq_u32 s56, 0
  s_cbranch_scc1 KF_acc2
  s_bitcmp1_b32 s59, 3
  s_cbranch_scc1 KF_p23
  s_ff1_i32_b32 s20, s56
  s_bitset0_b32 s56, s20
  s_cmp_lt_i32 s20, 0
  s_mul_i32 s20, s20, 2508800
  s_cselect_b32 s20, 0x40000000, s20
  s_cselect_b32 s62, 0, 8
  s_or_b32 s61, s61, s62
  s_add_u32 s23, s20, s76
  buffer_load_dwordx4 v[64:67], v3, s[44:47], s23 offen sc1
  s_add_u32 s23, s20, s77
  buffer_load_dwordx4 v[68:71], v3, s[44:47], s23 offen sc1
KF_p23:
  s_cmp_eq_u32 s56, 0
  s_cbranch_scc1 KF_acc2
  s_bitcmp1_b32 s59, 4
  s_cbranch_scc1 KF_p24
  s_ff1_i32_b32 s20, s56
  s_bitset0_b32 s56, s20
  s_cmp_lt_i32 s20, 0
  s_mul_i32 s20, s20, 2508800
  s_cselect_b32 s20, 0x40000000, s20
  s_cselect_b32 s62, 0, 16
  s_or_b32 s61, s61, s62
  s_add_u32 s23, s20, s76
  buffer_load_dwordx4 v[80:83], v3, s[44:47], s23 offen sc1
  s_add_u32 s23, s20, s77
  buffer_load_dwordx4 v[84:87], v3, s[44:47], s23 offen sc1
KF_p24:
  s_cmp_eq_u32 s56, 0
  s_cbranch_scc1 KF_acc2
  s_bitcmp1_b32 s59, 5
  s_cbranch_scc1 KF_p25
  s_ff1_i32_b32 s20, s56
  s_bitset0_b32 s56, s20
  s_cmp_lt_i32 s20, 0
  s_mul_i32 s20, s20, 2508800
  s_cselect_b32 s20, 0x40000000, s20
  s_cselect_b32 s62, 0, 32
  s_or_b32 s61, s61, s62
  s_add_u32 s23, s20, s76
  buffer_load_dwordx4 v[96:99], v3, s[44:47], s23 offen sc1
  s_add_u32 s23, s20, s77
  buffer_load_dwordx4 v[100:103], v3, s[44:47], s23 offen sc1
KF_p25:
  s_cmp_eq_u32 s56, 0
  s_cbranch_scc1 KF_acc2
  s_bitcmp1_b32 s59, 6
  s_cbranch_scc1 KF_p26
  s_ff1_i32_b32 s20, s56
  s_bitset0_b32 s56, s20
  s_cmp_lt_i32 s20, 0
  s_mul_i32 s20, s20, 2508800
  s_cselect_b32 s20, 0x40000000, s20
  s_cselect_b32 s62, 0, 64
  s_or_b32 s61, s61, s62
  s_add_u32 s23, s20, s76
  buffer_load_dwordx4 v[112:115], v3, s[44:47], s23 offen sc1
  s_add_u32 s23, s20, s77
  buffer_load_dwordx4 v[116:119], v3, s[44:47], s23 offen sc1
KF_p26:
  s_cmp_eq_u32 s56, 0
  s_cbranch_scc1 KF_acc2
  s_bitcmp1_b32 s59, 7
  s_cbranch_scc1 KF_p27
  s_ff1_i32_b32 s20, s56
  s_bitset0_b32 s56, s20
  s_cmp_lt_i32 s20, 0
  s_mul_i32 s20, s20, 2508800
  s_cselect_b32 s20, 0x40000000, s20
  s_cselect_b32 s62, 0, 128
  s_or_b32 s61, s61, s62
  s_add_u32 s23, s20, s76
  buffer_load_dwordx4 v[128:131], v3, s[44:47], s23 offen sc1
  s_add_u32 s23, s20, s77
  buffer_load_dwordx4 v[132:135], v3, s[44:47], s23 offen sc1
KF_p27:
KF_acc2:
  s_bitcmp1_b32 s59, 0
  s_cbranch_scc0 KF_a20
  v_dot2_f32_bf16 v192, v16, s54, v192
  v_dot2_f32_bf16 v193, v16, s55, v193
  v_dot2_f32_bf16 v194, v17, s54, v194
  v_dot2_f32_bf16 v195, v17, s55, v195
  v_dot2_f32_bf16 v196, v18, s54, v196
  v_dot2_f32_bf16 v197, v18, s55, v197
  v_dot2_f32_bf16 v198, v19, s54, v198
  v_dot2_f32_bf16 v199, v19, s55, v199
  v_dot2_f32_bf16 v200, v20, s54, v200
  v_dot2_f32_bf16 v201, v20, s55, v201
  v_dot2_f32_bf16 v202, v21, s54, v202
  v_dot2_f32_bf16 v203, v21, s55, v203
  v_dot2_f32_bf16 v204, v22, s54, v204
  v_dot2_f32_bf16 v205, v22, s55, v205
  v_dot2_f32_bf16 v206, v23, s54, v206
  v_dot2_f32_bf16 v207, v23, s55, v207
KF_a20:
  s_bitcmp1_b32 s59, 1
  s_cbranch_scc0 KF_a21
  v_dot2_f32_bf16 v192, v32, s54, v192
  v_dot2_f32_bf16 v193, v32, s55, v193
  v_dot2_f32_bf16 v194, v33, s54, v194
  v_dot2_f32_bf16 v195, v33, s55, v195
  v_dot2_f32_bf16 v196, v34, s54, v196
  v_dot2_f32_bf16 v197, v34, s55, v197
  v_dot2_f32_bf16 v198, v35, s54, v198
  v_dot2_f32_bf16 v199, v35, s55, v199
  v_dot2_f32_bf16 v200, v36, s54, v200
  v_dot2_f32_bf16 v201, v36, s55, v201
  v_dot2_f32_bf16 v202, v37, s54, v202
  v_dot2_f32_bf16 v203, v37, s55, v203
  v_dot2_f32_bf16 v204, v38, s54, v204
  v_dot2_f32_bf16 v205, v38, s55, v205
  v_dot2_f32_bf16 v206, v39, s54, v206
  v_dot2_f32_bf16 v207, v39, s55, v207
KF_a21:
  s_bitcmp1_b32 s59, 2
  s_cbranch_scc0 KF_a22
  v_dot2_f32_bf16 v192, v48, s54, v192
  v_dot2_f32_bf16 v193, v48, s55, v193
  v_dot2_f32_bf16 v194, v49, s54, v194
  v_dot2_f32_bf16 v195, v49, s55, v195
  v_dot2_f32_bf16 v196, v50, s54, v196
  v_dot2_f32_bf16 v197, v50, s55, v197
  v_dot2_f32_bf16 v198, v51, s54, v198
  v_dot2_f32_bf16 v199, v51, s55, v199
  v_dot2_f32_bf16 v200, v52, s54, v200
  v_dot2_f32_bf16 v201, v52, s55, v201
  v_dot2_f32_bf16 v202, v53, s54, v202
  v_dot2_f32_bf16 v203, v53, s55, v203
  v_dot2_f32_bf16 v204, v54, s54, v204
  v_dot2_f32_bf16 v205, v54, s55, v205
  v_dot2_f32_bf16 v206, v55, s54, v206
  v_dot2_f32_bf16 v207, v55, s55, v207
KF_a22:
  s_bitcmp1_b32 s59, 3
  s_cbranch_scc0 KF_a23
  v_dot2_f32_bf16 v192, v64, s54, v192
  v_dot2_f32_bf16 v193, v64, s55, v193
  v_dot2_f32_bf16 v194, v65, s54, v194
  v_dot2_f32_bf16 v195, v65, s55, v195
  v_dot2_f32_bf16 v196, v66, s54, v196
  v_dot2_f32_bf16 v197, v66, s55, v197
  v_dot2_f32_bf16 v198, v67, s54, v198
  v_dot2_f32_bf16 v199, v67, s55, v199
  v_dot2_f32_bf16 v200, v68, s54, v200
  v_dot2_f32_bf16 v201, v68, s55, v201
  v_dot2_f32_bf16 v202, v69, s54, v202
  v_dot2_f32_bf16 v203, v69, s55, v203
  v_dot2_f32_bf16 v204, v70, s54, v204
  v_dot2_f32_bf16 v205, v70, s55, v205
  v_dot2_f32_bf16 v206, v71, s54, v206
  v_dot2_f32_bf16 v207, v71, s55, v207
KF_a23:
  s_bitcmp1_b32 s59, 4
  s_cbranch_scc0 KF_a24
  v_dot2_f32_bf16 v192, v80, s54, v192
  v_dot2_f32_bf16 v193, v80, s55, v193
  v_dot2_f32_bf16 v194, v81, s54, v194
  v_dot2_f32_bf16 v195, v81, s55, v195
  v_dot2_f32_bf16 v196, v82, s54, v196
  v_dot2_f32_bf16 v197, v82, s55, v197
  v_dot2_f32_bf16 v198, v83, s54, v198
  v_dot2_f32_bf16 v199, v83, s55, v199
  v_dot2_f32_bf16 v200, v84, s54, v200
  v_dot2_f32_bf16 v201, v84, s55, v201
  v_dot2_f32_bf16 v202, v85, s54, v202
  v_dot2_f32_bf16 v203, v85, s55, v203
  v_dot2_f32_bf16 v204, v86, s54, v204
  v_dot2_f32_bf16 v205, v86, s55, v205
  v_dot2_f32_bf16 v206, v87, s54, v206
  v_dot2_f32_bf16 v207, v87, s55, v207
KF_a24:
  s_bitcmp1_b32 s59, 5
  s_cbranch_scc0 KF_a25
  v_dot2_f32_bf16 v192, v96, s54, v192
  v_dot2_f32_bf16 v193, v96, s55, v193
  v_dot2_f32_bf16 v194, v97, s54, v194
  v_dot2_f32_bf16 v195, v97, s55, v195
  v_dot2_f32_bf16 v196, v98, s54, v196
  v_dot2_f32_bf16 v197, v98, s55, v197
  v_dot2_f32_bf16 v198, v99, s54, v198
  v_dot2_f32_bf16 v199, v99, s55, v199
  v_dot2_f32_bf16 v200, v100, s54, v200
  v_dot2_f32_bf16 v201, v100, s55, v201
  v_dot2_f32_bf16 v202, v101, s54, v202
  v_dot2_f32_bf16 v203, v101, s55, v203
  v_dot2_f32_bf16 v204, v102, s54, v204
  v_dot2_f32_bf16 v205, v102, s55, v205
  v_dot2_f32_bf16 v206, v103, s54, v206
  v_dot2_f32_bf16 v207, v103, s55, v207
KF_a25:
  s_bitcmp1_b32 s59, 6
  s_cbranch_scc0 KF_a26
  v_dot2_f32_bf16 v192, v112, s54, v192
  v_dot2_f32_bf16 v193, v112, s55, v193
  v_dot2_f32_bf16 v194, v113, s54, v194
  v_dot2_f32_bf16 v195, v113, s55, v195
  v_dot2_f32_bf16 v196, v114, s54, v196
  v_dot2_f32_bf16 v197, v114, s55, v197
  v_dot2_f32_bf16 v198, v115, s54, v198
  v_dot2_f32_bf16 v199, v115, s55, v199
  v_dot2_f32_bf16 v200, v116, s54, v200
  v_dot2_f32_bf16 v201, v116, s55, v201
  v_dot2_f32_bf16 v202, v117, s54, v202
  v_dot2_f32_bf16 v203, v117, s55, v203
  v_dot2_f32_bf16 v204, v118, s54, v204
  v_dot2_f32_bf16 v205, v118, s55, v205
  v_dot2_f32_bf16 v206, v119, s54, v206
  v_dot2_f32_bf16 v207, v119, s55, v207
KF_a26:
  s_bitcmp1_b32 s59, 7
  s_cbranch_scc0 KF_a27
  v_dot2_f32_bf16 v192, v128, s54, v192
  v_dot2_f32_bf16 v193, v128, s55, v193
  v_dot2_f32_bf16 v194, v129, s54, v194
  v_dot2_f32_bf16 v195, v129, s55, v195
  v_dot2_f32_bf16 v196, v130, s54, v196
  v_dot2_f32_bf16 v197, v130, s55, v197
  v_dot2_f32_bf16 v198, v131, s54, v198
  v_dot2_f32_bf16 v199, v131, s55, v199
  v_dot2_f32_bf16 v200, v132, s54, v200
  v_dot2_f32_bf16 v201, v132, s55, v201
  v_dot2_f32_bf16 v202, v133, s54, v202
  v_dot2_f32_bf16 v203, v133, s55, v203
  v_dot2_f32_bf16 v204, v134, s54, v204
  v_dot2_f32_bf16 v205, v134, s55, v205
  v_dot2_f32_bf16 v206, v135, s54, v206
  v_dot2_f32_bf16 v207, v135, s55, v207
KF_a27:
  s_or_b32 s20, s56, s57
  s_or_b32 s20, s20, s61
  s_cmp_lg_u32 s20, 0
  s_cbranch_scc1 KF_loop2
KF_sum2:
  s_mov_b32 s58, 73728
  s_mov_b32 s59, 147456
  s_mov_b32 s60, 221184
  v_pk_mul_f32 v[168:169], v[192:193], v[244:245] op_sel_hi:[1,0]
  v_pk_mul_f32 v[170:171], v[194:195], v[244:245] op_sel_hi:[1,0]
  v_pk_mul_f32 v[172:173], v[196:197], v[244:245] op_sel_hi:[1,0]
  v_pk_mul_f32 v[174:175], v[198:199], v[244:245] op_sel_hi:[1,0]
  v_exp_f32 v168, v168
  v_exp_f32 v169, v169
  v_pk_mul_f32 v[192:193], v[192:193], v[24:25]
  v_exp_f32 v170, v170
  v_exp_f32 v171, v171
  v_pk_mul_f32 v[194:195], v[194:195], v[26:27]
  v_exp_f32 v172, v172
  v_exp_f32 v173, v173
  v_pk_mul_f32 v[196:197], v[196:197], v[28:29]
  v_exp_f32 v174, v174
  v_exp_f32 v175, v175
  v_pk_mul_f32 v[198:199], v[198:199], v[30:31]
  v_pk_add_f32 v[168:169], v[168:169], 1.0 op_sel_hi:[1,0]
  v_pk_add_f32 v[170:171], v[170:171], 1.0 op_sel_hi:[1,0]
  v_pk_add_f32 v[172:173], v[172:173], 1.0 op_sel_hi:[1,0]
  v_pk_add_f32 v[174:175], v[174:175], 1.0 op_sel_hi:[1,0]
  v_rcp_f32 v168, v168
  v_lshlrev_b32 v160, 16, v144
  v_rcp_f32 v169, v169
  v_and_b32 v161, 0xffff0000, v144
  v_rcp_f32 v170, v170
  v_lshlrev_b32 v162, 16, v145
  v_rcp_f32 v171, v171
  v_and_b32 v163, 0xffff0000, v145
  v_rcp_f32 v172, v172
  v_lshlrev_b32 v164, 16, v146
  v_rcp_f32 v173, v173
  v_and_b32 v165, 0xffff0000, v146
  v_rcp_f32 v174, v174
  v_lshlrev_b32 v166, 16, v147
  v_rcp_f32 v175, v175
  v_and_b32 v167, 0xffff0000, v147
  v_pk_fma_f32 v[160:161], v[192:193], v[168:169], v[160:161]
  v_pk_fma_f32 v[162:163], v[194:195], v[170:171], v[162:163]
  v_pk_fma_f32 v[164:165], v[196:197], v[172:173], v[164:165]
  v_pk_fma_f32 v[166:167], v[198:199], v[174:175], v[166:167]
  v_cvt_pk_bf16_f32 v144, v160, v161
  v_cvt_pk_bf16_f32 v145, v162, v163
  v_cvt_pk_bf16_f32 v146, v164, v165
  v_cvt_pk_bf16_f32 v147, v166, v167
  buffer_store_dwordx4 v[144:147], v238, s[32:35], 0 offen
  v_pk_mul_f32 v[168:169], v[200:201], v[244:245] op_sel:[0,1] op_sel_hi:[1,1]
  v_pk_mul_f32 v[170:171], v[202:203], v[244:245] op_sel:[0,1] op_sel_hi:[1,1]
  v_pk_mul_f32 v[172:173], v[204:205], v[244:245] op_sel:[0,1] op_sel_hi:[1,1]
  v_pk_mul_f32 v[174:175], v[206:207], v[244:245] op_sel:[0,1] op_sel_hi:[1,1]
  v_exp_f32 v168, v168
  v_exp_f32 v169, v169
  v_pk_mul_f32 v[200:201], v[200:201], v[40:41]
  v_exp_f32 v170, v170
  v_exp_f32 v171, v171
  v_pk_mul_f32 v[202:203], v[202:203], v[42:43]
  v_exp_f32 v172, v172
  v_exp_f32 v173, v173
  v_pk_mul_f32 v[204:205], v[204:205], v[44:45]
  v_exp_f32 v174, v174
  v_exp_f32 v175, v175
  v_pk_mul_f32 v[206:207], v[206:207], v[46:47]
  v_pk_add_f32 v[168:169], v[168:169], 1.0 op_sel_hi:[1,0]
  v_pk_add_f32 v[170:171], v[170:171], 1.0 op_sel_hi:[1,0]
  v_pk_add_f32 v[172:173], v[172:173], 1.0 op_sel_hi:[1,0]
  v_pk_add_f32 v[174:175], v[174:175], 1.0 op_sel_hi:[1,0]
  v_rcp_f32 v168, v168
  v_lshlrev_b32 v160, 16, v148
  v_rcp_f32 v169, v169
  v_and_b32 v161, 0xffff0000, v148
  v_rcp_f32 v170, v170
  v_lshlrev_b32 v162, 16, v149
  v_rcp_f32 v171, v171
  v_and_b32 v163, 0xffff0000, v149
  v_rcp_f32 v172, v172
  v_lshlrev_b32 v164, 16, v150
  v_rcp_f32 v173, v173
  v_and_b32 v165, 0xffff0000, v150
  v_rcp_f32 v174, v174
  v_lshlrev_b32 v166, 16, v151
  v_rcp_f32 v175, v175
  v_and_b32 v167, 0xffff0000, v151
  v_pk_fma_f32 v[160:161], v[200:201], v[168:169], v[160:161]
  v_pk_fma_f32 v[162:163], v[202:203], v[170:171], v[162:163]
  v_pk_fma_f32 v[164:165], v[204:205], v[172:173], v[164:165]
  v_pk_fma_f32 v[166:167], v[206:207], v[174:175], v[166:167]
  v_cvt_pk_bf16_f32 v148, v160, v161
  v_cvt_pk_bf16_f32 v149, v162, v163
  v_cvt_pk_bf16_f32 v150, v164, v165
  v_cvt_pk_bf16_f32 v151, v166, v167
  buffer_store_dwordx4 v[148:151], v238, s[32:35], s58 offen
  s_branch K1_fin
KF_conv1:
  ds_read2_b32 a[112:113], v224 offset0:0 offset1:1
  ds_read2_b32 a[114:115], v224 offset0:2 offset1:3
  ds_read_b128 a[164:167], v232 offset:1024
  ds_read_b128 a[160:163], v232 offset:1536
  ds_read_b128 a[156:159], v232 offset:2048
  ds_read2_b32 a[116:117], v224 offset0:128 offset1:129
  ds_read2_b32 a[118:119], v224 offset0:130 offset1:131
  ds_read_b128 a[152:155], v232 offset:2560
  ds_read2_b32 a[120:121], v225 offset0:0 offset1:1
  ds_read2_b32 a[122:123], v225 offset0:2 offset1:3
  ds_read_b128 a[148:151], v232 offset:3072
  ds_read2_b32 a[124:125], v225 offset0:128 offset1:129
  ds_read2_b32 a[126:127], v225 offset0:130 offset1:131
  ds_read_b128 a[144:147], v232 offset:3584
  ds_read2_b32 a[128:129], v226 offset0:0 offset1:1
  ds_read2_b32 a[130:131], v226 offset0:2 offset1:3
  ds_read2_b32 a[132:133], v226 offset0:128 offset1:129
  ds_read2_b32 a[134:135], v226 offset0:130 offset1:131
  s_waitcnt lgkmcnt(13)
  v_mfma_f32_16x16x32_bf16 v[168:171], a[112:115], a[164:167], 0
  ds_read2_b32 a[176:177], v224 offset0:16 offset1:17
  ds_read2_b32 a[178:179], v224 offset0:18 offset1:19
  v_mfma_f32_16x16x32_bf16 v[164:167], a[112:115], a[160:163], 0
  ds_read_b128 a[228:231], v232 offset:1088
  ds_read_b128 a[224:227], v232 offset:1600
  ds_write_b128 v255, a[244:247]
  v_mfma_f32_16x16x32_bf16 v[160:163], a[112:115], a[156:159], 0
  ds_read_b128 a[220:223], v232 offset:2112
  ds_read2_b32 a[180:181], v224 offset0:144 offset1:145
  s_waitcnt lgkmcnt(15)
  v_mfma_f32_16x16x32_bf16 v[168:171], a[116:119], a[160:163], v[168:171]
  ds_read2_b32 a[182:183], v224 offset0:146 offset1:147
  v_mfma_f32_16x16x32_bf16 v[164:167], a[116:119], a[156:159], v[164:167]
  ds_read_b128 a[216:219], v232 offset:2624
  ds_write_b128 v255, a[252:255] offset:4160
  v_mfma_f32_16x16x32_bf16 v[160:163], a[116:119], a[152:155], v[160:163]
  ds_read2_b32 a[184:185], v225 offset0:16 offset1:17
  s_waitcnt lgkmcnt(15)
  v_mfma_f32_16x16x32_bf16 v[168:171], a[120:123], a[156:159], v[168:171]
  ds_read2_b32 a[186:187], v225 offset0:18 offset1:19
  v_mfma_f32_16x16x32_bf16 v[164:167], a[120:123], a[152:155], v[164:167]
  ds_read_b128 a[212:215], v232 offset:3136
  ds_write_b128 v255, a[244:247] offset:12416
  v_mfma_f32_16x16x32_bf16 v[160:163], a[120:123], a[148:151], v[160:163]
  ds_read2_b32 a[188:189], v225 offset0:144 offset1:145
  v_mfma_f32_16x16x32_bf16 v[168:171], a[124:127], a[152:155], v[168:171]
  ds_read2_b32 a[190:191], v225 offset0:146 offset1:147
  v_mfma_f32_16x16x32_bf16 v[164:167], a[124:127], a[148:151], v[164:167]
  ds_read_b128 a[208:211], v232 offset:3648
  ds_write_b128 v255, v[208:211] offset:4192
  v_mfma_f32_16x16x32_bf16 v[160:163], a[124:127], a[144:147], v[160:163]
  ds_read2_b32 a[192:193], v226 offset0:16 offset1:17
  s_waitcnt lgkmcnt(15)
  v_mfma_f32_16x16x32_bf16 v[168:171], a[128:131], a[148:151], v[168:171]
  ds_read2_b32 a[194:195], v226 offset0:18 offset1:19
  v_mfma_f32_16x16x32_bf16 v[164:167], a[128:131], a[144:147], v[164:167]
  ds_read2_b32 a[196:197], v226 offset0:144 offset1:145
  ds_write_b128 v255, v[176:179] offset:32
  v_mfma_f32_16x16x32_bf16 v[168:171], a[132:135], a[144:147], v[168:171]
  ds_read2_b32 a[198:199], v226 offset0:146 offset1:147
  s_waitcnt lgkmcnt(15)
  v_mfma_f32_16x16x32_bf16 v[168:171], a[176:179], a[228:231], v[168:171]
  ds_read2_b32 a[112:113], v224 offset0:32 offset1:33
  ds_read2_b32 a[114:115], v224 offset0:34 offset1:35
  v_mfma_f32_16x16x32_bf16 v[164:167], a[176:179], a[224:227], v[164:167]
  ds_read_b128 a[164:167], v232 offset:1152
  ds_read_b128 a[160:163], v232 offset:1664
  ds_write_b128 v255, a[84:87] offset:8320
  v_mfma_f32_16x16x32_bf16 v[160:163], a[176:179], a[220:223], v[160:163]
  ds_read_b128 a[156:159], v232 offset:2176
  ds_read2_b32 a[116:117], v224 offset0:160 offset1:161
  s_waitcnt lgkmcnt(15)
  v_mfma_f32_16x16x32_bf16 v[168:171], a[180:183], a[224:227], v[168:171]
  ds_read2_b32 a[118:119], v224 offset0:162 offset1:163
  v_mfma_f32_16x16x32_bf16 v[164:167], a[180:183], a[220:223], v[164:167]
  ds_read_b128 a[152:155], v232 offset:2688
  ds_write_b128 v255, v[212:215] offset:5216
  v_mfma_f32_16x16x32_bf16 v[160:163], a[180:183], a[216:219], v[160:163]
  ds_read2_b32 a[120:121], v225 offset0:32 offset1:33
  v_mfma_f32_16x16x32_bf16 v[168:171], a[184:187], a[220:223], v[168:171]
  ds_read2_b32 a[122:123], v225 offset0:34 offset1:35
  v_mfma_f32_16x16x32_bf16 v[164:167], a[184:187], a[216:219], v[164:167]
  ds_read_b128 a[148:151], v232 offset:3200
  ds_write_b128 v255, v[180:183] offset:1056
  v_mfma_f32_16x16x32_bf16 v[160:163], a[184:187], a[212:215], v[160:163]
  ds_read2_b32 a[124:125], v225 offset0:160 offset1:161
  s_waitcnt lgkmcnt(15)
  v_mfma_f32_16x16x32_bf16 v[168:171], a[188:191], a[216:219], v[168:171]
  ds_read2_b32 a[126:127], v225 offset0:162 offset1:163
  v_mfma_f32_16x16x32_bf16 v[164:167], a[188:191], a[212:215], v[164:167]
  ds_read_b128 a[144:147], v232 offset:3712
  ds_write_b128 v255, a[88:91] offset:9344
  v_mfma_f32_16x16x32_bf16 v[160:163], a[188:191], a[208:211], v[160:163]
  ds_read2_b32 a[128:129], v226 offset0:32 offset1:33
  v_mfma_f32_16x16x32_bf16 v[168:171], a[192:195], a[212:215], v[168:171]
  ds_read2_b32 a[130:131], v226 offset0:34 offset1:35
  v_mfma_f32_16x16x32_bf16 v[164:167], a[192:195], a[208:211], v[164:167]
  ds_read2_b32 a[132:133], v226 offset0:160 offset1:161
  ds_write_b128 v255, v[216:219] offset:6240
  v_mfma_f32_16x16x32_bf16 v[168:171], a[196:199], a[208:211], v[168:171]
  ds_read2_b32 a[134:135], v226 offset0:162 offset1:163
  s_waitcnt lgkmcnt(15)
  v_mfma_f32_16x16x32_bf16 v[168:171], a[112:115], a[164:167], v[168:171]
  ds_read2_b32 a[176:177], v224 offset0:48 offset1:49
  ds_read2_b32 a[178:179], v224 offset0:50 offset1:51
  v_mfma_f32_16x16x32_bf16 v[164:167], a[112:115], a[160:163], v[164:167]
  ds_read_b128 a[228:231], v232 offset:1216
  ds_read_b128 a[224:227], v232 offset:1728
  ds_write_b128 v255, v[184:187] offset:2080
  v_mfma_f32_16x16x32_bf16 v[160:163], a[112:115], a[156:159], v[160:163]
  ds_read_b128 a[220:223], v232 offset:2240
  ds_read2_b32 a[180:181], v224 offset0:176 offset1:177
  s_waitcnt lgkmcnt(15)
  v_mfma_f32_16x16x32_bf16 v[168:171], a[116:119], a[160:163], v[168:171]
  ds_read2_b32 a[182:183], v224 offset0:178 offset1:179
  v_mfma_f32_16x16x32_bf16 v[164:167], a[116:119], a[156:159], v[164:167]
  ds_read_b128 a[216:219], v232 offset:2752
  ds_write_b128 v255, a[92:95] offset:10368
  v_mfma_f32_16x16x32_bf16 v[160:163], a[116:119], a[152:155], v[160:163]
  ds_read2_b32 a[184:185], v225 offset0:48 offset1:49
  v_mfma_f32_16x16x32_bf16 v[168:171], a[120:123], a[156:159], v[168:171]
  ds_read2_b32 a[186:187], v225 offset0:50 offset1:51
  v_mfma_f32_16x16x32_bf16 v[164:167], a[120:123], a[152:155], v[164:167]
  ds_read_b128 a[212:215], v232 offset:3264
  ds_write_b128 v255, v[220:223] offset:7264
  v_mfma_f32_16x16x32_bf16 v[160:163], a[120:123], a[148:151], v[160:163]
  ds_read2_b32 a[188:189], v225 offset0:176 offset1:177
  s_waitcnt lgkmcnt(15)
  v_mfma_f32_16x16x32_bf16 v[168:171], a[124:127], a[152:155], v[168:171]
  ds_read2_b32 a[190:191], v225 offset0:178 offset1:179
  v_mfma_f32_16x16x32_bf16 v[164:167], a[124:127], a[148:151], v[164:167]
  ds_read_b128 a[208:211], v232 offset:3776
  ds_write_b128 v255, v[188:191] offset:3104
  v_mfma_f32_16x16x32_bf16 v[160:163], a[124:127], a[144:147], v[160:163]
  ds_read2_b32 a[192:193], v226 offset0:48 offset1:49
  v_mfma_f32_16x16x32_bf16 v[168:171], a[128:131], a[148:151], v[168:171]
  ds_read2_b32 a[194:195], v226 offset0:50 offset1:51
  v_mfma_f32_16x16x32_bf16 v[164:167], a[128:131], a[144:147], v[164:167]
  ds_read2_b32 a[196:197], v226 offset0:176 offset1:177
  ds_write_b128 v255, a[96:99] offset:11392
  v_mfma_f32_16x16x32_bf16 v[168:171], a[132:135], a[144:147], v[168:171]
  ds_read2_b32 a[198:199], v226 offset0:178 offset1:179
  s_waitcnt lgkmcnt(15)
  v_mfma_f32_16x16x32_bf16 v[168:171], a[176:179], a[228:231], v[168:171]
  ds_read2_b32 a[112:113], v224 offset0:64 offset1:65
  ds_read2_b32 a[114:115], v224 offset0:66 offset1:67
  v_mfma_f32_16x16x32_bf16 v[164:167], a[176:179], a[224:227], v[164:167]
  ds_read_b128 a[164:167], v232 offset:1280
  ds_read_b128 a[160:163], v232 offset:1792
  v_mfma_f32_16x16x32_bf16 v[160:163], a[176:179], a[220:223], v[160:163]
  ds_read_b128 a[156:159], v232 offset:2304
  ds_read2_b32 a[116:117], v224 offset0:192 offset1:193
  s_waitcnt lgkmcnt(15)
  v_mfma_f32_16x16x32_bf16 v[168:171], a[180:183], a[224:227], v[168:171]
  ds_read2_b32 a[118:119], v224 offset0:194 offset1:195
  v_mfma_f32_16x16x32_bf16 v[164:167], a[180:183], a[220:223], v[164:167]
  ds_read_b128 a[152:155], v232 offset:2816
  v_mfma_f32_16x16x32_bf16 v[160:163], a[180:183], a[216:219], v[160:163]
  ds_read2_b32 a[120:121], v225 offset0:64 offset1:65
  v_mfma_f32_16x16x32_bf16 v[168:171], a[184:187], a[220:223], v[168:171]
  ds_read2_b32 a[122:123], v225 offset0:66 offset1:67
  v_mfma_f32_16x16x32_bf16 v[164:167], a[184:187], a[216:219], v[164:167]
  ds_read_b128 a[148:151], v232 offset:3328
  v_mfma_f32_16x16x32_bf16 v[160:163], a[184:187], a[212:215], v[160:163]
  ds_read2_b32 a[124:125], v225 offset0:192 offset1:193
  s_waitcnt lgkmcnt(15)
  v_mfma_f32_16x16x32_bf16 v[168:171], a[188:191], a[216:219], v[168:171]
  ds_read2_b32 a[126:127], v225 offset0:194 offset1:195
  v_mfma_f32_16x16x32_bf16 v[164:167], a[188:191], a[212:215], v[164:167]
  ds_read_b128 a[144:147], v232 offset:3840
  v_mfma_f32_16x16x32_bf16 v[160:163], a[188:191], a[208:211], v[160:163]
  ds_read2_b32 a[128:129], v226 offset0:64 offset1:65
  s_waitcnt lgkmcnt(15)
  v_mfma_f32_16x16x32_bf16 v[168:171], a[192:195], a[212:215], v[168:171]
  ds_read2_b32 a[130:131], v226 offset0:66 offset1:67
  v_mfma_f32_16x16x32_bf16 v[164:167], a[192:195], a[208:211], v[164:167]
  ds_read2_b32 a[132:133], v226 offset0:192 offset1:193
  v_mfma_f32_16x16x32_bf16 v[168:171], a[196:199], a[208:211], v[168:171]
  ds_read2_b32 a[134:135], v226 offset0:194 offset1:195
  s_waitcnt vmcnt(0)
  s_barrier
  buffer_store_dword v5, v1, s[44:47], s90 offen sc1
KF_chk1:
  v_subrev_u32 v253, s78, v252
  v_add_u32 v253, -1, v253
  v_cmp_lt_u32 vcc, 3, v253
  s_nop 4
  s_cbranch_vccz KF_go1
  s_add_u32 s63, s63, 1
  s_cmp_ge_u32 s63, 0x40000
  s_cbranch_scc1 KF_go1
  s_nop 0
  buffer_load_dword v252, v15, s[44:47], 0 offen sc1
  s_waitcnt vmcnt(0)
  s_branch KF_chk1
KF_go1:
  v_subrev_u32 v253, s78, v252
  v_cmp_eq_u32 vcc, 4, v253
  s_nop 1
  s_lshr_b32 s20, vcc_lo, 16
  s_and_b32 s20, s20, vcc_lo
  s_lshr_b32 s23, s20, 1
  s_and_b32 s20, s20, s23
  s_and_b32 s20, s20, s57
  s_andn2_b32 s57, s57, s20
  s_or_b32 s56, s56, s20
  s_waitcnt lgkmcnt(13)
  v_mfma_f32_16x16x32_bf16 v[168:171], a[112:115], a[164:167], v[168:171]
  ds_read2_b32 a[176:177], v224 offset0:80 offset1:81
  ds_read2_b32 a[178:179], v224 offset0:82 offset1:83
  buffer_load_dwordx4 v[144:147], v13, s[44:47], s88 offen sc1
  v_mfma_f32_16x16x32_bf16 v[164:167], a[112:115], a[160:163], v[164:167]
  ds_read_b128 a[228:231], v232 offset:1344
  ds_read_b128 a[224:227], v232 offset:1856
  buffer_load_dwordx4 v[148:151], v13, s[44:47], s89 offen sc1
  v_mfma_f32_16x16x32_bf16 v[160:163], a[112:115], a[156:159], v[160:163]
  ds_read_b128 a[220:223], v232 offset:2368
  ds_read2_b32 a[180:181], v224 offset0:208 offset1:209
  buffer_load_dwordx4 v[152:155], v13, s[44:47], s91 offen sc1
  s_waitcnt lgkmcnt(15)
  v_mfma_f32_16x16x32_bf16 v[168:171], a[116:119], a[160:163], v[168:171]
  ds_read2_b32 a[182:183], v224 offset0:210 offset1:211
  buffer_load_dwordx2 v[240:241], v12, s[44:47], s66 offen offset:0 sc1
  v_mfma_f32_16x16x32_bf16 v[164:167], a[116:119], a[156:159], v[164:167]
  ds_read_b128 a[216:219], v232 offset:2880
  buffer_load_dwordx2 v[242:243], v12, s[44:47], s66 offen offset:512 sc1
  v_mfma_f32_16x16x32_bf16 v[160:163], a[116:119], a[152:155], v[160:163]
  ds_read2_b32 a[184:185], v225 offset0:80 offset1:81
  buffer_load_dwordx2 v[244:245], v12, s[44:47], s66 offen offset:1024 sc1
  s_waitcnt lgkmcnt(15)
  v_mfma_f32_16x16x32_bf16 v[168:171], a[120:123], a[156:159], v[168:171]
  ds_read2_b32 a[186:187], v225 offset0:82 offset1:83
  buffer_load_ushort v8, off, s[36:39], s67 offset:0
  v_mfma_f32_16x16x32_bf16 v[164:167], a[120:123], a[152:155], v[164:167]
  ds_read_b128 a[212:215], v232 offset:3392
  buffer_load_ushort v10, off, s[36:39], s67 offset:2
  v_mfma_f32_16x16x32_bf16 v[160:163], a[120:123], a[148:151], v[160:163]
  ds_read2_b32 a[188:189], v225 offset0:208 offset1:209
  s_ff1_i32_b32 s20, s56
  s_bitset0_b32 s56, s20
  s_cmp_lt_i32 s20, 0
  s_mul_i32 s20, s20, 2508800
  s_cselect_b32 s20, 0x40000000, s20
  s_cselect_b32 s62, 0, 1
  s_or_b32 s61, s61, s62
  s_add_u32 s23, s20, s76
  buffer_load_dwordx4 v[16:19], v3, s[44:47], s23 offen sc1
  s_waitcnt lgkmcnt(15)
  v_mfma_f32_16x16x32_bf16 v[168:171], a[124:127], a[152:155], v[168:171]
  ds_read2_b32 a[190:191], v225 offset0:210 offset1:211
  s_add_u32 s23, s20, s77
  buffer_load_dwordx4 v[20:23], v3, s[44:47], s23 offen sc1
  v_mfma_f32_16x16x32_bf16 v[164:167], a[124:127], a[148:151], v[164:167]
  ds_read_b128 a[208:211], v232 offset:3904
  s_add_u32 s23, s20, s96
  buffer_load_dwordx4 v[24:27], v3, s[44:47], s23 offen sc1
  v_mfma_f32_16x16x32_bf16 v[160:163], a[124:127], a[144:147], v[160:163]
  ds_read2_b32 a[192:193], v226 offset0:80 offset1:81
  s_ff1_i32_b32 s20, s56
  s_bitset0_b32 s56, s20
  s_cmp_lt_i32 s20, 0
  s_mul_i32 s20, s20, 2508800
  s_cselect_b32 s20, 0x40000000, s20
  s_cselect_b32 s62, 0, 2
  s_or_b32 s61, s61, s62
  s_add_u32 s23, s20, s76
  buffer_load_dwordx4 v[32:35], v3, s[44:47], s23 offen sc1
  s_waitcnt lgkmcnt(15)
  v_mfma_f32_16x16x32_bf16 v[168:171], a[128:131], a[148:151], v[168:171]
  ds_read2_b32 a[194:195], v226 offset0:82 offset1:83
  s_add_u32 s23, s20, s77
  buffer_load_dwordx4 v[36:39], v3, s[44:47], s23 offen sc1
  v_mfma_f32_16x16x32_bf16 v[164:167], a[128:131], a[144:147], v[164:167]
  ds_read2_b32 a[196:197], v226 offset0:208 offset1:209
  s_add_u32 s23, s20, s96
  buffer_load_dwordx4 v[40:43], v3, s[44:47], s23 offen sc1
  v_mfma_f32_16x16x32_bf16 v[168:171], a[132:135], a[144:147], v[168:171]
  ds_read2_b32 a[198:199], v226 offset0:210 offset1:211
  s_ff1_i32_b32 s20, s56
  s_bitset0_b32 s56, s20
  s_cmp_lt_i32 s20, 0
  s_mul_i32 s20, s20, 2508800
  s_cselect_b32 s20, 0x40000000, s20
  s_cselect_b32 s62, 0, 4
  s_or_b32 s61, s61, s62
  s_add_u32 s23, s20, s76
  buffer_load_dwordx4 v[48:51], v3, s[44:47], s23 offen sc1
  s_waitcnt lgkmcnt(13)
  v_mfma_f32_16x16x32_bf16 v[168:171], a[176:179], a[228:231], v[168:171]
  ds_read2_b32 a[112:113], v224 offset0:96 offset1:97
  ds_read2_b32 a[114:115], v224 offset0:98 offset1:99
  s_add_u32 s23, s20, s77
  buffer_load_dwordx4 v[52:55], v3, s[44:47], s23 offen sc1
  v_mfma_f32_16x16x32_bf16 v[164:167], a[176:179], a[224:227], v[164:167]
  ds_read_b128 a[164:167], v232 offset:1408
  ds_read_b128 a[160:163], v232 offset:1920
  s_add_u32 s23, s20, s96
  buffer_load_dwordx4 v[56:59], v3, s[44:47], s23 offen sc1
  v_mfma_f32_16x16x32_bf16 v[160:163], a[176:179], a[220:223], v[160:163]
  ds_read_b128 a[156:159], v232 offset:2432
  ds_read2_b32 a[116:117], v224 offset0:224 offset1:225
  s_ff1_i32_b32 s20, s56
  s_bitset0_b32 s56, s20
  s_cmp_lt_i32 s20, 0
  s_mul_i32 s20, s20, 2508800
  s_cselect_b32 s20, 0x40000000, s20
  s_cselect_b32 s62, 0, 8
  s_or_b32 s61, s61, s62
  s_add_u32 s23, s20, s76
  buffer_load_dwordx4 v[64:67], v3, s[44:47], s23 offen sc1
  s_waitcnt lgkmcnt(15)
  v_mfma_f32_16x16x32_bf16 v[168:171], a[180:183], a[224:227], v[168:171]
  ds_read2_b32 a[118:119], v224 offset0:226 offset1:227
  s_add_u32 s23, s20, s77
  buffer_load_dwordx4 v[68:71], v3, s[44:47], s23 offen sc1
  v_mfma_f32_16x16x32_bf16 v[164:167], a[180:183], a[220:223], v[164:167]
  ds_read_b128 a[152:155], v232 offset:2944
  s_add_u32 s23, s20, s96
  buffer_load_dwordx4 v[72:75], v3, s[44:47], s23 offen sc1
  v_mfma_f32_16x16x32_bf16 v[160:163], a[180:183], a[216:219], v[160:163]
  ds_read2_b32 a[120:121], v225 offset0:96 offset1:97
  s_waitcnt lgkmcnt(15)
  v_mfma_f32_16x16x32_bf16 v[168:171], a[184:187], a[220:223], v[168:171]
  ds_read2_b32 a[122:123], v225 offset0:98 offset1:99
  v_mfma_f32_16x16x32_bf16 v[164:167], a[184:187], a[216:219], v[164:167]
  ds_read_b128 a[148:151], v232 offset:3456
  v_mfma_f32_16x16x32_bf16 v[160:163], a[184:187], a[212:215], v[160:163]
  ds_read2_b32 a[124:125], v225 offset0:224 offset1:225
  s_waitcnt lgkmcnt(15)
  v_mfma_f32_16x16x32_bf16 v[168:171], a[188:191], a[216:219], v[168:171]
  ds_read2_b32 a[126:127], v225 offset0:226 offset1:227
  v_mfma_f32_16x16x32_bf16 v[164:167], a[188:191], a[212:215], v[164:167]
  ds_read_b128 a[144:147], v232 offset:3968
  v_mfma_f32_16x16x32_bf16 v[160:163], a[188:191], a[208:211], v[160:163]
  ds_read2_b32 a[128:129], v226 offset0:96 offset1:97
  s_waitcnt lgkmcnt(15)
  v_mfma_f32_16x16x32_bf16 v[168:171], a[192:195], a[212:215], v[168:171]
  ds_read2_b32 a[130:131], v226 offset0:98 offset1:99
  v_mfma_f32_16x16x32_bf16 v[164:167], a[192:195], a[208:211], v[164:167]
  ds_read2_b32 a[132:133], v226 offset0:224 offset1:225
  v_mfma_f32_16x16x32_bf16 v[168:171], a[196:199], a[208:211], v[168:171]
  ds_read2_b32 a[134:135], v226 offset0:226 offset1:227
  s_waitcnt lgkmcnt(13)
  v_mfma_f32_16x16x32_bf16 v[168:171], a[112:115], a[164:167], v[168:171]
  ds_read2_b32 a[176:177], v224 offset0:112 offset1:113
  ds_read2_b32 a[178:179], v224 offset0:114 offset1:115
  v_mfma_f32_16x16x32_bf16 v[164:167], a[112:115], a[160:163], v[164:167]
  ds_read_b128 a[228:231], v232 offset:1472
  ds_read_b128 a[224:227], v232 offset:1984
  v_mfma_f32_16x16x32_bf16 v[160:163], a[112:115], a[156:159], v[160:163]
  ds_read_b128 a[220:223], v232 offset:2496
  ds_read2_b32 a[180:181], v224 offset0:240 offset1:241
  s_waitcnt lgkmcnt(15)
  v_mfma_f32_16x16x32_bf16 v[168:171], a[116:119], a[160:163], v[168:171]
  ds_read2_b32 a[182:183], v224 offset0:242 offset1:243
  v_mfma_f32_16x16x32_bf16 v[164:167], a[116:119], a[156:159], v[164:167]
  ds_read_b128 a[216:219], v232 offset:3008
  v_mfma_f32_16x16x32_bf16 v[160:163], a[116:119], a[152:155], v[160:163]
  ds_read2_b32 a[184:185], v225 offset0:112 offset1:113
  s_waitcnt lgkmcnt(15)
  v_mfma_f32_16x16x32_bf16 v[168:171], a[120:123], a[156:159], v[168:171]
  ds_read2_b32 a[186:187], v225 offset0:114 offset1:115
  v_mfma_f32_16x16x32_bf16 v[164:167], a[120:123], a[152:155], v[164:167]
  ds_read_b128 a[212:215], v232 offset:3520
  v_mfma_f32_16x16x32_bf16 v[160:163], a[120:123], a[148:151], v[160:163]
  ds_read2_b32 a[188:189], v225 offset0:240 offset1:241
  s_waitcnt lgkmcnt(15)
  v_mfma_f32_16x16x32_bf16 v[168:171], a[124:127], a[152:155], v[168:171]
  ds_read2_b32 a[190:191], v225 offset0:242 offset1:243
  v_mfma_f32_16x16x32_bf16 v[164:167], a[124:127], a[148:151], v[164:167]
  ds_read_b128 a[208:211], v232 offset:4032
  v_mfma_f32_16x16x32_bf16 v[160:163], a[124:127], a[144:147], v[160:163]
  ds_read2_b32 a[192:193], v226 offset0:112 offset1:113
  s_waitcnt lgkmcnt(15)
  v_mfma_f32_16x16x32_bf16 v[168:171], a[128:131], a[148:151], v[168:171]
  ds_read2_b32 a[194:195], v226 offset0:114 offset1:115
  v_mfma_f32_16x16x32_bf16 v[164:167], a[128:131], a[144:147], v[164:167]
  ds_read2_b32 a[196:197], v226 offset0:240 offset1:241
  v_mfma_f32_16x16x32_bf16 v[168:171], a[132:135], a[144:147], v[168:171]
  ds_read2_b32 a[198:199], v226 offset0:242 offset1:243
  s_waitcnt lgkmcnt(13)
  v_mfma_f32_16x16x32_bf16 v[168:171], a[176:179], a[228:231], v[168:171]
  ds_read2_b32 a[112:113], v228 offset0:0 offset1:1
  ds_read2_b32 a[114:115], v228 offset0:2 offset1:3
  v_mfma_f32_16x16x32_bf16 v[164:167], a[176:179], a[224:227], v[164:167]
  ds_read_b128 a[164:167], v233 offset:1024
  ds_read_b128 a[160:163], v233 offset:1536
  v_mfma_f32_16x16x32_bf16 v[160:163], a[176:179], a[220:223], v[160:163]
  ds_read_b128 a[156:159], v233 offset:2048
  ds_read2_b32 a[116:117], v228 offset0:128 offset1:129
  s_waitcnt lgkmcnt(15)
  v_mfma_f32_16x16x32_bf16 v[168:171], a[180:183], a[224:227], v[168:171]
  ds_read2_b32 a[118:119], v228 offset0:130 offset1:131
  v_mfma_f32_16x16x32_bf16 v[164:167], a[180:183], a[220:223], v[164:167]
  ds_read_b128 a[152:155], v233 offset:2560
  v_mfma_f32_16x16x32_bf16 v[160:163], a[180:183], a[216:219], v[160:163]
  ds_read2_b32 a[120:121], v229 offset0:0 offset1:1
  s_waitcnt lgkmcnt(15)
  v_mfma_f32_16x16x32_bf16 v[168:171], a[184:187], a[220:223], v[168:171]
  ds_read2_b32 a[122:123], v229 offset0:2 offset1:3
  v_mfma_f32_16x16x32_bf16 v[164:167], a[184:187], a[216:219], v[164:167]
  ds_read_b128 a[148:151], v233 offset:3072
  v_mfma_f32_16x16x32_bf16 v[160:163], a[184:187], a[212:215], v[160:163]
  ds_read2_b32 a[124:125], v229 offset0:128 offset1:129
  s_waitcnt lgkmcnt(15)
  v_mfma_f32_16x16x32_bf16 v[168:171], a[188:191], a[216:219], v[168:171]
  ds_read2_b32 a[126:127], v229 offset0:130 offset1:131
  v_mfma_f32_16x16x32_bf16 v[164:167], a[188:191], a[212:215], v[164:167]
  ds_read_b128 a[144:147], v233 offset:3584
  v_mfma_f32_16x16x32_bf16 v[160:163], a[188:191], a[208:211], v[160:163]
  ds_read2_b32 a[128:129], v230 offset0:0 offset1:1
  s_waitcnt lgkmcnt(15)
  v_mfma_f32_16x16x32_bf16 v[168:171], a[192:195], a[212:215], v[168:171]
  ds_read2_b32 a[130:131], v230 offset0:2 offset1:3
  v_mfma_f32_16x16x32_bf16 v[164:167], a[192:195], a[208:211], v[164:167]
  ds_read2_b32 a[132:133], v230 offset0:128 offset1:129
  v_mfma_f32_16x16x32_bf16 v[168:171], a[196:199], a[208:211], v[168:171]
  ds_read2_b32 a[134:135], v230 offset0:130 offset1:131
  buffer_load_dword v252, v15, s[44:47], 0 offen sc1
  s_waitcnt lgkmcnt(13)
  v_mfma_f32_16x16x32_bf16 v[184:187], a[112:115], a[164:167], 0
  ds_read2_b32 a[176:177], v228 offset0:16 offset1:17
  ds_read2_b32 a[178:179], v228 offset0:18 offset1:19
  s_ff1_i32_b32 s20, s56
  s_bitset0_b32 s56, s20
  s_cmp_lt_i32 s20, 0
  s_mul_i32 s20, s20, 2508800
  s_cselect_b32 s20, 0x40000000, s20
  s_cselect_b32 s62, 0, 16
  s_or_b32 s61, s61, s62
  s_add_u32 s23, s20, s76
  buffer_load_dwordx4 v[80:83], v3, s[44:47], s23 offen sc1
  v_mfma_f32_16x16x32_bf16 v[180:183], a[112:115], a[160:163], 0
  ds_read_b128 a[228:231], v233 offset:1088
  ds_read_b128 a[224:227], v233 offset:1600
  s_add_u32 s23, s20, s77
  buffer_load_dwordx4 v[84:87], v3, s[44:47], s23 offen sc1
  v_mfma_f32_16x16x32_bf16 v[176:179], a[112:115], a[156:159], 0
  ds_read_b128 a[220:223], v233 offset:2112
  ds_read2_b32 a[180:181], v228 offset0:144 offset1:145
  s_add_u32 s23, s20, s96
  buffer_load_dwordx4 v[88:91], v3, s[44:47], s23 offen sc1
  s_waitcnt lgkmcnt(15)
  v_mfma_f32_16x16x32_bf16 v[184:187], a[116:119], a[160:163], v[184:187]
  ds_read2_b32 a[182:183], v228 offset0:146 offset1:147
  v_mfma_f32_16x16x32_bf16 v[180:183], a[116:119], a[156:159], v[180:183]
  ds_read_b128 a[216:219], v233 offset:2624
  v_mfma_f32_16x16x32_bf16 v[176:179], a[116:119], a[152:155], v[176:179]
  ds_read2_b32 a[184:185], v229 offset0:16 offset1:17
  s_waitcnt lgkmcnt(15)
  v_mfma_f32_16x16x32_bf16 v[184:187], a[120:123], a[156:159], v[184:187]
  ds_read2_b32 a[186:187], v229 offset0:18 offset1:19
  v_mfma_f32_16x16x32_bf16 v[180:183], a[120:123], a[152:155], v[180:183]
  ds_read_b128 a[212:215], v233 offset:3136
  v_mfma_f32_16x16x32_bf16 v[176:179], a[120:123], a[148:151], v[176:179]
  ds_read2_b32 a[188:189], v229 offset0:144 offset1:145
  s_waitcnt lgkmcnt(15)
  v_mfma_f32_16x16x32_bf16 v[184:187], a[124:127], a[152:155], v[184:187]
  ds_read2_b32 a[190:191], v229 offset0:146 offset1:147
  v_mfma_f32_16x16x32_bf16 v[180:183], a[124:127], a[148:151], v[180:183]
  ds_read_b128 a[208:211], v233 offset:3648
  v_mfma_f32_16x16x32_bf16 v[176:179], a[124:127], a[144:147], v[176:179]
  ds_read2_b32 a[192:193], v230 offset0:16 offset1:17
  s_waitcnt lgkmcnt(15)
  v_mfma_f32_16x16x32_bf16 v[184:187], a[128:131], a[148:151], v[184:187]
  ds_read2_b32 a[194:195], v230 offset0:18 offset1:19
  v_mfma_f32_16x16x32_bf16 v[180:183], a[128:131], a[144:147], v[180:183]
  ds_read2_b32 a[196:197], v230 offset0:144 offset1:145
  v_mfma_f32_16x16x32_bf16 v[184:187], a[132:135], a[144:147], v[184:187]
  ds_read2_b32 a[198:199], v230 offset0:146 offset1:147
  s_waitcnt lgkmcnt(13)
  v_mfma_f32_16x16x32_bf16 v[184:187], a[176:179], a[228:231], v[184:187]
  ds_read2_b32 a[112:113], v228 offset0:32 offset1:33
  ds_read2_b32 a[114:115], v228 offset0:34 offset1:35
  v_mfma_f32_16x16x32_bf16 v[180:183], a[176:179], a[224:227], v[180:183]
  ds_read_b128 a[164:167], v233 offset:1152
  ds_read_b128 a[160:163], v233 offset:1664
  v_mfma_f32_16x16x32_bf16 v[176:179], a[176:179], a[220:223], v[176:179]
  ds_read_b128 a[156:159], v233 offset:2176
  ds_read2_b32 a[116:117], v228 offset0:160 offset1:161
  s_waitcnt lgkmcnt(15)
  v_mfma_f32_16x16x32_bf16 v[184:187], a[180:183], a[224:227], v[184:187]
  ds_read2_b32 a[118:119], v228 offset0:162 offset1:163
  v_mfma_f32_16x16x32_bf16 v[180:183], a[180:183], a[220:223], v[180:183]
  ds_read_b128 a[152:155], v233 offset:2688
  v_mfma_f32_16x16x32_bf16 v[176:179], a[180:183], a[216:219], v[176:179]
  ds_read2_b32 a[120:121], v229 offset0:32 offset1:33
  s_waitcnt lgkmcnt(15)
  v_mfma_f32_16x16x32_bf16 v[184:187], a[184:187], a[220:223], v[184:187]
  ds_read2_b32 a[122:123], v229 offset0:34 offset1:35
  v_mfma_f32_16x16x32_bf16 v[180:183], a[184:187], a[216:219], v[180:183]
  ds_read_b128 a[148:151], v233 offset:3200
  v_mfma_f32_16x16x32_bf16 v[176:179], a[184:187], a[212:215], v[176:179]
  ds_read2_b32 a[124:125], v229 offset0:160 offset1:161
  s_waitcnt lgkmcnt(15)
  v_mfma_f32_16x16x32_bf16 v[184:187], a[188:191], a[216:219], v[184:187]
  ds_read2_b32 a[126:127], v229 offset0:162 offset1:163
  v_mfma_f32_16x16x32_bf16 v[180:183], a[188:191], a[212:215], v[180:183]
  ds_read_b128 a[144:147], v233 offset:3712
  v_mfma_f32_16x16x32_bf16 v[176:179], a[188:191], a[208:211], v[176:179]
  ds_read2_b32 a[128:129], v230 offset0:32 offset1:33
  s_waitcnt lgkmcnt(15)
  v_mfma_f32_16x16x32_bf16 v[184:187], a[192:195], a[212:215], v[184:187]
  ds_read2_b32 a[130:131], v230 offset0:34 offset1:35
  v_mfma_f32_16x16x32_bf16 v[180:183], a[192:195], a[208:211], v[180:183]
  ds_read2_b32 a[132:133], v230 offset0:160 offset1:161
  v_mfma_f32_16x16x32_bf16 v[184:187], a[196:199], a[208:211], v[184:187]
  ds_read2_b32 a[134:135], v230 offset0:162 offset1:163
  s_waitcnt lgkmcnt(13)
  v_mfma_f32_16x16x32_bf16 v[184:187], a[112:115], a[164:167], v[184:187]
  ds_read2_b32 a[176:177], v228 offset0:48 offset1:49
  ds_read2_b32 a[178:179], v228 offset0:50 offset1:51
  v_mfma_f32_16x16x32_bf16 v[180:183], a[112:115], a[160:163], v[180:183]
  ds_read_b128 a[228:231], v233 offset:1216
  ds_read_b128 a[224:227], v233 offset:1728
  v_mfma_f32_16x16x32_bf16 v[176:179], a[112:115], a[156:159], v[176:179]
  ds_read_b128 a[220:223], v233 offset:2240
  ds_read2_b32 a[180:181], v228 offset0:176 offset1:177
  s_waitcnt lgkmcnt(15)
  v_mfma_f32_16x16x32_bf16 v[184:187], a[116:119], a[160:163], v[184:187]
  ds_read2_b32 a[182:183], v228 offset0:178 offset1:179
  v_mfma_f32_16x16x32_bf16 v[180:183], a[116:119], a[156:159], v[180:183]
  ds_read_b128 a[216:219], v233 offset:2752
  v_mfma_f32_16x16x32_bf16 v[176:179], a[116:119], a[152:155], v[176:179]
  ds_read2_b32 a[184:185], v229 offset0:48 offset1:49
  s_waitcnt lgkmcnt(15)
  v_mfma_f32_16x16x32_bf16 v[184:187], a[120:123], a[156:159], v[184:187]
  ds_read2_b32 a[186:187], v229 offset0:50 offset1:51
  v_mfma_f32_16x16x32_bf16 v[180:183], a[120:123], a[152:155], v[180:183]
  ds_read_b128 a[212:215], v233 offset:3264
  v_mfma_f32_16x16x32_bf16 v[176:179], a[120:123], a[148:151], v[176:179]
  ds_read2_b32 a[188:189], v229 offset0:176 offset1:177
  s_waitcnt lgkmcnt(15)
  v_mfma_f32_16x16x32_bf16 v[184:187], a[124:127], a[152:155], v[184:187]
  ds_read2_b32 a[190:191], v229 offset0:178 offset1:179
  v_mfma_f32_16x16x32_bf16 v[180:183], a[124:127], a[148:151], v[180:183]
  ds_read_b128 a[208:211], v233 offset:3776
  v_mfma_f32_16x16x32_bf16 v[176:179], a[124:127], a[144:147], v[176:179]
  ds_read2_b32 a[192:193], v230 offset0:48 offset1:49
  s_waitcnt lgkmcnt(15)
  v_mfma_f32_16x16x32_bf16 v[184:187], a[128:131], a[148:151], v[184:187]
  ds_read2_b32 a[194:195], v230 offset0:50 offset1:51
  v_mfma_f32_16x16x32_bf16 v[180:183], a[128:131], a[144:147], v[180:183]
  ds_read2_b32 a[196:197], v230 offset0:176 offset1:177
  v_mfma_f32_16x16x32_bf16 v[184:187], a[132:135], a[144:147], v[184:187]
  ds_read2_b32 a[198:199], v230 offset0:178 offset1:179
  s_waitcnt lgkmcnt(13)
  v_mfma_f32_16x16x32_bf16 v[184:187], a[176:179], a[228:231], v[184:187]
  ds_read2_b32 a[112:113], v228 offset0:64 offset1:65
  ds_read2_b32 a[114:115], v228 offset0:66 offset1:67
  v_mfma_f32_16x16x32_bf16 v[180:183], a[176:179], a[224:227], v[180:183]
  ds_read_b128 a[164:167], v233 offset:1280
  ds_read_b128 a[160:163], v233 offset:1792
  v_mfma_f32_16x16x32_bf16 v[176:179], a[176:179], a[220:223], v[176:179]
  ds_read_b128 a[156:159], v233 offset:2304
  ds_read2_b32 a[116:117], v228 offset0:192 offset1:193
  s_waitcnt lgkmcnt(15)
  v_mfma_f32_16x16x32_bf16 v[184:187], a[180:183], a[224:227], v[184:187]
  ds_read2_b32 a[118:119], v228 offset0:194 offset1:195
  v_mfma_f32_16x16x32_bf16 v[180:183], a[180:183], a[220:223], v[180:183]
  ds_read_b128 a[152:155], v233 offset:2816
  v_mfma_f32_16x16x32_bf16 v[176:179], a[180:183], a[216:219], v[176:179]
  ds_read2_b32 a[120:121], v229 offset0:64 offset1:65
  s_waitcnt lgkmcnt(15)
  v_mfma_f32_16x16x32_bf16 v[184:187], a[184:187], a[220:223], v[184:187]
  ds_read2_b32 a[122:123], v229 offset0:66 offset1:67
  v_mfma_f32_16x16x32_bf16 v[180:183], a[184:187], a[216:219], v[180:183]
  ds_read_b128 a[148:151], v233 offset:3328
  v_mfma_f32_16x16x32_bf16 v[176:179], a[184:187], a[212:215], v[176:179]
  ds_read2_b32 a[124:125], v229 offset0:192 offset1:193
  s_waitcnt lgkmcnt(15)
  v_mfma_f32_16x16x32_bf16 v[184:187], a[188:191], a[216:219], v[184:187]
  ds_read2_b32 a[126:127], v229 offset0:194 offset1:195
  v_mfma_f32_16x16x32_bf16 v[180:183], a[188:191], a[212:215], v[180:183]
  ds_read_b128 a[144:147], v233 offset:3840
  v_mfma_f32_16x16x32_bf16 v[176:179], a[188:191], a[208:211], v[176:179]
  ds_read2_b32 a[128:129], v230 offset0:64 offset1:65
  s_waitcnt lgkmcnt(15)
  v_mfma_f32_16x16x32_bf16 v[184:187], a[192:195], a[212:215], v[184:187]
  ds_read2_b32 a[130:131], v230 offset0:66 offset1:67
  v_mfma_f32_16x16x32_bf16 v[180:183], a[192:195], a[208:211], v[180:183]
  ds_read2_b32 a[132:133], v230 offset0:192 offset1:193
  v_mfma_f32_16x16x32_bf16 v[184:187], a[196:199], a[208:211], v[184:187]
  ds_read2_b32 a[134:135], v230 offset0:194 offset1:195
  s_waitcnt lgkmcnt(13)
  v_mfma_f32_16x16x32_bf16 v[184:187], a[112:115], a[164:167], v[184:187]
  ds_read2_b32 a[176:177], v228 offset0:80 offset1:81
  ds_read2_b32 a[178:179], v228 offset0:82 offset1:83
  v_mfma_f32_16x16x32_bf16 v[180:183], a[112:115], a[160:163], v[180:183]
  ds_read_b128 a[228:231], v233 offset:1344
  ds_read_b128 a[224:227], v233 offset:1856
  v_mfma_f32_16x16x32_bf16 v[176:179], a[112:115], a[156:159], v[176:179]
  ds_read_b128 a[220:223], v233 offset:2368
  ds_read2_b32 a[180:181], v228 offset0:208 offset1:209
  s_waitcnt lgkmcnt(15)
  v_mfma_f32_16x16x32_bf16 v[184:187], a[116:119], a[160:163], v[184:187]
  ds_read2_b32 a[182:183], v228 offset0:210 offset1:211
  v_mfma_f32_16x16x32_bf16 v[180:183], a[116:119], a[156:159], v[180:183]
  ds_read_b128 a[216:219], v233 offset:2880
  v_mfma_f32_16x16x32_bf16 v[176:179], a[116:119], a[152:155], v[176:179]
  ds_read2_b32 a[184:185], v229 offset0:80 offset1:81
  s_waitcnt lgkmcnt(15)
  v_mfma_f32_16x16x32_bf16 v[184:187], a[120:123], a[156:159], v[184:187]
  ds_read2_b32 a[186:187], v229 offset0:82 offset1:83
  v_mfma_f32_16x16x32_bf16 v[180:183], a[120:123], a[152:155], v[180:183]
  ds_read_b128 a[212:215], v233 offset:3392
  v_mfma_f32_16x16x32_bf16 v[176:179], a[120:123], a[148:151], v[176:179]
  ds_read2_b32 a[188:189], v229 offset0:208 offset1:209
  s_waitcnt lgkmcnt(15)
  v_mfma_f32_16x16x32_bf16 v[184:187], a[124:127], a[152:155], v[184:187]
  ds_read2_b32 a[190:191], v229 offset0:210 offset1:211
  v_mfma_f32_16x16x32_bf16 v[180:183], a[124:127], a[148:151], v[180:183]
  ds_read_b128 a[208:211], v233 offset:3904
  v_mfma_f32_16x16x32_bf16 v[176:179], a[124:127], a[144:147], v[176:179]
  ds_read2_b32 a[192:193], v230 offset0:80 offset1:81
  s_waitcnt lgkmcnt(15)
  v_mfma_f32_16x16x32_bf16 v[184:187], a[128:131], a[148:151], v[184:187]
  ds_read2_b32 a[194:195], v230 offset0:82 offset1:83
  v_mfma_f32_16x16x32_bf16 v[180:183], a[128:131], a[144:147], v[180:183]
  ds_read2_b32 a[196:197], v230 offset0:208 offset1:209
  v_mfma_f32_16x16x32_bf16 v[184:187], a[132:135], a[144:147], v[184:187]
  ds_read2_b32 a[198:199], v230 offset0:210 offset1:211
  s_waitcnt vmcnt(3)
  v_subrev_u32 v253, s78, v252
  v_cmp_eq_u32 vcc, 4, v253
  s_nop 1
  s_lshr_b32 s20, vcc_lo, 16
  s_and_b32 s20, s20, vcc_lo
  s_lshr_b32 s23, s20, 1
  s_and_b32 s20, s20, s23
  s_and_b32 s20, s20, s57
  s_andn2_b32 s57, s57, s20
  s_or_b32 s56, s56, s20
  buffer_load_dword v252, v15, s[44:47], 0 offen sc1
  s_waitcnt lgkmcnt(13)
  v_mfma_f32_16x16x32_bf16 v[184:187], a[176:179], a[228:231], v[184:187]
  ds_read2_b32 a[112:113], v228 offset0:96 offset1:97
  ds_read2_b32 a[114:115], v228 offset0:98 offset1:99
  s_ff1_i32_b32 s20, s56
  s_bitset0_b32 s56, s20
  s_cmp_lt_i32 s20, 0
  s_mul_i32 s20, s20, 2508800
  s_cselect_b32 s20, 0x40000000, s20
  s_cselect_b32 s62, 0, 32
  s_or_b32 s61, s61, s62
  s_add_u32 s23, s20, s76
  buffer_load_dwordx4 v[96:99], v3, s[44:47], s23 offen sc1
  v_mfma_f32_16x16x32_bf16 v[180:183], a[176:179], a[224:227], v[180:183]
  ds_read_b128 a[164:167], v233 offset:1408
  ds_read_b128 a[160:163], v233 offset:1920
  s_add_u32 s23, s20, s77
  buffer_load_dwordx4 v[100:103], v3, s[44:47], s23 offen sc1
  v_mfma_f32_16x16x32_bf16 v[176:179], a[176:179], a[220:223], v[176:179]
  ds_read_b128 a[156:159], v233 offset:2432
  ds_read2_b32 a[116:117], v228 offset0:224 offset1:225
  s_add_u32 s23, s20, s96
  buffer_load_dwordx4 v[104:107], v3, s[44:47], s23 offen sc1
  s_waitcnt lgkmcnt(15)
  v_mfma_f32_16x16x32_bf16 v[184:187], a[180:183], a[224:227], v[184:187]
  ds_read2_b32 a[118:119], v228 offset0:226 offset1:227
  s_ff1_i32_b32 s20, s56
  s_bitset0_b32 s56, s20
  s_cmp_lt_i32 s20, 0
  s_mul_i32 s20, s20, 2508800
  s_cselect_b32 s20, 0x40000000, s20
  s_cselect_b32 s62, 0, 64
  s_or_b32 s61, s61, s62
  s_add_u32 s23, s20, s76
  buffer_load_dwordx4 v[112:115], v3, s[44:47], s23 offen sc1
  v_mfma_f32_16x16x32_bf16 v[180:183], a[180:183], a[220:223], v[180:183]
  ds_read_b128 a[152:155], v233 offset:2944
  s_add_u32 s23, s20, s77
  buffer_load_dwordx4 v[116:119], v3, s[44:47], s23 offen sc1
  v_mfma_f32_16x16x32_bf16 v[176:179], a[180:183], a[216:219], v[176:179]
  ds_read2_b32 a[120:121], v229 offset0:96 offset1:97
  s_add_u32 s23, s20, s96
  buffer_load_dwordx4 v[120:123], v3, s[44:47], s23 offen sc1
  s_waitcnt lgkmcnt(15)
  v_mfma_f32_16x16x32_bf16 v[184:187], a[184:187], a[220:223], v[184:187]
  ds_read2_b32 a[122:123], v229 offset0:98 offset1:99
  v_mfma_f32_16x16x32_bf16 v[180:183], a[184:187], a[216:219], v[180:183]
  ds_read_b128 a[148:151], v233 offset:3456
  v_mfma_f32_16x16x32_bf16 v[176:179], a[184:187], a[212:215], v[176:179]
  ds_read2_b32 a[124:125], v229 offset0:224 offset1:225
  s_waitcnt lgkmcnt(15)
  v_mfma_f32_16x16x32_bf16 v[184:187], a[188:191], a[216:219], v[184:187]
  ds_read2_b32 a[126:127], v229 offset0:226 offset1:227
  v_mfma_f32_16x16x32_bf16 v[180:183], a[188:191], a[212:215], v[180:183]
  ds_read_b128 a[144:147], v233 offset:3968
  v_mfma_f32_16x16x32_bf16 v[176:179], a[188:191], a[208:211], v[176:179]
  ds_read2_b32 a[128:129], v230 offset0:96 offset1:97
  s_waitcnt lgkmcnt(15)
  v_mfma_f32_16x16x32_bf16 v[184:187], a[192:195], a[212:215], v[184:187]
  ds_read2_b32 a[130:131], v230 offset0:98 offset1:99
  v_mfma_f32_16x16x32_bf16 v[180:183], a[192:195], a[208:211], v[180:183]
  ds_read2_b32 a[132:133], v230 offset0:224 offset1:225
  v_mfma_f32_16x16x32_bf16 v[184:187], a[196:199], a[208:211], v[184:187]
  ds_read2_b32 a[134:135], v230 offset0:226 offset1:227
  s_waitcnt lgkmcnt(13)
  v_mfma_f32_16x16x32_bf16 v[184:187], a[112:115], a[164:167], v[184:187]
  ds_read2_b32 a[176:177], v228 offset0:112 offset1:113
  ds_read2_b32 a[178:179], v228 offset0:114 offset1:115
  v_mfma_f32_16x16x32_bf16 v[180:183], a[112:115], a[160:163], v[180:183]
  ds_read_b128 a[228:231], v233 offset:1472
  ds_read_b128 a[224:227], v233 offset:1984
  v_mfma_f32_16x16x32_bf16 v[176:179], a[112:115], a[156:159], v[176:179]
  ds_read_b128 a[220:223], v233 offset:2496
  ds_read2_b32 a[180:181], v228 offset0:240 offset1:241
  s_waitcnt lgkmcnt(15)
  v_mfma_f32_16x16x32_bf16 v[184:187], a[116:119], a[160:163], v[184:187]
  ds_read2_b32 a[182:183], v228 offset0:242 offset1:243
  v_mfma_f32_16x16x32_bf16 v[180:183], a[116:119], a[156:159], v[180:183]
  ds_read_b128 a[216:219], v233 offset:3008
  v_mfma_f32_16x16x32_bf16 v[176:179], a[116:119], a[152:155], v[176:179]
  ds_read2_b32 a[184:185], v229 offset0:112 offset1:113
  s_waitcnt lgkmcnt(15)
  v_mfma_f32_16x16x32_bf16 v[184:187], a[120:123], a[156:159], v[184:187]
  ds_read2_b32 a[186:187], v229 offset0:114 offset1:115
  v_mfma_f32_16x16x32_bf16 v[180:183], a[120:123], a[152:155], v[180:183]
  ds_read_b128 a[212:215], v233 offset:3520
  v_mfma_f32_16x16x32_bf16 v[176:179], a[120:123], a[148:151], v[176:179]
  ds_read2_b32 a[188:189], v229 offset0:240 offset1:241
  s_waitcnt lgkmcnt(15)
  v_mfma_f32_16x16x32_bf16 v[184:187], a[124:127], a[152:155], v[184:187]
  ds_read2_b32 a[190:191], v229 offset0:242 offset1:243
  v_mfma_f32_16x16x32_bf16 v[180:183], a[124:127], a[148:151], v[180:183]
  ds_read_b128 a[208:211], v233 offset:4032
  v_mfma_f32_16x16x32_bf16 v[176:179], a[124:127], a[144:147], v[176:179]
  ds_read2_b32 a[192:193], v230 offset0:112 offset1:113
  s_waitcnt lgkmcnt(15)
  v_mfma_f32_16x16x32_bf16 v[184:187], a[128:131], a[148:151], v[184:187]
  ds_read2_b32 a[194:195], v230 offset0:114 offset1:115
  v_mfma_f32_16x16x32_bf16 v[180:183], a[128:131], a[144:147], v[180:183]
  ds_read2_b32 a[196:197], v230 offset0:240 offset1:241
  v_mfma_f32_16x16x32_bf16 v[184:187], a[132:135], a[144:147], v[184:187]
  ds_read2_b32 a[198:199], v230 offset0:242 offset1:243
  s_waitcnt lgkmcnt(13)
  v_mfma_f32_16x16x32_bf16 v[184:187], a[176:179], a[228:231], v[184:187]
  v_mfma_f32_16x16x32_bf16 v[180:183], a[176:179], a[224:227], v[180:183]
  v_mfma_f32_16x16x32_bf16 v[176:179], a[176:179], a[220:223], v[176:179]
  s_waitcnt lgkmcnt(10)
  v_mfma_f32_16x16x32_bf16 v[184:187], a[180:183], a[224:227], v[184:187]
  v_mfma_f32_16x16x32_bf16 v[180:183], a[180:183], a[220:223], v[180:183]
  v_mfma_f32_16x16x32_bf16 v[176:179], a[180:183], a[216:219], v[176:179]
  s_waitcnt lgkmcnt(7)
  v_mfma_f32_16x16x32_bf16 v[184:187], a[184:187], a[220:223], v[184:187]
  v_mfma_f32_16x16x32_bf16 v[180:183], a[184:187], a[216:219], v[180:183]
  v_mfma_f32_16x16x32_bf16 v[176:179], a[184:187], a[212:215], v[176:179]
  s_waitcnt lgkmcnt(4)
  v_mfma_f32_16x16x32_bf16 v[184:187], a[188:191], a[216:219], v[184:187]
  v_mfma_f32_16x16x32_bf16 v[180:183], a[188:191], a[212:215], v[180:183]
  v_mfma_f32_16x16x32_bf16 v[176:179], a[188:191], a[208:211], v[176:179]
  s_waitcnt lgkmcnt(0)
  v_mfma_f32_16x16x32_bf16 v[184:187], a[192:195], a[212:215], v[184:187]
  v_mfma_f32_16x16x32_bf16 v[180:183], a[192:195], a[208:211], v[180:183]
  v_mfma_f32_16x16x32_bf16 v[184:187], a[196:199], a[208:211], v[184:187]
  s_ff1_i32_b32 s20, s56
  s_bitset0_b32 s56, s20
  s_cmp_lt_i32 s20, 0
  s_mul_i32 s20, s20, 2508800
  s_cselect_b32 s20, 0x40000000, s20
  s_cselect_b32 s62, 0, 128
  s_or_b32 s61, s61, s62
  s_add_u32 s23, s20, s76
  buffer_load_dwordx4 v[128:131], v3, s[44:47], s23 offen sc1
  s_add_u32 s23, s20, s77
  buffer_load_dwordx4 v[132:135], v3, s[44:47], s23 offen sc1
  s_add_u32 s23, s20, s96
  buffer_load_dwordx4 v[136:139], v3, s[44:47], s23 offen sc1
  v_dot2_f32_bf16 v192, v16, s54, 0
  v_dot2_f32_bf16 v193, v16, s55, 0
  v_dot2_f32_bf16 v194, v17, s54, 0
  v_dot2_f32_bf16 v195, v17, s55, 0
  v_dot2_f32_bf16 v196, v18, s54, 0
  v_dot2_f32_bf16 v197, v18, s55, 0
  v_dot2_f32_bf16 v198, v19, s54, 0
  v_dot2_f32_bf16 v199, v19, s55, 0
  v_dot2_f32_bf16 v200, v20, s54, 0
  v_dot2_f32_bf16 v201, v20, s55, 0
  v_dot2_f32_bf16 v202, v21, s54, 0
  v_dot2_f32_bf16 v203, v21, s55, 0
  v_dot2_f32_bf16 v204, v22, s54, 0
  v_dot2_f32_bf16 v205, v22, s55, 0
  v_dot2_f32_bf16 v206, v23, s54, 0
  v_dot2_f32_bf16 v207, v23, s55, 0
  v_dot2_f32_bf16 v208, v24, s54, 0
  v_dot2_f32_bf16 v209, v24, s55, 0
  v_dot2_f32_bf16 v210, v25, s54, 0
  v_dot2_f32_bf16 v211, v25, s55, 0
  v_dot2_f32_bf16 v212, v26, s54, 0
  v_dot2_f32_bf16 v213, v26, s55, 0
  v_dot2_f32_bf16 v214, v27, s54, 0
  v_dot2_f32_bf16 v215, v27, s55, 0
  v_dot2_f32_bf16 v192, v32, s54, v192
  v_dot2_f32_bf16 v193, v32, s55, v193
  v_dot2_f32_bf16 v194, v33, s54, v194
  v_dot2_f32_bf16 v195, v33, s55, v195
  v_dot2_f32_bf16 v196, v34, s54, v196
  v_dot2_f32_bf16 v197, v34, s55, v197
  v_dot2_f32_bf16 v198, v35, s54, v198
  v_dot2_f32_bf16 v199, v35, s55, v199
  v_dot2_f32_bf16 v200, v36, s54, v200
  v_dot2_f32_bf16 v201, v36, s55, v201
  v_dot2_f32_bf16 v202, v37, s54, v202
  v_dot2_f32_bf16 v203, v37, s55, v203
  v_dot2_f32_bf16 v204, v38, s54, v204
  v_dot2_f32_bf16 v205, v38, s55, v205
  v_dot2_f32_bf16 v206, v39, s54, v206
  v_dot2_f32_bf16 v207, v39, s55, v207
  v_dot2_f32_bf16 v208, v40, s54, v208
  v_dot2_f32_bf16 v209, v40, s55, v209
  v_dot2_f32_bf16 v210, v41, s54, v210
  v_dot2_f32_bf16 v211, v41, s55, v211
  v_dot2_f32_bf16 v212, v42, s54, v212
  v_dot2_f32_bf16 v213, v42, s55, v213
  v_dot2_f32_bf16 v214, v43, s54, v214
  v_dot2_f32_bf16 v215, v43, s55, v215
  v_dot2_f32_bf16 v192, v48, s54, v192
  v_dot2_f32_bf16 v193, v48, s55, v193
  v_dot2_f32_bf16 v194, v49, s54, v194
  v_dot2_f32_bf16 v195, v49, s55, v195
  v_dot2_f32_bf16 v196, v50, s54, v196
  v_dot2_f32_bf16 v197, v50, s55, v197
  v_dot2_f32_bf16 v198, v51, s54, v198
  v_dot2_f32_bf16 v199, v51, s55, v199
  v_dot2_f32_bf16 v200, v52, s54, v200
  v_dot2_f32_bf16 v201, v52, s55, v201
  v_dot2_f32_bf16 v202, v53, s54, v202
  v_dot2_f32_bf16 v203, v53, s55, v203
  v_dot2_f32_bf16 v204, v54, s54, v204
  v_dot2_f32_bf16 v205, v54, s55, v205
  v_dot2_f32_bf16 v206, v55, s54, v206
  v_dot2_f32_bf16 v207, v55, s55, v207
  v_dot2_f32_bf16 v208, v56, s54, v208
  v_dot2_f32_bf16 v209, v56, s55, v209
  v_dot2_f32_bf16 v210, v57, s54, v210
  v_dot2_f32_bf16 v211, v57, s55, v211
  v_dot2_f32_bf16 v212, v58, s54, v212
  v_dot2_f32_bf16 v213, v58, s55, v213
  v_dot2_f32_bf16 v214, v59, s54, v214
  v_dot2_f32_bf16 v215, v59, s55, v215
  v_dot2_f32_bf16 v192, v64, s54, v192
  v_dot2_f32_bf16 v193, v64, s55, v193
  v_dot2_f32_bf16 v194, v65, s54, v194
  v_dot2_f32_bf16 v195, v65, s55, v195
  v_dot2_f32_bf16 v196, v66, s54, v196
  v_dot2_f32_bf16 v197, v66, s55, v197
  v_dot2_f32_bf16 v198, v67, s54, v198
  v_dot2_f32_bf16 v199, v67, s55, v199
  v_dot2_f32_bf16 v200, v68, s54, v200
  v_dot2_f32_bf16 v201, v68, s55, v201
  v_dot2_f32_bf16 v202, v69, s54, v202
  v_dot2_f32_bf16 v203, v69, s55, v203
  v_dot2_f32_bf16 v204, v70, s54, v204
  v_dot2_f32_bf16 v205, v70, s55, v205
  v_dot2_f32_bf16 v206, v71, s54, v206
  v_dot2_f32_bf16 v207, v71, s55, v207
  v_dot2_f32_bf16 v208, v72, s54, v208
  v_dot2_f32_bf16 v209, v72, s55, v209
  v_dot2_f32_bf16 v210, v73, s54, v210
  v_dot2_f32_bf16 v211, v73, s55, v211
  v_dot2_f32_bf16 v212, v74, s54, v212
  v_dot2_f32_bf16 v213, v74, s55, v213
  v_dot2_f32_bf16 v214, v75, s54, v214
  v_dot2_f32_bf16 v215, v75, s55, v215
  s_andn2_b32 s61, s61, 15
  ds_read_b64 v[16:17], v234 offset:2048
  ds_read_b64 v[18:19], v234 offset:1536
  ds_read_b64 v[20:21], v234 offset:1024
  ds_read_b64 v[22:23], v235 offset:2048
  ds_read_b64 v[24:25], v235 offset:1536
  ds_read_b64 v[26:27], v235 offset:1024
  v_lshlrev_b32 v8, 16, v8
  v_lshlrev_b32 v10, 16, v10
  s_waitcnt lgkmcnt(5)
  v_and_b32 v248, 0xffff0000, v17
  v_lshlrev_b32 v249, 16, v17
  v_and_b32 v250, 0xffff0000, v16
  v_lshlrev_b32 v251, 16, v16
  v_pk_fma_f32 v[160:161], v[248:249], v[8:9], v[160:161] op_sel_hi:[1,0,1]
  v_pk_fma_f32 v[162:163], v[250:251], v[8:9], v[162:163] op_sel_hi:[1,0,1]
  v_cvt_pk_bf16_f32 v16, v160, v161
  v_cvt_pk_bf16_f32 v17, v162, v163
  ds_write_b64 v236, v[16:17] offset:0
  s_waitcnt lgkmcnt(5)
  v_and_b32 v248, 0xffff0000, v19
  v_lshlrev_b32 v249, 16, v19
  v_and_b32 v250, 0xffff0000, v18
  v_lshlrev_b32 v251, 16, v18
  v_pk_fma_f32 v[164:165], v[248:249], v[8:9], v[164:165] op_sel_hi:[1,0,1]
  v_pk_fma_f32 v[166:167], v[250:251], v[8:9], v[166:167] op_sel_hi:[1,0,1]
  v_cvt_pk_bf16_f32 v18, v164, v165
  v_cvt_pk_bf16_f32 v19, v166, v167
  ds_write_b64 v236, v[18:19] offset:512
  s_waitcnt lgkmcnt(5)
  v_and_b32 v248, 0xffff0000, v21
  v_lshlrev_b32 v249, 16, v21
  v_and_b32 v250, 0xffff0000, v20
  v_lshlrev_b32 v251, 16, v20
  v_pk_fma_f32 v[168:169], v[248:249], v[8:9], v[168:169] op_sel_hi:[1,0,1]
  v_pk_fma_f32 v[170:171], v[250:251], v[8:9], v[170:171] op_sel_hi:[1,0,1]
  v_cvt_pk_bf16_f32 v20, v168, v169
  v_cvt_pk_bf16_f32 v21, v170, v171
  ds_write_b64 v236, v[20:21] offset:1024
  s_waitcnt lgkmcnt(5)
  v_and_b32 v248, 0xffff0000, v23
  v_lshlrev_b32 v249, 16, v23
  v_and_b32 v250, 0xffff0000, v22
  v_lshlrev_b32 v251, 16, v22
  v_pk_fma_f32 v[176:177], v[248:249], v[10:11], v[176:177] op_sel_hi:[1,0,1]
  v_pk_fma_f32 v[178:179], v[250:251], v[10:11], v[178:179] op_sel_hi:[1,0,1]
  v_cvt_pk_bf16_f32 v22, v176, v177
  v_cvt_pk_bf16_f32 v23, v178, v179
  ds_write_b64 v236, v[22:23] offset:2112
  s_waitcnt lgkmcnt(5)
  v_and_b32 v248, 0xffff0000, v25
  v_lshlrev_b32 v249, 16, v25
  v_and_b32 v250, 0xffff0000, v24
  v_lshlrev_b32 v251, 16, v24
  v_pk_fma_f32 v[180:181], v[248:249], v[10:11], v[180:181] op_sel_hi:[1,0,1]
  v_pk_fma_f32 v[182:183], v[250:251], v[10:11], v[182:183] op_sel_hi:[1,0,1]
  v_cvt_pk_bf16_f32 v24, v180, v181
  v_cvt_pk_bf16_f32 v25, v182, v183
  ds_write_b64 v236, v[24:25] offset:2624
  s_waitcnt lgkmcnt(5)
  v_and_b32 v248, 0xffff0000, v27
  v_lshlrev_b32 v249, 16, v27
  v_and_b32 v250, 0xffff0000, v26
  v_lshlrev_b32 v251, 16, v26
  v_pk_fma_f32 v[184:185], v[248:249], v[10:11], v[184:185] op_sel_hi:[1,0,1]
  v_pk_fma_f32 v[186:187], v[250:251], v[10:11], v[186:187] op_sel_hi:[1,0,1]
  v_cvt_pk_bf16_f32 v26, v184, v185
  v_cvt_pk_bf16_f32 v27, v186, v187
  ds_write_b64 v236, v[26:27] offset:3136
  s_branch KF_post3
KF_conv2:
  ds_read2_b32 a[112:113], v224 offset0:0 offset1:1
  ds_read2_b32 a[114:115], v224 offset0:2 offset1:3
  ds_read_b128 a[152:155], v232 offset:2560
  ds_read_b128 a[148:151], v232 offset:3072
  ds_read_b128 a[144:147], v232 offset:3584
  ds_read2_b32 a[116:117], v224 offset0:128 offset1:129
  ds_read2_b32 a[118:119], v224 offset0:130 offset1:131
  ds_read2_b32 a[120:121], v225 offset0:0 offset1:1
  ds_read2_b32 a[122:123], v225 offset0:2 offset1:3
  s_waitcnt lgkmcnt(4)
  v_mfma_f32_16x16x32_bf16 v[168:171], a[112:115], a[152:155], 0
  ds_read2_b32 a[176:177], v224 offset0:16 offset1:17
  ds_read2_b32 a[178:179], v224 offset0:18 offset1:19
  v_mfma_f32_16x16x32_bf16 v[164:167], a[112:115], a[148:151], 0
  ds_read_b128 a[216:219], v232 offset:2624
  ds_read_b128 a[212:215], v232 offset:3136
  ds_write_b128 v255, a[244:247]
  v_mfma_f32_16x16x32_bf16 v[160:163], a[112:115], a[144:147], 0
  ds_read_b128 a[208:211], v232 offset:3648
  ds_read2_b32 a[180:181], v224 offset0:144 offset1:145
  s_waitcnt lgkmcnt(7)
  v_mfma_f32_16x16x32_bf16 v[168:171], a[116:119], a[148:151], v[168:171]
  ds_read2_b32 a[182:183], v224 offset0:146 offset1:147
  v_mfma_f32_16x16x32_bf16 v[164:167], a[116:119], a[144:147], v[164:167]
  ds_read2_b32 a[184:185], v225 offset0:16 offset1:17
  ds_write_b128 v255, a[252:255] offset:4160
  v_mfma_f32_16x16x32_bf16 v[168:171], a[120:123], a[144:147], v[168:171]
  ds_read2_b32 a[186:187], v225 offset0:18 offset1:19
  s_waitcnt lgkmcnt(5)
  v_mfma_f32_16x16x32_bf16 v[168:171], a[176:179], a[216:219], v[168:171]
  ds_read2_b32 a[112:113], v224 offset0:32 offset1:33
  ds_read2_b32 a[114:115], v224 offset0:34 offset1:35
  v_mfma_f32_16x16x32_bf16 v[164:167], a[176:179], a[212:215], v[164:167]
  ds_read_b128 a[152:155], v232 offset:2688
  ds_read_b128 a[148:151], v232 offset:3200
  ds_write_b128 v255, a[244:247] offset:12416
  v_mfma_f32_16x16x32_bf16 v[160:163], a[176:179], a[208:211], v[160:163]
  ds_read_b128 a[144:147], v232 offset:3712
  ds_read2_b32 a[116:117], v224 offset0:160 offset1:161
  s_waitcnt lgkmcnt(7)
  v_mfma_f32_16x16x32_bf16 v[168:171], a[180:183], a[212:215], v[168:171]
  ds_read2_b32 a[118:119], v224 offset0:162 offset1:163
  v_mfma_f32_16x16x32_bf16 v[164:167], a[180:183], a[208:211], v[164:167]
  ds_read2_b32 a[120:121], v225 offset0:32 offset1:33
  ds_write_b128 v255, v[208:211] offset:4192
  v_mfma_f32_16x16x32_bf16 v[168:171], a[184:187], a[208:211], v[168:171]
  ds_read2_b32 a[122:123], v225 offset0:34 offset1:35
  s_waitcnt lgkmcnt(5)
  v_mfma_f32_16x16x32_bf16 v[168:171], a[112:115], a[152:155], v[168:171]
  ds_read2_b32 a[176:177], v224 offset0:48 offset1:49
  ds_read2_b32 a[178:179], v224 offset0:50 offset1:51
  v_mfma_f32_16x16x32_bf16 v[164:167], a[112:115], a[148:151], v[164:167]
  ds_read_b128 a[216:219], v232 offset:2752
  ds_read_b128 a[212:215], v232 offset:3264
  ds_write_b128 v255, v[176:179] offset:32
  v_mfma_f32_16x16x32_bf16 v[160:163], a[112:115], a[144:147], v[160:163]
  ds_read_b128 a[208:211], v232 offset:3776
  ds_read2_b32 a[180:181], v224 offset0:176 offset1:177
  s_waitcnt lgkmcnt(7)
  v_mfma_f32_16x16x32_bf16 v[168:171], a[116:119], a[148:151], v[168:171]
  ds_read2_b32 a[182:183], v224 offset0:178 offset1:179
  v_mfma_f32_16x16x32_bf16 v[164:167], a[116:119], a[144:147], v[164:167]
  ds_read2_b32 a[184:185], v225 offset0:48 offset1:49
  ds_write_b128 v255, a[84:87] offset:8320
  v_mfma_f32_16x16x32_bf16 v[168:171], a[120:123], a[144:147], v[168:171]
  ds_read2_b32 a[186:187], v225 offset0:50 offset1:51
  s_waitcnt lgkmcnt(5)
  v_mfma_f32_16x16x32_bf16 v[168:171], a[176:179], a[216:219], v[168:171]
  ds_read2_b32 a[112:113], v224 offset0:64 offset1:65
  ds_read2_b32 a[114:115], v224 offset0:66 offset1:67
  v_mfma_f32_16x16x32_bf16 v[164:167], a[176:179], a[212:215], v[164:167]
  ds_read_b128 a[152:155], v232 offset:2816
  ds_read_b128 a[148:151], v232 offset:3328
  ds_write_b128 v255, v[212:215] offset:5216
  v_mfma_f32_16x16x32_bf16 v[160:163], a[176:179], a[208:211], v[160:163]
  ds_read_b128 a[144:147], v232 offset:3840
  ds_read2_b32 a[116:117], v224 offset0:192 offset1:193
  s_waitcnt lgkmcnt(7)
  v_mfma_f32_16x16x32_bf16 v[168:171], a[180:183], a[212:215], v[168:171]
  ds_read2_b32 a[118:119], v224 offset0:194 offset1:195
  v_mfma_f32_16x16x32_bf16 v[164:167], a[180:183], a[208:211], v[164:167]
  ds_read2_b32 a[120:121], v225 offset0:64 offset1:65
  ds_write_b128 v255, v[180:183] offset:1056
  v_mfma_f32_16x16x32_bf16 v[168:171], a[184:187], a[208:211], v[168:171]
  ds_read2_b32 a[122:123], v225 offset0:66 offset1:67
  s_waitcnt lgkmcnt(5)
  v_mfma_f32_16x16x32_bf16 v[168:171], a[112:115], a[152:155], v[168:171]
  ds_read2_b32 a[176:177], v224 offset0:80 offset1:81
  ds_read2_b32 a[178:179], v224 offset0:82 offset1:83
  v_mfma_f32_16x16x32_bf16 v[164:167], a[112:115], a[148:151], v[164:167]
  ds_read_b128 a[216:219], v232 offset:2880
  ds_read_b128 a[212:215], v232 offset:3392
  ds_write_b128 v255, a[88:91] offset:9344
  v_mfma_f32_16x16x32_bf16 v[160:163], a[112:115], a[144:147], v[160:163]
  ds_read_b128 a[208:211], v232 offset:3904
  ds_read2_b32 a[180:181], v224 offset0:208 offset1:209
  s_waitcnt lgkmcnt(7)
  v_mfma_f32_16x16x32_bf16 v[168:171], a[116:119], a[148:151], v[168:171]
  ds_read2_b32 a[182:183], v224 offset0:210 offset1:211
  v_mfma_f32_16x16x32_bf16 v[164:167], a[116:119], a[144:147], v[164:167]
  ds_read2_b32 a[184:185], v225 offset0:80 offset1:81
  ds_write_b128 v255, v[216:219] offset:6240
  v_mfma_f32_16x16x32_bf16 v[168:171], a[120:123], a[144:147], v[168:171]
  ds_read2_b32 a[186:187], v225 offset0:82 offset1:83
  s_waitcnt lgkmcnt(5)
  v_mfma_f32_16x16x32_bf16 v[168:171], a[176:179], a[216:219], v[168:171]
  ds_read2_b32 a[112:113], v224 offset0:96 offset1:97
  ds_read2_b32 a[114:115], v224 offset0:98 offset1:99
  v_mfma_f32_16x16x32_bf16 v[164:167], a[176:179], a[212:215], v[164:167]
  ds_read_b128 a[152:155], v232 offset:2944
  ds_read_b128 a[148:151], v232 offset:3456
  ds_write_b128 v255, v[184:187] offset:2080
  v_mfma_f32_16x16x32_bf16 v[160:163], a[176:179], a[208:211], v[160:163]
  ds_read_b128 a[144:147], v232 offset:3968
  ds_read2_b32 a[116:117], v224 offset0:224 offset1:225
  s_waitcnt lgkmcnt(7)
  v_mfma_f32_16x16x32_bf16 v[168:171], a[180:183], a[212:215], v[168:171]
  ds_read2_b32 a[118:119], v224 offset0:226 offset1:227
  v_mfma_f32_16x16x32_bf16 v[164:167], a[180:183], a[208:211], v[164:167]
  ds_read2_b32 a[120:121], v225 offset0:96 offset1:97
  ds_write_b128 v255, a[92:95] offset:10368
  v_mfma_f32_16x16x32_bf16 v[168:171], a[184:187], a[208:211], v[168:171]
  ds_read2_b32 a[122:123], v225 offset0:98 offset1:99
  ds_write_b128 v255, v[220:223] offset:7264
  ds_write_b128 v255, v[188:191] offset:3104
  ds_write_b128 v255, a[96:99] offset:11392
  s_waitcnt lgkmcnt(8)
  v_mfma_f32_16x16x32_bf16 v[168:171], a[112:115], a[152:155], v[168:171]
  ds_read2_b32 a[176:177], v224 offset0:112 offset1:113
  ds_read2_b32 a[178:179], v224 offset0:114 offset1:115
  v_mfma_f32_16x16x32_bf16 v[164:167], a[112:115], a[148:151], v[164:167]
  ds_read_b128 a[216:219], v232 offset:3008
  ds_read_b128 a[212:215], v232 offset:3520
  v_mfma_f32_16x16x32_bf16 v[160:163], a[112:115], a[144:147], v[160:163]
  ds_read_b128 a[208:211], v232 offset:4032
  ds_read2_b32 a[180:181], v224 offset0:240 offset1:241
  s_waitcnt lgkmcnt(9)
  v_mfma_f32_16x16x32_bf16 v[168:171], a[116:119], a[148:151], v[168:171]
  ds_read2_b32 a[182:183], v224 offset0:242 offset1:243
  v_mfma_f32_16x16x32_bf16 v[164:167], a[116:119], a[144:147], v[164:167]
  ds_read2_b32 a[184:185], v225 offset0:112 offset1:113
  v_mfma_f32_16x16x32_bf16 v[168:171], a[120:123], a[144:147], v[168:171]
  ds_read2_b32 a[186:187], v225 offset0:114 offset1:115
  s_waitcnt vmcnt(0)
  s_barrier
  buffer_store_dword v5, v1, s[44:47], s90 offen sc1
KF_chk2:
  v_subrev_u32 v253, s78, v252
  v_add_u32 v253, -1, v253
  v_cmp_lt_u32 vcc, 3, v253
  s_nop 4
  s_cbranch_vccz KF_go2
  s_add_u32 s63, s63, 1
  s_cmp_ge_u32 s63, 0x40000
  s_cbranch_scc1 KF_go2
  s_nop 0
  buffer_load_dword v252, v15, s[44:47], 0 offen sc1
  s_waitcnt vmcnt(0)
  s_branch KF_chk2
KF_go2:
  v_subrev_u32 v253, s78, v252
  v_cmp_eq_u32 vcc, 4, v253
  s_nop 1
  s_lshr_b32 s20, vcc_lo, 16
  s_and_b32 s20, s20, vcc_lo
  s_lshr_b32 s23, s20, 1
  s_and_b32 s20, s20, s23
  s_and_b32 s20, s20, s57
  s_andn2_b32 s57, s57, s20
  s_or_b32 s56, s56, s20
  s_waitcnt lgkmcnt(4)
  v_mfma_f32_16x16x32_bf16 v[168:171], a[176:179], a[216:219], v[168:171]
  ds_read2_b32 a[112:113], v228 offset0:0 offset1:1
  ds_read2_b32 a[114:115], v228 offset0:2 offset1:3
  buffer_load_dwordx4 v[144:147], v13, s[44:47], s88 offen sc1
  v_mfma_f32_16x16x32_bf16 v[164:167], a[176:179], a[212:215], v[164:167]
  ds_read_b128 a[152:155], v233 offset:2560
  ds_read_b128 a[148:151], v233 offset:3072
  buffer_load_dwordx4 v[148:151], v13, s[44:47], s89 offen sc1
  v_mfma_f32_16x16x32_bf16 v[160:163], a[176:179], a[208:211], v[160:163]
  ds_read_b128 a[144:147], v233 offset:3584
  ds_read2_b32 a[116:117], v228 offset0:128 offset1:129
  buffer_load_dwordx4 v[152:155], v13, s[44:47], s91 offen sc1
  s_waitcnt lgkmcnt(6)
  v_mfma_f32_16x16x32_bf16 v[168:171], a[180:183], a[212:215], v[168:171]
  ds_read2_b32 a[118:119], v228 offset0:130 offset1:131
  buffer_load_dwordx2 v[240:241], v12, s[44:47], s66 offen offset:0 sc1
  v_mfma_f32_16x16x32_bf16 v[164:167], a[180:183], a[208:211], v[164:167]
  ds_read2_b32 a[120:121], v229 offset0:0 offset1:1
  buffer_load_dwordx2 v[242:243], v12, s[44:47], s66 offen offset:512 sc1
  v_mfma_f32_16x16x32_bf16 v[168:171], a[184:187], a[208:211], v[168:171]
  ds_read2_b32 a[122:123], v229 offset0:2 offset1:3
  buffer_load_dwordx2 v[244:245], v12, s[44:47], s66 offen offset:1024 sc1
  s_waitcnt lgkmcnt(4)
  v_mfma_f32_16x16x32_bf16 v[184:187], a[112:115], a[152:155], 0
  ds_read2_b32 a[176:177], v228 offset0:16 offset1:17
  ds_read2_b32 a[178:179], v228 offset0:18 offset1:19
  buffer_load_ushort v8, off, s[36:39], s67 offset:0
  v_mfma_f32_16x16x32_bf16 v[180:183], a[112:115], a[148:151], 0
  ds_read_b128 a[216:219], v233 offset:2624
  ds_read_b128 a[212:215], v233 offset:3136
  buffer_load_ushort v10, off, s[36:39], s67 offset:2
  v_mfma_f32_16x16x32_bf16 v[176:179], a[112:115], a[144:147], 0
  ds_read_b128 a[208:211], v233 offset:3648
  ds_read2_b32 a[180:181], v228 offset0:144 offset1:145
  s_ff1_i32_b32 s20, s56
  s_bitset0_b32 s56, s20
  s_cmp_lt_i32 s20, 0
  s_mul_i32 s20, s20, 2508800
  s_cselect_b32 s20, 0x40000000, s20
  s_cselect_b32 s62, 0, 1
  s_or_b32 s61, s61, s62
  s_add_u32 s23, s20, s76
  buffer_load_dwordx4 v[16:19], v3, s[44:47], s23 offen sc1
  s_waitcnt lgkmcnt(6)
  v_mfma_f32_16x16x32_bf16 v[184:187], a[116:119], a[148:151], v[184:187]
  ds_read2_b32 a[182:183], v228 offset0:146 offset1:147
  s_add_u32 s23, s20, s77
  buffer_load_dwordx4 v[20:23], v3, s[44:47], s23 offen sc1
  v_mfma_f32_16x16x32_bf16 v[180:183], a[116:119], a[144:147], v[180:183]
  ds_read2_b32 a[184:185], v229 offset0:16 offset1:17
  s_add_u32 s23, s20, s96
  buffer_load_dwordx4 v[24:27], v3, s[44:47], s23 offen sc1
  v_mfma_f32_16x16x32_bf16 v[184:187], a[120:123], a[144:147], v[184:187]
  ds_read2_b32 a[186:187], v229 offset0:18 offset1:19
  s_ff1_i32_b32 s20, s56
  s_bitset0_b32 s56, s20
  s_cmp_lt_i32 s20, 0
  s_mul_i32 s20, s20, 2508800
  s_cselect_b32 s20, 0x40000000, s20
  s_cselect_b32 s62, 0, 2
  s_or_b32 s61, s61, s62
  s_add_u32 s23, s20, s76
  buffer_load_dwordx4 v[32:35], v3, s[44:47], s23 offen sc1
  s_waitcnt lgkmcnt(4)
  v_mfma_f32_16x16x32_bf16 v[184:187], a[176:179], a[216:219], v[184:187]
  ds_read2_b32 a[112:113], v228 offset0:32 offset1:33
  ds_read2_b32 a[114:115], v228 offset0:34 offset1:35
  s_add_u32 s23, s20, s77
  buffer_load_dwordx4 v[36:39], v3, s[44:47], s23 offen sc1
  v_mfma_f32_16x16x32_bf16 v[180:183], a[176:179], a[212:215], v[180:183]
  ds_read_b128 a[152:155], v233 offset:2688
  ds_read_b128 a[148:151], v233 offset:3200
  s_add_u32 s23, s20, s96
  buffer_load_dwordx4 v[40:43], v3, s[44:47], s23 offen sc1
  v_mfma_f32_16x16x32_bf16 v[176:179], a[176:179], a[208:211], v[176:179]
  ds_read_b128 a[144:147], v233 offset:3712
  ds_read2_b32 a[116:117], v228 offset0:160 offset1:161
  s_ff1_i32_b32 s20, s56
  s_bitset0_b32 s56, s20
  s_cmp_lt_i32 s20, 0
  s_mul_i32 s20, s20, 2508800
  s_cselect_b32 s20, 0x40000000, s20
  s_cselect_b32 s62, 0, 4
  s_or_b32 s61, s61, s62
  s_add_u32 s23, s20, s76
  buffer_load_dwordx4 v[48:51], v3, s[44:47], s23 offen sc1
  s_waitcnt lgkmcnt(6)
  v_mfma_f32_16x16x32_bf16 v[184:187], a[180:183], a[212:215], v[184:187]
  ds_read2_b32 a[118:119], v228 offset0:162 offset1:163
  s_add_u32 s23, s20, s77
  buffer_load_dwordx4 v[52:55], v3, s[44:47], s23 offen sc1
  v_mfma_f32_16x16x32_bf16 v[180:183], a[180:183], a[208:211], v[180:183]
  ds_read2_b32 a[120:121], v229 offset0:32 offset1:33
  s_add_u32 s23, s20, s96
  buffer_load_dwordx4 v[56:59], v3, s[44:47], s23 offen sc1
  v_mfma_f32_16x16x32_bf16 v[184:187], a[184:187], a[208:211], v[184:187]
  ds_read2_b32 a[122:123], v229 offset0:34 offset1:35
  s_ff1_i32_b32 s20, s56
  s_bitset0_b32 s56, s20
  s_cmp_lt_i32 s20, 0
  s_mul_i32 s20, s20, 2508800
  s_cselect_b32 s20, 0x40000000, s20
  s_cselect_b32 s62, 0, 8
  s_or_b32 s61, s61, s62
  s_add_u32 s23, s20, s76
  buffer_load_dwordx4 v[64:67], v3, s[44:47], s23 offen sc1
  s_add_u32 s23, s20, s77
  buffer_load_dwordx4 v[68:71], v3, s[44:47], s23 offen sc1
  s_add_u32 s23, s20, s96
  buffer_load_dwordx4 v[72:75], v3, s[44:47], s23 offen sc1
  s_ff1_i32_b32 s20, s56
  s_bitset0_b32 s56, s20
  s_cmp_lt_i32 s20, 0
  s_mul_i32 s20, s20, 2508800
  s_cselect_b32 s20, 0x40000000, s20
  s_cselect_b32 s62, 0, 16
  s_or_b32 s61, s61, s62
  s_add_u32 s23, s20, s76
  buffer_load_dwordx4 v[80:83], v3, s[44:47], s23 offen sc1
  s_add_u32 s23, s20, s77
  buffer_load_dwordx4 v[84:87], v3, s[44:47], s23 offen sc1
  s_add_u32 s23, s20, s96
  buffer_load_dwordx4 v[88:91], v3, s[44:47], s23 offen sc1
  buffer_load_dword v252, v15, s[44:47], 0 offen sc1
  s_waitcnt lgkmcnt(4)
  v_mfma_f32_16x16x32_bf16 v[184:187], a[112:115], a[152:155], v[184:187]
  ds_read2_b32 a[176:177], v228 offset0:48 offset1:49
  ds_read2_b32 a[178:179], v228 offset0:50 offset1:51
  v_mfma_f32_16x16x32_bf16 v[180:183], a[112:115], a[148:151], v[180:183]
  ds_read_b128 a[216:219], v233 offset:2752
  ds_read_b128 a[212:215], v233 offset:3264
  v_mfma_f32_16x16x32_bf16 v[176:179], a[112:115], a[144:147], v[176:179]
  ds_read_b128 a[208:211], v233 offset:3776
  ds_read2_b32 a[180:181], v228 offset0:176 offset1:177
  s_waitcnt lgkmcnt(6)
  v_mfma_f32_16x16x32_bf16 v[184:187], a[116:119], a[148:151], v[184:187]
  ds_read2_b32 a[182:183], v228 offset0:178 offset1:179
  v_mfma_f32_16x16x32_bf16 v[180:183], a[116:119], a[144:147], v[180:183]
  ds_read2_b32 a[184:185], v229 offset0:48 offset1:49
  v_mfma_f32_16x16x32_bf16 v[184:187], a[120:123], a[144:147], v[184:187]
  ds_read2_b32 a[186:187], v229 offset0:50 offset1:51
  s_waitcnt lgkmcnt(4)
  v_mfma_f32_16x16x32_bf16 v[184:187], a[176:179], a[216:219], v[184:187]
  ds_read2_b32 a[112:113], v228 offset0:64 offset1:65
  ds_read2_b32 a[114:115], v228 offset0:66 offset1:67
  v_mfma_f32_16x16x32_bf16 v[180:183], a[176:179], a[212:215], v[180:183]
  ds_read_b128 a[152:155], v233 offset:2816
  ds_read_b128 a[148:151], v233 offset:3328
  v_mfma_f32_16x16x32_bf16 v[176:179], a[176:179], a[208:211], v[176:179]
  ds_read_b128 a[144:147], v233 offset:3840
  ds_read2_b32 a[116:117], v228 offset0:192 offset1:193
  s_waitcnt lgkmcnt(6)
  v_mfma_f32_16x16x32_bf16 v[184:187], a[180:183], a[212:215], v[184:187]
  ds_read2_b32 a[118:119], v228 offset0:194 offset1:195
  v_mfma_f32_16x16x32_bf16 v[180:183], a[180:183], a[208:211], v[180:183]
  ds_read2_b32 a[120:121], v229 offset0:64 offset1:65
  v_mfma_f32_16x16x32_bf16 v[184:187], a[184:187], a[208:211], v[184:187]
  ds_read2_b32 a[122:123], v229 offset0:66 offset1:67
  s_waitcnt lgkmcnt(4)
  v_mfma_f32_16x16x32_bf16 v[184:187], a[112:115], a[152:155], v[184:187]
  ds_read2_b32 a[176:177], v228 offset0:80 offset1:81
  ds_read2_b32 a[178:179], v228 offset0:82 offset1:83
  v_mfma_f32_16x16x32_bf16 v[180:183], a[112:115], a[148:151], v[180:183]
  ds_read_b128 a[216:219], v233 offset:2880
  ds_read_b128 a[212:215], v233 offset:3392
  v_mfma_f32_16x16x32_bf16 v[176:179], a[112:115], a[144:147], v[176:179]
  ds_read_b128 a[208:211], v233 offset:3904
  ds_read2_b32 a[180:181], v228 offset0:208 offset1:209
  s_waitcnt lgkmcnt(6)
  v_mfma_f32_16x16x32_bf16 v[184:187], a[116:119], a[148:151], v[184:187]
  ds_read2_b32 a[182:183], v228 offset0:210 offset1:211
  v_mfma_f32_16x16x32_bf16 v[180:183], a[116:119], a[144:147], v[180:183]
  ds_read2_b32 a[184:185], v229 offset0:80 offset1:81
  v_mfma_f32_16x16x32_bf16 v[184:187], a[120:123], a[144:147], v[184:187]
  ds_read2_b32 a[186:187], v229 offset0:82 offset1:83
  s_waitcnt lgkmcnt(4)
  v_mfma_f32_16x16x32_bf16 v[184:187], a[176:179], a[216:219], v[184:187]
  ds_read2_b32 a[112:113], v228 offset0:96 offset1:97
  ds_read2_b32 a[114:115], v228 offset0:98 offset1:99
  v_mfma_f32_16x16x32_bf16 v[180:183], a[176:179], a[212:215], v[180:183]
  ds_read_b128 a[152:155], v233 offset:2944
  ds_read_b128 a[148:151], v233 offset:3456
  v_mfma_f32_16x16x32_bf16 v[176:179], a[176:179], a[208:211], v[176:179]
  ds_read_b128 a[144:147], v233 offset:3968
  ds_read2_b32 a[116:117], v228 offset0:224 offset1:225
  s_waitcnt lgkmcnt(6)
  v_mfma_f32_16x16x32_bf16 v[184:187], a[180:183], a[212:215], v[184:187]
  ds_read2_b32 a[118:119], v228 offset0:226 offset1:227
  v_mfma_f32_16x16x32_bf16 v[180:183], a[180:183], a[208:211], v[180:183]
  ds_read2_b32 a[120:121], v229 offset0:96 offset1:97
  v_mfma_f32_16x16x32_bf16 v[184:187], a[184:187], a[208:211], v[184:187]
  ds_read2_b32 a[122:123], v229 offset0:98 offset1:99
  s_waitcnt lgkmcnt(4)
  v_mfma_f32_16x16x32_bf16 v[184:187], a[112:115], a[152:155], v[184:187]
  ds_read2_b32 a[176:177], v228 offset0:112 offset1:113
  ds_read2_b32 a[178:179], v228 offset0:114 offset1:115
  v_mfma_f32_16x16x32_bf16 v[180:183], a[112:115], a[148:151], v[180:183]
  ds_read_b128 a[216:219], v233 offset:3008
  ds_read_b128 a[212:215], v233 offset:3520
  v_mfma_f32_16x16x32_bf16 v[176:179], a[112:115], a[144:147], v[176:179]
  ds_read_b128 a[208:211], v233 offset:4032
  ds_read2_b32 a[180:181], v228 offset0:240 offset1:241
  s_waitcnt lgkmcnt(6)
  v_mfma_f32_16x16x32_bf16 v[184:187], a[116:119], a[148:151], v[184:187]
  ds_read2_b32 a[182:183], v228 offset0:242 offset1:243
  v_mfma_f32_16x16x32_bf16 v[180:183], a[116:119], a[144:147], v[180:183]
  ds_read2_b32 a[184:185], v229 offset0:112 offset1:113
  v_mfma_f32_16x16x32_bf16 v[184:187], a[120:123], a[144:147], v[184:187]
  ds_read2_b32 a[186:187], v229 offset0:114 offset1:115
  s_waitcnt lgkmcnt(4)
  v_mfma_f32_16x16x32_bf16 v[184:187], a[176:179], a[216:219], v[184:187]
  v_mfma_f32_16x16x32_bf16 v[180:183], a[176:179], a[212:215], v[180:183]
  v_mfma_f32_16x16x32_bf16 v[176:179], a[176:179], a[208:211], v[176:179]
  s_waitcnt lgkmcnt(0)
  v_mfma_f32_16x16x32_bf16 v[184:187], a[180:183], a[212:215], v[184:187]
  v_mfma_f32_16x16x32_bf16 v[180:183], a[180:183], a[208:211], v[180:183]
  v_mfma_f32_16x16x32_bf16 v[184:187], a[184:187], a[208:211], v[184:187]
  s_waitcnt vmcnt(0)
  v_subrev_u32 v253, s78, v252
  v_cmp_eq_u32 vcc, 4, v253
  s_nop 1
  s_lshr_b32 s20, vcc_lo, 16
  s_and_b32 s20, s20, vcc_lo
  s_lshr_b32 s23, s20, 1
  s_and_b32 s20, s20, s23
  s_and_b32 s20, s20, s57
  s_andn2_b32 s57, s57, s20
  s_or_b32 s56, s56, s20
  buffer_load_dword v252, v15, s[44:47], 0 offen sc1
  s_ff1_i32_b32 s20, s56
  s_bitset0_b32 s56, s20
  s_cmp_lt_i32 s20, 0
  s_mul_i32 s20, s20, 2508800
  s_cselect_b32 s20, 0x40000000, s20
  s_cselect_b32 s62, 0, 32
  s_or_b32 s61, s61, s62
  s_add_u32 s23, s20, s76
  buffer_load_dwordx4 v[96:99], v3, s[44:47], s23 offen sc1
  s_add_u32 s23, s20, s77
  buffer_load_dwordx4 v[100:103], v3, s[44:47], s23 offen sc1
  s_add_u32 s23, s20, s96
  buffer_load_dwordx4 v[104:107], v3, s[44:47], s23 offen sc1
  s_ff1_i32_b32 s20, s56
  s_bitset0_b32 s56, s20
  s_cmp_lt_i32 s20, 0
  s_mul_i32 s20, s20, 2508800
  s_cselect_b32 s20, 0x40000000, s20
  s_cselect_b32 s62, 0, 64
  s_or_b32 s61, s61, s62
  s_add_u32 s23, s20, s76
  buffer_load_dwordx4 v[112:115], v3, s[44:47], s23 offen sc1
  s_add_u32 s23, s20, s77
  buffer_load_dwordx4 v[116:119], v3, s[44:47], s23 offen sc1
  s_add_u32 s23, s20, s96
  buffer_load_dwordx4 v[120:123], v3, s[44:47], s23 offen sc1
  s_ff1_i32_b32 s20, s56
  s_bitset0_b32 s56, s20
  s_cmp_lt_i32 s20, 0
  s_mul_i32 s20, s20, 2508800
  s_cselect_b32 s20, 0x40000000, s20
  s_cselect_b32 s62, 0, 128
  s_or_b32 s61, s61, s62
  s_add_u32 s23, s20, s76
  buffer_load_dwordx4 v[128:131], v3, s[44:47], s23 offen sc1
  s_add_u32 s23, s20, s77
  buffer_load_dwordx4 v[132:135], v3, s[44:47], s23 offen sc1
  s_add_u32 s23, s20, s96
  buffer_load_dwordx4 v[136:139], v3, s[44:47], s23 offen sc1
  v_dot2_f32_bf16 v192, v16, s54, 0
  v_dot2_f32_bf16 v193, v16, s55, 0
  v_dot2_f32_bf16 v194, v17, s54, 0
  v_dot2_f32_bf16 v195, v17, s55, 0
  v_dot2_f32_bf16 v196, v18, s54, 0
  v_dot2_f32_bf16 v197, v18, s55, 0
  v_dot2_f32_bf16 v198, v19, s54, 0
  v_dot2_f32_bf16 v199, v19, s55, 0
  v_dot2_f32_bf16 v200, v20, s54, 0
  v_dot2_f32_bf16 v201, v20, s55, 0
  v_dot2_f32_bf16 v202, v21, s54, 0
  v_dot2_f32_bf16 v203, v21, s55, 0
  v_dot2_f32_bf16 v204, v22, s54, 0
  v_dot2_f32_bf16 v205, v22, s55, 0
  v_dot2_f32_bf16 v206, v23, s54, 0
  v_dot2_f32_bf16 v207, v23, s55, 0
  v_dot2_f32_bf16 v208, v24, s54, 0
  v_dot2_f32_bf16 v209, v24, s55, 0
  v_dot2_f32_bf16 v210, v25, s54, 0
  v_dot2_f32_bf16 v211, v25, s55, 0
  v_dot2_f32_bf16 v212, v26, s54, 0
  v_dot2_f32_bf16 v213, v26, s55, 0
  v_dot2_f32_bf16 v214, v27, s54, 0
  v_dot2_f32_bf16 v215, v27, s55, 0
  v_dot2_f32_bf16 v192, v32, s54, v192
  v_dot2_f32_bf16 v193, v32, s55, v193
  v_dot2_f32_bf16 v194, v33, s54, v194
  v_dot2_f32_bf16 v195, v33, s55, v195
  v_dot2_f32_bf16 v196, v34, s54, v196
  v_dot2_f32_bf16 v197, v34, s55, v197
  v_dot2_f32_bf16 v198, v35, s54, v198
  v_dot2_f32_bf16 v199, v35, s55, v199
  v_dot2_f32_bf16 v200, v36, s54, v200
  v_dot2_f32_bf16 v201, v36, s55, v201
  v_dot2_f32_bf16 v202, v37, s54, v202
  v_dot2_f32_bf16 v203, v37, s55, v203
  v_dot2_f32_bf16 v204, v38, s54, v204
  v_dot2_f32_bf16 v205, v38, s55, v205
  v_dot2_f32_bf16 v206, v39, s54, v206
  v_dot2_f32_bf16 v207, v39, s55, v207
  v_dot2_f32_bf16 v208, v40, s54, v208
  v_dot2_f32_bf16 v209, v40, s55, v209
  v_dot2_f32_bf16 v210, v41, s54, v210
  v_dot2_f32_bf16 v211, v41, s55, v211
  v_dot2_f32_bf16 v212, v42, s54, v212
  v_dot2_f32_bf16 v213, v42, s55, v213
  v_dot2_f32_bf16 v214, v43, s54, v214
  v_dot2_f32_bf16 v215, v43, s55, v215
  v_dot2_f32_bf16 v192, v48, s54, v192
  v_dot2_f32_bf16 v193, v48, s55, v193
  v_dot2_f32_bf16 v194, v49, s54, v194
  v_dot2_f32_bf16 v195, v49, s55, v195
  v_dot2_f32_bf16 v196, v50, s54, v196
  v_dot2_f32_bf16 v197, v50, s55, v197
  v_dot2_f32_bf16 v198, v51, s54, v198
  v_dot2_f32_bf16 v199, v51, s55, v199
  v_dot2_f32_bf16 v200, v52, s54, v200
  v_dot2_f32_bf16 v201, v52, s55, v201
  v_dot2_f32_bf16 v202, v53, s54, v202
  v_dot2_f32_bf16 v203, v53, s55, v203
  v_dot2_f32_bf16 v204, v54, s54, v204
  v_dot2_f32_bf16 v205, v54, s55, v205
  v_dot2_f32_bf16 v206, v55, s54, v206
  v_dot2_f32_bf16 v207, v55, s55, v207
  v_dot2_f32_bf16 v208, v56, s54, v208
  v_dot2_f32_bf16 v209, v56, s55, v209
  v_dot2_f32_bf16 v210, v57, s54, v210
  v_dot2_f32_bf16 v211, v57, s55, v211
  v_dot2_f32_bf16 v212, v58, s54, v212
  v_dot2_f32_bf16 v213, v58, s55, v213
  v_dot2_f32_bf16 v214, v59, s54, v214
  v_dot2_f32_bf16 v215, v59, s55, v215
  v_dot2_f32_bf16 v192, v64, s54, v192
  v_dot2_f32_bf16 v193, v64, s55, v193
  v_dot2_f32_bf16 v194, v65, s54, v194
  v_dot2_f32_bf16 v195, v65, s55, v195
  v_dot2_f32_bf16 v196, v66, s54, v196
  v_dot2_f32_bf16 v197, v66, s55, v197
  v_dot2_f32_bf16 v198, v67, s54, v198
  v_dot2_f32_bf16 v199, v67, s55, v199
  v_dot2_f32_bf16 v200, v68, s54, v200
  v_dot2_f32_bf16 v201, v68, s55, v201
  v_dot2_f32_bf16 v202, v69, s54, v202
  v_dot2_f32_bf16 v203, v69, s55, v203
  v_dot2_f32_bf16 v204, v70, s54, v204
  v_dot2_f32_bf16 v205, v70, s55, v205
  v_dot2_f32_bf16 v206, v71, s54, v206
  v_dot2_f32_bf16 v207, v71, s55, v207
  v_dot2_f32_bf16 v208, v72, s54, v208
  v_dot2_f32_bf16 v209, v72, s55, v209
  v_dot2_f32_bf16 v210, v73, s54, v210
  v_dot2_f32_bf16 v211, v73, s55, v211
  v_dot2_f32_bf16 v212, v74, s54, v212
  v_dot2_f32_bf16 v213, v74, s55, v213
  v_dot2_f32_bf16 v214, v75, s54, v214
  v_dot2_f32_bf16 v215, v75, s55, v215
  s_andn2_b32 s61, s61, 15
  ds_read_b64 v[16:17], v234 offset:3584
  ds_read_b64 v[18:19], v234 offset:3072
  ds_read_b64 v[20:21], v234 offset:2560
  ds_read_b64 v[22:23], v235 offset:3584
  ds_read_b64 v[24:25], v235 offset:3072
  ds_read_b64 v[26:27], v235 offset:2560
  v_lshlrev_b32 v8, 16, v8
  v_lshlrev_b32 v10, 16, v10
  s_waitcnt lgkmcnt(5)
  v_and_b32 v248, 0xffff0000, v17
  v_lshlrev_b32 v249, 16, v17
  v_and_b32 v250, 0xffff0000, v16
  v_lshlrev_b32 v251, 16, v16
  v_pk_fma_f32 v[160:161], v[248:249], v[8:9], v[160:161] op_sel_hi:[1,0,1]
  v_pk_fma_f32 v[162:163], v[250:251], v[8:9], v[162:163] op_sel_hi:[1,0,1]
  v_cvt_pk_bf16_f32 v16, v160, v161
  v_cvt_pk_bf16_f32 v17, v162, v163
  ds_write_b64 v236, v[16:17] offset:0
  s_waitcnt lgkmcnt(5)
  v_and_b32 v248, 0xffff0000, v19
  v_lshlrev_b32 v249, 16, v19
  v_and_b32 v250, 0xffff0000, v18
  v_lshlrev_b32 v251, 16, v18
  v_pk_fma_f32 v[164:165], v[248:249], v[8:9], v[164:165] op_sel_hi:[1,0,1]
  v_pk_fma_f32 v[166:167], v[250:251], v[8:9], v[166:167] op_sel_hi:[1,0,1]
  v_cvt_pk_bf16_f32 v18, v164, v165
  v_cvt_pk_bf16_f32 v19, v166, v167
  ds_write_b64 v236, v[18:19] offset:512
  s_waitcnt lgkmcnt(5)
  v_and_b32 v248, 0xffff0000, v21
  v_lshlrev_b32 v249, 16, v21
  v_and_b32 v250, 0xffff0000, v20
  v_lshlrev_b32 v251, 16, v20
  v_pk_fma_f32 v[168:169], v[248:249], v[8:9], v[168:169] op_sel_hi:[1,0,1]
  v_pk_fma_f32 v[170:171], v[250:251], v[8:9], v[170:171] op_sel_hi:[1,0,1]
  v_cvt_pk_bf16_f32 v20, v168, v169
  v_cvt_pk_bf16_f32 v21, v170, v171
  ds_write_b64 v236, v[20:21] offset:1024
  s_waitcnt lgkmcnt(5)
  v_and_b32 v248, 0xffff0000, v23
  v_lshlrev_b32 v249, 16, v23
  v_and_b32 v250, 0xffff0000, v22
  v_lshlrev_b32 v251, 16, v22
  v_pk_fma_f32 v[176:177], v[248:249], v[10:11], v[176:177] op_sel_hi:[1,0,1]
  v_pk_fma_f32 v[178:179], v[250:251], v[10:11], v[178:179] op_sel_hi:[1,0,1]
  v_cvt_pk_bf16_f32 v22, v176, v177
  v_cvt_pk_bf16_f32 v23, v178, v179
  ds_write_b64 v236, v[22:23] offset:2112
  s_waitcnt lgkmcnt(5)
  v_and_b32 v248, 0xffff0000, v25
  v_lshlrev_b32 v249, 16, v25
  v_and_b32 v250, 0xffff0000, v24
  v_lshlrev_b32 v251, 16, v24
  v_pk_fma_f32 v[180:181], v[248:249], v[10:11], v[180:181] op_sel_hi:[1,0,1]
  v_pk_fma_f32 v[182:183], v[250:251], v[10:11], v[182:183] op_sel_hi:[1,0,1]
  v_cvt_pk_bf16_f32 v24, v180, v181
  v_cvt_pk_bf16_f32 v25, v182, v183
  ds_write_b64 v236, v[24:25] offset:2624
  s_waitcnt lgkmcnt(5)
  v_and_b32 v248, 0xffff0000, v27
  v_lshlrev_b32 v249, 16, v27
  v_and_b32 v250, 0xffff0000, v26
  v_lshlrev_b32 v251, 16, v26
  v_pk_fma_f32 v[184:185], v[248:249], v[10:11], v[184:185] op_sel_hi:[1,0,1]
  v_pk_fma_f32 v[186:187], v[250:251], v[10:11], v[186:187] op_sel_hi:[1,0,1]
  v_cvt_pk_bf16_f32 v26, v184, v185
  v_cvt_pk_bf16_f32 v27, v186, v187
  ds_write_b64 v236, v[26:27] offset:3136
KF_post3:
  s_waitcnt lgkmcnt(0)
  s_barrier
  ds_read_b64_tr_b16 v[32:33], v237 offset:0
  ds_read_b64_tr_b16 v[34:35], v237 offset:8448
  ds_read_b64_tr_b16 v[36:37], v237 offset:128
  ds_read_b64_tr_b16 v[38:39], v237 offset:8576
  ds_read_b64_tr_b16 v[40:41], v237 offset:256
  ds_read_b64_tr_b16 v[42:43], v237 offset:8704
  v_mul_f32 v248, v241, v241
  v_mul_f32 v241, v241, v248
  v_mul_f32 v248, 0xbfb8aa3b, v248
  v_lshlrev_b32 v160, 16, v144
  v_and_b32 v161, 0xffff0000, v144
  v_pk_add_f32 v[160:161], v[160:161], v[240:241] op_sel_hi:[1,0] neg_lo:[0,1] neg_hi:[0,1]
  v_pk_mul_f32 v[160:161], v[160:161], v[240:241] op_sel:[0,1] op_sel_hi:[1,1]
  v_lshlrev_b32 v162, 16, v145
  v_and_b32 v163, 0xffff0000, v145
  v_pk_add_f32 v[162:163], v[162:163], v[240:241] op_sel_hi:[1,0] neg_lo:[0,1] neg_hi:[0,1]
  v_pk_mul_f32 v[162:163], v[162:163], v[240:241] op_sel:[0,1] op_sel_hi:[1,1]
  v_lshlrev_b32 v164, 16, v146
  v_and_b32 v165, 0xffff0000, v146
  v_pk_add_f32 v[164:165], v[164:165], v[240:241] op_sel_hi:[1,0] neg_lo:[0,1] neg_hi:[0,1]
  v_pk_mul_f32 v[164:165], v[164:165], v[240:241] op_sel:[0,1] op_sel_hi:[1,1]
  v_lshlrev_b32 v166, 16, v147
  v_and_b32 v167, 0xffff0000, v147
  v_pk_add_f32 v[166:167], v[166:167], v[240:241] op_sel_hi:[1,0] neg_lo:[0,1] neg_hi:[0,1]
  v_pk_mul_f32 v[166:167], v[166:167], v[240:241] op_sel:[0,1] op_sel_hi:[1,1]
  s_waitcnt lgkmcnt(4)
  v_lshlrev_b32 v254, 16, v32
  v_and_b32 v255, 0xffff0000, v32
  v_pk_mul_f32 v[160:161], v[160:161], v[254:255]
  v_lshlrev_b32 v254, 16, v33
  v_and_b32 v255, 0xffff0000, v33
  v_pk_mul_f32 v[162:163], v[162:163], v[254:255]
  v_lshlrev_b32 v254, 16, v34
  v_and_b32 v255, 0xffff0000, v34
  v_pk_mul_f32 v[164:165], v[164:165], v[254:255]
  v_lshlrev_b32 v254, 16, v35
  v_and_b32 v255, 0xffff0000, v35
  v_pk_mul_f32 v[166:167], v[166:167], v[254:255]
  v_mul_f32 v249, v243, v243
  v_mul_f32 v243, v243, v249
  v_mul_f32 v249, 0xbfb8aa3b, v249
  v_lshlrev_b32 v168, 16, v148
  v_and_b32 v169, 0xffff0000, v148
  v_pk_add_f32 v[168:169], v[168:169], v[242:243] op_sel_hi:[1,0] neg_lo:[0,1] neg_hi:[0,1]
  v_pk_mul_f32 v[168:169], v[168:169], v[242:243] op_sel:[0,1] op_sel_hi:[1,1]
  v_lshlrev_b32 v170, 16, v149
  v_and_b32 v171, 0xffff0000, v149
  v_pk_add_f32 v[170:171], v[170:171], v[242:243] op_sel_hi:[1,0] neg_lo:[0,1] neg_hi:[0,1]
  v_pk_mul_f32 v[170:171], v[170:171], v[242:243] op_sel:[0,1] op_sel_hi:[1,1]
  v_lshlrev_b32 v172, 16, v150
  v_and_b32 v173, 0xffff0000, v150
  v_pk_add_f32 v[172:173], v[172:173], v[242:243] op_sel_hi:[1,0] neg_lo:[0,1] neg_hi:[0,1]
  v_pk_mul_f32 v[172:173], v[172:173], v[242:243] op_sel:[0,1] op_sel_hi:[1,1]
  v_lshlrev_b32 v174, 16, v151
  v_and_b32 v175, 0xffff0000, v151
  v_pk_add_f32 v[174:175], v[174:175], v[242:243] op_sel_hi:[1,0] neg_lo:[0,1] neg_hi:[0,1]
  v_pk_mul_f32 v[174:175], v[174:175], v[242:243] op_sel:[0,1] op_sel_hi:[1,1]
  s_waitcnt lgkmcnt(2)
  v_lshlrev_b32 v254, 16, v36
  v_and_b32 v255, 0xffff0000, v36
  v_pk_mul_f32 v[168:169], v[168:169], v[254:255]
  v_lshlrev_b32 v254, 16, v37
  v_and_b32 v255, 0xffff0000, v37
  v_pk_mul_f32 v[170:171], v[170:171], v[254:255]
  v_lshlrev_b32 v254, 16, v38
  v_and_b32 v255, 0xffff0000, v38
  v_pk_mul_f32 v[172:173], v[172:173], v[254:255]
  v_lshlrev_b32 v254, 16, v39
  v_and_b32 v255, 0xffff0000, v39
  v_pk_mul_f32 v[174:175], v[174:175], v[254:255]
  v_mul_f32 v250, v245, v245
  v_mul_f32 v245, v245, v250
  v_mul_f32 v250, 0xbfb8aa3b, v250
  v_lshlrev_b32 v176, 16, v152
  v_and_b32 v177, 0xffff0000, v152
  v_pk_add_f32 v[176:177], v[176:177], v[244:245] op_sel_hi:[1,0] neg_lo:[0,1] neg_hi:[0,1]
  v_pk_mul_f32 v[176:177], v[176:177], v[244:245] op_sel:[0,1] op_sel_hi:[1,1]
  v_lshlrev_b32 v178, 16, v153
  v_and_b32 v179, 0xffff0000, v153
  v_pk_add_f32 v[178:179], v[178:179], v[244:245] op_sel_hi:[1,0] neg_lo:[0,1] neg_hi:[0,1]
  v_pk_mul_f32 v[178:179], v[178:179], v[244:245] op_sel:[0,1] op_sel_hi:[1,1]
  v_lshlrev_b32 v180, 16, v154
  v_and_b32 v181, 0xffff0000, v154
  v_pk_add_f32 v[180:181], v[180:181], v[244:245] op_sel_hi:[1,0] neg_lo:[0,1] neg_hi:[0,1]
  v_pk_mul_f32 v[180:181], v[180:181], v[244:245] op_sel:[0,1] op_sel_hi:[1,1]
  v_lshlrev_b32 v182, 16, v155
  v_and_b32 v183, 0xffff0000, v155
  v_pk_add_f32 v[182:183], v[182:183], v[244:245] op_sel_hi:[1,0] neg_lo:[0,1] neg_hi:[0,1]
  v_pk_mul_f32 v[182:183], v[182:183], v[244:245] op_sel:[0,1] op_sel_hi:[1,1]
  s_waitcnt lgkmcnt(0)
  v_lshlrev_b32 v254, 16, v40
  v_and_b32 v255, 0xffff0000, v40
  v_pk_mul_f32 v[176:177], v[176:177], v[254:255]
  v_lshlrev_b32 v254, 16, v41
  v_and_b32 v255, 0xffff0000, v41
  v_pk_mul_f32 v[178:179], v[178:179], v[254:255]
  v_lshlrev_b32 v254, 16, v42
  v_and_b32 v255, 0xffff0000, v42
  v_pk_mul_f32 v[180:181], v[180:181], v[254:255]
  v_lshlrev_b32 v254, 16, v43
  v_and_b32 v255, 0xffff0000, v43
  v_pk_mul_f32 v[182:183], v[182:183], v[254:255]
KF_loop3:
  s_waitcnt vmcnt(0)
  s_mov_b32 s59, s61
  s_mov_b32 s61, 0
  s_or_b32 s20, s56, s57
  s_cmp_eq_u32 s20, 0
  s_cbranch_scc1 KF_acc3
  s_add_u32 s63, s63, 1
  s_cmp_ge_u32 s63, 0x40000
  s_cbranch_scc1 KF_sum3
  v_subrev_u32 v253, s78, v252
  v_cmp_eq_u32 vcc, 4, v253
  s_nop 1
  s_lshr_b32 s20, vcc_lo, 16
  s_and_b32 s20, s20, vcc_lo
  s_lshr_b32 s23, s20, 1
  s_and_b32 s20, s20, s23
  s_and_b32 s20, s20, s57
  s_andn2_b32 s57, s57, s20
  s_or_b32 s56, s56, s20
  buffer_load_dword v252, v15, s[44:47], 0 offen sc1
  s_cmp_eq_u32 s56, 0
  s_cbranch_scc1 KF_acc3
  s_bitcmp1_b32 s59, 0
  s_cbranch_scc1 KF_p30
  s_ff1_i32_b32 s20, s56
  s_bitset0_b32 s56, s20
  s_cmp_lt_i32 s20, 0
  s_mul_i32 s20, s20, 2508800
  s_cselect_b32 s20, 0x40000000, s20
  s_cselect_b32 s62, 0, 1
  s_or_b32 s61, s61, s62
  s_add_u32 s23, s20, s76
  buffer_load_dwordx4 v[16:19], v3, s[44:47], s23 offen sc1
  s_add_u32 s23, s20, s77
  buffer_load_dwordx4 v[20:23], v3, s[44:47], s23 offen sc1
  s_add_u32 s23, s20, s96
  buffer_load_dwordx4 v[24:27], v3, s[44:47], s23 offen sc1
KF_p30:
  s_cmp_eq_u32 s56, 0
  s_cbranch_scc1 KF_acc3
  s_bitcmp1_b32 s59, 1
  s_cbranch_scc1 KF_p31
  s_ff1_i32_b32 s20, s56
  s_bitset0_b32 s56, s20
  s_cmp_lt_i32 s20, 0
  s_mul_i32 s20, s20, 2508800
  s_cselect_b32 s20, 0x40000000, s20
  s_cselect_b32 s62, 0, 2
  s_or_b32 s61, s61, s62
  s_add_u32 s23, s20, s76
  buffer_load_dwordx4 v[32:35], v3, s[44:47], s23 offen sc1
  s_add_u32 s23, s20, s77
  buffer_load_dwordx4 v[36:39], v3, s[44:47], s23 offen sc1
  s_add_u32 s23, s20, s96
  buffer_load_dwordx4 v[40:43], v3, s[44:47], s23 offen sc1
KF_p31:
  s_cmp_eq_u32 s56, 0
  s_cbranch_scc1 KF_acc3
  s_bitcmp1_b32 s59, 2
  s_cbranch_scc1 KF_p32
  s_ff1_i32_b32 s20, s56
  s_bitset0_b32 s56, s20
  s_cmp_lt_i32 s20, 0
  s_mul_i32 s20, s20, 2508800
  s_cselect_b32 s20, 0x40000000, s20
  s_cselect_b32 s62, 0, 4
  s_or_b32 s61, s61, s62
  s_add_u32 s23, s20, s76
  buffer_load_dwordx4 v[48:51], v3, s[44:47], s23 offen sc1
  s_add_u32 s23, s20, s77
  buffer_load_dwordx4 v[52:55], v3, s[44:47], s23 offen sc1
  s_add_u32 s23, s20, s96
  buffer_load_dwordx4 v[56:59], v3, s[44:47], s23 offen sc1
KF_p32:
  s_cmp_eq_u32 s56, 0
  s_cbranch_scc1 KF_acc3
  s_bitcmp1_b32 s59, 3
  s_cbranch_scc1 KF_p33
  s_ff1_i32_b32 s20, s56
  s_bitset0_b32 s56, s20
  s_cmp_lt_i32 s20, 0
  s_mul_i32 s20, s20, 2508800
  s_cselect_b32 s20, 0x40000000, s20
  s_cselect_b32 s62, 0, 8
  s_or_b32 s61, s61, s62
  s_add_u32 s23, s20, s76
  buffer_load_dwordx4 v[64:67], v3, s[44:47], s23 offen sc1
  s_add_u32 s23, s20, s77
  buffer_load_dwordx4 v[68:71], v3, s[44:47], s23 offen sc1
  s_add_u32 s23, s20, s96
  buffer_load_dwordx4 v[72:75], v3, s[44:47], s23 offen sc1
KF_p33:
  s_cmp_eq_u32 s56, 0
  s_cbranch_scc1 KF_acc3
  s_bitcmp1_b32 s59, 4
  s_cbranch_scc1 KF_p34
  s_ff1_i32_b32 s20, s56
  s_bitset0_b32 s56, s20
  s_cmp_lt_i32 s20, 0
  s_mul_i32 s20, s20, 2508800
  s_cselect_b32 s20, 0x40000000, s20
  s_cselect_b32 s62, 0, 16
  s_or_b32 s61, s61, s62
  s_add_u32 s23, s20, s76
  buffer_load_dwordx4 v[80:83], v3, s[44:47], s23 offen sc1
  s_add_u32 s23, s20, s77
  buffer_load_dwordx4 v[84:87], v3, s[44:47], s23 offen sc1
  s_add_u32 s23, s20, s96
  buffer_load_dwordx4 v[88:91], v3, s[44:47], s23 offen sc1
KF_p34:
  s_cmp_eq_u32 s56, 0
  s_cbranch_scc1 KF_acc3
  s_bitcmp1_b32 s59, 5
  s_cbranch_scc1 KF_p35
  s_ff1_i32_b32 s20, s56
  s_bitset0_b32 s56, s20
  s_cmp_lt_i32 s20, 0
  s_mul_i32 s20, s20, 2508800
  s_cselect_b32 s20, 0x40000000, s20
  s_cselect_b32 s62, 0, 32
  s_or_b32 s61, s61, s62
  s_add_u32 s23, s20, s76
  buffer_load_dwordx4 v[96:99], v3, s[44:47], s23 offen sc1
  s_add_u32 s23, s20, s77
  buffer_load_dwordx4 v[100:103], v3, s[44:47], s23 offen sc1
  s_add_u32 s23, s20, s96
  buffer_load_dwordx4 v[104:107], v3, s[44:47], s23 offen sc1
KF_p35:
  s_cmp_eq_u32 s56, 0
  s_cbranch_scc1 KF_acc3
  s_bitcmp1_b32 s59, 6
  s_cbranch_scc1 KF_p36
  s_ff1_i32_b32 s20, s56
  s_bitset0_b32 s56, s20
  s_cmp_lt_i32 s20, 0
  s_mul_i32 s20, s20, 2508800
  s_cselect_b32 s20, 0x40000000, s20
  s_cselect_b32 s62, 0, 64
  s_or_b32 s61, s61, s62
  s_add_u32 s23, s20, s76
  buffer_load_dwordx4 v[112:115], v3, s[44:47], s23 offen sc1
  s_add_u32 s23, s20, s77
  buffer_load_dwordx4 v[116:119], v3, s[44:47], s23 offen sc1
  s_add_u32 s23, s20, s96
  buffer_load_dwordx4 v[120:123], v3, s[44:47], s23 offen sc1
KF_p36:
  s_cmp_eq_u32 s56, 0
  s_cbranch_scc1 KF_acc3
  s_bitcmp1_b32 s59, 7
  s_cbranch_scc1 KF_p37
  s_ff1_i32_b32 s20, s56
  s_bitset0_b32 s56, s20
  s_cmp_lt_i32 s20, 0
  s_mul_i32 s20, s20, 2508800
  s_cselect_b32 s20, 0x40000000, s20
  s_cselect_b32 s62, 0, 128
  s_or_b32 s61, s61, s62
  s_add_u32 s23, s20, s76
  buffer_load_dwordx4 v[128:131], v3, s[44:47], s23 offen sc1
  s_add_u32 s23, s20, s77
  buffer_load_dwordx4 v[132:135], v3, s[44:47], s23 offen sc1
  s_add_u32 s23, s20, s96
  buffer_load_dwordx4 v[136:139], v3, s[44:47], s23 offen sc1
KF_p37:
KF_acc3:
  s_bitcmp1_b32 s59, 0
  s_cbranch_scc0 KF_a30
  v_dot2_f32_bf16 v192, v16, s54, v192
  v_dot2_f32_bf16 v193, v16, s55, v193
  v_dot2_f32_bf16 v194, v17, s54, v194
  v_dot2_f32_bf16 v195, v17, s55, v195
  v_dot2_f32_bf16 v196, v18, s54, v196
  v_dot2_f32_bf16 v197, v18, s55, v197
  v_dot2_f32_bf16 v198, v19, s54, v198
  v_dot2_f32_bf16 v199, v19, s55, v199
  v_dot2_f32_bf16 v200, v20, s54, v200
  v_dot2_f32_bf16 v201, v20, s55, v201
  v_dot2_f32_bf16 v202, v21, s54, v202
  v_dot2_f32_bf16 v203, v21, s55, v203
  v_dot2_f32_bf16 v204, v22, s54, v204
  v_dot2_f32_bf16 v205, v22, s55, v205
  v_dot2_f32_bf16 v206, v23, s54, v206
  v_dot2_f32_bf16 v207, v23, s55, v207
  v_dot2_f32_bf16 v208, v24, s54, v208
  v_dot2_f32_bf16 v209, v24, s55, v209
  v_dot2_f32_bf16 v210, v25, s54, v210
  v_dot2_f32_bf16 v211, v25, s55, v211
  v_dot2_f32_bf16 v212, v26, s54, v212
  v_dot2_f32_bf16 v213, v26, s55, v213
  v_dot2_f32_bf16 v214, v27, s54, v214
  v_dot2_f32_bf16 v215, v27, s55, v215
KF_a30:
  s_bitcmp1_b32 s59, 1
  s_cbranch_scc0 KF_a31
  v_dot2_f32_bf16 v192, v32, s54, v192
  v_dot2_f32_bf16 v193, v32, s55, v193
  v_dot2_f32_bf16 v194, v33, s54, v194
  v_dot2_f32_bf16 v195, v33, s55, v195
  v_dot2_f32_bf16 v196, v34, s54, v196
  v_dot2_f32_bf16 v197, v34, s55, v197
  v_dot2_f32_bf16 v198, v35, s54, v198
  v_dot2_f32_bf16 v199, v35, s55, v199
  v_dot2_f32_bf16 v200, v36, s54, v200
  v_dot2_f32_bf16 v201, v36, s55, v201
  v_dot2_f32_bf16 v202, v37, s54, v202
  v_dot2_f32_bf16 v203, v37, s55, v203
  v_dot2_f32_bf16 v204, v38, s54, v204
  v_dot2_f32_bf16 v205, v38, s55, v205
  v_dot2_f32_bf16 v206, v39, s54, v206
  v_dot2_f32_bf16 v207, v39, s55, v207
  v_dot2_f32_bf16 v208, v40, s54, v208
  v_dot2_f32_bf16 v209, v40, s55, v209
  v_dot2_f32_bf16 v210, v41, s54, v210
  v_dot2_f32_bf16 v211, v41, s55, v211
  v_dot2_f32_bf16 v212, v42, s54, v212
  v_dot2_f32_bf16 v213, v42, s55, v213
  v_dot2_f32_bf16 v214, v43, s54, v214
  v_dot2_f32_bf16 v215, v43, s55, v215
KF_a31:
  s_bitcmp1_b32 s59, 2
  s_cbranch_scc0 KF_a32
  v_dot2_f32_bf16 v192, v48, s54, v192
  v_dot2_f32_bf16 v193, v48, s55, v193
  v_dot2_f32_bf16 v194, v49, s54, v194
  v_dot2_f32_bf16 v195, v49, s55, v195
  v_dot2_f32_bf16 v196, v50, s54, v196
  v_dot2_f32_bf16 v197, v50, s55, v197
  v_dot2_f32_bf16 v198, v51, s54, v198
  v_dot2_f32_bf16 v199, v51, s55, v199
  v_dot2_f32_bf16 v200, v52, s54, v200
  v_dot2_f32_bf16 v201, v52, s55, v201
  v_dot2_f32_bf16 v202, v53, s54, v202
  v_dot2_f32_bf16 v203, v53, s55, v203
  v_dot2_f32_bf16 v204, v54, s54, v204
  v_dot2_f32_bf16 v205, v54, s55, v205
  v_dot2_f32_bf16 v206, v55, s54, v206
  v_dot2_f32_bf16 v207, v55, s55, v207
  v_dot2_f32_bf16 v208, v56, s54, v208
  v_dot2_f32_bf16 v209, v56, s55, v209
  v_dot2_f32_bf16 v210, v57, s54, v210
  v_dot2_f32_bf16 v211, v57, s55, v211
  v_dot2_f32_bf16 v212, v58, s54, v212
  v_dot2_f32_bf16 v213, v58, s55, v213
  v_dot2_f32_bf16 v214, v59, s54, v214
  v_dot2_f32_bf16 v215, v59, s55, v215
KF_a32:
  s_bitcmp1_b32 s59, 3
  s_cbranch_scc0 KF_a33
  v_dot2_f32_bf16 v192, v64, s54, v192
  v_dot2_f32_bf16 v193, v64, s55, v193
  v_dot2_f32_bf16 v194, v65, s54, v194
  v_dot2_f32_bf16 v195, v65, s55, v195
  v_dot2_f32_bf16 v196, v66, s54, v196
  v_dot2_f32_bf16 v197, v66, s55, v197
  v_dot2_f32_bf16 v198, v67, s54, v198
  v_dot2_f32_bf16 v199, v67, s55, v199
  v_dot2_f32_bf16 v200, v68, s54, v200
  v_dot2_f32_bf16 v201, v68, s55, v201
  v_dot2_f32_bf16 v202, v69, s54, v202
  v_dot2_f32_bf16 v203, v69, s55, v203
  v_dot2_f32_bf16 v204, v70, s54, v204
  v_dot2_f32_bf16 v205, v70, s55, v205
  v_dot2_f32_bf16 v206, v71, s54, v206
  v_dot2_f32_bf16 v207, v71, s55, v207
  v_dot2_f32_bf16 v208, v72, s54, v208
  v_dot2_f32_bf16 v209, v72, s55, v209
  v_dot2_f32_bf16 v210, v73, s54, v210
  v_dot2_f32_bf16 v211, v73, s55, v211
  v_dot2_f32_bf16 v212, v74, s54, v212
  v_dot2_f32_bf16 v213, v74, s55, v213
  v_dot2_f32_bf16 v214, v75, s54, v214
  v_dot2_f32_bf16 v215, v75, s55, v215
KF_a33:
  s_bitcmp1_b32 s59, 4
  s_cbranch_scc0 KF_a34
  v_dot2_f32_bf16 v192, v80, s54, v192
  v_dot2_f32_bf16 v193, v80, s55, v193
  v_dot2_f32_bf16 v194, v81, s54, v194
  v_dot2_f32_bf16 v195, v81, s55, v195
  v_dot2_f32_bf16 v196, v82, s54, v196
  v_dot2_f32_bf16 v197, v82, s55, v197
  v_dot2_f32_bf16 v198, v83, s54, v198
  v_dot2_f32_bf16 v199, v83, s55, v199
  v_dot2_f32_bf16 v200, v84, s54, v200
  v_dot2_f32_bf16 v201, v84, s55, v201
  v_dot2_f32_bf16 v202, v85, s54, v202
  v_dot2_f32_bf16 v203, v85, s55, v203
  v_dot2_f32_bf16 v204, v86, s54, v204
  v_dot2_f32_bf16 v205, v86, s55, v205
  v_dot2_f32_bf16 v206, v87, s54, v206
  v_dot2_f32_bf16 v207, v87, s55, v207
  v_dot2_f32_bf16 v208, v88, s54, v208
  v_dot2_f32_bf16 v209, v88, s55, v209
  v_dot2_f32_bf16 v210, v89, s54, v210
  v_dot2_f32_bf16 v211, v89, s55, v211
  v_dot2_f32_bf16 v212, v90, s54, v212
  v_dot2_f32_bf16 v213, v90, s55, v213
  v_dot2_f32_bf16 v214, v91, s54, v214
  v_dot2_f32_bf16 v215, v91, s55, v215
KF_a34:
  s_bitcmp1_b32 s59, 5
  s_cbranch_scc0 KF_a35
  v_dot2_f32_bf16 v192, v96, s54, v192
  v_dot2_f32_bf16 v193, v96, s55, v193
  v_dot2_f32_bf16 v194, v97, s54, v194
  v_dot2_f32_bf16 v195, v97, s55, v195
  v_dot2_f32_bf16 v196, v98, s54, v196
  v_dot2_f32_bf16 v197, v98, s55, v197
  v_dot2_f32_bf16 v198, v99, s54, v198
  v_dot2_f32_bf16 v199, v99, s55, v199
  v_dot2_f32_bf16 v200, v100, s54, v200
  v_dot2_f32_bf16 v201, v100, s55, v201
  v_dot2_f32_bf16 v202, v101, s54, v202
  v_dot2_f32_bf16 v203, v101, s55, v203
  v_dot2_f32_bf16 v204, v102, s54, v204
  v_dot2_f32_bf16 v205, v102, s55, v205
  v_dot2_f32_bf16 v206, v103, s54, v206
  v_dot2_f32_bf16 v207, v103, s55, v207
  v_dot2_f32_bf16 v208, v104, s54, v208
  v_dot2_f32_bf16 v209, v104, s55, v209
  v_dot2_f32_bf16 v210, v105, s54, v210
  v_dot2_f32_bf16 v211, v105, s55, v211
  v_dot2_f32_bf16 v212, v106, s54, v212
  v_dot2_f32_bf16 v213, v106, s55, v213
  v_dot2_f32_bf16 v214, v107, s54, v214
  v_dot2_f32_bf16 v215, v107, s55, v215
KF_a35:
  s_bitcmp1_b32 s59, 6
  s_cbranch_scc0 KF_a36
  v_dot2_f32_bf16 v192, v112, s54, v192
  v_dot2_f32_bf16 v193, v112, s55, v193
  v_dot2_f32_bf16 v194, v113, s54, v194
  v_dot2_f32_bf16 v195, v113, s55, v195
  v_dot2_f32_bf16 v196, v114, s54, v196
  v_dot2_f32_bf16 v197, v114, s55, v197
  v_dot2_f32_bf16 v198, v115, s54, v198
  v_dot2_f32_bf16 v199, v115, s55, v199
  v_dot2_f32_bf16 v200, v116, s54, v200
  v_dot2_f32_bf16 v201, v116, s55, v201
  v_dot2_f32_bf16 v202, v117, s54, v202
  v_dot2_f32_bf16 v203, v117, s55, v203
  v_dot2_f32_bf16 v204, v118, s54, v204
  v_dot2_f32_bf16 v205, v118, s55, v205
  v_dot2_f32_bf16 v206, v119, s54, v206
  v_dot2_f32_bf16 v207, v119, s55, v207
  v_dot2_f32_bf16 v208, v120, s54, v208
  v_dot2_f32_bf16 v209, v120, s55, v209
  v_dot2_f32_bf16 v210, v121, s54, v210
  v_dot2_f32_bf16 v211, v121, s55, v211
  v_dot2_f32_bf16 v212, v122, s54, v212
  v_dot2_f32_bf16 v213, v122, s55, v213
  v_dot2_f32_bf16 v214, v123, s54, v214
  v_dot2_f32_bf16 v215, v123, s55, v215
KF_a36:
  s_bitcmp1_b32 s59, 7
  s_cbranch_scc0 KF_a37
  v_dot2_f32_bf16 v192, v128, s54, v192
  v_dot2_f32_bf16 v193, v128, s55, v193
  v_dot2_f32_bf16 v194, v129, s54, v194
  v_dot2_f32_bf16 v195, v129, s55, v195
  v_dot2_f32_bf16 v196, v130, s54, v196
  v_dot2_f32_bf16 v197, v130, s55, v197
  v_dot2_f32_bf16 v198, v131, s54, v198
  v_dot2_f32_bf16 v199, v131, s55, v199
  v_dot2_f32_bf16 v200, v132, s54, v200
  v_dot2_f32_bf16 v201, v132, s55, v201
  v_dot2_f32_bf16 v202, v133, s54, v202
  v_dot2_f32_bf16 v203, v133, s55, v203
  v_dot2_f32_bf16 v204, v134, s54, v204
  v_dot2_f32_bf16 v205, v134, s55, v205
  v_dot2_f32_bf16 v206, v135, s54, v206
  v_dot2_f32_bf16 v207, v135, s55, v207
  v_dot2_f32_bf16 v208, v136, s54, v208
  v_dot2_f32_bf16 v209, v136, s55, v209
  v_dot2_f32_bf16 v210, v137, s54, v210
  v_dot2_f32_bf16 v211, v137, s55, v211
  v_dot2_f32_bf16 v212, v138, s54, v212
  v_dot2_f32_bf16 v213, v138, s55, v213
  v_dot2_f32_bf16 v214, v139, s54, v214
  v_dot2_f32_bf16 v215, v139, s55, v215
KF_a37:
  s_or_b32 s20, s56, s57
  s_or_b32 s20, s20, s61
  s_cmp_lg_u32 s20, 0
  s_cbranch_scc1 KF_loop3
KF_sum3:
  s_mov_b32 s58, 73728
  s_mov_b32 s59, 147456
  s_mov_b32 s60, 221184
  v_pk_mul_f32 v[16:17], v[192:193], v[248:249] op_sel_hi:[1,0]
  v_pk_mul_f32 v[18:19], v[194:195], v[248:249] op_sel_hi:[1,0]
  v_pk_mul_f32 v[20:21], v[196:197], v[248:249] op_sel_hi:[1,0]
  v_pk_mul_f32 v[22:23], v[198:199], v[248:249] op_sel_hi:[1,0]
  v_exp_f32 v16, v16
  v_exp_f32 v17, v17
  v_pk_mul_f32 v[192:193], v[192:193], v[160:161]
  v_exp_f32 v18, v18
  v_exp_f32 v19, v19
  v_pk_mul_f32 v[194:195], v[194:195], v[162:163]
  v_exp_f32 v20, v20
  v_exp_f32 v21, v21
  v_pk_mul_f32 v[196:197], v[196:197], v[164:165]
  v_exp_f32 v22, v22
  v_exp_f32 v23, v23
  v_pk_mul_f32 v[198:199], v[198:199], v[166:167]
  v_pk_add_f32 v[16:17], v[16:17], 1.0 op_sel_hi:[1,0]
  v_pk_add_f32 v[18:19], v[18:19], 1.0 op_sel_hi:[1,0]
  v_pk_add_f32 v[20:21], v[20:21], 1.0 op_sel_hi:[1,0]
  v_pk_add_f32 v[22:23], v[22:23], 1.0 op_sel_hi:[1,0]
  v_rcp_f32 v16, v16
  v_lshlrev_b32 v24, 16, v144
  v_rcp_f32 v17, v17
  v_and_b32 v25, 0xffff0000, v144
  v_rcp_f32 v18, v18
  v_lshlrev_b32 v26, 16, v145
  v_rcp_f32 v19, v19
  v_and_b32 v27, 0xffff0000, v145
  v_rcp_f32 v20, v20
  v_lshlrev_b32 v28, 16, v146
  v_rcp_f32 v21, v21
  v_and_b32 v29, 0xffff0000, v146
  v_rcp_f32 v22, v22
  v_lshlrev_b32 v30, 16, v147
  v_rcp_f32 v23, v23
  v_and_b32 v31, 0xffff0000, v147
  v_pk_fma_f32 v[24:25], v[192:193], v[16:17], v[24:25]
  v_pk_fma_f32 v[26:27], v[194:195], v[18:19], v[26:27]
  v_pk_fma_f32 v[28:29], v[196:197], v[20:21], v[28:29]
  v_pk_fma_f32 v[30:31], v[198:199], v[22:23], v[30:31]
  v_cvt_pk_bf16_f32 v144, v24, v25
  v_cvt_pk_bf16_f32 v145, v26, v27
  v_cvt_pk_bf16_f32 v146, v28, v29
  v_cvt_pk_bf16_f32 v147, v30, v31
  buffer_store_dwordx4 v[144:147], v238, s[32:35], 0 offen
  v_pk_mul_f32 v[16:17], v[200:201], v[248:249] op_sel:[0,1] op_sel_hi:[1,1]
  v_pk_mul_f32 v[18:19], v[202:203], v[248:249] op_sel:[0,1] op_sel_hi:[1,1]
  v_pk_mul_f32 v[20:21], v[204:205], v[248:249] op_sel:[0,1] op_sel_hi:[1,1]
  v_pk_mul_f32 v[22:23], v[206:207], v[248:249] op_sel:[0,1] op_sel_hi:[1,1]
  v_exp_f32 v16, v16
  v_exp_f32 v17, v17
  v_pk_mul_f32 v[200:201], v[200:201], v[168:169]
  v_exp_f32 v18, v18
  v_exp_f32 v19, v19
  v_pk_mul_f32 v[202:203], v[202:203], v[170:171]
  v_exp_f32 v20, v20
  v_exp_f32 v21, v21
  v_pk_mul_f32 v[204:205], v[204:205], v[172:173]
  v_exp_f32 v22, v22
  v_exp_f32 v23, v23
  v_pk_mul_f32 v[206:207], v[206:207], v[174:175]
  v_pk_add_f32 v[16:17], v[16:17], 1.0 op_sel_hi:[1,0]
  v_pk_add_f32 v[18:19], v[18:19], 1.0 op_sel_hi:[1,0]
  v_pk_add_f32 v[20:21], v[20:21], 1.0 op_sel_hi:[1,0]
  v_pk_add_f32 v[22:23], v[22:23], 1.0 op_sel_hi:[1,0]
  v_rcp_f32 v16, v16
  v_lshlrev_b32 v24, 16, v148
  v_rcp_f32 v17, v17
  v_and_b32 v25, 0xffff0000, v148
  v_rcp_f32 v18, v18
  v_lshlrev_b32 v26, 16, v149
  v_rcp_f32 v19, v19
  v_and_b32 v27, 0xffff0000, v149
  v_rcp_f32 v20, v20
  v_lshlrev_b32 v28, 16, v150
  v_rcp_f32 v21, v21
  v_and_b32 v29, 0xffff0000, v150
  v_rcp_f32 v22, v22
  v_lshlrev_b32 v30, 16, v151
  v_rcp_f32 v23, v23
  v_and_b32 v31, 0xffff0000, v151
  v_pk_fma_f32 v[24:25], v[200:201], v[16:17], v[24:25]
  v_pk_fma_f32 v[26:27], v[202:203], v[18:19], v[26:27]
  v_pk_fma_f32 v[28:29], v[204:205], v[20:21], v[28:29]
  v_pk_fma_f32 v[30:31], v[206:207], v[22:23], v[30:31]
  v_cvt_pk_bf16_f32 v148, v24, v25
  v_cvt_pk_bf16_f32 v149, v26, v27
  v_cvt_pk_bf16_f32 v150, v28, v29
  v_cvt_pk_bf16_f32 v151, v30, v31
  buffer_store_dwordx4 v[148:151], v238, s[32:35], s58 offen
  v_pk_mul_f32 v[16:17], v[208:209], v[250:251] op_sel_hi:[1,0]
  v_pk_mul_f32 v[18:19], v[210:211], v[250:251] op_sel_hi:[1,0]
  v_pk_mul_f32 v[20:21], v[212:213], v[250:251] op_sel_hi:[1,0]
  v_pk_mul_f32 v[22:23], v[214:215], v[250:251] op_sel_hi:[1,0]
  v_exp_f32 v16, v16
  v_exp_f32 v17, v17
  v_pk_mul_f32 v[208:209], v[208:209], v[176:177]
  v_exp_f32 v18, v18
  v_exp_f32 v19, v19
  v_pk_mul_f32 v[210:211], v[210:211], v[178:179]
  v_exp_f32 v20, v20
  v_exp_f32 v21, v21
  v_pk_mul_f32 v[212:213], v[212:213], v[180:181]
  v_exp_f32 v22, v22
  v_exp_f32 v23, v23
  v_pk_mul_f32 v[214:215], v[214:215], v[182:183]
  v_pk_add_f32 v[16:17], v[16:17], 1.0 op_sel_hi:[1,0]
  v_pk_add_f32 v[18:19], v[18:19], 1.0 op_sel_hi:[1,0]
  v_pk_add_f32 v[20:21], v[20:21], 1.0 op_sel_hi:[1,0]
  v_pk_add_f32 v[22:23], v[22:23], 1.0 op_sel_hi:[1,0]
  v_rcp_f32 v16, v16
  v_lshlrev_b32 v24, 16, v152
  v_rcp_f32 v17, v17
  v_and_b32 v25, 0xffff0000, v152
  v_rcp_f32 v18, v18
  v_lshlrev_b32 v26, 16, v153
  v_rcp_f32 v19, v19
  v_and_b32 v27, 0xffff0000, v153
  v_rcp_f32 v20, v20
  v_lshlrev_b32 v28, 16, v154
  v_rcp_f32 v21, v21
  v_and_b32 v29, 0xffff0000, v154
  v_rcp_f32 v22, v22
  v_lshlrev_b32 v30, 16, v155
  v_rcp_f32 v23, v23
  v_and_b32 v31, 0xffff0000, v155
  v_pk_fma_f32 v[24:25], v[208:209], v[16:17], v[24:25]
  v_pk_fma_f32 v[26:27], v[210:211], v[18:19], v[26:27]
  v_pk_fma_f32 v[28:29], v[212:213], v[20:21], v[28:29]
  v_pk_fma_f32 v[30:31], v[214:215], v[22:23], v[30:31]
  v_cvt_pk_bf16_f32 v152, v24, v25
  v_cvt_pk_bf16_f32 v153, v26, v27
  v_cvt_pk_bf16_f32 v154, v28, v29
  v_cvt_pk_bf16_f32 v155, v30, v31
  buffer_store_dwordx4 v[152:155], v238, s[32:35], s59 offen
K1_fin:
K1_done:
  s_endpgm
K1_slowN:
  s_add_u32 s63, s63, 1
  s_cmp_ge_u32 s63, 0x40000
  s_cbranch_scc1 K1_backN
  s_sleep 2
  buffer_load_dword v5, off, s[24:27], 0 sc1
  s_waitcnt vmcnt(0)
  v_readfirstlane_b32 s78, v5
  s_nop 0
  s_cmp_eq_u32 s78, 0
  s_cbranch_scc1 K1_slowN
  s_branch K1_backN
K1_slow0:
  s_add_u32 s63, s63, 1
  s_cmp_ge_u32 s63, 0x40000
  s_cbranch_scc1 K1_back0
  s_sleep 2
  buffer_load_dword v4, off, s[44:47], s91 sc1
  s_waitcnt vmcnt(0)
  v_readfirstlane_b32 s69, v4
  s_nop 0
  s_sub_u32 s69, s69, s79
  s_cmp_gt_u32 s69, 3
  s_cbranch_scc1 K1_slow0
  s_branch K1_back0
K1_slow1:
  s_add_u32 s63, s63, 1
  s_cmp_ge_u32 s63, 0x40000
  s_cbranch_scc1 K1_back1
  s_sleep 2
  buffer_load_dword v4, off, s[44:47], s91 sc1
  s_waitcnt vmcnt(0)
  v_readfirstlane_b32 s69, v4
  s_nop 0
  s_sub_u32 s69, s69, s79
  s_cmp_gt_u32 s69, 2
  s_cbranch_scc1 K1_slow1
  s_branch K1_back1
K1_slow2:
  s_add_u32 s63, s63, 1
  s_cmp_ge_u32 s63, 0x40000
  s_cbranch_scc1 K1_back2
  s_sleep 2
  buffer_load_dword v4, off, s[44:47], s91 sc1
  s_waitcnt vmcnt(0)
  v_readfirstlane_b32 s69, v4
  s_nop 0
  s_sub_u32 s69, s69, s79
  s_cmp_gt_u32 s69, 1
  s_cbranch_scc1 K1_slow2
  s_branch K1_back2
K1_slowK:
  s_add_u32 s63, s63, 1
  s_cmp_ge_u32 s63, 0x40000
  s_cbranch_scc1 K1_backK
  s_sleep 2
  buffer_load_dword v252, v254, s[44:47], 0 offen sc1
  s_waitcnt vmcnt(0)
  v_subrev_u32 v252, s78, v252
  v_add_u32 v252, -2, v252
  v_cmp_ne_u32 vcc, 0, v252
  s_nop 4
  s_cbranch_vccnz K1_slowK
  s_branch K1_backK
K1_stat:
  s_nop 7
  s_cmp_eq_u32 s18, 1
  s_cbranch_scc1 K1_stat1
  v_mfma_f32_16x16x32_bf16 v[232:235], v[16:19], v[16:19], 0
  v_mfma_f32_16x16x32_bf16 v[232:235], v[20:23], v[20:23], v[232:235]
  v_mfma_f32_16x16x32_bf16 v[232:235], v[24:27], v[24:27], v[232:235]
  v_mfma_f32_16x16x32_bf16 v[232:235], v[28:31], v[28:31], v[232:235]
  v_mfma_f32_16x16x32_bf16 v[232:235], v[32:35], v[32:35], v[232:235]
  v_mfma_f32_16x16x32_bf16 v[232:235], v[36:39], v[36:39], v[232:235]
  v_mfma_f32_16x16x32_bf16 v[232:235], v[40:43], v[40:43], v[232:235]
  v_mfma_f32_16x16x32_bf16 v[232:235], v[44:47], v[44:47], v[232:235]
  v_mfma_f32_16x16x32_bf16 v[232:235], v[48:51], v[48:51], v[232:235]
  v_mfma_f32_16x16x32_bf16 v[232:235], v[52:55], v[52:55], v[232:235]
  v_mfma_f32_16x16x32_bf16 v[232:235], v[56:59], v[56:59], v[232:235]
  v_mfma_f32_16x16x32_bf16 v[232:235], v[60:63], v[60:63], v[232:235]
  v_mfma_f32_16x16x32_bf16 v[232:235], v[64:67], v[64:67], v[232:235]
  v_mfma_f32_16x16x32_bf16 v[232:235], v[68:71], v[68:71], v[232:235]
  v_mfma_f32_16x16x32_bf16 v[232:235], v[72:75], v[72:75], v[232:235]
  v_mfma_f32_16x16x32_bf16 v[232:235], v[76:79], v[76:79], v[232:235]
  v_mfma_f32_16x16x32_bf16 v[232:235], v[80:83], v[80:83], v[232:235]
  v_mfma_f32_16x16x32_bf16 v[232:235], v[84:87], v[84:87], v[232:235]
  v_and_b32 v238, 3, v2
  v_cmp_eq_u32 vcc, 1, v238
  s_nop 5
  v_cndmask_b32 v236, v232, v233, vcc
  v_cmp_eq_u32 vcc, 2, v238
  s_nop 1
  v_cndmask_b32 v236, v236, v234, vcc
  v_cmp_eq_u32 vcc, 3, v238
  s_nop 1
  v_cndmask_b32 v236, v236, v235, vcc
  v_add_f32 v238, v6, v8
  v_mul_f32 v238, v238, v238
  v_mul_f32 v236, 0x3ae38e39, v236
  v_sub_f32 v236, v236, v238
  v_max_f32 v236, 0, v236
  v_cvt_pk_bf16_f32 v236, v236, v236
  v_lshlrev_b32 v236, 16, v236
  v_add_f32 v236, 0x3727c5ac, v236
  v_cvt_pk_bf16_f32 v236, v236, v236
  v_lshlrev_b32 v236, 16, v236
  v_sqrt_f32 v236, v236
  s_nop 0
  v_cvt_pk_bf16_f32 v236, v236, v236
  v_lshlrev_b32 v236, 16, v236
  v_rcp_f32 v239, v236
  v_xor_b32 v238, 0x80000000, v8
  v_accvgpr_read_b32 v236, a215
  buffer_store_dwordx2 v[238:239], v236, s[44:47], 0 offen offset:0 sc1
  s_nop 1
  s_branch K1_statback
K1_stat1:
  v_mfma_f32_16x16x32_bf16 v[232:235], v[88:91], v[88:91], 0
  v_mfma_f32_16x16x32_bf16 v[232:235], v[92:95], v[92:95], v[232:235]
  v_mfma_f32_16x16x32_bf16 v[232:235], v[96:99], v[96:99], v[232:235]
  v_mfma_f32_16x16x32_bf16 v[232:235], v[100:103], v[100:103], v[232:235]
  v_mfma_f32_16x16x32_bf16 v[232:235], v[104:107], v[104:107], v[232:235]
  v_mfma_f32_16x16x32_bf16 v[232:235], v[108:111], v[108:111], v[232:235]
  v_mfma_f32_16x16x32_bf16 v[232:235], v[112:115], v[112:115], v[232:235]
  v_mfma_f32_16x16x32_bf16 v[232:235], v[116:119], v[116:119], v[232:235]
  v_mfma_f32_16x16x32_bf16 v[232:235], v[120:123], v[120:123], v[232:235]
  v_mfma_f32_16x16x32_bf16 v[232:235], v[124:127], v[124:127], v[232:235]
  v_mfma_f32_16x16x32_bf16 v[232:235], v[128:131], v[128:131], v[232:235]
  v_mfma_f32_16x16x32_bf16 v[232:235], v[132:135], v[132:135], v[232:235]
  v_mfma_f32_16x16x32_bf16 v[232:235], v[136:139], v[136:139], v[232:235]
  v_mfma_f32_16x16x32_bf16 v[232:235], v[140:143], v[140:143], v[232:235]
  v_mfma_f32_16x16x32_bf16 v[232:235], v[144:147], v[144:147], v[232:235]
  v_mfma_f32_16x16x32_bf16 v[232:235], v[148:151], v[148:151], v[232:235]
  v_mfma_f32_16x16x32_bf16 v[232:235], v[152:155], v[152:155], v[232:235]
  v_mfma_f32_16x16x32_bf16 v[232:235], v[156:159], v[156:159], v[232:235]
  v_and_b32 v238, 3, v2
  v_cmp_eq_u32 vcc, 1, v238
  s_nop 5
  v_cndmask_b32 v236, v232, v233, vcc
  v_cmp_eq_u32 vcc, 2, v238
  s_nop 1
  v_cndmask_b32 v236, v236, v234, vcc
  v_cmp_eq_u32 vcc, 3, v238
  s_nop 1
  v_cndmask_b32 v236, v236, v235, vcc
  v_add_f32 v238, v7, v12
  v_mul_f32 v238, v238, v238
  v_mul_f32 v236, 0x3ae38e39, v236
  v_sub_f32 v236, v236, v238
  v_max_f32 v236, 0, v236
  v_cvt_pk_bf16_f32 v236, v236, v236
  v_lshlrev_b32 v236, 16, v236
  v_add_f32 v236, 0x3727c5ac, v236
  v_cvt_pk_bf16_f32 v236, v236, v236
  v_lshlrev_b32 v236, 16, v236
  v_sqrt_f32 v236, v236
  s_nop 0
  v_cvt_pk_bf16_f32 v236, v236, v236
  v_lshlrev_b32 v236, 16, v236
  v_rcp_f32 v239, v236
  v_xor_b32 v238, 0x80000000, v12
  v_accvgpr_read_b32 v236, a215
  buffer_store_dwordx2 v[238:239], v236, s[44:47], 0 offen offset:128 sc1
  s_nop 1
  s_branch K1_statback
.section .rodata,"a"
.p2align 6
.amdhsa_kernel recurrent_scan__ssm_conv_h3__glu_gated_bilinear__prompt_kernel
  .amdhsa_next_free_vgpr 512
  .amdhsa_next_free_sgpr 102
  .amdhsa_accum_offset 256
  .amdhsa_group_segment_fixed_size 0
  .amdhsa_kernarg_size 104
  .amdhsa_user_sgpr_count 2
  .amdhsa_user_sgpr_kernarg_segment_ptr 1
  .amdhsa_system_sgpr_workgroup_id_x 1
  .amdhsa_float_denorm_mode_32 3
.end_amdhsa_kernel
```
